```python
import torch

def _softmax(x, axis=-1):
    return torch.softmax(x, dim=axis)
def _gelu(x):
    return torch.nn.functional.gelu(x, approximate="tanh")
def _silu(x):
    return torch.nn.functional.silu(x)
def _sigmoid(x):
    return torch.sigmoid(x)
def _layernorm(x, axis=-1, eps=1e-5):
    m = x.mean(dim=axis, keepdim=True)
    v = x.var(dim=axis, keepdim=True, unbiased=False)
    return (x - m) / torch.sqrt(v + eps)
def _scatter_add(tgt, idx, src, axis=0):
    return tgt.clone().index_add_(axis, idx, src)
def _segment_sum(src, seg, n):
    out = torch.zeros((n,) + src.shape[1:], dtype=src.dtype)
    return out.index_add_(0, seg, src)
def _pad(x, pw):
    flat = tuple(v for pair in reversed(pw) for v in pair)
    return torch.nn.functional.pad(x, flat)

kernel_name = 'recurrent_scan__mha_block_cached__geglu_ffn__prompt'

def setup_inputs():

    _w = (lambda a: (lambda t: t.to(torch.bfloat16) if t.is_floating_point() else t)(torch.as_tensor(a)))
    def _A_setup():
        B, Sq, D = 1, 2048, 1024
        H, Sk, Dh = 32, 2048, 128
        return {
            "x": _w((lambda *s: torch.randn(*s, dtype=torch.bfloat16) * 0.05)(B, Sq, D)),
            "k_cache": _w((lambda *s: torch.randn(*s, dtype=torch.bfloat16) * 0.8)(B, H, Sk, Dh)),
            "v_cache": _w((lambda *s: torch.randn(*s, dtype=torch.bfloat16) * 0.2)(B, H, Sk, Dh)),
            "wq": _w((lambda *s: torch.randn(*s, dtype=torch.bfloat16) * 0.8)(D, H * Dh) * (D ** -0.5)),
            "wo": _w((lambda *s: torch.randn(*s, dtype=torch.bfloat16) * 0.2)(H * Dh, D) * ((H * Dh) ** -0.5)),
        }
    _A_in = _A_setup()

    def _B_setup():
        B, S, D, F = 1, 2048, 1024, 3584
        return {
            "x": _w((lambda *s: torch.randn(*s, dtype=torch.bfloat16) * 0.05)(B, S, D)),
            "w_gate": _w((lambda *s: torch.randn(*s, dtype=torch.bfloat16) * 0.1)(D, F)),
            "w_up": _w((lambda *s: torch.randn(*s, dtype=torch.bfloat16) * 0.1)(D, F)),
            "w_down": _w((lambda *s: torch.randn(*s, dtype=torch.bfloat16) * 0.1)(F, D)),
        }
    _B_in = _B_setup()

    return {
        "A_x": _A_in["x"],
        "A_k_cache": _A_in["k_cache"],
        "A_v_cache": _A_in["v_cache"],
        "A_wq": _A_in["wq"],
        "A_wo": _A_in["wo"],
        "B_x": _B_in["x"],
        "B_w_gate": _B_in["w_gate"],
        "B_w_up": _B_in["w_up"],
        "B_w_down": _B_in["w_down"],
    }

def reference(A_x, A_k_cache, A_v_cache, A_wq, A_wo, B_x, B_w_gate, B_w_up, B_w_down):
    def _A_ref(x, k_cache, v_cache, wq, wo):
        B, Sq, D = x.shape
        H, Dh = 32, 128
        q = (lambda x, *d: x.permute(*d))((x @ wq).reshape(B, Sq, H, Dh), 0, 2, 1, 3)
        scores = torch.einsum("bhqd,bhkd->bhqk", q, k_cache) * (Dh ** -0.5)
        p = _softmax(scores, axis=-1)
        o = torch.einsum("bhqk,bhkd->bhqd", p, v_cache)
        return (lambda x, *d: x.permute(*d))(o, 0, 2, 1, 3).reshape(B, Sq, H * Dh) @ wo

    def _B_ref(x, w_gate, w_up, w_down):
        return (_gelu(x @ w_gate) * (x @ w_up)) @ w_down

    x = A_x
    xn = _layernorm(x, axis=-1)
    s = _A_ref(xn, A_k_cache, A_v_cache, A_wq, A_wo)
    g = _silu(_B_ref(xn, B_w_gate, B_w_up, B_w_down))
    return x + s * g
```

```asm
; @launch kernel=main_kernel grid=(256,1,1) block=(256,1,1) lds=163840
.amdgcn_target "amdgcn-amd-amdhsa--gfx950"
.text
.globl main_kernel
.p2align 8
.type main_kernel,@function
main_kernel:
s_cmp_ge_u32 s2, 256
s_cbranch_scc1 L_main_kernel_end
s_mov_b32 s78, 0
v_lshrrev_b32 v13, 6, v0
v_and_b32 v0, 63, v0
v_readfirstlane_b32 s40, v13
L_main_kernel_top:
s_load_dwordx2 s[60:61], s[0:1], 88
s_load_dwordx2 s[62:63], s[0:1], 24
s_load_dwordx4 s[64:67], s[0:1], 48
s_load_dwordx4 s[68:71], s[0:1], 8
s_load_dwordx2 s[36:37], s[0:1], 0
s_load_dwordx2 s[88:89], s[0:1], 80
s_getpc_b64 s[92:93]
L_main_kernel_pc:
s_sub_u32 s92, s92, L_main_kernel_pc-main_kernel
s_subb_u32 s93, s93, 0
s_mov_b32 s94, L_code_end-main_kernel
s_mov_b32 s95, 0x20000
s_cmp_lg_u32 s40, 3
s_cselect_b32 s94, 0, s94
s_bfe_u32 s55, s2, 0x40003
s_lshl_b32 s55, s55, 13
v_lshlrev_b32 v254, 7, v0
buffer_load_dword a255, v254, s[92:95], s55 offen
v_and_b32 v168, 7, v0
v_lshrrev_b32 v169, 3, v0
v_lshlrev_b32 v171, 11, v168
v_lshl_add_u32 v170, v169, 4, v171
v_lshl_add_u32 v170, v13, 9, v170
s_lshl_b32 s3, s2, 14
s_mov_b32 s38, 0x400000
s_mov_b32 s39, 0x20000
s_mov_b32 s90, 256
s_mov_b32 s91, 0x20000
s_and_b32 s41, s2, 7
s_lshl_b32 s41, s41, 2
s_bfe_u32 s42, s2, 0x20003
s_add_u32 s41, s41, s42
s_lshr_b32 s42, s2, 5
s_lshl_b32 s46, s40, 10
s_lshl_b32 s57, s40, 12
v_lshrrev_b32 v14, 3, v0
v_and_b32 v15, 7, v0
v_bfe_u32 v240, v14, 1, 1
v_and_b32 v241, 1, v13
v_lshl_add_u32 v240, v241, 1, v240
v_lshlrev_b32 v240, 1, v240
v_xor_b32 v240, v240, v15
v_lshl_add_u32 v241, v13, 3, v14
v_lshlrev_b32 v2, 13, v241
v_lshl_add_u32 v2, v240, 4, v2
s_and_b32 s47, s41, 3
s_lshl_b32 s58, s47, 1
v_mul_u32_u24 v242, 7168, v241
v_add_u32 v243, s58, v240
v_lshl_add_u32 v3, v243, 4, v242
v_add_u32 v243, 8, v243
v_subrev_u32 v244, 14, v243
v_cmp_le_u32 vcc, 14, v243
s_nop 1
v_cndmask_b32 v243, v243, v244, vcc
v_lshl_add_u32 v15, v243, 4, v242
v_bfrev_b32 v244, 1
v_cmp_le_u32 vcc, 6, v240
s_nop 1
v_cndmask_b32 v15, v15, v244, vcc
v_and_b32 v240, 15, v0
v_lshl_add_u32 v240, v13, 6, v240
v_lshlrev_b32 v240, 11, v240
v_and_b32 v241, 48, v0
s_lshl_b32 s59, s42, 19
v_add3_u32 v1, v240, v241, s59
s_mov_b32 s54, 0x8000
s_mov_b32 s56, 0x10000
s_mov_b32 s100, 0x18000
s_lshl_b32 s59, s41, 8
s_sub_u32 s14, 0x800000, s59
s_mov_b32 s15, 0x20000
s_mul_i32 s58, s41, 224
s_sub_u32 s18, 7340032, s58
s_mov_b32 s19, 0x20000
s_mov_b32 s22, s18
s_mov_b32 s23, 0x20000
s_mov_b32 s44, 0
s_mov_b32 s45, 0
s_mov_b32 s4, 0x40000
s_mov_b32 s5, 229376
s_add_u32 s6, s46, 49152
s_add_u32 s7, s46, 147456
s_lshr_b32 s99, s2, 3
s_lshl_b32 s98, s99, 1
s_and_b32 s96, s40, 1
s_add_u32 s98, s98, s96
s_lshl_b32 s98, s98, 3
s_and_b32 s96, s2, 7
s_add_u32 s98, s98, s96
s_lshl_b32 s96, s98, 10
s_mul_i32 s97, s98, 896
s_lshr_b32 s98, s40, 1
s_mul_i32 s72, s98, 384
s_add_u32 s97, s97, s72
s_lshl_b32 s98, s98, 9
s_add_u32 s96, s96, s98
s_lshl_b32 s99, s99, 17
s_lshl_b32 s98, s40, 15
s_add_u32 s99, s99, s98
s_waitcnt lgkmcnt(0)
s_add_u32 s12, s62, s59
s_addc_u32 s13, s63, 0
buffer_load_dwordx4 v[208:211], v170, s[36:39], s3 offen offset:0
s_load_dword s98, s[62:63], s96 offset:0x80000
s_add_u32 s16, s64, s58
s_load_dword s98, s[62:63], s96 offset:0x80080
s_addc_u32 s17, s65, 0
s_load_dword s98, s[62:63], s96 offset:0x80100
s_add_u32 s20, s66, s58
s_load_dword s98, s[62:63], s96 offset:0x80180
s_addc_u32 s21, s67, 0
buffer_load_dwordx4 v[212:215], v170, s[36:39], s3 offen offset:128
s_load_dword s98, s[64:65], s97 offset:0x70000
s_add_u32 s84, s60, 73400320
s_load_dword s98, s[66:67], s97 offset:0x70000
s_addc_u32 s85, s61, 0
s_load_dword s98, s[64:65], s97 offset:0x70080
s_mov_b32 s87, 0x20000
buffer_load_dwordx4 v[216:219], v170, s[36:39], s3 offen offset:256
s_load_dword s98, s[66:67], s97 offset:0x70080
s_or_b32 s55, s78, s40
s_load_dword s98, s[64:65], s97 offset:0x70100
s_cmp_lg_u32 s55, 0
s_load_dword s98, s[66:67], s97 offset:0x70100
s_cselect_b32 s86, 0, 262144
buffer_load_dwordx4 v[220:223], v170, s[36:39], s3 offen offset:384
s_load_dword s98, s[64:65], s97 offset:0x70180
s_lshl_b32 s83, s2, 10
s_load_dword s98, s[66:67], s97 offset:0x70180
v_lshlrev_b32 v228, 4, v0
v_mov_b32 v224, 0
v_mov_b32 v225, 0
buffer_load_dword v171, v171, s[36:39], s3 offen
v_mov_b32 v226, 0
v_mov_b32 v227, 0
buffer_store_dwordx4 v[224:227], v228, s[84:87], s83 offen sc0 sc1
s_cmp_eq_u32 s40, 0
s_cselect_b32 s92, s62, s64
s_cselect_b32 s93, s63, s65
s_mov_b32 s55, 7168
s_cselect_b32 s55, 0x2000, s55
s_add_u32 m0, s6, 0
s_cmp_eq_u32 s40, 2
buffer_load_dwordx4 v2, s[12:15], s44 offen offset:0  lds
s_cselect_b32 s92, s66, s92
s_cselect_b32 s93, s67, s93
s_mul_i32 s94, s55, 192
s_cmp_eq_u32 s40, 3
s_cselect_b32 s94, 0, s94
s_add_u32 m0, s6, 3968
s_add_u32 s59, s2, 64
buffer_load_dwordx4 v2, s[12:15], s44 offen offset:128  lds
s_mul_i32 s59, s55, s59
s_sub_u32 s55, s55, 128
v_min_u32 v229, s55, v254
buffer_load_dword a255, v229, s[92:95], s59 offen
s_mov_b32 s86, 294912
s_add_u32 m0, s6, 24576
s_lshl_b32 s59, s41, 19
buffer_load_dwordx4 v2, s[12:15], s4 offen offset:0  lds
s_add_u32 s24, s68, s59
s_addc_u32 s25, s69, 0
s_mov_b32 s26, 0x80000
s_mov_b32 s27, 0x20000
s_add_u32 s28, s70, s59
s_addc_u32 s29, s71, 0
s_add_u32 m0, s6, 28544
s_mov_b32 s30, 0x80000
buffer_load_dwordx4 v2, s[12:15], s4 offen offset:128  lds
s_mov_b32 s31, 0x20000
s_lshr_b32 s59, s40, 1
s_lshl_b32 s55, s42, 1
s_add_u32 s59, s59, s55
s_mul_i32 s55, s59, 917504
s_add_u32 s55, s55, 4194304
s_add_u32 s32, s60, s55
s_addc_u32 s33, s61, 0
s_mov_b32 s34, 917504
s_mov_b32 s35, 0x20000
s_lshl_b32 s55, s59, 20
s_add_u32 s55, s55, 20971520
s_and_b32 s59, s41, 4
s_lshl_b32 s59, s59, 1
s_lshr_b32 s72, s41, 3
s_lshl_b32 s72, s72, 1
s_add_u32 s59, s59, s72
s_and_b32 s72, s41, 1
s_add_u32 s59, s59, s72
buffer_load_dwordx4 a[128:131], v1, s[36:39], 0 offen offset:0
s_bfe_i32 s72, s41, 0x10001
s_and_b32 s72, s72, 31
s_xor_b32 s59, s59, s72
s_lshl_b32 s59, s59, 15
s_add_u32 s55, s55, s59
s_mov_b32 s101, s55
s_bfe_u32 s59, s41, 0x10001
s_lshl_b32 s59, s59, 3
s_lshr_b32 s55, s41, 2
s_add_u32 s59, s59, s55
s_mul_i32 s59, s59, 0xe000
s_and_b32 s55, s41, 1
s_mul_i32 s72, s55, 0x6000
s_add_u32 s48, s59, s72
s_add_u32 s49, s48, 0x2000
s_add_u32 s50, s48, 0x4000
s_lshl_b32 s55, s55, 9
s_add_u32 s51, s59, s55
s_add_u32 s51, s51, 0xc000
v_and_b32 v241, 1, v13
buffer_load_dwordx4 a[144:147], v1, s[36:39], 0 offen offset:64
v_lshlrev_b32 v5, 4, v0
v_lshl_add_u32 v5, v241, 12, v5
v_lshrrev_b32 v242, 4, v0
v_and_b32 v243, 15, v0
v_lshl_add_u32 v244, v13, 4, v242
v_lshlrev_b32 v244, 8, v244
v_xor_b32 v245, v243, v242
v_lshl_add_u32 v245, v245, 4, v244
v_xor_b32 v6, 0, v245
v_xor_b32 v7, 64, v245
v_xor_b32 v8, 128, v245
v_xor_b32 v9, 192, v245
v_lshlrev_b32 v245, 1, v242
v_xor_b32 v245, v243, v245
v_lshl_add_u32 v10, v245, 4, v244
v_xor_b32 v11, 128, v10
v_bfe_u32 v243, v0, 2, 2
v_and_b32 v244, 3, v0
v_lshrrev_b32 v245, 1, v243
v_and_b32 v246, 1, v242
buffer_load_dwordx4 a[132:135], v1, s[36:39], s54 offen offset:0
v_lshl_add_u32 v245, v246, 1, v245
v_lshlrev_b32 v246, 10, v242
v_lshl_add_u32 v246, v243, 7, v246
v_lshrrev_b32 v247, 1, v244
v_xor_b32 v247, v247, v245
v_lshl_add_u32 v247, v247, 5, v246
v_and_b32 v248, 1, v244
v_lshl_add_u32 v252, v248, 4, v247
v_lshl_add_u32 v246, v244, 3, v246
v_lshl_add_u32 v253, v245, 5, v246
v_add_u32 v253, 49152, v253
v_add_u32 v252, 49152, v252
v_xor_b32 v240, 0, v253
v_add_u32 v244, 49152, v240
v_xor_b32 v241, 32, v253
v_add_u32 v245, 49152, v241
v_xor_b32 v242, 64, v253
v_add_u32 v246, 49152, v242
v_xor_b32 v243, 96, v253
v_add_u32 v247, 49152, v243
buffer_load_dwordx4 a[148:151], v1, s[36:39], s54 offen offset:64
v_mov_b32 v248, v252
v_xor_b32 v249, 64, v252
v_add_u32 v250, 49152, v248
v_add_u32 v251, 49152, v249
s_cmp_eq_u32 s40, 0
s_cselect_b32 s92, s62, s64
s_cselect_b32 s93, s63, s65
s_mov_b32 s81, 7168
s_cselect_b32 s81, 0x2000, s81
s_cmp_eq_u32 s40, 2
s_cselect_b32 s92, s66, s92
s_cselect_b32 s93, s67, s93
s_lshl_b32 s94, s81, 10
s_mov_b32 s95, 0x20000
s_cmp_eq_u32 s40, 3
s_cselect_b32 s94, 0, s94
s_lshr_b32 s80, s2, 1
s_add_u32 s80, s80, 128
s_mul_i32 s80, s80, s81
s_and_b32 s83, s2, 1
buffer_load_dwordx4 a[136:139], v1, s[36:39], s56 offen offset:0
s_lshl_b32 s83, s83, 12
v_lshlrev_b32 v254, 7, v0
v_add_u32 v254, s83, v254
v_bfrev_b32 v255, 2
v_cmp_le_u32 vcc, s81, v254
s_lshl_b32 s81, s81, 7
s_nop 0
v_cndmask_b32 v254, v254, v255, vcc
v_cmp_le_u32 vcc, 32, v0
s_nop 1
v_cndmask_b32 v254, v254, v255, vcc
s_and_b32 s55, s2, 1
s_lshr_b32 s58, s2, 6
s_bfe_u32 s59, s2, 0x20004
s_bfe_u32 s64, s2, 0x30001
s_lshl_b32 s62, s55, 2
s_add_u32 s62, s62, s58
s_lshl_b32 s62, s62, 2
s_add_u32 s62, s62, s59
s_lshl_b32 s62, s62, 2
buffer_load_dwordx4 a[152:155], v1, s[36:39], s56 offen offset:64
s_add_u32 s62, s62, s40
s_lshl_b32 s62, s62, 6
s_add_u32 s62, s62, s64
s_lshl_b32 s62, s62, 8
s_lshl_b32 s55, s55, 3
s_and_b32 s58, s58, 1
s_add_u32 s55, s55, s58
s_xor_b32 s58, s55, 31
s_bitcmp1_b32 s2, 7
s_cselect_b32 s55, s58, s55
s_lshl_b32 s55, s55, 2
s_add_u32 s55, s55, s59
s_lshl_b32 s55, s55, 13
s_lshl_b32 s63, s64, 20
s_add_u32 s63, s63, s55
s_lshr_b32 s55, s2, 3
s_mul_i32 s58, s55, 37
s_lshr_b32 s58, s58, 8
s_mul_i32 s59, s58, 7
s_sub_u32 s59, s55, s59
buffer_load_dwordx4 a[140:143], v1, s[36:39], s100 offen offset:0
s_lshr_b32 s64, s58, 1
s_and_b32 s58, s58, 1
s_mul_i32 s53, s58, 56
s_mul_i32 s72, s64, 7
s_add_u32 s53, s53, s72
s_add_u32 s53, s53, s59
s_lshl_b32 s53, s53, 13
s_and_b32 s72, s2, 7
s_lshl_b32 s73, s72, 20
s_add_u32 s53, s53, s73
s_add_u32 s53, s53, 0x800000
s_cmp_ge_u32 s59, 3
s_cselect_b32 s73, 1, 0
s_mul_i32 s74, s73, 3
s_sub_u32 s74, s59, s74
s_lshl_b32 s74, s74, 1
s_lshr_b32 s75, s40, 1
s_add_u32 s74, s74, s75
s_and_b32 s65, s40, 1
s_lshl_b32 s52, s65, 3
buffer_load_dwordx4 a[156:159], v1, s[36:39], s100 offen offset:64
s_lshl_b32 s75, s75, 2
s_cmp_eq_u32 s59, 6
s_cselect_b32 s73, s65, s73
s_cselect_b32 s74, 6, s74
s_cselect_b32 s52, s75, s52
s_cselect_b32 s77, 0x2000, 0
s_lshl_b32 s58, s58, 1
s_add_u32 s58, s58, s73
s_add_u32 s74, s74, s58
s_sub_u32 s73, s74, 7
s_cmp_ge_u32 s74, 7
s_cselect_b32 s74, s73, s74
s_mul_i32 s64, s64, 448
s_mul_i32 s58, s58, 112
s_lshl_b32 s74, s74, 4
s_add_u32 s52, s52, s64
s_add_u32 s52, s52, s58
s_add_u32 s52, s52, s74
s_lshl_b32 s52, s52, 3
s_add_u32 s52, s52, s72
s_add_u32 m0, s6, 8192
s_lshl_b32 s52, s52, 8
buffer_load_dwordx4 v3, s[16:19], s45 offen  lds
s_cmp_ge_u32 s2, 224
s_cselect_b32 s52, 0x40000000, s52
s_cselect_b32 s53, 0x40000000, s53
s_load_dwordx2 s[66:67], s[0:1], 0
s_load_dwordx2 s[64:65], s[0:1], 32
s_load_dwordx4 s[68:71], s[0:1], 64
v_accvgpr_write_b32 a238, v5
v_accvgpr_write_b32 a241, v6
v_accvgpr_write_b32 a239, v10
s_or_b32 s83, s40, s78
s_min_u32 s83, s83, 1
s_lshl_b32 s83, s83, 12
s_bfe_u32 s76, s2, 0x40003
s_lshl_b32 s76, s76, 7
s_add_u32 s76, s76, 131072
v_lshrrev_b32 v252, 3, v0
v_and_b32 v253, 6, v252
v_xor_b32 v253, v0, v253
v_and_b32 v253, 7, v253
s_add_u32 m0, s6, 12288
v_lshlrev_b32 v253, 4, v253
buffer_load_dwordx4 v15, s[16:19], s45 offen  lds
v_lshl_add_u32 v253, v252, 11, v253
s_lshr_b32 s55, s40, 1
s_lshl_b32 s55, s55, 10
s_add_u32 s55, s55, 81920
s_lshl_b32 s59, s40, 6
s_and_b32 s59, s59, 64
v_lshrrev_b32 v252, 5, v0
v_lshlrev_b32 v255, 12, v252
v_bfe_u32 v252, v0, 2, 3
v_lshl_add_u32 v255, v252, 7, v255
v_lshrrev_b32 v252, 1, v252
v_lshl_add_u32 v255, v252, 5, v255
v_and_b32 v252, 3, v0
v_lshl_add_u32 v255, v252, 3, v255
v_xor_b32 v255, s59, v255
v_add_u32 v255, s55, v255
v_accvgpr_write_b32 a254, v255
v_accvgpr_write_b32 a247, v253
v_and_b32 v252, 15, v0
s_add_u32 m0, s6, 16384
v_lshrrev_b32 v253, 4, v0
buffer_load_dwordx4 v3, s[20:23], s45 offen  lds
v_xor_b32 v253, v252, v253
v_lshlrev_b32 v253, 4, v253
v_lshl_add_u32 v253, v252, 8, v253
v_add_u32 v253, 98304, v253
v_accvgpr_write_b32 a244, v253
v_lshrrev_b32 v252, 2, v0
v_and_b32 v253, 7, v252
v_lshlrev_b32 v253, 5, v253
v_lshl_add_u32 v253, v252, 8, v253
v_and_b32 v252, 3, v0
v_lshl_add_u32 v253, v252, 3, v253
v_accvgpr_write_b32 a245, v253
v_and_b32 v252, 1, v0
v_mul_u32_u24 v252, 0xaaaa, v252
v_add_u32 v252, 0x4444, v252
v_lshl_or_b32 v252, v252, 16, v252
v_accvgpr_write_b32 a246, v252
s_lshl_b32 s55, s42, 12
s_add_u32 s55, s55, 0x30000
s_add_u32 m0, s6, 20480
v_lshlrev_b32 v252, 7, v0
buffer_load_dwordx4 v15, s[20:23], s45 offen  lds
v_bfrev_b32 v255, 2
s_mov_b32 vcc_hi, 0
s_cmp_eq_u32 s40, 3
s_cselect_b32 vcc_lo, -1, 0
s_cselect_b64 s[92:93], s[24:25], s[92:93]
s_cselect_b32 s94, s26, s94
s_cselect_b32 s80, s55, s80
s_cselect_b32 s81, 0xffff8000, s81
v_cndmask_b32 v254, v254, v252, vcc
v_cndmask_b32 v255, v255, v252, vcc
s_lshl_b32 s59, s42, 19
s_add_u32 s59, s59, 0
s_add_u32 s8, s60, s59
s_addc_u32 s9, s61, 0
s_mov_b32 s10, 0x80000
s_mov_b32 s11, 0x20000
v_accvgpr_read_b32 v14, a246
v_bfe_i32 v252, v0, 1, 1
v_not_b32 v252, v252
s_add_u32 m0, s6, 32768
v_and_b32 v252, 0x3f803f80, v252
buffer_load_dwordx4 v3, s[16:19], s5 offen  lds
v_accvgpr_write_b32 a250, v252
v_accvgpr_write_b32 a251, v252
v_accvgpr_write_b32 a252, v252
v_accvgpr_write_b32 a253, v252
v_accvgpr_write_b32 a224, 0
v_accvgpr_write_b32 a225, 0
v_accvgpr_write_b32 a226, 0
v_accvgpr_write_b32 a227, 0
v_accvgpr_write_b32 a228, 0
v_accvgpr_write_b32 a229, 0
v_accvgpr_write_b32 a230, 0
v_accvgpr_write_b32 a231, 0
v_accvgpr_write_b32 a232, 0
v_accvgpr_write_b32 a233, 0
v_accvgpr_write_b32 a234, 0
v_accvgpr_write_b32 a235, 0
v_accvgpr_write_b32 a236, 0
v_accvgpr_write_b32 a237, 0
s_lshl_b32 s55, s40, 5
s_add_u32 m0, s6, 36864
s_and_b32 s59, s55, 64
buffer_load_dwordx4 v15, s[16:19], s5 offen  lds
s_lshl_b32 s72, s40, 3
s_and_b32 s72, s72, 8
v_xor_b32 v252, s59, v248
v_add_u32 v252, s72, v252
v_xor_b32 v253, s55, v240
v_lshrrev_b32 v172, 2, v169
v_lshl_add_u32 v172, v13, 3, v172
v_lshlrev_b32 v172, 14, v172
v_and_b32 v173, 3, v169
v_lshl_add_u32 v172, v173, 8, v172
v_lshl_add_u32 v172, v168, 4, v172
s_bfe_u32 s72, s2, 0x40001
s_lshl_b32 s72, s72, 10
s_and_b32 s73, s2, 1
s_lshl_b32 s73, s73, 7
s_add_u32 s72, s72, s73
s_add_u32 s73, s72, 32768
s_add_u32 s74, s72, 65536
s_add_u32 s75, s72, 98304
s_add_u32 m0, s6, 40960
v_lshlrev_b32 v174, 5, v168
buffer_load_dwordx4 v3, s[20:23], s5 offen  lds
v_add_u32 v174, 147456, v174
v_and_b32 v173, 16, v0
v_add_u32 v173, v173, v174
v_lshl_add_u32 v173, v13, 2, v173
v_or_b32 v175, v169, v13
v_lshlrev_b32 v175, 19, v175
v_lshl_add_u32 v175, v168, 4, v175
s_lshl_b32 s55, s2, 7
s_add_u32 s55, s55, 262144
v_add_u32 v175, s55, v175
v_bfe_u32 v13, v0, 2, 3
v_lshlrev_b32 v13, 10, v13
v_and_b32 v167, 3, v0
v_lshl_add_u32 v13, v167, 2, v13
s_mov_b32 s43, 65536
s_mov_b32 s47, 6
s_mov_b32 s79, 0xffff0000
s_lshl_b32 s82, s2, 10
s_mov_b32 s58, s46
s_add_u32 m0, s6, 45056
s_add_u32 s59, s46, 49152
buffer_load_dwordx4 v15, s[20:23], s5 offen  lds
s_mov_b32 s3, 81920
s_add_u32 s44, s44, 0x80000
s_add_u32 s4, s4, 0x80000
s_add_u32 s45, s45, 458752
s_add_u32 s5, s5, 458752
s_add_u32 s6, s6, 49152
s_cmp_eq_u32 s6, s7
s_cselect_b32 s6, s46, s6
s_waitcnt vmcnt(22)
v_and_b32 v171, s79, v171
v_lshlrev_b32 v176, 16, v208
v_and_b32 v177, s79, v208
v_pk_add_f32 v[232:233], v[176:177], v[170:171] op_sel:[0,1] op_sel_hi:[1,1] neg_lo:[0,1] neg_hi:[0,1]
v_lshlrev_b32 v178, 16, v209
v_and_b32 v179, s79, v209
v_pk_add_f32 v[234:235], v[178:179], v[170:171] op_sel:[0,1] op_sel_hi:[1,1] neg_lo:[0,1] neg_hi:[0,1]
v_pk_add_f32 v[224:225], v[176:177], v[178:179]
v_pk_mul_f32 v[228:229], v[232:233], v[232:233]
v_lshlrev_b32 v180, 16, v210
v_and_b32 v181, s79, v210
v_pk_add_f32 v[232:233], v[180:181], v[170:171] op_sel:[0,1] op_sel_hi:[1,1] neg_lo:[0,1] neg_hi:[0,1]
v_pk_mul_f32 v[230:231], v[234:235], v[234:235]
v_lshlrev_b32 v182, 16, v211
v_and_b32 v183, s79, v211
v_pk_add_f32 v[234:235], v[182:183], v[170:171] op_sel:[0,1] op_sel_hi:[1,1] neg_lo:[0,1] neg_hi:[0,1]
v_pk_add_f32 v[226:227], v[180:181], v[182:183]
v_pk_fma_f32 v[228:229], v[232:233], v[232:233], v[228:229]
v_lshlrev_b32 v184, 16, v212
v_and_b32 v185, s79, v212
v_pk_add_f32 v[232:233], v[184:185], v[170:171] op_sel:[0,1] op_sel_hi:[1,1] neg_lo:[0,1] neg_hi:[0,1]
v_pk_add_f32 v[224:225], v[224:225], v[184:185]
v_pk_fma_f32 v[230:231], v[234:235], v[234:235], v[230:231]
v_lshlrev_b32 v186, 16, v213
v_and_b32 v187, s79, v213
v_pk_add_f32 v[234:235], v[186:187], v[170:171] op_sel:[0,1] op_sel_hi:[1,1] neg_lo:[0,1] neg_hi:[0,1]
v_pk_add_f32 v[226:227], v[226:227], v[186:187]
v_pk_fma_f32 v[228:229], v[232:233], v[232:233], v[228:229]
v_lshlrev_b32 v188, 16, v214
v_and_b32 v189, s79, v214
v_pk_add_f32 v[232:233], v[188:189], v[170:171] op_sel:[0,1] op_sel_hi:[1,1] neg_lo:[0,1] neg_hi:[0,1]
v_pk_add_f32 v[224:225], v[224:225], v[188:189]
v_pk_fma_f32 v[230:231], v[234:235], v[234:235], v[230:231]
v_lshlrev_b32 v190, 16, v215
v_and_b32 v191, s79, v215
v_pk_add_f32 v[234:235], v[190:191], v[170:171] op_sel:[0,1] op_sel_hi:[1,1] neg_lo:[0,1] neg_hi:[0,1]
v_pk_add_f32 v[226:227], v[226:227], v[190:191]
v_pk_fma_f32 v[228:229], v[232:233], v[232:233], v[228:229]
v_lshlrev_b32 v192, 16, v216
v_and_b32 v193, s79, v216
v_pk_add_f32 v[232:233], v[192:193], v[170:171] op_sel:[0,1] op_sel_hi:[1,1] neg_lo:[0,1] neg_hi:[0,1]
v_pk_add_f32 v[224:225], v[224:225], v[192:193]
v_pk_fma_f32 v[230:231], v[234:235], v[234:235], v[230:231]
v_lshlrev_b32 v194, 16, v217
v_and_b32 v195, s79, v217
v_pk_add_f32 v[234:235], v[194:195], v[170:171] op_sel:[0,1] op_sel_hi:[1,1] neg_lo:[0,1] neg_hi:[0,1]
v_pk_add_f32 v[226:227], v[226:227], v[194:195]
v_pk_fma_f32 v[228:229], v[232:233], v[232:233], v[228:229]
v_lshlrev_b32 v196, 16, v218
v_and_b32 v197, s79, v218
v_pk_add_f32 v[232:233], v[196:197], v[170:171] op_sel:[0,1] op_sel_hi:[1,1] neg_lo:[0,1] neg_hi:[0,1]
v_pk_add_f32 v[224:225], v[224:225], v[196:197]
v_pk_fma_f32 v[230:231], v[234:235], v[234:235], v[230:231]
v_lshlrev_b32 v198, 16, v219
v_and_b32 v199, s79, v219
v_pk_add_f32 v[234:235], v[198:199], v[170:171] op_sel:[0,1] op_sel_hi:[1,1] neg_lo:[0,1] neg_hi:[0,1]
v_pk_add_f32 v[226:227], v[226:227], v[198:199]
v_pk_fma_f32 v[228:229], v[232:233], v[232:233], v[228:229]
v_lshlrev_b32 v200, 16, v220
v_and_b32 v201, s79, v220
v_pk_add_f32 v[232:233], v[200:201], v[170:171] op_sel:[0,1] op_sel_hi:[1,1] neg_lo:[0,1] neg_hi:[0,1]
v_pk_add_f32 v[224:225], v[224:225], v[200:201]
v_pk_fma_f32 v[230:231], v[234:235], v[234:235], v[230:231]
v_lshlrev_b32 v202, 16, v221
v_and_b32 v203, s79, v221
v_pk_add_f32 v[234:235], v[202:203], v[170:171] op_sel:[0,1] op_sel_hi:[1,1] neg_lo:[0,1] neg_hi:[0,1]
v_pk_add_f32 v[226:227], v[226:227], v[202:203]
v_pk_fma_f32 v[228:229], v[232:233], v[232:233], v[228:229]
v_lshlrev_b32 v204, 16, v222
v_and_b32 v205, s79, v222
v_pk_add_f32 v[232:233], v[204:205], v[170:171] op_sel:[0,1] op_sel_hi:[1,1] neg_lo:[0,1] neg_hi:[0,1]
v_pk_add_f32 v[224:225], v[224:225], v[204:205]
v_pk_fma_f32 v[230:231], v[234:235], v[234:235], v[230:231]
v_lshlrev_b32 v206, 16, v223
v_and_b32 v207, s79, v223
v_pk_add_f32 v[234:235], v[206:207], v[170:171] op_sel:[0,1] op_sel_hi:[1,1] neg_lo:[0,1] neg_hi:[0,1]
v_pk_add_f32 v[226:227], v[226:227], v[206:207]
v_pk_fma_f32 v[228:229], v[232:233], v[232:233], v[228:229]
v_pk_fma_f32 v[230:231], v[234:235], v[234:235], v[230:231]
v_pk_add_f32 v[224:225], v[224:225], v[226:227]
v_pk_add_f32 v[228:229], v[228:229], v[230:231]
v_add_f32 v224, v224, v225
v_add_f32 v228, v228, v229
s_or_b32 s55, s78, s40
s_min_u32 s55, s55, 1
v_add_f32_dpp v225, v224, v224 row_ror:8 row_mask:0xf bank_mask:0xf
v_add_f32_dpp v229, v228, v228 row_ror:8 row_mask:0xf bank_mask:0xf
s_lshl_b32 s55, s55, 12
s_lshl_b32 s79, s42, 5
v_permlane16_swap_b32 v225, v229
s_add_u32 s55, s55, s79
s_add_u32 s79, s79, s57
v_add_f32 v225, v225, v229
v_mov_b32 v224, v225
s_nop 1
v_permlane32_swap_b32 v224, v225
v_mov_b32 v234, 1
s_nop 0
v_add_f32 v224, v224, v225
ds_write_b32 v173, v224
s_waitcnt vmcnt(16) lgkmcnt(0)
s_mov_b64 exec, 1
buffer_atomic_add v234, off, s[88:91], s55 sc1
s_mov_b64 exec, -1
s_barrier
ds_read_b128 v[224:227], v174
ds_read_b128 v[228:231], v174 offset:16
ds_read_b64_tr_b16 a[192:193], v248 offset:0
ds_read_b64_tr_b16 a[194:195], v248 offset:512
ds_read_b64_tr_b16 a[196:197], v248 offset:24576
ds_read_b64_tr_b16 a[198:199], v248 offset:25088
ds_read_b64_tr_b16 a[200:201], v248 offset:8
ds_read_b64_tr_b16 a[202:203], v248 offset:520
ds_read_b64_tr_b16 a[204:205], v248 offset:24584
ds_read_b64_tr_b16 a[206:207], v248 offset:25096
ds_read_b64_tr_b16 a[208:209], v249 offset:0
ds_read_b64_tr_b16 a[210:211], v249 offset:512
ds_read_b64_tr_b16 a[212:213], v249 offset:24576
ds_read_b64_tr_b16 a[214:215], v249 offset:25088
s_waitcnt vmcnt(9) lgkmcnt(8)
v_mfma_f32_16x16x32_bf16 a[0:3], a[192:195], a[128:131], 0
ds_read_b64_tr_b16 a[216:217], v249 offset:8
s_add_u32 m0, s6, 0
v_add_f32 v224, v224, v225
v_add_f32 v226, v226, v227
v_add_f32 v224, v224, v226
v_mfma_f32_16x16x32_bf16 a[0:3], a[196:199], a[144:147], a[0:3]
buffer_load_dwordx4 v2, s[12:15], s44 offen offset:0  lds
v_mfma_f32_16x16x32_bf16 a[4:7], a[196:199], a[148:151], 0
ds_read_b64_tr_b16 a[218:219], v249 offset:520
v_mul_f32 v224, 0x3a800000, v224
v_cvt_pk_bf16_f32 v232, 0, v224
v_sub_f32 v176, v176, v232
v_sub_f32 v177, v177, v232
v_mfma_f32_16x16x32_bf16 a[4:7], a[192:195], a[132:135], a[4:7]
v_add_f32 v228, v228, v229
v_sub_f32 v178, v178, v232
v_sub_f32 v179, v179, v232
v_add_f32 v230, v230, v231
v_sub_f32 v180, v180, v232
v_mfma_f32_16x16x32_bf16 a[8:11], a[192:195], a[136:139], 0
ds_read_b64_tr_b16 a[220:221], v249 offset:24584
s_add_u32 m0, s6, 3968
v_sub_f32 v181, v181, v232
v_add_f32 v228, v228, v230
v_sub_f32 v182, v182, v232
v_mfma_f32_16x16x32_bf16 a[8:11], a[196:199], a[152:155], a[8:11]
buffer_load_dwordx4 v2, s[12:15], s44 offen offset:128  lds
v_mfma_f32_16x16x32_bf16 a[12:15], a[196:199], a[156:159], 0
ds_read_b64_tr_b16 a[222:223], v249 offset:25096
v_sub_f32 v183, v183, v232
v_sub_f32 v224, v224, v171
v_cvt_pk_bf16_f32 v208, v176, v177
v_cvt_pk_bf16_f32 v209, v178, v179
v_mfma_f32_16x16x32_bf16 a[12:15], a[192:195], a[140:143], a[12:15]
v_mul_f32 v228, 0x3a800000, v228
v_cvt_pk_bf16_f32 v210, v180, v181
v_cvt_pk_bf16_f32 v211, v182, v183
v_fma_f32 v228, -v224, v224, v228
s_waitcnt lgkmcnt(8)
v_mfma_f32_16x16x32_bf16 a[28:31], a[200:203], a[140:143], 0
ds_read_b64_tr_b16 a[192:193], v248 offset:4096
s_add_u32 m0, s6, 8192
v_sub_f32 v184, v184, v232
v_max_f32 v228, 0, v228
v_sub_f32 v185, v185, v232
v_mfma_f32_16x16x32_bf16 a[28:31], a[204:207], a[156:159], a[28:31]
buffer_load_dwordx4 v3, s[16:19], s45 offen  lds
v_mfma_f32_16x16x32_bf16 a[24:27], a[204:207], a[152:155], 0
ds_read_b64_tr_b16 a[194:195], v248 offset:4608
v_sub_f32 v186, v186, v232
v_cvt_pk_bf16_f32 v228, 0, v228
v_sub_f32 v187, v187, v232
v_sub_f32 v188, v188, v232
v_mfma_f32_16x16x32_bf16 a[24:27], a[200:203], a[136:139], a[24:27]
buffer_store_dwordx4 v[208:211], v172, s[8:11], s72 offen sc0 sc1
v_mfma_f32_16x16x32_bf16 a[20:23], a[200:203], a[132:135], 0
ds_read_b64_tr_b16 a[196:197], v248 offset:28672
v_add_f32 v228, 0x3727c5ac, v228
v_sub_f32 v189, v189, v232
v_sub_f32 v190, v190, v232
v_cvt_pk_bf16_f32 v228, 0, v228
v_mfma_f32_16x16x32_bf16 a[20:23], a[204:207], a[148:151], a[20:23]
v_sub_f32 v191, v191, v232
v_cvt_pk_bf16_f32 v212, v184, v185
v_sqrt_f32 v228, v228
v_mfma_f32_16x16x32_bf16 a[16:19], a[204:207], a[144:147], 0
ds_read_b64_tr_b16 a[198:199], v248 offset:29184
v_cvt_pk_bf16_f32 v213, v186, v187
v_cvt_pk_bf16_f32 v214, v188, v189
v_cvt_pk_bf16_f32 v228, 0, v228
v_cvt_pk_bf16_f32 v215, v190, v191
v_mfma_f32_16x16x32_bf16 a[16:19], a[200:203], a[128:131], a[16:19]
buffer_store_dwordx4 v[212:215], v172, s[8:11], s73 offen sc0 sc1
s_waitcnt lgkmcnt(8)
v_mfma_f32_16x16x32_bf16 a[32:35], a[208:211], a[128:131], 0
ds_read_b64_tr_b16 a[200:201], v248 offset:4104
s_add_u32 m0, s6, 12288
v_rcp_f32 v233, v228
v_mfma_f32_16x16x32_bf16 a[32:35], a[212:215], a[144:147], a[32:35]
buffer_load_dwordx4 v15, s[16:19], s45 offen  lds
v_mfma_f32_16x16x32_bf16 a[36:39], a[212:215], a[148:151], 0
ds_read_b64_tr_b16 a[202:203], v248 offset:4616
v_sub_f32 v192, v192, v232
v_sub_f32 v193, v193, v232
v_mul_f32 v239, v228, v228
v_sub_f32 v194, v194, v232
v_mfma_f32_16x16x32_bf16 a[36:39], a[208:211], a[132:135], a[36:39]
v_sub_f32 v195, v195, v232
v_cvt_pk_bf16_f32 v236, -v232, -v232
v_sub_f32 v196, v196, v232
v_sub_f32 v197, v197, v232
v_mul_f32 v238, 0xc0135761, v233
v_mfma_f32_16x16x32_bf16 a[40:43], a[208:211], a[136:139], 0
ds_read_b64_tr_b16 a[204:205], v248 offset:28680
v_sub_f32 v198, v198, v232
v_sub_f32 v199, v199, v232
v_mul_f32 v237, v233, v233
v_cvt_pk_bf16_f32 v216, v192, v193
v_mfma_f32_16x16x32_bf16 a[40:43], a[212:215], a[152:155], a[40:43]
v_cvt_pk_bf16_f32 v217, v194, v195
v_mul_f32 v233, 0xbdd2d3e8, v233
v_cvt_pk_bf16_f32 v218, v196, v197
v_cvt_pk_bf16_f32 v219, v198, v199
v_mul_f32 v237, v237, v233
v_mfma_f32_16x16x32_bf16 a[44:47], a[212:215], a[156:159], 0
ds_read_b64_tr_b16 a[206:207], v248 offset:29192
buffer_store_dwordx4 v[216:219], v172, s[8:11], s74 offen sc0 sc1
v_mfma_f32_16x16x32_bf16 a[44:47], a[208:211], a[140:143], a[44:47]
v_sub_f32 v200, v200, v232
v_sub_f32 v201, v201, v232
v_sub_f32 v202, v202, v232
v_sub_f32 v203, v203, v232
s_waitcnt lgkmcnt(8)
v_mfma_f32_16x16x32_bf16 a[60:63], a[216:219], a[140:143], 0
ds_read_b64_tr_b16 a[208:209], v249 offset:4096
s_add_u32 m0, s6, 16384
v_sub_f32 v204, v204, v232
v_sub_f32 v205, v205, v232
v_sub_f32 v206, v206, v232
v_mfma_f32_16x16x32_bf16 a[60:63], a[220:223], a[156:159], a[60:63]
buffer_load_dwordx4 v3, s[20:23], s45 offen  lds
v_mfma_f32_16x16x32_bf16 a[56:59], a[220:223], a[152:155], 0
ds_read_b64_tr_b16 a[210:211], v249 offset:4608
v_sub_f32 v207, v207, v232
v_cvt_pk_bf16_f32 v220, v200, v201
v_cvt_pk_bf16_f32 v221, v202, v203
v_cvt_pk_bf16_f32 v222, v204, v205
v_mfma_f32_16x16x32_bf16 a[56:59], a[216:219], a[136:139], a[56:59]
buffer_store_dwordx4 v[236:239], v175, s[84:87], 0 offen sc0 sc1
v_mfma_f32_16x16x32_bf16 a[52:55], a[216:219], a[132:135], 0
ds_read_b64_tr_b16 a[212:213], v249 offset:28672
v_cvt_pk_bf16_f32 v223, v206, v207
v_mfma_f32_16x16x32_bf16 a[52:55], a[220:223], a[148:151], a[52:55]
buffer_store_dwordx4 v[220:223], v172, s[8:11], s75 offen sc0 sc1
v_mfma_f32_16x16x32_bf16 a[48:51], a[220:223], a[144:147], 0
ds_read_b64_tr_b16 a[214:215], v249 offset:29184
v_mfma_f32_16x16x32_bf16 a[48:51], a[216:219], a[128:131], a[48:51]
s_waitcnt lgkmcnt(8)
v_mfma_f32_16x16x32_bf16 a[64:67], a[192:195], a[128:131], 0
ds_read_b64_tr_b16 a[216:217], v249 offset:4104
s_add_u32 m0, s6, 20480
v_mfma_f32_16x16x32_bf16 a[64:67], a[196:199], a[144:147], a[64:67]
buffer_load_dwordx4 v15, s[20:23], s45 offen  lds
v_mfma_f32_16x16x32_bf16 a[68:71], a[196:199], a[148:151], 0
ds_read_b64_tr_b16 a[218:219], v249 offset:4616
v_mfma_f32_16x16x32_bf16 a[68:71], a[192:195], a[132:135], a[68:71]
v_mfma_f32_16x16x32_bf16 a[72:75], a[192:195], a[136:139], 0
ds_read_b64_tr_b16 a[220:221], v249 offset:28680
v_mfma_f32_16x16x32_bf16 a[72:75], a[196:199], a[152:155], a[72:75]
v_mfma_f32_16x16x32_bf16 a[76:79], a[196:199], a[156:159], 0
ds_read_b64_tr_b16 a[222:223], v249 offset:29192
v_mfma_f32_16x16x32_bf16 a[76:79], a[192:195], a[140:143], a[76:79]
s_waitcnt vmcnt(12)
s_barrier
s_waitcnt lgkmcnt(8)
v_mfma_f32_16x16x32_bf16 a[92:95], a[200:203], a[140:143], 0
ds_read_b64_tr_b16 a[192:193], v240 offset:8192
s_add_u32 m0, s6, 24576
v_mfma_f32_16x16x32_bf16 a[92:95], a[204:207], a[156:159], a[92:95]
buffer_load_dwordx4 v2, s[12:15], s4 offen offset:0  lds
v_mfma_f32_16x16x32_bf16 a[88:91], a[204:207], a[152:155], 0
ds_read_b64_tr_b16 a[194:195], v240 offset:8704
v_mfma_f32_16x16x32_bf16 a[88:91], a[200:203], a[136:139], a[88:91]
v_mfma_f32_16x16x32_bf16 a[84:87], a[200:203], a[132:135], 0
ds_read_b64_tr_b16 a[196:197], v240 offset:32768
s_add_u32 m0, s6, 28544
v_mfma_f32_16x16x32_bf16 a[84:87], a[204:207], a[148:151], a[84:87]
buffer_load_dwordx4 v2, s[12:15], s4 offen offset:128  lds
v_mfma_f32_16x16x32_bf16 a[80:83], a[204:207], a[144:147], 0
ds_read_b64_tr_b16 a[198:199], v240 offset:33280
v_mfma_f32_16x16x32_bf16 a[80:83], a[200:203], a[128:131], a[80:83]
s_waitcnt lgkmcnt(8)
v_mfma_f32_16x16x32_bf16 a[96:99], a[208:211], a[128:131], 0
ds_read_b64_tr_b16 a[200:201], v240 offset:16384
s_add_u32 m0, s6, 32768
v_mfma_f32_16x16x32_bf16 a[96:99], a[212:215], a[144:147], a[96:99]
buffer_load_dwordx4 v3, s[16:19], s5 offen  lds
v_mfma_f32_16x16x32_bf16 a[100:103], a[212:215], a[148:151], 0
ds_read_b64_tr_b16 a[202:203], v240 offset:16896
ds_read_b64_tr_b16 v[4:5], v252 offset:0
v_mfma_f32_16x16x32_bf16 a[100:103], a[208:211], a[132:135], a[100:103]
ds_read_b64_tr_b16 v[6:7], v252 offset:512
ds_read_b64_tr_b16 v[8:9], v252 offset:24576
v_mfma_f32_16x16x32_bf16 a[104:107], a[208:211], a[136:139], 0
ds_read_b64_tr_b16 a[204:205], v240 offset:40960
ds_read_b64_tr_b16 v[10:11], v252 offset:25088
v_mfma_f32_16x16x32_bf16 a[104:107], a[212:215], a[152:155], a[104:107]
s_lshl_b32 s98, s40, 2
s_add_u32 s82, s82, s98
v_mfma_f32_16x16x32_bf16 a[108:111], a[212:215], a[156:159], 0
ds_read_b64_tr_b16 a[206:207], v240 offset:41472
s_waitcnt vmcnt(4)
v_mfma_f32_16x16x32_bf16 a[108:111], a[208:211], a[140:143], a[108:111]
s_waitcnt lgkmcnt(12)
v_mfma_f32_16x16x32_bf16 a[124:127], a[216:219], a[140:143], 0
ds_read_b64_tr_b16 a[208:209], v241 offset:8192
s_add_u32 m0, s6, 36864
v_mfma_f32_16x16x32_bf16 a[124:127], a[220:223], a[156:159], a[124:127]
buffer_load_dwordx4 v15, s[16:19], s5 offen  lds
v_mfma_f32_16x16x32_bf16 a[120:123], a[220:223], a[152:155], 0
ds_read_b64_tr_b16 a[210:211], v241 offset:8704
v_mfma_f32_16x16x32_bf16 a[120:123], a[216:219], a[136:139], a[120:123]
buffer_store_dword a246, off, s[84:87], s82 offset:0x3f0 sc0 sc1
s_waitcnt lgkmcnt(3)
v_smfmac_f32_16x16x64_bf16 a[224:227], a[250:253], v[4:11], v14
v_mfma_f32_16x16x32_bf16 a[116:119], a[216:219], a[132:135], 0
ds_read_b64_tr_b16 a[212:213], v241 offset:32768
ds_read_b64_tr_b16 v[4:5], v252 offset:4096
v_mfma_f32_16x16x32_bf16 a[116:119], a[220:223], a[148:151], a[116:119]
ds_read_b64_tr_b16 v[6:7], v252 offset:4608
ds_read_b64_tr_b16 v[8:9], v252 offset:28672
v_mfma_f32_16x16x32_bf16 a[112:115], a[220:223], a[144:147], 0
ds_read_b64_tr_b16 a[214:215], v241 offset:33280
ds_read_b64_tr_b16 v[10:11], v252 offset:29184
v_mfma_f32_16x16x32_bf16 a[112:115], a[216:219], a[128:131], a[112:115]
v_mfma_f32_16x16x32_bf16 v[16:19], a[192:195], a[128:131], 0
ds_read_b64_tr_b16 a[216:217], v241 offset:16384
s_add_u32 m0, s6, 40960
v_mfma_f32_16x16x32_bf16 v[16:19], a[196:199], a[144:147], v[16:19]
buffer_load_dwordx4 v3, s[20:23], s5 offen  lds
v_mfma_f32_16x16x32_bf16 v[20:23], a[196:199], a[148:151], 0
ds_read_b64_tr_b16 a[218:219], v241 offset:16896
v_mfma_f32_16x16x32_bf16 v[20:23], a[192:195], a[132:135], v[20:23]
v_mfma_f32_16x16x32_bf16 v[24:27], a[192:195], a[136:139], 0
ds_read_b64_tr_b16 a[220:221], v241 offset:40960
v_mfma_f32_16x16x32_bf16 v[24:27], a[196:199], a[152:155], v[24:27]
s_waitcnt lgkmcnt(3)
v_smfmac_f32_16x16x64_bf16 a[226:229], a[250:253], v[4:11], v14
v_mfma_f32_16x16x32_bf16 v[28:31], a[196:199], a[156:159], 0
ds_read_b64_tr_b16 a[222:223], v241 offset:41472
ds_read_b64_tr_b16 v[4:5], v253 offset:8192
v_mfma_f32_16x16x32_bf16 v[28:31], a[192:195], a[140:143], v[28:31]
ds_read_b64_tr_b16 v[6:7], v253 offset:8704
v_mfma_f32_16x16x32_bf16 v[44:47], a[200:203], a[140:143], 0
ds_read_b64_tr_b16 a[192:193], v242 offset:8192
s_add_u32 m0, s6, 45056
v_mfma_f32_16x16x32_bf16 v[44:47], a[204:207], a[156:159], v[44:47]
buffer_load_dwordx4 v15, s[20:23], s5 offen  lds
v_mfma_f32_16x16x32_bf16 v[40:43], a[204:207], a[152:155], 0
ds_read_b64_tr_b16 a[194:195], v242 offset:8704
s_add_u32 s44, s44, 0x80000
v_mfma_f32_16x16x32_bf16 v[40:43], a[200:203], a[136:139], v[40:43]
s_add_u32 s4, s4, 0x80000
s_add_u32 s45, s45, 458752
v_mfma_f32_16x16x32_bf16 v[36:39], a[200:203], a[132:135], 0
ds_read_b64_tr_b16 a[196:197], v242 offset:32768
s_add_u32 s5, s5, 458752
v_mfma_f32_16x16x32_bf16 v[36:39], a[204:207], a[148:151], v[36:39]
s_add_u32 s6, s6, 49152
ds_read_b64_tr_b16 v[8:9], v253 offset:32768
v_mfma_f32_16x16x32_bf16 v[32:35], a[204:207], a[144:147], 0
ds_read_b64_tr_b16 a[198:199], v242 offset:33280
ds_read_b64_tr_b16 v[10:11], v253 offset:33280
v_mfma_f32_16x16x32_bf16 v[32:35], a[200:203], a[128:131], v[32:35]
v_mfma_f32_16x16x32_bf16 v[48:51], a[208:211], a[128:131], 0
ds_read_b64_tr_b16 a[200:201], v242 offset:16384
v_mfma_f32_16x16x32_bf16 v[48:51], a[212:215], a[144:147], v[48:51]
buffer_load_dwordx4 a[160:163], v1, s[36:39], 0 offen offset:128
v_mfma_f32_16x16x32_bf16 v[52:55], a[212:215], a[148:151], 0
ds_read_b64_tr_b16 a[202:203], v242 offset:16896
v_mfma_f32_16x16x32_bf16 v[52:55], a[208:211], a[132:135], v[52:55]
s_cmp_eq_u32 s6, s7
s_cselect_b32 s6, s46, s6
v_mfma_f32_16x16x32_bf16 v[56:59], a[208:211], a[136:139], 0
ds_read_b64_tr_b16 a[204:205], v242 offset:40960
v_mfma_f32_16x16x32_bf16 v[56:59], a[212:215], a[152:155], v[56:59]
buffer_load_dword v235, off, s[88:91], s79 sc0 sc1
s_waitcnt lgkmcnt(3)
v_smfmac_f32_16x16x64_bf16 a[228:231], a[250:253], v[4:11], v14
v_mfma_f32_16x16x32_bf16 v[60:63], a[212:215], a[156:159], 0
ds_read_b64_tr_b16 a[206:207], v242 offset:41472
ds_read_b64_tr_b16 v[4:5], v253 offset:16384
v_mfma_f32_16x16x32_bf16 v[60:63], a[208:211], a[140:143], v[60:63]
ds_read_b64_tr_b16 v[6:7], v253 offset:16896
v_mfma_f32_16x16x32_bf16 v[76:79], a[216:219], a[140:143], 0
ds_read_b64_tr_b16 a[208:209], v243 offset:8192
ds_read_b64_tr_b16 v[8:9], v253 offset:40960
v_mfma_f32_16x16x32_bf16 v[76:79], a[220:223], a[156:159], v[76:79]
buffer_load_dwordx4 a[176:179], v1, s[36:39], 0 offen offset:192
v_mfma_f32_16x16x32_bf16 v[72:75], a[220:223], a[152:155], 0
ds_read_b64_tr_b16 a[210:211], v243 offset:8704
ds_read_b64_tr_b16 v[10:11], v253 offset:41472
v_mfma_f32_16x16x32_bf16 v[72:75], a[216:219], a[136:139], v[72:75]
v_mfma_f32_16x16x32_bf16 v[68:71], a[216:219], a[132:135], 0
ds_read_b64_tr_b16 a[212:213], v243 offset:32768
v_mfma_f32_16x16x32_bf16 v[68:71], a[220:223], a[148:151], v[68:71]
buffer_load_dwordx4 a[164:167], v1, s[36:39], s54 offen offset:128
v_mfma_f32_16x16x32_bf16 v[64:67], a[220:223], a[144:147], 0
ds_read_b64_tr_b16 a[214:215], v243 offset:33280
v_mfma_f32_16x16x32_bf16 v[64:67], a[216:219], a[128:131], v[64:67]
v_mfma_f32_16x16x32_bf16 v[80:83], a[192:195], a[128:131], 0
ds_read_b64_tr_b16 a[216:217], v243 offset:16384
v_mfma_f32_16x16x32_bf16 v[80:83], a[196:199], a[144:147], v[80:83]
buffer_load_dwordx4 a[180:183], v1, s[36:39], s54 offen offset:192
s_waitcnt lgkmcnt(3)
v_smfmac_f32_16x16x64_bf16 a[230:233], a[250:253], v[4:11], v14
v_mfma_f32_16x16x32_bf16 v[84:87], a[196:199], a[148:151], 0
ds_read_b64_tr_b16 a[218:219], v243 offset:16896
ds_read_b64_tr_b16 v[4:5], v253 offset:12288
v_mfma_f32_16x16x32_bf16 v[84:87], a[192:195], a[132:135], v[84:87]
ds_read_b64_tr_b16 v[6:7], v253 offset:12800
ds_read_b64_tr_b16 v[8:9], v253 offset:36864
v_mfma_f32_16x16x32_bf16 v[88:91], a[192:195], a[136:139], 0
ds_read_b64_tr_b16 a[220:221], v243 offset:40960
ds_read_b64_tr_b16 v[10:11], v253 offset:37376
v_mfma_f32_16x16x32_bf16 v[88:91], a[196:199], a[152:155], v[88:91]
v_mfma_f32_16x16x32_bf16 v[92:95], a[196:199], a[156:159], 0
ds_read_b64_tr_b16 a[222:223], v243 offset:41472
v_mfma_f32_16x16x32_bf16 v[92:95], a[192:195], a[140:143], v[92:95]
v_mfma_f32_16x16x32_bf16 v[108:111], a[200:203], a[140:143], 0
ds_read_b64_tr_b16 a[192:193], v240 offset:12288
v_mfma_f32_16x16x32_bf16 v[108:111], a[204:207], a[156:159], v[108:111]
buffer_load_dwordx4 a[168:171], v1, s[36:39], s56 offen offset:128
v_mfma_f32_16x16x32_bf16 v[104:107], a[204:207], a[152:155], 0
ds_read_b64_tr_b16 a[194:195], v240 offset:12800
v_mfma_f32_16x16x32_bf16 v[104:107], a[200:203], a[136:139], v[104:107]
s_waitcnt lgkmcnt(3)
v_smfmac_f32_16x16x64_bf16 a[232:235], a[250:253], v[4:11], v14
v_mfma_f32_16x16x32_bf16 v[100:103], a[200:203], a[132:135], 0
ds_read_b64_tr_b16 a[196:197], v240 offset:36864
ds_read_b64_tr_b16 v[4:5], v253 offset:20480
v_mfma_f32_16x16x32_bf16 v[100:103], a[204:207], a[148:151], v[100:103]
ds_read_b64_tr_b16 v[6:7], v253 offset:20992
ds_read_b64_tr_b16 v[8:9], v253 offset:45056
v_mfma_f32_16x16x32_bf16 v[96:99], a[204:207], a[144:147], 0
ds_read_b64_tr_b16 a[198:199], v240 offset:37376
ds_read_b64_tr_b16 v[10:11], v253 offset:45568
v_mfma_f32_16x16x32_bf16 v[96:99], a[200:203], a[128:131], v[96:99]
v_mfma_f32_16x16x32_bf16 v[112:115], a[208:211], a[128:131], 0
ds_read_b64_tr_b16 a[200:201], v240 offset:20480
v_mfma_f32_16x16x32_bf16 v[112:115], a[212:215], a[144:147], v[112:115]
buffer_load_dwordx4 a[184:187], v1, s[36:39], s56 offen offset:192
v_mfma_f32_16x16x32_bf16 v[116:119], a[212:215], a[148:151], 0
ds_read_b64_tr_b16 a[202:203], v240 offset:20992
v_mfma_f32_16x16x32_bf16 v[116:119], a[208:211], a[132:135], v[116:119]
v_mfma_f32_16x16x32_bf16 v[120:123], a[208:211], a[136:139], 0
ds_read_b64_tr_b16 a[204:205], v240 offset:45056
v_mfma_f32_16x16x32_bf16 v[120:123], a[212:215], a[152:155], v[120:123]
s_waitcnt lgkmcnt(3)
v_smfmac_f32_16x16x64_bf16 a[234:237], a[250:253], v[4:11], v14
v_mfma_f32_16x16x32_bf16 v[124:127], a[212:215], a[156:159], 0
ds_read_b64_tr_b16 a[206:207], v240 offset:45568
v_add_u32 v252, 49152, v252
v_mfma_f32_16x16x32_bf16 v[124:127], a[208:211], a[140:143], v[124:127]
v_add_u32 v253, 49152, v253
v_mfma_f32_16x16x32_bf16 v[140:143], a[216:219], a[140:143], 0
ds_read_b64_tr_b16 a[208:209], v241 offset:12288
v_mfma_f32_16x16x32_bf16 v[140:143], a[220:223], a[156:159], v[140:143]
buffer_load_dwordx4 a[172:175], v1, s[36:39], s100 offen offset:128
v_mfma_f32_16x16x32_bf16 v[136:139], a[220:223], a[152:155], 0
ds_read_b64_tr_b16 a[210:211], v241 offset:12800
v_mfma_f32_16x16x32_bf16 v[136:139], a[216:219], a[136:139], v[136:139]
v_mfma_f32_16x16x32_bf16 v[132:135], a[216:219], a[132:135], 0
ds_read_b64_tr_b16 a[212:213], v241 offset:36864
v_mfma_f32_16x16x32_bf16 v[132:135], a[220:223], a[148:151], v[132:135]
v_mfma_f32_16x16x32_bf16 v[128:131], a[220:223], a[144:147], 0
ds_read_b64_tr_b16 a[214:215], v241 offset:37376
v_mfma_f32_16x16x32_bf16 v[128:131], a[216:219], a[128:131], v[128:131]
v_mfma_f32_16x16x32_bf16 v[144:147], a[192:195], a[128:131], 0
ds_read_b64_tr_b16 a[216:217], v241 offset:20480
v_mfma_f32_16x16x32_bf16 v[144:147], a[196:199], a[144:147], v[144:147]
buffer_load_dwordx4 a[188:191], v1, s[36:39], s100 offen offset:192
v_mfma_f32_16x16x32_bf16 v[148:151], a[196:199], a[148:151], 0
ds_read_b64_tr_b16 a[218:219], v241 offset:20992
v_mfma_f32_16x16x32_bf16 v[148:151], a[192:195], a[132:135], v[148:151]
v_mfma_f32_16x16x32_bf16 v[152:155], a[192:195], a[136:139], 0
ds_read_b64_tr_b16 a[220:221], v241 offset:45056
v_mfma_f32_16x16x32_bf16 v[152:155], a[196:199], a[152:155], v[152:155]
buffer_load_dword a255, v254, s[92:95], s80 offen
v_mfma_f32_16x16x32_bf16 v[156:159], a[196:199], a[156:159], 0
ds_read_b64_tr_b16 a[222:223], v241 offset:45568
v_mfma_f32_16x16x32_bf16 v[156:159], a[192:195], a[140:143], v[156:159]
s_waitcnt lgkmcnt(8)
v_mfma_f32_16x16x32_bf16 v[172:175], a[200:203], a[140:143], 0
ds_read_b64_tr_b16 a[192:193], v242 offset:12288
s_add_u32 m0, s6, 0
v_mfma_f32_16x16x32_bf16 v[172:175], a[204:207], a[156:159], v[172:175]
buffer_load_dwordx4 v2, s[12:15], s44 offen offset:0  lds
v_mfma_f32_16x16x32_bf16 v[168:171], a[204:207], a[152:155], 0
ds_read_b64_tr_b16 a[194:195], v242 offset:12800
s_waitcnt vmcnt(9)
v_readfirstlane_b32 s98, v235
v_mfma_f32_16x16x32_bf16 v[168:171], a[200:203], a[136:139], v[168:171]
s_or_b32 s98, s98, s57
v_mfma_f32_16x16x32_bf16 v[164:167], a[200:203], a[132:135], 0
ds_read_b64_tr_b16 a[196:197], v242 offset:36864
v_mfma_f32_16x16x32_bf16 v[164:167], a[204:207], a[148:151], v[164:167]
s_cmp_lt_u32 s98, 32
s_cbranch_scc1 L_main_kernel_xw
L_main_kernel_xa:
v_mfma_f32_16x16x32_bf16 v[160:163], a[204:207], a[144:147], 0
ds_read_b64_tr_b16 a[198:199], v242 offset:37376
v_mfma_f32_16x16x32_bf16 v[160:163], a[200:203], a[128:131], v[160:163]
s_waitcnt lgkmcnt(8)
v_mfma_f32_16x16x32_bf16 v[176:179], a[208:211], a[128:131], 0
ds_read_b64_tr_b16 a[200:201], v242 offset:20480
v_mfma_f32_16x16x32_bf16 v[176:179], a[212:215], a[144:147], v[176:179]
ds_read_b64_tr_b16 a[202:203], v242 offset:20992
v_mfma_f32_16x16x32_bf16 v[180:183], a[212:215], a[148:151], 0
ds_read_b64_tr_b16 a[204:205], v242 offset:45056
v_mfma_f32_16x16x32_bf16 v[180:183], a[208:211], a[132:135], v[180:183]
ds_read_b64_tr_b16 a[206:207], v242 offset:45568
v_mfma_f32_16x16x32_bf16 v[184:187], a[208:211], a[136:139], 0
s_add_u32 m0, s6, 3968
v_mfma_f32_16x16x32_bf16 v[184:187], a[212:215], a[152:155], v[184:187]
buffer_load_dwordx4 v2, s[12:15], s44 offen offset:128  lds
v_mfma_f32_16x16x32_bf16 v[188:191], a[212:215], a[156:159], 0
v_mfma_f32_16x16x32_bf16 v[188:191], a[208:211], a[140:143], v[188:191]
s_waitcnt lgkmcnt(0)
s_barrier
v_mfma_f32_16x16x32_bf16 v[204:207], a[216:219], a[140:143], 0
ds_read_b64_tr_b16 a[208:209], v250 offset:0
s_add_u32 m0, s6, 8192
v_mfma_f32_16x16x32_bf16 v[204:207], a[220:223], a[156:159], v[204:207]
buffer_load_dwordx4 v3, s[16:19], s45 offen  lds
v_mfma_f32_16x16x32_bf16 v[200:203], a[220:223], a[152:155], 0
ds_read_b64_tr_b16 a[210:211], v250 offset:512
v_subrev_u32 v240, 49152, v240
v_mfma_f32_16x16x32_bf16 v[200:203], a[216:219], a[136:139], v[200:203]
v_subrev_u32 v241, 49152, v241
v_subrev_u32 v242, 49152, v242
v_mfma_f32_16x16x32_bf16 v[196:199], a[216:219], a[132:135], 0
ds_read_b64_tr_b16 a[212:213], v250 offset:24576
v_subrev_u32 v243, 49152, v243
v_mfma_f32_16x16x32_bf16 v[196:199], a[220:223], a[148:151], v[196:199]
v_subrev_u32 v248, 49152, v248
v_subrev_u32 v249, 49152, v249
v_mfma_f32_16x16x32_bf16 v[192:195], a[220:223], a[144:147], 0
ds_read_b64_tr_b16 a[214:215], v250 offset:25088
ds_read_b64_tr_b16 v[4:5], v252 offset:0
v_mfma_f32_16x16x32_bf16 v[192:195], a[216:219], a[128:131], v[192:195]
ds_read_b64_tr_b16 v[6:7], v252 offset:512
v_mfma_f32_16x16x32_bf16 v[208:211], a[192:195], a[128:131], 0
ds_read_b64_tr_b16 a[216:217], v250 offset:8
s_add_u32 m0, s6, 12288
v_mfma_f32_16x16x32_bf16 v[208:211], a[196:199], a[144:147], v[208:211]
buffer_load_dwordx4 v15, s[16:19], s45 offen  lds
v_mfma_f32_16x16x32_bf16 v[212:215], a[196:199], a[148:151], 0
ds_read_b64_tr_b16 a[218:219], v250 offset:520
ds_read_b64_tr_b16 v[8:9], v252 offset:24576
v_mfma_f32_16x16x32_bf16 v[212:215], a[192:195], a[132:135], v[212:215]
ds_read_b64_tr_b16 v[10:11], v252 offset:25088
v_mfma_f32_16x16x32_bf16 v[216:219], a[192:195], a[136:139], 0
ds_read_b64_tr_b16 a[220:221], v250 offset:24584
v_mfma_f32_16x16x32_bf16 v[216:219], a[196:199], a[152:155], v[216:219]
v_mfma_f32_16x16x32_bf16 v[220:223], a[196:199], a[156:159], 0
ds_read_b64_tr_b16 a[222:223], v250 offset:25096
v_mfma_f32_16x16x32_bf16 v[220:223], a[192:195], a[140:143], v[220:223]
v_mfma_f32_16x16x32_bf16 v[236:239], a[200:203], a[140:143], 0
ds_read_b64_tr_b16 a[192:193], v251 offset:0
s_add_u32 m0, s6, 16384
v_mfma_f32_16x16x32_bf16 v[236:239], a[204:207], a[156:159], v[236:239]
buffer_load_dwordx4 v3, s[20:23], s45 offen  lds
v_mfma_f32_16x16x32_bf16 v[232:235], a[204:207], a[152:155], 0
ds_read_b64_tr_b16 a[194:195], v251 offset:512
s_waitcnt lgkmcnt(4)
v_smfmac_f32_16x16x64_bf16 a[224:227], a[250:253], v[4:11], v14
v_mfma_f32_16x16x32_bf16 v[232:235], a[200:203], a[136:139], v[232:235]
ds_read_b64_tr_b16 v[4:5], v252 offset:4096
ds_read_b64_tr_b16 v[6:7], v252 offset:4608
v_mfma_f32_16x16x32_bf16 v[228:231], a[200:203], a[132:135], 0
ds_read_b64_tr_b16 a[196:197], v251 offset:24576
ds_read_b64_tr_b16 v[8:9], v252 offset:28672
v_mfma_f32_16x16x32_bf16 v[228:231], a[204:207], a[148:151], v[228:231]
ds_read_b64_tr_b16 v[10:11], v252 offset:29184
v_mfma_f32_16x16x32_bf16 v[224:227], a[204:207], a[144:147], 0
ds_read_b64_tr_b16 a[198:199], v251 offset:25088
v_mfma_f32_16x16x32_bf16 v[224:227], a[200:203], a[128:131], v[224:227]
s_waitcnt vmcnt(6)
v_mfma_f32_16x16x32_bf16 a[0:3], a[208:211], a[160:163], a[0:3]
ds_read_b64_tr_b16 a[200:201], v251 offset:8
s_add_u32 m0, s6, 20480
v_mfma_f32_16x16x32_bf16 a[0:3], a[212:215], a[176:179], a[0:3]
buffer_load_dwordx4 v15, s[20:23], s45 offen  lds
s_waitcnt lgkmcnt(2)
v_smfmac_f32_16x16x64_bf16 a[226:229], a[250:253], v[4:11], v14
s_lshl_b32 s72, s42, 15
v_mfma_f32_16x16x32_bf16 a[4:7], a[212:215], a[180:183], a[4:7]
ds_read_b64_tr_b16 a[202:203], v251 offset:520
ds_read_b64_tr_b16 v[4:5], v253 offset:8192
v_mfma_f32_16x16x32_bf16 a[4:7], a[208:211], a[164:167], a[4:7]
s_lshl_b32 s98, s40, 13
s_add_u32 s72, s72, s98
v_mfma_f32_16x16x32_bf16 a[8:11], a[208:211], a[168:171], a[8:11]
ds_read_b64_tr_b16 a[204:205], v251 offset:24584
s_add_u32 m0, s6, 24576
v_mfma_f32_16x16x32_bf16 a[8:11], a[212:215], a[184:187], a[8:11]
buffer_load_dwordx4 v2, s[12:15], s4 offen offset:0  lds
v_mfma_f32_16x16x32_bf16 a[12:15], a[212:215], a[188:191], a[12:15]
ds_read_b64_tr_b16 a[206:207], v251 offset:25096
ds_read_b64_tr_b16 v[6:7], v253 offset:8704
v_mfma_f32_16x16x32_bf16 a[12:15], a[208:211], a[172:175], a[12:15]
ds_read_b64_tr_b16 v[8:9], v253 offset:32768
v_mfma_f32_16x16x32_bf16 a[28:31], a[216:219], a[172:175], a[28:31]
ds_read_b64_tr_b16 a[208:209], v250 offset:4096
s_add_u32 m0, s6, 28544
v_mfma_f32_16x16x32_bf16 a[28:31], a[220:223], a[188:191], a[28:31]
buffer_load_dwordx4 v2, s[12:15], s4 offen offset:128  lds
v_mfma_f32_16x16x32_bf16 a[24:27], a[220:223], a[184:187], a[24:27]
ds_read_b64_tr_b16 a[210:211], v250 offset:4608
ds_read_b64_tr_b16 v[10:11], v253 offset:33280
v_mfma_f32_16x16x32_bf16 a[24:27], a[216:219], a[168:171], a[24:27]
v_mfma_f32_16x16x32_bf16 a[20:23], a[216:219], a[164:167], a[20:23]
ds_read_b64_tr_b16 a[212:213], v250 offset:28672
v_mfma_f32_16x16x32_bf16 a[20:23], a[220:223], a[180:183], a[20:23]
v_mfma_f32_16x16x32_bf16 a[16:19], a[220:223], a[176:179], a[16:19]
ds_read_b64_tr_b16 a[214:215], v250 offset:29184
v_mfma_f32_16x16x32_bf16 a[16:19], a[216:219], a[160:163], a[16:19]
s_waitcnt lgkmcnt(12)
v_mfma_f32_16x16x32_bf16 a[32:35], a[192:195], a[160:163], a[32:35]
ds_read_b64_tr_b16 a[216:217], v250 offset:4104
s_add_u32 m0, s6, 32768
v_mfma_f32_16x16x32_bf16 a[32:35], a[196:199], a[176:179], a[32:35]
buffer_load_dwordx4 v3, s[16:19], s5 offen  lds
s_waitcnt lgkmcnt(3)
v_smfmac_f32_16x16x64_bf16 a[228:231], a[250:253], v[4:11], v14
v_mfma_f32_16x16x32_bf16 a[36:39], a[196:199], a[180:183], a[36:39]
ds_read_b64_tr_b16 a[218:219], v250 offset:4616
ds_read_b64_tr_b16 v[4:5], v253 offset:16384
v_mfma_f32_16x16x32_bf16 a[36:39], a[192:195], a[164:167], a[36:39]
buffer_load_dword v1, v13, s[84:87], s72 offen offset:0x3f0 sc0 sc1
v_mfma_f32_16x16x32_bf16 a[40:43], a[192:195], a[168:171], a[40:43]
ds_read_b64_tr_b16 a[220:221], v250 offset:28680
ds_read_b64_tr_b16 v[6:7], v253 offset:16896
v_mfma_f32_16x16x32_bf16 a[40:43], a[196:199], a[184:187], a[40:43]
s_add_u32 s36, s60, s101
s_addc_u32 s37, s61, 0
v_mfma_f32_16x16x32_bf16 a[44:47], a[196:199], a[188:191], a[44:47]
ds_read_b64_tr_b16 a[222:223], v250 offset:29192
s_mov_b32 s38, 0x8000
v_mfma_f32_16x16x32_bf16 a[44:47], a[192:195], a[172:175], a[44:47]
s_mov_b32 s73, 0
v_mfma_f32_16x16x32_bf16 a[60:63], a[200:203], a[172:175], a[60:63]
ds_read_b64_tr_b16 a[192:193], v251 offset:4096
s_add_u32 m0, s6, 36864
v_mfma_f32_16x16x32_bf16 a[60:63], a[204:207], a[188:191], a[60:63]
buffer_load_dwordx4 v15, s[16:19], s5 offen  lds
v_mfma_f32_16x16x32_bf16 a[56:59], a[204:207], a[184:187], a[56:59]
ds_read_b64_tr_b16 a[194:195], v251 offset:4608
s_mov_b32 s74, 0x4000
v_mfma_f32_16x16x32_bf16 a[56:59], a[200:203], a[168:171], a[56:59]
s_mov_b32 s75, 0x8000
s_mov_b32 s82, 0xc000
v_mfma_f32_16x16x32_bf16 a[52:55], a[200:203], a[164:167], a[52:55]
ds_read_b64_tr_b16 a[196:197], v251 offset:28672
ds_read_b64_tr_b16 v[8:9], v253 offset:40960
v_mfma_f32_16x16x32_bf16 a[52:55], a[204:207], a[180:183], a[52:55]
ds_read_b64_tr_b16 v[10:11], v253 offset:41472
v_mfma_f32_16x16x32_bf16 a[48:51], a[204:207], a[176:179], a[48:51]
ds_read_b64_tr_b16 a[198:199], v251 offset:29184
v_mfma_f32_16x16x32_bf16 a[48:51], a[200:203], a[160:163], a[48:51]
s_waitcnt lgkmcnt(12)
v_mfma_f32_16x16x32_bf16 a[64:67], a[208:211], a[160:163], a[64:67]
ds_read_b64_tr_b16 a[200:201], v251 offset:4104
s_add_u32 m0, s6, 40960
v_mfma_f32_16x16x32_bf16 a[64:67], a[212:215], a[176:179], a[64:67]
buffer_load_dwordx4 v3, s[20:23], s5 offen  lds
v_mfma_f32_16x16x32_bf16 a[68:71], a[212:215], a[180:183], a[68:71]
ds_read_b64_tr_b16 a[202:203], v251 offset:4616
v_mfma_f32_16x16x32_bf16 a[68:71], a[208:211], a[164:167], a[68:71]
v_mfma_f32_16x16x32_bf16 a[72:75], a[208:211], a[168:171], a[72:75]
ds_read_b64_tr_b16 a[204:205], v251 offset:28680
s_waitcnt lgkmcnt(4)
v_smfmac_f32_16x16x64_bf16 a[230:233], a[250:253], v[4:11], v14
v_mfma_f32_16x16x32_bf16 a[72:75], a[212:215], a[184:187], a[72:75]
ds_read_b64_tr_b16 v[4:5], v253 offset:12288
ds_read_b64_tr_b16 v[6:7], v253 offset:12800
v_mfma_f32_16x16x32_bf16 a[76:79], a[212:215], a[188:191], a[76:79]
ds_read_b64_tr_b16 a[206:207], v251 offset:29192
ds_read_b64_tr_b16 v[8:9], v253 offset:36864
v_mfma_f32_16x16x32_bf16 a[76:79], a[208:211], a[172:175], a[76:79]
ds_read_b64_tr_b16 v[10:11], v253 offset:37376
v_mfma_f32_16x16x32_bf16 a[92:95], a[216:219], a[172:175], a[92:95]
ds_read_b64_tr_b16 a[208:209], v244 offset:8192
s_add_u32 m0, s6, 45056
v_mfma_f32_16x16x32_bf16 a[92:95], a[220:223], a[188:191], a[92:95]
buffer_load_dwordx4 v15, s[20:23], s5 offen  lds
v_mfma_f32_16x16x32_bf16 a[88:91], a[220:223], a[184:187], a[88:91]
ds_read_b64_tr_b16 a[210:211], v244 offset:8704
s_add_u32 s44, s44, 0x80000
v_mfma_f32_16x16x32_bf16 a[88:91], a[216:219], a[168:171], a[88:91]
s_add_u32 s4, s4, 0x80000
s_add_u32 s45, s45, 458752
v_mfma_f32_16x16x32_bf16 a[84:87], a[216:219], a[164:167], a[84:87]
ds_read_b64_tr_b16 a[212:213], v244 offset:32768
s_add_u32 s5, s5, 458752
v_mfma_f32_16x16x32_bf16 a[84:87], a[220:223], a[180:183], a[84:87]
s_add_u32 s6, s6, 49152
v_mfma_f32_16x16x32_bf16 a[80:83], a[220:223], a[176:179], a[80:83]
ds_read_b64_tr_b16 a[214:215], v244 offset:33280
s_waitcnt lgkmcnt(4)
v_smfmac_f32_16x16x64_bf16 a[232:235], a[250:253], v[4:11], v14
v_mfma_f32_16x16x32_bf16 a[80:83], a[216:219], a[160:163], a[80:83]
ds_read_b64_tr_b16 v[4:5], v253 offset:20480
v_mfma_f32_16x16x32_bf16 a[96:99], a[192:195], a[160:163], a[96:99]
ds_read_b64_tr_b16 a[216:217], v244 offset:16384
ds_read_b64_tr_b16 v[6:7], v253 offset:20992
v_mfma_f32_16x16x32_bf16 a[96:99], a[196:199], a[176:179], a[96:99]
buffer_load_dword a255, v255, s[28:31], s80 offen
v_mfma_f32_16x16x32_bf16 a[100:103], a[196:199], a[180:183], a[100:103]
ds_read_b64_tr_b16 a[218:219], v244 offset:16896
ds_read_b64_tr_b16 v[8:9], v253 offset:45056
v_mfma_f32_16x16x32_bf16 a[100:103], a[192:195], a[164:167], a[100:103]
s_cmp_eq_u32 s6, s7
s_cselect_b32 s6, s46, s6
v_mfma_f32_16x16x32_bf16 a[104:107], a[192:195], a[168:171], a[104:107]
ds_read_b64_tr_b16 a[220:221], v244 offset:40960
s_add_u32 s80, s80, s81
v_mfma_f32_16x16x32_bf16 a[104:107], a[196:199], a[184:187], a[104:107]
ds_read_b64_tr_b16 v[10:11], v253 offset:45568
v_mfma_f32_16x16x32_bf16 a[108:111], a[196:199], a[188:191], a[108:111]
ds_read_b64_tr_b16 a[222:223], v244 offset:41472
v_mfma_f32_16x16x32_bf16 a[108:111], a[192:195], a[172:175], a[108:111]
v_mfma_f32_16x16x32_bf16 a[124:127], a[200:203], a[172:175], a[124:127]
ds_read_b64_tr_b16 a[192:193], v245 offset:8192
v_mfma_f32_16x16x32_bf16 a[124:127], a[204:207], a[188:191], a[124:127]
v_mfma_f32_16x16x32_bf16 a[120:123], a[204:207], a[184:187], a[120:123]
ds_read_b64_tr_b16 a[194:195], v245 offset:8704
v_mfma_f32_16x16x32_bf16 a[120:123], a[200:203], a[168:171], a[120:123]
v_mfma_f32_16x16x32_bf16 a[116:119], a[200:203], a[164:167], a[116:119]
ds_read_b64_tr_b16 a[196:197], v245 offset:32768
s_waitcnt lgkmcnt(4)
v_smfmac_f32_16x16x64_bf16 a[234:237], a[250:253], v[4:11], v14
v_mfma_f32_16x16x32_bf16 a[116:119], a[204:207], a[180:183], a[116:119]
s_lshl_b32 s98, s40, 8
s_add_u32 s98, s98, 148480
v_lshl_add_u32 v253, v0, 2, s98
v_mfma_f32_16x16x32_bf16 a[112:115], a[204:207], a[176:179], a[112:115]
ds_read_b64_tr_b16 a[198:199], v245 offset:33280
v_accvgpr_read_b32 v4, a224
v_mfma_f32_16x16x32_bf16 a[112:115], a[200:203], a[160:163], a[112:115]
v_accvgpr_read_b32 v5, a225
v_mfma_f32_16x16x32_bf16 v[16:19], a[208:211], a[160:163], v[16:19]
ds_read_b64_tr_b16 a[200:201], v245 offset:16384
s_waitcnt vmcnt(4)
v_cmp_eq_u32 vcc, 0, v1
v_mfma_f32_16x16x32_bf16 v[16:19], a[212:215], a[176:179], v[16:19]
s_cbranch_vccnz L_main_kernel_xb
L_main_kernel_xd:
v_lshl_add_u32 v1, v0, 4, s57
v_mfma_f32_16x16x32_bf16 v[20:23], a[212:215], a[180:183], v[20:23]
ds_read_b64_tr_b16 a[202:203], v245 offset:16896
v_add_f32 v4, v4, v5
v_mfma_f32_16x16x32_bf16 v[20:23], a[208:211], a[164:167], v[20:23]
v_cvt_pk_bf16_f32 v5, 0, v4
v_sub_f32 v5, v4, v5
v_mfma_f32_16x16x32_bf16 v[24:27], a[208:211], a[168:171], v[24:27]
ds_read_b64_tr_b16 a[204:205], v245 offset:40960
v_cvt_pk_bf16_f32 v4, v4, v5
v_mfma_f32_16x16x32_bf16 v[24:27], a[212:215], a[184:187], v[24:27]
ds_write_b32 v253, v4 offset:0
v_accvgpr_read_b32 v6, a226
v_mfma_f32_16x16x32_bf16 v[28:31], a[212:215], a[188:191], v[28:31]
ds_read_b64_tr_b16 a[206:207], v245 offset:41472
v_accvgpr_read_b32 v7, a227
v_mfma_f32_16x16x32_bf16 v[28:31], a[208:211], a[172:175], v[28:31]
v_add_f32 v6, v6, v7
s_waitcnt lgkmcnt(9)
v_mfma_f32_16x16x32_bf16 v[44:47], a[216:219], a[172:175], v[44:47]
ds_read_b64_tr_b16 a[208:209], v246 offset:8192
v_cvt_pk_bf16_f32 v7, 0, v6
v_mfma_f32_16x16x32_bf16 v[44:47], a[220:223], a[188:191], v[44:47]
buffer_load_dwordx4 a[128:131], v1, s[8:11], s43 offen offset:0
v_mfma_f32_16x16x32_bf16 v[40:43], a[220:223], a[184:187], v[40:43]
ds_read_b64_tr_b16 a[210:211], v246 offset:8704
v_sub_f32 v7, v6, v7
v_mfma_f32_16x16x32_bf16 v[40:43], a[216:219], a[168:171], v[40:43]
v_cvt_pk_bf16_f32 v6, v6, v7
ds_write_b32 v253, v6 offset:1024
v_mfma_f32_16x16x32_bf16 v[36:39], a[216:219], a[164:167], v[36:39]
ds_read_b64_tr_b16 a[212:213], v246 offset:32768
v_accvgpr_read_b32 v8, a228
v_mfma_f32_16x16x32_bf16 v[36:39], a[220:223], a[180:183], v[36:39]
buffer_load_dwordx4 a[132:135], v1, s[8:11], s43 offen offset:1024
v_mfma_f32_16x16x32_bf16 v[32:35], a[220:223], a[176:179], v[32:35]
ds_read_b64_tr_b16 a[214:215], v246 offset:33280
v_accvgpr_read_b32 v9, a229
v_mfma_f32_16x16x32_bf16 v[32:35], a[216:219], a[160:163], v[32:35]
v_add_f32 v8, v8, v9
s_waitcnt lgkmcnt(10)
v_mfma_f32_16x16x32_bf16 v[48:51], a[192:195], a[160:163], v[48:51]
ds_read_b64_tr_b16 a[216:217], v246 offset:16384
v_cvt_pk_bf16_f32 v9, 0, v8
v_mfma_f32_16x16x32_bf16 v[48:51], a[196:199], a[176:179], v[48:51]
buffer_load_dwordx4 a[136:139], v1, s[8:11], s43 offen offset:2048
v_mfma_f32_16x16x32_bf16 v[52:55], a[196:199], a[180:183], v[52:55]
ds_read_b64_tr_b16 a[218:219], v246 offset:16896
v_sub_f32 v9, v8, v9
v_mfma_f32_16x16x32_bf16 v[52:55], a[192:195], a[164:167], v[52:55]
v_cvt_pk_bf16_f32 v8, v8, v9
ds_write_b32 v253, v8 offset:2048
v_mfma_f32_16x16x32_bf16 v[56:59], a[192:195], a[168:171], v[56:59]
ds_read_b64_tr_b16 a[220:221], v246 offset:40960
v_accvgpr_read_b32 v10, a230
v_mfma_f32_16x16x32_bf16 v[56:59], a[196:199], a[184:187], v[56:59]
buffer_load_dwordx4 a[140:143], v1, s[8:11], s43 offen offset:3072
v_mfma_f32_16x16x32_bf16 v[60:63], a[196:199], a[188:191], v[60:63]
ds_read_b64_tr_b16 a[222:223], v246 offset:41472
v_accvgpr_read_b32 v11, a231
v_mfma_f32_16x16x32_bf16 v[60:63], a[192:195], a[172:175], v[60:63]
v_add_f32 v10, v10, v11
s_waitcnt lgkmcnt(10)
v_mfma_f32_16x16x32_bf16 v[76:79], a[200:203], a[172:175], v[76:79]
ds_read_b64_tr_b16 a[192:193], v247 offset:8192
v_cvt_pk_bf16_f32 v11, 0, v10
v_mfma_f32_16x16x32_bf16 v[76:79], a[204:207], a[188:191], v[76:79]
buffer_load_dwordx4 a[144:147], v1, s[8:11], s3 offen offset:0
v_mfma_f32_16x16x32_bf16 v[72:75], a[204:207], a[184:187], v[72:75]
ds_read_b64_tr_b16 a[194:195], v247 offset:8704
v_sub_f32 v11, v10, v11
v_mfma_f32_16x16x32_bf16 v[72:75], a[200:203], a[168:171], v[72:75]
v_cvt_pk_bf16_f32 v10, v10, v11
ds_write_b32 v253, v10 offset:3072
v_mfma_f32_16x16x32_bf16 v[68:71], a[200:203], a[164:167], v[68:71]
ds_read_b64_tr_b16 a[196:197], v247 offset:32768
v_accvgpr_read_b32 v4, a232
v_mfma_f32_16x16x32_bf16 v[68:71], a[204:207], a[180:183], v[68:71]
buffer_load_dwordx4 a[148:151], v1, s[8:11], s3 offen offset:1024
v_mfma_f32_16x16x32_bf16 v[64:67], a[204:207], a[176:179], v[64:67]
ds_read_b64_tr_b16 a[198:199], v247 offset:33280
v_accvgpr_read_b32 v5, a233
v_mfma_f32_16x16x32_bf16 v[64:67], a[200:203], a[160:163], v[64:67]
v_add_f32 v4, v4, v5
s_waitcnt lgkmcnt(10)
v_mfma_f32_16x16x32_bf16 v[80:83], a[208:211], a[160:163], v[80:83]
ds_read_b64_tr_b16 a[200:201], v247 offset:16384
v_cvt_pk_bf16_f32 v5, 0, v4
v_mfma_f32_16x16x32_bf16 v[80:83], a[212:215], a[176:179], v[80:83]
buffer_load_dwordx4 a[152:155], v1, s[8:11], s3 offen offset:2048
v_mfma_f32_16x16x32_bf16 v[84:87], a[212:215], a[180:183], v[84:87]
ds_read_b64_tr_b16 a[202:203], v247 offset:16896
v_sub_f32 v5, v4, v5
v_mfma_f32_16x16x32_bf16 v[84:87], a[208:211], a[164:167], v[84:87]
v_cvt_pk_bf16_f32 v4, v4, v5
ds_write_b32 v253, v4 offset:4096
v_mfma_f32_16x16x32_bf16 v[88:91], a[208:211], a[168:171], v[88:91]
ds_read_b64_tr_b16 a[204:205], v247 offset:40960
v_accvgpr_read_b32 v6, a234
v_mfma_f32_16x16x32_bf16 v[88:91], a[212:215], a[184:187], v[88:91]
buffer_load_dwordx4 a[156:159], v1, s[8:11], s3 offen offset:3072
v_mfma_f32_16x16x32_bf16 v[92:95], a[212:215], a[188:191], v[92:95]
ds_read_b64_tr_b16 a[206:207], v247 offset:41472
s_add_u32 s43, s43, 0x8000
v_mfma_f32_16x16x32_bf16 v[92:95], a[208:211], a[172:175], v[92:95]
s_add_u32 s3, s3, 0x8000
s_waitcnt lgkmcnt(10)
v_mfma_f32_16x16x32_bf16 v[108:111], a[216:219], a[172:175], v[108:111]
ds_read_b64_tr_b16 a[208:209], v244 offset:12288
s_add_u32 m0, s6, 0
v_mfma_f32_16x16x32_bf16 v[108:111], a[220:223], a[188:191], v[108:111]
buffer_load_dwordx4 v2, s[12:15], s44 offen offset:0  lds
v_mfma_f32_16x16x32_bf16 v[104:107], a[220:223], a[184:187], v[104:107]
ds_read_b64_tr_b16 a[210:211], v244 offset:12800
v_accvgpr_read_b32 v7, a235
v_mfma_f32_16x16x32_bf16 v[104:107], a[216:219], a[168:171], v[104:107]
v_add_f32 v6, v6, v7
v_cvt_pk_bf16_f32 v7, 0, v6
v_mfma_f32_16x16x32_bf16 v[100:103], a[216:219], a[164:167], v[100:103]
ds_read_b64_tr_b16 a[212:213], v244 offset:36864
s_add_u32 m0, s6, 3968
v_mfma_f32_16x16x32_bf16 v[100:103], a[220:223], a[180:183], v[100:103]
buffer_load_dwordx4 v2, s[12:15], s44 offen offset:128  lds
v_mfma_f32_16x16x32_bf16 v[96:99], a[220:223], a[176:179], v[96:99]
ds_read_b64_tr_b16 a[214:215], v244 offset:37376
v_sub_f32 v7, v6, v7
v_mfma_f32_16x16x32_bf16 v[96:99], a[216:219], a[160:163], v[96:99]
v_cvt_pk_bf16_f32 v6, v6, v7
s_waitcnt lgkmcnt(9)
v_mfma_f32_16x16x32_bf16 v[112:115], a[192:195], a[160:163], v[112:115]
ds_read_b64_tr_b16 a[216:217], v244 offset:20480
s_add_u32 m0, s6, 8192
v_mfma_f32_16x16x32_bf16 v[112:115], a[196:199], a[176:179], v[112:115]
buffer_load_dwordx4 v3, s[16:19], s45 offen  lds
v_mfma_f32_16x16x32_bf16 v[116:119], a[196:199], a[180:183], v[116:119]
ds_read_b64_tr_b16 a[218:219], v244 offset:20992
ds_write_b32 v253, v6 offset:5120
v_mfma_f32_16x16x32_bf16 v[116:119], a[192:195], a[164:167], v[116:119]
v_accvgpr_read_b32 v6, a241
v_accvgpr_read_b32 v10, a239
v_mfma_f32_16x16x32_bf16 v[120:123], a[192:195], a[168:171], v[120:123]
ds_read_b64_tr_b16 a[220:221], v244 offset:45056
s_add_u32 m0, s6, 12288
v_mfma_f32_16x16x32_bf16 v[120:123], a[196:199], a[184:187], v[120:123]
buffer_load_dwordx4 v15, s[16:19], s45 offen  lds
v_mfma_f32_16x16x32_bf16 v[124:127], a[196:199], a[188:191], v[124:127]
ds_read_b64_tr_b16 a[222:223], v244 offset:45568
v_accvgpr_read_b32 v5, a238
v_mfma_f32_16x16x32_bf16 v[124:127], a[192:195], a[172:175], v[124:127]
v_xor_b32 v7, 64, v6
s_waitcnt lgkmcnt(9)
v_mfma_f32_16x16x32_bf16 v[140:143], a[200:203], a[172:175], v[140:143]
ds_read_b64_tr_b16 a[192:193], v245 offset:12288
s_add_u32 m0, s6, 16384
v_mfma_f32_16x16x32_bf16 v[140:143], a[204:207], a[188:191], v[140:143]
buffer_load_dwordx4 v3, s[20:23], s45 offen  lds
v_mfma_f32_16x16x32_bf16 v[136:139], a[204:207], a[184:187], v[136:139]
ds_read_b64_tr_b16 a[194:195], v245 offset:12800
v_xor_b32 v8, 128, v6
v_mfma_f32_16x16x32_bf16 v[136:139], a[200:203], a[168:171], v[136:139]
v_xor_b32 v9, 192, v6
v_xor_b32 v11, 128, v10
v_mfma_f32_16x16x32_bf16 v[132:135], a[200:203], a[164:167], v[132:135]
ds_read_b64_tr_b16 a[196:197], v245 offset:36864
s_add_u32 m0, s6, 20480
v_mfma_f32_16x16x32_bf16 v[132:135], a[204:207], a[180:183], v[132:135]
buffer_load_dwordx4 v15, s[20:23], s45 offen  lds
v_mfma_f32_16x16x32_bf16 v[128:131], a[204:207], a[176:179], v[128:131]
ds_read_b64_tr_b16 a[198:199], v245 offset:37376
v_accvgpr_write_b32 a224, 0
v_mfma_f32_16x16x32_bf16 v[128:131], a[200:203], a[160:163], v[128:131]
v_accvgpr_write_b32 a225, 0
s_waitcnt lgkmcnt(9)
v_mfma_f32_16x16x32_bf16 v[144:147], a[208:211], a[160:163], v[144:147]
ds_read_b64_tr_b16 a[200:201], v245 offset:20480
s_add_u32 m0, s6, 24576
v_mfma_f32_16x16x32_bf16 v[144:147], a[212:215], a[176:179], v[144:147]
buffer_load_dwordx4 v2, s[12:15], s4 offen offset:0  lds
v_mfma_f32_16x16x32_bf16 v[148:151], a[212:215], a[180:183], v[148:151]
ds_read_b64_tr_b16 a[202:203], v245 offset:20992
v_accvgpr_write_b32 a228, 0
v_mfma_f32_16x16x32_bf16 v[148:151], a[208:211], a[164:167], v[148:151]
v_accvgpr_write_b32 a229, 0
v_accvgpr_write_b32 a232, 0
v_mfma_f32_16x16x32_bf16 v[152:155], a[208:211], a[168:171], v[152:155]
ds_read_b64_tr_b16 a[204:205], v245 offset:45056
s_add_u32 m0, s6, 28544
v_mfma_f32_16x16x32_bf16 v[152:155], a[212:215], a[184:187], v[152:155]
buffer_load_dwordx4 v2, s[12:15], s4 offen offset:128  lds
v_mfma_f32_16x16x32_bf16 v[156:159], a[212:215], a[188:191], v[156:159]
ds_read_b64_tr_b16 a[206:207], v245 offset:45568
v_accvgpr_write_b32 a233, 0
v_mfma_f32_16x16x32_bf16 v[156:159], a[208:211], a[172:175], v[156:159]
v_accvgpr_write_b32 a236, 0
s_waitcnt lgkmcnt(8)
v_mfma_f32_16x16x32_bf16 v[172:175], a[216:219], a[172:175], v[172:175]
ds_read_b64_tr_b16 a[208:209], v246 offset:12288
s_add_u32 m0, s6, 32768
v_mfma_f32_16x16x32_bf16 v[172:175], a[220:223], a[188:191], v[172:175]
buffer_load_dwordx4 v3, s[16:19], s5 offen  lds
v_mfma_f32_16x16x32_bf16 v[168:171], a[220:223], a[184:187], v[168:171]
ds_read_b64_tr_b16 a[210:211], v246 offset:12800
v_accvgpr_write_b32 a237, 0
v_mfma_f32_16x16x32_bf16 v[168:171], a[216:219], a[168:171], v[168:171]
v_accvgpr_write_b32 a239, 0
v_accvgpr_write_b32 a242, 0
v_mfma_f32_16x16x32_bf16 v[164:167], a[216:219], a[164:167], v[164:167]
ds_read_b64_tr_b16 a[212:213], v246 offset:36864
s_add_u32 m0, s6, 36864
v_mfma_f32_16x16x32_bf16 v[164:167], a[220:223], a[180:183], v[164:167]
buffer_load_dwordx4 v15, s[16:19], s5 offen  lds
v_mfma_f32_16x16x32_bf16 v[160:163], a[220:223], a[176:179], v[160:163]
ds_read_b64_tr_b16 a[214:215], v246 offset:37376
v_lshrrev_b32 v4, 4, v0
v_mfma_f32_16x16x32_bf16 v[160:163], a[216:219], a[160:163], v[160:163]
v_lshlrev_b32 v253, 2, v0
s_waitcnt lgkmcnt(8)
v_mfma_f32_16x16x32_bf16 v[176:179], a[192:195], a[160:163], v[176:179]
ds_read_b64_tr_b16 a[216:217], v246 offset:20480
v_lshl_add_u32 v253, v4, 8, v253
v_mfma_f32_16x16x32_bf16 v[176:179], a[196:199], a[176:179], v[176:179]
ds_read_b64_tr_b16 a[218:219], v246 offset:20992
v_add_u32 v253, 148480, v253
v_mfma_f32_16x16x32_bf16 v[180:183], a[196:199], a[180:183], v[180:183]
ds_read_b64_tr_b16 a[220:221], v246 offset:45056
v_mfma_f32_16x16x32_bf16 v[180:183], a[192:195], a[164:167], v[180:183]
ds_read_b64_tr_b16 a[222:223], v246 offset:45568
v_mfma_f32_16x16x32_bf16 v[184:187], a[192:195], a[168:171], v[184:187]
s_add_u32 m0, s6, 40960
v_mfma_f32_16x16x32_bf16 v[184:187], a[196:199], a[184:187], v[184:187]
buffer_load_dwordx4 v3, s[20:23], s5 offen  lds
v_mfma_f32_16x16x32_bf16 v[188:191], a[196:199], a[188:191], v[188:191]
s_lshl_b32 s98, s42, 12
s_add_u32 s98, s98, s46
v_lshl_add_u32 v14, v0, 4, s98
v_mfma_f32_16x16x32_bf16 v[188:191], a[192:195], a[172:175], v[188:191]
v_add_u32 v14, 262144, v14
s_waitcnt vmcnt(20) lgkmcnt(0)
s_barrier
v_mfma_f32_16x16x32_bf16 v[204:207], a[200:203], a[172:175], v[204:207]
ds_read_b64_tr_b16 a[192:193], v248 offset:0
s_add_u32 m0, s6, 45056
v_mfma_f32_16x16x32_bf16 v[204:207], a[204:207], a[188:191], v[204:207]
buffer_load_dwordx4 v15, s[20:23], s5 offen  lds
v_mfma_f32_16x16x32_bf16 v[200:203], a[204:207], a[184:187], v[200:203]
ds_read_b64_tr_b16 a[194:195], v248 offset:512
s_add_u32 s44, s44, 0x80000
v_mfma_f32_16x16x32_bf16 v[200:203], a[200:203], a[168:171], v[200:203]
s_add_u32 s4, s4, 0x80000
s_add_u32 s45, s45, 458752
v_mfma_f32_16x16x32_bf16 v[196:199], a[200:203], a[164:167], v[196:199]
ds_read_b64_tr_b16 a[196:197], v248 offset:24576
s_add_u32 s5, s5, 458752
v_mfma_f32_16x16x32_bf16 v[196:199], a[204:207], a[180:183], v[196:199]
s_add_u32 s6, s6, 49152
v_subrev_u32 v244, 49152, v244
v_mfma_f32_16x16x32_bf16 v[192:195], a[204:207], a[176:179], v[192:195]
ds_read_b64_tr_b16 a[198:199], v248 offset:25088
v_subrev_u32 v245, 49152, v245
v_mfma_f32_16x16x32_bf16 v[192:195], a[200:203], a[160:163], v[192:195]
v_mfma_f32_16x16x32_bf16 v[208:211], a[208:211], a[160:163], v[208:211]
ds_read_b64_tr_b16 a[200:201], v248 offset:8
v_subrev_u32 v246, 49152, v246
v_mfma_f32_16x16x32_bf16 v[208:211], a[212:215], a[176:179], v[208:211]
s_cmp_eq_u32 s6, s7
s_cselect_b32 s6, s46, s6
v_mfma_f32_16x16x32_bf16 v[212:215], a[212:215], a[180:183], v[212:215]
ds_read_b64_tr_b16 a[202:203], v248 offset:520
v_subrev_u32 v247, 49152, v247
v_mfma_f32_16x16x32_bf16 v[212:215], a[208:211], a[164:167], v[212:215]
v_subrev_u32 v250, 49152, v250
v_subrev_u32 v251, 49152, v251
v_mfma_f32_16x16x32_bf16 v[216:219], a[208:211], a[168:171], v[216:219]
ds_read_b64_tr_b16 a[204:205], v248 offset:24584
v_mfma_f32_16x16x32_bf16 v[216:219], a[212:215], a[184:187], v[216:219]
buffer_load_dwordx3 a[250:252], v14, s[84:87], 0 offen offset:4
v_mfma_f32_16x16x32_bf16 v[220:223], a[212:215], a[188:191], v[220:223]
ds_read_b64_tr_b16 a[206:207], v248 offset:25096
v_mfma_f32_16x16x32_bf16 v[220:223], a[208:211], a[172:175], v[220:223]
v_mfma_f32_16x16x32_bf16 v[236:239], a[216:219], a[172:175], v[236:239]
ds_read_b64_tr_b16 a[208:209], v249 offset:0
v_mfma_f32_16x16x32_bf16 v[236:239], a[220:223], a[188:191], v[236:239]
buffer_load_dword a238, v14, s[84:87], 0 offen
v_mfma_f32_16x16x32_bf16 v[232:235], a[220:223], a[184:187], v[232:235]
ds_read_b64_tr_b16 a[210:211], v249 offset:512
ds_read2st64_b32 a[226:227], v253 offset0:0 offset1:4
v_mfma_f32_16x16x32_bf16 v[232:235], a[216:219], a[168:171], v[232:235]
buffer_load_dword a243, v14, s[84:87], 0 offen
v_mfma_f32_16x16x32_bf16 v[228:231], a[216:219], a[164:167], v[228:231]
ds_read_b64_tr_b16 a[212:213], v249 offset:24576
ds_read2st64_b32 a[230:231], v253 offset0:8 offset1:12
v_mfma_f32_16x16x32_bf16 v[228:231], a[220:223], a[180:183], v[228:231]
ds_read2st64_b32 a[234:235], v253 offset0:16 offset1:20
v_mfma_f32_16x16x32_bf16 v[224:227], a[220:223], a[176:179], v[224:227]
ds_read_b64_tr_b16 a[214:215], v249 offset:25088
v_mfma_f32_16x16x32_bf16 v[224:227], a[216:219], a[160:163], v[224:227]
s_waitcnt vmcnt(15)
.p2align 6
L_main_kernel_g:
s_waitcnt vmcnt(13) lgkmcnt(8)
v_mfma_f32_16x16x32_bf16 a[0:3], a[192:195], a[128:131], a[0:3]
ds_read_b64_tr_b16 a[216:217], v249 offset:8
v_mfma_f32_16x16x32_bf16 a[0:3], a[196:199], a[144:147], a[0:3]
buffer_load_dwordx4 a[160:163], v1, s[8:11], s43 offen offset:0
v_mfma_f32_16x16x32_bf16 a[4:7], a[196:199], a[148:151], a[4:7]
ds_read_b64_tr_b16 a[218:219], v249 offset:520
v_mfma_f32_16x16x32_bf16 a[4:7], a[192:195], a[132:135], a[4:7]
v_mfma_f32_16x16x32_bf16 a[8:11], a[192:195], a[136:139], a[8:11]
ds_read_b64_tr_b16 a[220:221], v249 offset:24584
v_mfma_f32_16x16x32_bf16 a[8:11], a[196:199], a[152:155], a[8:11]
buffer_load_dwordx4 a[164:167], v1, s[8:11], s43 offen offset:1024
v_mfma_f32_16x16x32_bf16 a[12:15], a[196:199], a[156:159], a[12:15]
ds_read_b64_tr_b16 a[222:223], v249 offset:25096
v_mfma_f32_16x16x32_bf16 a[12:15], a[192:195], a[140:143], a[12:15]
s_waitcnt lgkmcnt(8)
v_mfma_f32_16x16x32_bf16 a[28:31], a[200:203], a[140:143], a[28:31]
ds_read_b64_tr_b16 a[192:193], v248 offset:4096
v_mfma_f32_16x16x32_bf16 a[28:31], a[204:207], a[156:159], a[28:31]
buffer_load_dwordx4 a[168:171], v1, s[8:11], s43 offen offset:2048
v_mfma_f32_16x16x32_bf16 a[24:27], a[204:207], a[152:155], a[24:27]
ds_read_b64_tr_b16 a[194:195], v248 offset:4608
v_mfma_f32_16x16x32_bf16 a[24:27], a[200:203], a[136:139], a[24:27]
v_mfma_f32_16x16x32_bf16 a[20:23], a[200:203], a[132:135], a[20:23]
ds_read_b64_tr_b16 a[196:197], v248 offset:28672
v_mfma_f32_16x16x32_bf16 a[20:23], a[204:207], a[148:151], a[20:23]
buffer_load_dwordx4 a[172:175], v1, s[8:11], s43 offen offset:3072
v_mfma_f32_16x16x32_bf16 a[16:19], a[204:207], a[144:147], a[16:19]
ds_read_b64_tr_b16 a[198:199], v248 offset:29184
v_mfma_f32_16x16x32_bf16 a[16:19], a[200:203], a[128:131], a[16:19]
s_waitcnt lgkmcnt(8)
v_mfma_f32_16x16x32_bf16 a[32:35], a[208:211], a[128:131], a[32:35]
ds_read_b64_tr_b16 a[200:201], v248 offset:4104
v_mfma_f32_16x16x32_bf16 a[32:35], a[212:215], a[144:147], a[32:35]
buffer_load_dwordx4 a[176:179], v1, s[8:11], s3 offen offset:0
v_mfma_f32_16x16x32_bf16 a[36:39], a[212:215], a[148:151], a[36:39]
ds_read_b64_tr_b16 a[202:203], v248 offset:4616
v_mfma_f32_16x16x32_bf16 a[36:39], a[208:211], a[132:135], a[36:39]
v_mfma_f32_16x16x32_bf16 a[40:43], a[208:211], a[136:139], a[40:43]
ds_read_b64_tr_b16 a[204:205], v248 offset:28680
v_mfma_f32_16x16x32_bf16 a[40:43], a[212:215], a[152:155], a[40:43]
buffer_load_dwordx4 a[180:183], v1, s[8:11], s3 offen offset:1024
v_mfma_f32_16x16x32_bf16 a[44:47], a[212:215], a[156:159], a[44:47]
ds_read_b64_tr_b16 a[206:207], v248 offset:29192
v_mfma_f32_16x16x32_bf16 a[44:47], a[208:211], a[140:143], a[44:47]
s_waitcnt lgkmcnt(8)
v_mfma_f32_16x16x32_bf16 a[60:63], a[216:219], a[140:143], a[60:63]
ds_read_b64_tr_b16 a[208:209], v249 offset:4096
v_mfma_f32_16x16x32_bf16 a[60:63], a[220:223], a[156:159], a[60:63]
buffer_load_dwordx4 a[184:187], v1, s[8:11], s3 offen offset:2048
v_mfma_f32_16x16x32_bf16 a[56:59], a[220:223], a[152:155], a[56:59]
ds_read_b64_tr_b16 a[210:211], v249 offset:4608
v_mfma_f32_16x16x32_bf16 a[56:59], a[216:219], a[136:139], a[56:59]
v_mfma_f32_16x16x32_bf16 a[52:55], a[216:219], a[132:135], a[52:55]
ds_read_b64_tr_b16 a[212:213], v249 offset:28672
v_mfma_f32_16x16x32_bf16 a[52:55], a[220:223], a[148:151], a[52:55]
buffer_load_dwordx4 a[188:191], v1, s[8:11], s3 offen offset:3072
v_mfma_f32_16x16x32_bf16 a[48:51], a[220:223], a[144:147], a[48:51]
ds_read_b64_tr_b16 a[214:215], v249 offset:29184
v_mfma_f32_16x16x32_bf16 a[48:51], a[216:219], a[128:131], a[48:51]
s_waitcnt lgkmcnt(8)
v_mfma_f32_16x16x32_bf16 a[64:67], a[192:195], a[128:131], a[64:67]
ds_read_b64_tr_b16 a[216:217], v249 offset:4104
s_add_u32 s43, s43, 0x8000
v_mfma_f32_16x16x32_bf16 a[64:67], a[196:199], a[144:147], a[64:67]
buffer_load_dword a255, v254, s[92:95], s80 offen
v_mfma_f32_16x16x32_bf16 a[68:71], a[196:199], a[148:151], a[68:71]
ds_read_b64_tr_b16 a[218:219], v249 offset:4616
s_add_u32 s3, s3, 0x8000
v_mfma_f32_16x16x32_bf16 a[68:71], a[192:195], a[132:135], a[68:71]
v_mfma_f32_16x16x32_bf16 a[72:75], a[192:195], a[136:139], a[72:75]
ds_read_b64_tr_b16 a[220:221], v249 offset:28680
v_mfma_f32_16x16x32_bf16 a[72:75], a[196:199], a[152:155], a[72:75]
v_mfma_f32_16x16x32_bf16 a[76:79], a[196:199], a[156:159], a[76:79]
ds_read_b64_tr_b16 a[222:223], v249 offset:29192
v_mfma_f32_16x16x32_bf16 a[76:79], a[192:195], a[140:143], a[76:79]
s_waitcnt lgkmcnt(8)
v_mfma_f32_16x16x32_bf16 a[92:95], a[200:203], a[140:143], a[92:95]
ds_read_b64_tr_b16 a[192:193], v240 offset:8192
s_add_u32 m0, s6, 0
v_mfma_f32_16x16x32_bf16 a[92:95], a[204:207], a[156:159], a[92:95]
buffer_load_dwordx4 v2, s[12:15], s44 offen offset:0  lds
v_mfma_f32_16x16x32_bf16 a[88:91], a[204:207], a[152:155], a[88:91]
ds_read_b64_tr_b16 a[194:195], v240 offset:8704
v_mfma_f32_16x16x32_bf16 a[88:91], a[200:203], a[136:139], a[88:91]
v_mfma_f32_16x16x32_bf16 a[84:87], a[200:203], a[132:135], a[84:87]
ds_read_b64_tr_b16 a[196:197], v240 offset:32768
v_mfma_f32_16x16x32_bf16 a[84:87], a[204:207], a[148:151], a[84:87]
v_mfma_f32_16x16x32_bf16 a[80:83], a[204:207], a[144:147], a[80:83]
ds_read_b64_tr_b16 a[198:199], v240 offset:33280
v_mfma_f32_16x16x32_bf16 a[80:83], a[200:203], a[128:131], a[80:83]
s_waitcnt lgkmcnt(8)
v_mfma_f32_16x16x32_bf16 a[96:99], a[208:211], a[128:131], a[96:99]
ds_read_b64_tr_b16 a[200:201], v240 offset:16384
s_add_u32 m0, s6, 3968
v_mfma_f32_16x16x32_bf16 a[96:99], a[212:215], a[144:147], a[96:99]
buffer_load_dwordx4 v2, s[12:15], s44 offen offset:128  lds
v_mfma_f32_16x16x32_bf16 a[100:103], a[212:215], a[148:151], a[100:103]
ds_read_b64_tr_b16 a[202:203], v240 offset:16896
v_mfma_f32_16x16x32_bf16 a[100:103], a[208:211], a[132:135], a[100:103]
v_mfma_f32_16x16x32_bf16 a[104:107], a[208:211], a[136:139], a[104:107]
ds_read_b64_tr_b16 a[204:205], v240 offset:40960
v_mfma_f32_16x16x32_bf16 a[104:107], a[212:215], a[152:155], a[104:107]
v_mfma_f32_16x16x32_bf16 a[108:111], a[212:215], a[156:159], a[108:111]
ds_read_b64_tr_b16 a[206:207], v240 offset:41472
v_mfma_f32_16x16x32_bf16 a[108:111], a[208:211], a[140:143], a[108:111]
s_waitcnt lgkmcnt(8)
v_mfma_f32_16x16x32_bf16 a[124:127], a[216:219], a[140:143], a[124:127]
ds_read_b64_tr_b16 a[208:209], v241 offset:8192
s_add_u32 m0, s6, 8192
v_mfma_f32_16x16x32_bf16 a[124:127], a[220:223], a[156:159], a[124:127]
buffer_load_dwordx4 v3, s[16:19], s45 offen  lds
v_mfma_f32_16x16x32_bf16 a[120:123], a[220:223], a[152:155], a[120:123]
ds_read_b64_tr_b16 a[210:211], v241 offset:8704
v_mfma_f32_16x16x32_bf16 a[120:123], a[216:219], a[136:139], a[120:123]
v_mfma_f32_16x16x32_bf16 a[116:119], a[216:219], a[132:135], a[116:119]
ds_read_b64_tr_b16 a[212:213], v241 offset:32768
v_mfma_f32_16x16x32_bf16 a[116:119], a[220:223], a[148:151], a[116:119]
v_mfma_f32_16x16x32_bf16 a[112:115], a[220:223], a[144:147], a[112:115]
ds_read_b64_tr_b16 a[214:215], v241 offset:33280
v_mfma_f32_16x16x32_bf16 a[112:115], a[216:219], a[128:131], a[112:115]
s_waitcnt lgkmcnt(8)
v_mfma_f32_16x16x32_bf16 v[16:19], a[192:195], a[128:131], v[16:19]
ds_read_b64_tr_b16 a[216:217], v241 offset:16384
s_add_u32 m0, s6, 12288
v_mfma_f32_16x16x32_bf16 v[16:19], a[196:199], a[144:147], v[16:19]
buffer_load_dwordx4 v15, s[16:19], s45 offen  lds
v_mfma_f32_16x16x32_bf16 v[20:23], a[196:199], a[148:151], v[20:23]
ds_read_b64_tr_b16 a[218:219], v241 offset:16896
v_mfma_f32_16x16x32_bf16 v[20:23], a[192:195], a[132:135], v[20:23]
v_mfma_f32_16x16x32_bf16 v[24:27], a[192:195], a[136:139], v[24:27]
ds_read_b64_tr_b16 a[220:221], v241 offset:40960
v_mfma_f32_16x16x32_bf16 v[24:27], a[196:199], a[152:155], v[24:27]
v_mfma_f32_16x16x32_bf16 v[28:31], a[196:199], a[156:159], v[28:31]
ds_read_b64_tr_b16 a[222:223], v241 offset:41472
v_mfma_f32_16x16x32_bf16 v[28:31], a[192:195], a[140:143], v[28:31]
s_waitcnt lgkmcnt(8)
v_mfma_f32_16x16x32_bf16 v[44:47], a[200:203], a[140:143], v[44:47]
ds_read_b64_tr_b16 a[192:193], v242 offset:8192
s_add_u32 m0, s6, 16384
v_mfma_f32_16x16x32_bf16 v[44:47], a[204:207], a[156:159], v[44:47]
buffer_load_dwordx4 v3, s[20:23], s45 offen  lds
v_mfma_f32_16x16x32_bf16 v[40:43], a[204:207], a[152:155], v[40:43]
ds_read_b64_tr_b16 a[194:195], v242 offset:8704
v_mfma_f32_16x16x32_bf16 v[40:43], a[200:203], a[136:139], v[40:43]
v_mfma_f32_16x16x32_bf16 v[36:39], a[200:203], a[132:135], v[36:39]
ds_read_b64_tr_b16 a[196:197], v242 offset:32768
v_mfma_f32_16x16x32_bf16 v[36:39], a[204:207], a[148:151], v[36:39]
v_mfma_f32_16x16x32_bf16 v[32:35], a[204:207], a[144:147], v[32:35]
ds_read_b64_tr_b16 a[198:199], v242 offset:33280
v_mfma_f32_16x16x32_bf16 v[32:35], a[200:203], a[128:131], v[32:35]
s_waitcnt lgkmcnt(8)
v_mfma_f32_16x16x32_bf16 v[48:51], a[208:211], a[128:131], v[48:51]
ds_read_b64_tr_b16 a[200:201], v242 offset:16384
s_add_u32 m0, s6, 20480
v_mfma_f32_16x16x32_bf16 v[48:51], a[212:215], a[144:147], v[48:51]
buffer_load_dwordx4 v15, s[20:23], s45 offen  lds
v_mfma_f32_16x16x32_bf16 v[52:55], a[212:215], a[148:151], v[52:55]
ds_read_b64_tr_b16 a[202:203], v242 offset:16896
v_mfma_f32_16x16x32_bf16 v[52:55], a[208:211], a[132:135], v[52:55]
v_mfma_f32_16x16x32_bf16 v[56:59], a[208:211], a[136:139], v[56:59]
ds_read_b64_tr_b16 a[204:205], v242 offset:40960
v_mfma_f32_16x16x32_bf16 v[56:59], a[212:215], a[152:155], v[56:59]
v_mfma_f32_16x16x32_bf16 v[60:63], a[212:215], a[156:159], v[60:63]
ds_read_b64_tr_b16 a[206:207], v242 offset:41472
v_mfma_f32_16x16x32_bf16 v[60:63], a[208:211], a[140:143], v[60:63]
s_waitcnt lgkmcnt(8)
v_mfma_f32_16x16x32_bf16 v[76:79], a[216:219], a[140:143], v[76:79]
ds_read_b64_tr_b16 a[208:209], v243 offset:8192
s_add_u32 m0, s6, 24576
v_mfma_f32_16x16x32_bf16 v[76:79], a[220:223], a[156:159], v[76:79]
buffer_load_dwordx4 v2, s[12:15], s4 offen offset:0  lds
v_mfma_f32_16x16x32_bf16 v[72:75], a[220:223], a[152:155], v[72:75]
ds_read_b64_tr_b16 a[210:211], v243 offset:8704
v_mfma_f32_16x16x32_bf16 v[72:75], a[216:219], a[136:139], v[72:75]
v_mfma_f32_16x16x32_bf16 v[68:71], a[216:219], a[132:135], v[68:71]
ds_read_b64_tr_b16 a[212:213], v243 offset:32768
v_mfma_f32_16x16x32_bf16 v[68:71], a[220:223], a[148:151], v[68:71]
v_mfma_f32_16x16x32_bf16 v[64:67], a[220:223], a[144:147], v[64:67]
ds_read_b64_tr_b16 a[214:215], v243 offset:33280
v_mfma_f32_16x16x32_bf16 v[64:67], a[216:219], a[128:131], v[64:67]
s_waitcnt lgkmcnt(8)
v_mfma_f32_16x16x32_bf16 v[80:83], a[192:195], a[128:131], v[80:83]
ds_read_b64_tr_b16 a[216:217], v243 offset:16384
s_add_u32 m0, s6, 28544
v_mfma_f32_16x16x32_bf16 v[80:83], a[196:199], a[144:147], v[80:83]
buffer_load_dwordx4 v2, s[12:15], s4 offen offset:128  lds
v_mfma_f32_16x16x32_bf16 v[84:87], a[196:199], a[148:151], v[84:87]
ds_read_b64_tr_b16 a[218:219], v243 offset:16896
v_mfma_f32_16x16x32_bf16 v[84:87], a[192:195], a[132:135], v[84:87]
v_mfma_f32_16x16x32_bf16 v[88:91], a[192:195], a[136:139], v[88:91]
ds_read_b64_tr_b16 a[220:221], v243 offset:40960
v_mfma_f32_16x16x32_bf16 v[88:91], a[196:199], a[152:155], v[88:91]
v_mfma_f32_16x16x32_bf16 v[92:95], a[196:199], a[156:159], v[92:95]
ds_read_b64_tr_b16 a[222:223], v243 offset:41472
v_mfma_f32_16x16x32_bf16 v[92:95], a[192:195], a[140:143], v[92:95]
s_waitcnt lgkmcnt(8)
v_mfma_f32_16x16x32_bf16 v[108:111], a[200:203], a[140:143], v[108:111]
ds_read_b64_tr_b16 a[192:193], v240 offset:12288
s_add_u32 m0, s6, 32768
v_mfma_f32_16x16x32_bf16 v[108:111], a[204:207], a[156:159], v[108:111]
buffer_load_dwordx4 v3, s[16:19], s5 offen  lds
v_mfma_f32_16x16x32_bf16 v[104:107], a[204:207], a[152:155], v[104:107]
ds_read_b64_tr_b16 a[194:195], v240 offset:12800
v_mfma_f32_16x16x32_bf16 v[104:107], a[200:203], a[136:139], v[104:107]
v_mfma_f32_16x16x32_bf16 v[100:103], a[200:203], a[132:135], v[100:103]
ds_read_b64_tr_b16 a[196:197], v240 offset:36864
v_mfma_f32_16x16x32_bf16 v[100:103], a[204:207], a[148:151], v[100:103]
v_mfma_f32_16x16x32_bf16 v[96:99], a[204:207], a[144:147], v[96:99]
ds_read_b64_tr_b16 a[198:199], v240 offset:37376
v_mfma_f32_16x16x32_bf16 v[96:99], a[200:203], a[128:131], v[96:99]
s_waitcnt lgkmcnt(8)
v_mfma_f32_16x16x32_bf16 v[112:115], a[208:211], a[128:131], v[112:115]
ds_read_b64_tr_b16 a[200:201], v240 offset:20480
s_add_u32 m0, s6, 36864
v_mfma_f32_16x16x32_bf16 v[112:115], a[212:215], a[144:147], v[112:115]
buffer_load_dwordx4 v15, s[16:19], s5 offen  lds
v_mfma_f32_16x16x32_bf16 v[116:119], a[212:215], a[148:151], v[116:119]
ds_read_b64_tr_b16 a[202:203], v240 offset:20992
v_mfma_f32_16x16x32_bf16 v[116:119], a[208:211], a[132:135], v[116:119]
v_mfma_f32_16x16x32_bf16 v[120:123], a[208:211], a[136:139], v[120:123]
ds_read_b64_tr_b16 a[204:205], v240 offset:45056
v_mfma_f32_16x16x32_bf16 v[120:123], a[212:215], a[152:155], v[120:123]
v_mfma_f32_16x16x32_bf16 v[124:127], a[212:215], a[156:159], v[124:127]
ds_read_b64_tr_b16 a[206:207], v240 offset:45568
v_mfma_f32_16x16x32_bf16 v[124:127], a[208:211], a[140:143], v[124:127]
s_waitcnt lgkmcnt(8)
v_mfma_f32_16x16x32_bf16 v[140:143], a[216:219], a[140:143], v[140:143]
ds_read_b64_tr_b16 a[208:209], v241 offset:12288
s_add_u32 m0, s6, 40960
v_mfma_f32_16x16x32_bf16 v[140:143], a[220:223], a[156:159], v[140:143]
buffer_load_dwordx4 v3, s[20:23], s5 offen  lds
v_mfma_f32_16x16x32_bf16 v[136:139], a[220:223], a[152:155], v[136:139]
ds_read_b64_tr_b16 a[210:211], v241 offset:12800
v_mfma_f32_16x16x32_bf16 v[136:139], a[216:219], a[136:139], v[136:139]
v_mfma_f32_16x16x32_bf16 v[132:135], a[216:219], a[132:135], v[132:135]
ds_read_b64_tr_b16 a[212:213], v241 offset:36864
v_mfma_f32_16x16x32_bf16 v[132:135], a[220:223], a[148:151], v[132:135]
v_mfma_f32_16x16x32_bf16 v[128:131], a[220:223], a[144:147], v[128:131]
ds_read_b64_tr_b16 a[214:215], v241 offset:37376
v_mfma_f32_16x16x32_bf16 v[128:131], a[216:219], a[128:131], v[128:131]
s_waitcnt lgkmcnt(8)
v_mfma_f32_16x16x32_bf16 v[144:147], a[192:195], a[128:131], v[144:147]
ds_read_b64_tr_b16 a[216:217], v241 offset:20480
s_add_u32 m0, s6, 45056
v_mfma_f32_16x16x32_bf16 v[144:147], a[196:199], a[144:147], v[144:147]
buffer_load_dwordx4 v15, s[20:23], s5 offen  lds
v_mfma_f32_16x16x32_bf16 v[148:151], a[196:199], a[148:151], v[148:151]
ds_read_b64_tr_b16 a[218:219], v241 offset:20992
v_mfma_f32_16x16x32_bf16 v[148:151], a[192:195], a[132:135], v[148:151]
v_mfma_f32_16x16x32_bf16 v[152:155], a[192:195], a[136:139], v[152:155]
ds_read_b64_tr_b16 a[220:221], v241 offset:45056
v_mfma_f32_16x16x32_bf16 v[152:155], a[196:199], a[152:155], v[152:155]
v_mfma_f32_16x16x32_bf16 v[156:159], a[196:199], a[156:159], v[156:159]
ds_read_b64_tr_b16 a[222:223], v241 offset:45568
v_mfma_f32_16x16x32_bf16 v[156:159], a[192:195], a[140:143], v[156:159]
s_waitcnt lgkmcnt(8)
v_mfma_f32_16x16x32_bf16 v[172:175], a[200:203], a[140:143], v[172:175]
ds_read_b64_tr_b16 a[192:193], v242 offset:12288
s_sub_u32 s55, s6, s58
v_mfma_f32_16x16x32_bf16 v[172:175], a[204:207], a[156:159], v[172:175]
s_mov_b32 s58, s6
v_mfma_f32_16x16x32_bf16 v[168:171], a[204:207], a[152:155], v[168:171]
ds_read_b64_tr_b16 a[194:195], v242 offset:12800
v_mfma_f32_16x16x32_bf16 v[168:171], a[200:203], a[136:139], v[168:171]
v_mfma_f32_16x16x32_bf16 v[164:167], a[200:203], a[132:135], v[164:167]
ds_read_b64_tr_b16 a[196:197], v242 offset:36864
v_mfma_f32_16x16x32_bf16 v[164:167], a[204:207], a[148:151], v[164:167]
v_mfma_f32_16x16x32_bf16 v[160:163], a[204:207], a[144:147], v[160:163]
ds_read_b64_tr_b16 a[198:199], v242 offset:37376
v_mfma_f32_16x16x32_bf16 v[160:163], a[200:203], a[128:131], v[160:163]
s_waitcnt lgkmcnt(8)
v_mfma_f32_16x16x32_bf16 v[176:179], a[208:211], a[128:131], v[176:179]
ds_read_b64_tr_b16 a[200:201], v242 offset:20480
s_add_u32 s44, s44, 0x80000
v_mfma_f32_16x16x32_bf16 v[176:179], a[212:215], a[144:147], v[176:179]
ds_read_b64_tr_b16 a[202:203], v242 offset:20992
s_add_u32 s4, s4, 0x80000
v_mfma_f32_16x16x32_bf16 v[180:183], a[212:215], a[148:151], v[180:183]
ds_read_b64_tr_b16 a[204:205], v242 offset:45056
s_add_u32 s45, s45, 458752
v_mfma_f32_16x16x32_bf16 v[180:183], a[208:211], a[132:135], v[180:183]
ds_read_b64_tr_b16 a[206:207], v242 offset:45568
s_add_u32 s5, s5, 458752
v_mfma_f32_16x16x32_bf16 v[184:187], a[208:211], a[136:139], v[184:187]
s_add_u32 s6, s6, 49152
v_mfma_f32_16x16x32_bf16 v[184:187], a[212:215], a[152:155], v[184:187]
s_cmp_eq_u32 s6, s7
s_cselect_b32 s6, s46, s6
v_mfma_f32_16x16x32_bf16 v[188:191], a[212:215], a[156:159], v[188:191]
v_mfma_f32_16x16x32_bf16 v[188:191], a[208:211], a[140:143], v[188:191]
s_waitcnt vmcnt(21) lgkmcnt(0)
s_barrier
v_mfma_f32_16x16x32_bf16 v[204:207], a[216:219], a[140:143], v[204:207]
ds_read_b64_tr_b16 a[208:209], v250 offset:0
v_add_u32 v240, s55, v240
v_mfma_f32_16x16x32_bf16 v[204:207], a[220:223], a[156:159], v[204:207]
v_add_u32 v241, s55, v241
v_add_u32 v242, s55, v242
v_mfma_f32_16x16x32_bf16 v[200:203], a[220:223], a[152:155], v[200:203]
ds_read_b64_tr_b16 a[210:211], v250 offset:512
v_add_u32 v243, s55, v243
v_mfma_f32_16x16x32_bf16 v[200:203], a[216:219], a[136:139], v[200:203]
v_add_u32 v248, s55, v248
v_add_u32 v249, s55, v249
v_mfma_f32_16x16x32_bf16 v[196:199], a[216:219], a[132:135], v[196:199]
ds_read_b64_tr_b16 a[212:213], v250 offset:24576
v_mfma_f32_16x16x32_bf16 v[196:199], a[220:223], a[148:151], v[196:199]
v_mfma_f32_16x16x32_bf16 v[192:195], a[220:223], a[144:147], v[192:195]
ds_read_b64_tr_b16 a[214:215], v250 offset:25088
v_mfma_f32_16x16x32_bf16 v[192:195], a[216:219], a[128:131], v[192:195]
v_mfma_f32_16x16x32_bf16 v[208:211], a[192:195], a[128:131], v[208:211]
ds_read_b64_tr_b16 a[216:217], v250 offset:8
v_mfma_f32_16x16x32_bf16 v[208:211], a[196:199], a[144:147], v[208:211]
v_mfma_f32_16x16x32_bf16 v[212:215], a[196:199], a[148:151], v[212:215]
ds_read_b64_tr_b16 a[218:219], v250 offset:520
v_mfma_f32_16x16x32_bf16 v[212:215], a[192:195], a[132:135], v[212:215]
v_mfma_f32_16x16x32_bf16 v[216:219], a[192:195], a[136:139], v[216:219]
ds_read_b64_tr_b16 a[220:221], v250 offset:24584
v_mfma_f32_16x16x32_bf16 v[216:219], a[196:199], a[152:155], v[216:219]
v_mfma_f32_16x16x32_bf16 v[220:223], a[196:199], a[156:159], v[220:223]
ds_read_b64_tr_b16 a[222:223], v250 offset:25096
v_mfma_f32_16x16x32_bf16 v[220:223], a[192:195], a[140:143], v[220:223]
v_mfma_f32_16x16x32_bf16 v[236:239], a[200:203], a[140:143], v[236:239]
ds_read_b64_tr_b16 a[192:193], v251 offset:0
v_mfma_f32_16x16x32_bf16 v[236:239], a[204:207], a[156:159], v[236:239]
v_mfma_f32_16x16x32_bf16 v[232:235], a[204:207], a[152:155], v[232:235]
ds_read_b64_tr_b16 a[194:195], v251 offset:512
v_mfma_f32_16x16x32_bf16 v[232:235], a[200:203], a[136:139], v[232:235]
v_mfma_f32_16x16x32_bf16 v[228:231], a[200:203], a[132:135], v[228:231]
ds_read_b64_tr_b16 a[196:197], v251 offset:24576
v_mfma_f32_16x16x32_bf16 v[228:231], a[204:207], a[148:151], v[228:231]
v_mfma_f32_16x16x32_bf16 v[224:227], a[204:207], a[144:147], v[224:227]
ds_read_b64_tr_b16 a[198:199], v251 offset:25088
v_mfma_f32_16x16x32_bf16 v[224:227], a[200:203], a[128:131], v[224:227]
s_waitcnt vmcnt(13) lgkmcnt(8)
v_mfma_f32_16x16x32_bf16 a[0:3], a[208:211], a[160:163], a[0:3]
ds_read_b64_tr_b16 a[200:201], v251 offset:8
v_mfma_f32_16x16x32_bf16 a[0:3], a[212:215], a[176:179], a[0:3]
buffer_load_dwordx4 a[128:131], v1, s[8:11], s43 offen offset:0
v_mfma_f32_16x16x32_bf16 a[4:7], a[212:215], a[180:183], a[4:7]
ds_read_b64_tr_b16 a[202:203], v251 offset:520
v_mfma_f32_16x16x32_bf16 a[4:7], a[208:211], a[164:167], a[4:7]
v_mfma_f32_16x16x32_bf16 a[8:11], a[208:211], a[168:171], a[8:11]
ds_read_b64_tr_b16 a[204:205], v251 offset:24584
v_mfma_f32_16x16x32_bf16 a[8:11], a[212:215], a[184:187], a[8:11]
buffer_load_dwordx4 a[132:135], v1, s[8:11], s43 offen offset:1024
v_mfma_f32_16x16x32_bf16 a[12:15], a[212:215], a[188:191], a[12:15]
ds_read_b64_tr_b16 a[206:207], v251 offset:25096
v_mfma_f32_16x16x32_bf16 a[12:15], a[208:211], a[172:175], a[12:15]
s_waitcnt lgkmcnt(8)
v_mfma_f32_16x16x32_bf16 a[28:31], a[216:219], a[172:175], a[28:31]
ds_read_b64_tr_b16 a[208:209], v250 offset:4096
v_mfma_f32_16x16x32_bf16 a[28:31], a[220:223], a[188:191], a[28:31]
buffer_load_dwordx4 a[136:139], v1, s[8:11], s43 offen offset:2048
v_mfma_f32_16x16x32_bf16 a[24:27], a[220:223], a[184:187], a[24:27]
ds_read_b64_tr_b16 a[210:211], v250 offset:4608
v_mfma_f32_16x16x32_bf16 a[24:27], a[216:219], a[168:171], a[24:27]
v_mfma_f32_16x16x32_bf16 a[20:23], a[216:219], a[164:167], a[20:23]
ds_read_b64_tr_b16 a[212:213], v250 offset:28672
v_mfma_f32_16x16x32_bf16 a[20:23], a[220:223], a[180:183], a[20:23]
buffer_load_dwordx4 a[140:143], v1, s[8:11], s43 offen offset:3072
v_mfma_f32_16x16x32_bf16 a[16:19], a[220:223], a[176:179], a[16:19]
ds_read_b64_tr_b16 a[214:215], v250 offset:29184
v_mfma_f32_16x16x32_bf16 a[16:19], a[216:219], a[160:163], a[16:19]
s_waitcnt lgkmcnt(8)
v_mfma_f32_16x16x32_bf16 a[32:35], a[192:195], a[160:163], a[32:35]
ds_read_b64_tr_b16 a[216:217], v250 offset:4104
v_mfma_f32_16x16x32_bf16 a[32:35], a[196:199], a[176:179], a[32:35]
buffer_load_dwordx4 a[144:147], v1, s[8:11], s3 offen offset:0
v_mfma_f32_16x16x32_bf16 a[36:39], a[196:199], a[180:183], a[36:39]
ds_read_b64_tr_b16 a[218:219], v250 offset:4616
v_mfma_f32_16x16x32_bf16 a[36:39], a[192:195], a[164:167], a[36:39]
v_mfma_f32_16x16x32_bf16 a[40:43], a[192:195], a[168:171], a[40:43]
ds_read_b64_tr_b16 a[220:221], v250 offset:28680
v_mfma_f32_16x16x32_bf16 a[40:43], a[196:199], a[184:187], a[40:43]
buffer_load_dwordx4 a[148:151], v1, s[8:11], s3 offen offset:1024
v_mfma_f32_16x16x32_bf16 a[44:47], a[196:199], a[188:191], a[44:47]
ds_read_b64_tr_b16 a[222:223], v250 offset:29192
v_mfma_f32_16x16x32_bf16 a[44:47], a[192:195], a[172:175], a[44:47]
s_waitcnt lgkmcnt(8)
v_mfma_f32_16x16x32_bf16 a[60:63], a[200:203], a[172:175], a[60:63]
ds_read_b64_tr_b16 a[192:193], v251 offset:4096
v_mfma_f32_16x16x32_bf16 a[60:63], a[204:207], a[188:191], a[60:63]
buffer_load_dwordx4 a[152:155], v1, s[8:11], s3 offen offset:2048
v_mfma_f32_16x16x32_bf16 a[56:59], a[204:207], a[184:187], a[56:59]
ds_read_b64_tr_b16 a[194:195], v251 offset:4608
v_mfma_f32_16x16x32_bf16 a[56:59], a[200:203], a[168:171], a[56:59]
v_mfma_f32_16x16x32_bf16 a[52:55], a[200:203], a[164:167], a[52:55]
ds_read_b64_tr_b16 a[196:197], v251 offset:28672
v_mfma_f32_16x16x32_bf16 a[52:55], a[204:207], a[180:183], a[52:55]
buffer_load_dwordx4 a[156:159], v1, s[8:11], s3 offen offset:3072
v_mfma_f32_16x16x32_bf16 a[48:51], a[204:207], a[176:179], a[48:51]
ds_read_b64_tr_b16 a[198:199], v251 offset:29184
v_mfma_f32_16x16x32_bf16 a[48:51], a[200:203], a[160:163], a[48:51]
s_waitcnt lgkmcnt(8)
v_mfma_f32_16x16x32_bf16 a[64:67], a[208:211], a[160:163], a[64:67]
ds_read_b64_tr_b16 a[200:201], v251 offset:4104
s_add_u32 s43, s43, 0x8000
v_mfma_f32_16x16x32_bf16 a[64:67], a[212:215], a[176:179], a[64:67]
buffer_load_dword a255, v255, s[28:31], s80 offen
v_mfma_f32_16x16x32_bf16 a[68:71], a[212:215], a[180:183], a[68:71]
ds_read_b64_tr_b16 a[202:203], v251 offset:4616
s_add_u32 s3, s3, 0x8000
v_mfma_f32_16x16x32_bf16 a[68:71], a[208:211], a[164:167], a[68:71]
v_mfma_f32_16x16x32_bf16 a[72:75], a[208:211], a[168:171], a[72:75]
ds_read_b64_tr_b16 a[204:205], v251 offset:28680
v_mfma_f32_16x16x32_bf16 a[72:75], a[212:215], a[184:187], a[72:75]
v_mfma_f32_16x16x32_bf16 a[76:79], a[212:215], a[188:191], a[76:79]
ds_read_b64_tr_b16 a[206:207], v251 offset:29192
v_mfma_f32_16x16x32_bf16 a[76:79], a[208:211], a[172:175], a[76:79]
s_waitcnt lgkmcnt(8)
v_mfma_f32_16x16x32_bf16 a[92:95], a[216:219], a[172:175], a[92:95]
ds_read_b64_tr_b16 a[208:209], v244 offset:8192
s_add_u32 m0, s6, 0
v_mfma_f32_16x16x32_bf16 a[92:95], a[220:223], a[188:191], a[92:95]
buffer_load_dwordx4 v2, s[12:15], s44 offen offset:0  lds
v_mfma_f32_16x16x32_bf16 a[88:91], a[220:223], a[184:187], a[88:91]
ds_read_b64_tr_b16 a[210:211], v244 offset:8704
s_add_u32 s80, s80, s81
v_mfma_f32_16x16x32_bf16 a[88:91], a[216:219], a[168:171], a[88:91]
v_mfma_f32_16x16x32_bf16 a[84:87], a[216:219], a[164:167], a[84:87]
ds_read_b64_tr_b16 a[212:213], v244 offset:32768
v_mfma_f32_16x16x32_bf16 a[84:87], a[220:223], a[180:183], a[84:87]
v_mfma_f32_16x16x32_bf16 a[80:83], a[220:223], a[176:179], a[80:83]
ds_read_b64_tr_b16 a[214:215], v244 offset:33280
v_mfma_f32_16x16x32_bf16 a[80:83], a[216:219], a[160:163], a[80:83]
s_waitcnt lgkmcnt(8)
v_mfma_f32_16x16x32_bf16 a[96:99], a[192:195], a[160:163], a[96:99]
ds_read_b64_tr_b16 a[216:217], v244 offset:16384
s_add_u32 m0, s6, 3968
v_mfma_f32_16x16x32_bf16 a[96:99], a[196:199], a[176:179], a[96:99]
buffer_load_dwordx4 v2, s[12:15], s44 offen offset:128  lds
v_mfma_f32_16x16x32_bf16 a[100:103], a[196:199], a[180:183], a[100:103]
ds_read_b64_tr_b16 a[218:219], v244 offset:16896
v_mfma_f32_16x16x32_bf16 a[100:103], a[192:195], a[164:167], a[100:103]
v_mfma_f32_16x16x32_bf16 a[104:107], a[192:195], a[168:171], a[104:107]
ds_read_b64_tr_b16 a[220:221], v244 offset:40960
v_mfma_f32_16x16x32_bf16 a[104:107], a[196:199], a[184:187], a[104:107]
v_mfma_f32_16x16x32_bf16 a[108:111], a[196:199], a[188:191], a[108:111]
ds_read_b64_tr_b16 a[222:223], v244 offset:41472
v_mfma_f32_16x16x32_bf16 a[108:111], a[192:195], a[172:175], a[108:111]
s_waitcnt lgkmcnt(8)
v_mfma_f32_16x16x32_bf16 a[124:127], a[200:203], a[172:175], a[124:127]
ds_read_b64_tr_b16 a[192:193], v245 offset:8192
s_add_u32 m0, s6, 8192
v_mfma_f32_16x16x32_bf16 a[124:127], a[204:207], a[188:191], a[124:127]
buffer_load_dwordx4 v3, s[16:19], s45 offen  lds
v_mfma_f32_16x16x32_bf16 a[120:123], a[204:207], a[184:187], a[120:123]
ds_read_b64_tr_b16 a[194:195], v245 offset:8704
v_mfma_f32_16x16x32_bf16 a[120:123], a[200:203], a[168:171], a[120:123]
v_mfma_f32_16x16x32_bf16 a[116:119], a[200:203], a[164:167], a[116:119]
ds_read_b64_tr_b16 a[196:197], v245 offset:32768
v_mfma_f32_16x16x32_bf16 a[116:119], a[204:207], a[180:183], a[116:119]
v_mfma_f32_16x16x32_bf16 a[112:115], a[204:207], a[176:179], a[112:115]
ds_read_b64_tr_b16 a[198:199], v245 offset:33280
v_mfma_f32_16x16x32_bf16 a[112:115], a[200:203], a[160:163], a[112:115]
s_waitcnt lgkmcnt(8)
v_mfma_f32_16x16x32_bf16 v[16:19], a[208:211], a[160:163], v[16:19]
ds_read_b64_tr_b16 a[200:201], v245 offset:16384
s_add_u32 m0, s6, 12288
v_mfma_f32_16x16x32_bf16 v[16:19], a[212:215], a[176:179], v[16:19]
buffer_load_dwordx4 v15, s[16:19], s45 offen  lds
v_mfma_f32_16x16x32_bf16 v[20:23], a[212:215], a[180:183], v[20:23]
ds_read_b64_tr_b16 a[202:203], v245 offset:16896
v_mfma_f32_16x16x32_bf16 v[20:23], a[208:211], a[164:167], v[20:23]
v_mfma_f32_16x16x32_bf16 v[24:27], a[208:211], a[168:171], v[24:27]
ds_read_b64_tr_b16 a[204:205], v245 offset:40960
v_mfma_f32_16x16x32_bf16 v[24:27], a[212:215], a[184:187], v[24:27]
v_mfma_f32_16x16x32_bf16 v[28:31], a[212:215], a[188:191], v[28:31]
ds_read_b64_tr_b16 a[206:207], v245 offset:41472
v_mfma_f32_16x16x32_bf16 v[28:31], a[208:211], a[172:175], v[28:31]
s_waitcnt lgkmcnt(8)
v_mfma_f32_16x16x32_bf16 v[44:47], a[216:219], a[172:175], v[44:47]
ds_read_b64_tr_b16 a[208:209], v246 offset:8192
s_add_u32 m0, s6, 16384
v_mfma_f32_16x16x32_bf16 v[44:47], a[220:223], a[188:191], v[44:47]
buffer_load_dwordx4 v3, s[20:23], s45 offen  lds
v_mfma_f32_16x16x32_bf16 v[40:43], a[220:223], a[184:187], v[40:43]
ds_read_b64_tr_b16 a[210:211], v246 offset:8704
v_mfma_f32_16x16x32_bf16 v[40:43], a[216:219], a[168:171], v[40:43]
v_mfma_f32_16x16x32_bf16 v[36:39], a[216:219], a[164:167], v[36:39]
ds_read_b64_tr_b16 a[212:213], v246 offset:32768
v_mfma_f32_16x16x32_bf16 v[36:39], a[220:223], a[180:183], v[36:39]
v_mfma_f32_16x16x32_bf16 v[32:35], a[220:223], a[176:179], v[32:35]
ds_read_b64_tr_b16 a[214:215], v246 offset:33280
v_mfma_f32_16x16x32_bf16 v[32:35], a[216:219], a[160:163], v[32:35]
s_waitcnt lgkmcnt(8)
v_mfma_f32_16x16x32_bf16 v[48:51], a[192:195], a[160:163], v[48:51]
ds_read_b64_tr_b16 a[216:217], v246 offset:16384
s_add_u32 m0, s6, 20480
v_mfma_f32_16x16x32_bf16 v[48:51], a[196:199], a[176:179], v[48:51]
buffer_load_dwordx4 v15, s[20:23], s45 offen  lds
v_mfma_f32_16x16x32_bf16 v[52:55], a[196:199], a[180:183], v[52:55]
ds_read_b64_tr_b16 a[218:219], v246 offset:16896
v_mfma_f32_16x16x32_bf16 v[52:55], a[192:195], a[164:167], v[52:55]
v_mfma_f32_16x16x32_bf16 v[56:59], a[192:195], a[168:171], v[56:59]
ds_read_b64_tr_b16 a[220:221], v246 offset:40960
v_mfma_f32_16x16x32_bf16 v[56:59], a[196:199], a[184:187], v[56:59]
v_mfma_f32_16x16x32_bf16 v[60:63], a[196:199], a[188:191], v[60:63]
ds_read_b64_tr_b16 a[222:223], v246 offset:41472
v_mfma_f32_16x16x32_bf16 v[60:63], a[192:195], a[172:175], v[60:63]
s_waitcnt lgkmcnt(8)
v_mfma_f32_16x16x32_bf16 v[76:79], a[200:203], a[172:175], v[76:79]
ds_read_b64_tr_b16 a[192:193], v247 offset:8192
s_add_u32 m0, s6, 24576
v_mfma_f32_16x16x32_bf16 v[76:79], a[204:207], a[188:191], v[76:79]
buffer_load_dwordx4 v2, s[12:15], s4 offen offset:0  lds
v_mfma_f32_16x16x32_bf16 v[72:75], a[204:207], a[184:187], v[72:75]
ds_read_b64_tr_b16 a[194:195], v247 offset:8704
v_mfma_f32_16x16x32_bf16 v[72:75], a[200:203], a[168:171], v[72:75]
v_mfma_f32_16x16x32_bf16 v[68:71], a[200:203], a[164:167], v[68:71]
ds_read_b64_tr_b16 a[196:197], v247 offset:32768
v_mfma_f32_16x16x32_bf16 v[68:71], a[204:207], a[180:183], v[68:71]
v_mfma_f32_16x16x32_bf16 v[64:67], a[204:207], a[176:179], v[64:67]
ds_read_b64_tr_b16 a[198:199], v247 offset:33280
v_mfma_f32_16x16x32_bf16 v[64:67], a[200:203], a[160:163], v[64:67]
s_waitcnt lgkmcnt(8)
v_mfma_f32_16x16x32_bf16 v[80:83], a[208:211], a[160:163], v[80:83]
ds_read_b64_tr_b16 a[200:201], v247 offset:16384
s_add_u32 m0, s6, 28544
v_mfma_f32_16x16x32_bf16 v[80:83], a[212:215], a[176:179], v[80:83]
buffer_load_dwordx4 v2, s[12:15], s4 offen offset:128  lds
v_mfma_f32_16x16x32_bf16 v[84:87], a[212:215], a[180:183], v[84:87]
ds_read_b64_tr_b16 a[202:203], v247 offset:16896
v_mfma_f32_16x16x32_bf16 v[84:87], a[208:211], a[164:167], v[84:87]
v_mfma_f32_16x16x32_bf16 v[88:91], a[208:211], a[168:171], v[88:91]
ds_read_b64_tr_b16 a[204:205], v247 offset:40960
v_mfma_f32_16x16x32_bf16 v[88:91], a[212:215], a[184:187], v[88:91]
v_mfma_f32_16x16x32_bf16 v[92:95], a[212:215], a[188:191], v[92:95]
ds_read_b64_tr_b16 a[206:207], v247 offset:41472
v_mfma_f32_16x16x32_bf16 v[92:95], a[208:211], a[172:175], v[92:95]
s_waitcnt lgkmcnt(8)
v_mfma_f32_16x16x32_bf16 v[108:111], a[216:219], a[172:175], v[108:111]
ds_read_b64_tr_b16 a[208:209], v244 offset:12288
s_add_u32 m0, s6, 32768
v_mfma_f32_16x16x32_bf16 v[108:111], a[220:223], a[188:191], v[108:111]
buffer_load_dwordx4 v3, s[16:19], s5 offen  lds
v_mfma_f32_16x16x32_bf16 v[104:107], a[220:223], a[184:187], v[104:107]
ds_read_b64_tr_b16 a[210:211], v244 offset:12800
v_mfma_f32_16x16x32_bf16 v[104:107], a[216:219], a[168:171], v[104:107]
v_mfma_f32_16x16x32_bf16 v[100:103], a[216:219], a[164:167], v[100:103]
ds_read_b64_tr_b16 a[212:213], v244 offset:36864
v_mfma_f32_16x16x32_bf16 v[100:103], a[220:223], a[180:183], v[100:103]
v_mfma_f32_16x16x32_bf16 v[96:99], a[220:223], a[176:179], v[96:99]
ds_read_b64_tr_b16 a[214:215], v244 offset:37376
v_mfma_f32_16x16x32_bf16 v[96:99], a[216:219], a[160:163], v[96:99]
s_waitcnt lgkmcnt(8)
v_mfma_f32_16x16x32_bf16 v[112:115], a[192:195], a[160:163], v[112:115]
ds_read_b64_tr_b16 a[216:217], v244 offset:20480
s_add_u32 m0, s6, 36864
v_mfma_f32_16x16x32_bf16 v[112:115], a[196:199], a[176:179], v[112:115]
buffer_load_dwordx4 v15, s[16:19], s5 offen  lds
v_mfma_f32_16x16x32_bf16 v[116:119], a[196:199], a[180:183], v[116:119]
ds_read_b64_tr_b16 a[218:219], v244 offset:20992
v_mfma_f32_16x16x32_bf16 v[116:119], a[192:195], a[164:167], v[116:119]
v_mfma_f32_16x16x32_bf16 v[120:123], a[192:195], a[168:171], v[120:123]
ds_read_b64_tr_b16 a[220:221], v244 offset:45056
v_mfma_f32_16x16x32_bf16 v[120:123], a[196:199], a[184:187], v[120:123]
v_mfma_f32_16x16x32_bf16 v[124:127], a[196:199], a[188:191], v[124:127]
ds_read_b64_tr_b16 a[222:223], v244 offset:45568
v_mfma_f32_16x16x32_bf16 v[124:127], a[192:195], a[172:175], v[124:127]
s_waitcnt lgkmcnt(8)
v_mfma_f32_16x16x32_bf16 v[140:143], a[200:203], a[172:175], v[140:143]
ds_read_b64_tr_b16 a[192:193], v245 offset:12288
s_add_u32 m0, s6, 40960
v_mfma_f32_16x16x32_bf16 v[140:143], a[204:207], a[188:191], v[140:143]
buffer_load_dwordx4 v3, s[20:23], s5 offen  lds
v_mfma_f32_16x16x32_bf16 v[136:139], a[204:207], a[184:187], v[136:139]
ds_read_b64_tr_b16 a[194:195], v245 offset:12800
v_mfma_f32_16x16x32_bf16 v[136:139], a[200:203], a[168:171], v[136:139]
v_mfma_f32_16x16x32_bf16 v[132:135], a[200:203], a[164:167], v[132:135]
ds_read_b64_tr_b16 a[196:197], v245 offset:36864
v_mfma_f32_16x16x32_bf16 v[132:135], a[204:207], a[180:183], v[132:135]
v_mfma_f32_16x16x32_bf16 v[128:131], a[204:207], a[176:179], v[128:131]
ds_read_b64_tr_b16 a[198:199], v245 offset:37376
v_mfma_f32_16x16x32_bf16 v[128:131], a[200:203], a[160:163], v[128:131]
s_waitcnt lgkmcnt(8)
v_mfma_f32_16x16x32_bf16 v[144:147], a[208:211], a[160:163], v[144:147]
ds_read_b64_tr_b16 a[200:201], v245 offset:20480
s_add_u32 m0, s6, 45056
v_mfma_f32_16x16x32_bf16 v[144:147], a[212:215], a[176:179], v[144:147]
buffer_load_dwordx4 v15, s[20:23], s5 offen  lds
v_mfma_f32_16x16x32_bf16 v[148:151], a[212:215], a[180:183], v[148:151]
ds_read_b64_tr_b16 a[202:203], v245 offset:20992
v_mfma_f32_16x16x32_bf16 v[148:151], a[208:211], a[164:167], v[148:151]
v_mfma_f32_16x16x32_bf16 v[152:155], a[208:211], a[168:171], v[152:155]
ds_read_b64_tr_b16 a[204:205], v245 offset:45056
v_mfma_f32_16x16x32_bf16 v[152:155], a[212:215], a[184:187], v[152:155]
v_mfma_f32_16x16x32_bf16 v[156:159], a[212:215], a[188:191], v[156:159]
ds_read_b64_tr_b16 a[206:207], v245 offset:45568
v_mfma_f32_16x16x32_bf16 v[156:159], a[208:211], a[172:175], v[156:159]
s_waitcnt lgkmcnt(8)
v_mfma_f32_16x16x32_bf16 v[172:175], a[216:219], a[172:175], v[172:175]
ds_read_b64_tr_b16 a[208:209], v246 offset:12288
s_sub_u32 s55, s6, s59
v_mfma_f32_16x16x32_bf16 v[172:175], a[220:223], a[188:191], v[172:175]
s_mov_b32 s59, s6
v_mfma_f32_16x16x32_bf16 v[168:171], a[220:223], a[184:187], v[168:171]
ds_read_b64_tr_b16 a[210:211], v246 offset:12800
v_mfma_f32_16x16x32_bf16 v[168:171], a[216:219], a[168:171], v[168:171]
v_mfma_f32_16x16x32_bf16 v[164:167], a[216:219], a[164:167], v[164:167]
ds_read_b64_tr_b16 a[212:213], v246 offset:36864
v_mfma_f32_16x16x32_bf16 v[164:167], a[220:223], a[180:183], v[164:167]
v_mfma_f32_16x16x32_bf16 v[160:163], a[220:223], a[176:179], v[160:163]
ds_read_b64_tr_b16 a[214:215], v246 offset:37376
v_mfma_f32_16x16x32_bf16 v[160:163], a[216:219], a[160:163], v[160:163]
s_waitcnt lgkmcnt(8)
v_mfma_f32_16x16x32_bf16 v[176:179], a[192:195], a[160:163], v[176:179]
ds_read_b64_tr_b16 a[216:217], v246 offset:20480
s_add_u32 s44, s44, 0x80000
v_mfma_f32_16x16x32_bf16 v[176:179], a[196:199], a[176:179], v[176:179]
ds_read_b64_tr_b16 a[218:219], v246 offset:20992
s_add_u32 s4, s4, 0x80000
v_mfma_f32_16x16x32_bf16 v[180:183], a[196:199], a[180:183], v[180:183]
ds_read_b64_tr_b16 a[220:221], v246 offset:45056
s_add_u32 s45, s45, 458752
v_mfma_f32_16x16x32_bf16 v[180:183], a[192:195], a[164:167], v[180:183]
ds_read_b64_tr_b16 a[222:223], v246 offset:45568
s_add_u32 s5, s5, 458752
v_mfma_f32_16x16x32_bf16 v[184:187], a[192:195], a[168:171], v[184:187]
s_add_u32 s6, s6, 49152
v_mfma_f32_16x16x32_bf16 v[184:187], a[196:199], a[184:187], v[184:187]
s_cmp_eq_u32 s6, s7
s_cselect_b32 s6, s46, s6
v_mfma_f32_16x16x32_bf16 v[188:191], a[196:199], a[188:191], v[188:191]
v_mfma_f32_16x16x32_bf16 v[188:191], a[192:195], a[172:175], v[188:191]
s_waitcnt vmcnt(21) lgkmcnt(0)
s_barrier
v_mfma_f32_16x16x32_bf16 v[204:207], a[200:203], a[172:175], v[204:207]
ds_read_b64_tr_b16 a[192:193], v248 offset:0
v_add_u32 v244, s55, v244
v_mfma_f32_16x16x32_bf16 v[204:207], a[204:207], a[188:191], v[204:207]
v_add_u32 v245, s55, v245
v_add_u32 v246, s55, v246
v_mfma_f32_16x16x32_bf16 v[200:203], a[204:207], a[184:187], v[200:203]
ds_read_b64_tr_b16 a[194:195], v248 offset:512
v_add_u32 v247, s55, v247
v_mfma_f32_16x16x32_bf16 v[200:203], a[200:203], a[168:171], v[200:203]
v_add_u32 v250, s55, v250
v_add_u32 v251, s55, v251
v_mfma_f32_16x16x32_bf16 v[196:199], a[200:203], a[164:167], v[196:199]
ds_read_b64_tr_b16 a[196:197], v248 offset:24576
v_mfma_f32_16x16x32_bf16 v[196:199], a[204:207], a[180:183], v[196:199]
v_mfma_f32_16x16x32_bf16 v[192:195], a[204:207], a[176:179], v[192:195]
ds_read_b64_tr_b16 a[198:199], v248 offset:25088
v_mfma_f32_16x16x32_bf16 v[192:195], a[200:203], a[160:163], v[192:195]
v_mfma_f32_16x16x32_bf16 v[208:211], a[208:211], a[160:163], v[208:211]
ds_read_b64_tr_b16 a[200:201], v248 offset:8
v_mfma_f32_16x16x32_bf16 v[208:211], a[212:215], a[176:179], v[208:211]
v_mfma_f32_16x16x32_bf16 v[212:215], a[212:215], a[180:183], v[212:215]
ds_read_b64_tr_b16 a[202:203], v248 offset:520
v_mfma_f32_16x16x32_bf16 v[212:215], a[208:211], a[164:167], v[212:215]
v_mfma_f32_16x16x32_bf16 v[216:219], a[208:211], a[168:171], v[216:219]
ds_read_b64_tr_b16 a[204:205], v248 offset:24584
v_mfma_f32_16x16x32_bf16 v[216:219], a[212:215], a[184:187], v[216:219]
v_mfma_f32_16x16x32_bf16 v[220:223], a[212:215], a[188:191], v[220:223]
ds_read_b64_tr_b16 a[206:207], v248 offset:25096
v_mfma_f32_16x16x32_bf16 v[220:223], a[208:211], a[172:175], v[220:223]
v_mfma_f32_16x16x32_bf16 v[236:239], a[216:219], a[172:175], v[236:239]
ds_read_b64_tr_b16 a[208:209], v249 offset:0
v_mfma_f32_16x16x32_bf16 v[236:239], a[220:223], a[188:191], v[236:239]
v_mfma_f32_16x16x32_bf16 v[232:235], a[220:223], a[184:187], v[232:235]
ds_read_b64_tr_b16 a[210:211], v249 offset:512
v_mfma_f32_16x16x32_bf16 v[232:235], a[216:219], a[168:171], v[232:235]
v_mfma_f32_16x16x32_bf16 v[228:231], a[216:219], a[164:167], v[228:231]
ds_read_b64_tr_b16 a[212:213], v249 offset:24576
v_mfma_f32_16x16x32_bf16 v[228:231], a[220:223], a[180:183], v[228:231]
v_mfma_f32_16x16x32_bf16 v[224:227], a[220:223], a[176:179], v[224:227]
ds_read_b64_tr_b16 a[214:215], v249 offset:25088
v_mfma_f32_16x16x32_bf16 v[224:227], a[216:219], a[160:163], v[224:227]
s_sub_u32 s47, s47, 1
s_cmp_lg_u32 s47, 0
s_cbranch_scc1 L_main_kernel_g
s_waitcnt vmcnt(13) lgkmcnt(8)
v_mfma_f32_16x16x32_bf16 a[0:3], a[192:195], a[128:131], a[0:3]
ds_read_b64_tr_b16 a[216:217], v241 offset:8192
v_mfma_f32_16x16x32_bf16 a[0:3], a[196:199], a[144:147], a[0:3]
buffer_load_dwordx4 a[160:163], v1, s[8:11], s43 offen offset:0
v_mfma_f32_16x16x32_bf16 a[4:7], a[196:199], a[148:151], a[4:7]
ds_read_b64_tr_b16 a[218:219], v241 offset:8704
v_mfma_f32_16x16x32_bf16 a[4:7], a[192:195], a[132:135], a[4:7]
s_getpc_b64 s[92:93]
L_main_kernel_pc2:
v_mfma_f32_16x16x32_bf16 a[8:11], a[192:195], a[136:139], a[8:11]
ds_read_b64_tr_b16 a[220:221], v241 offset:32768
s_mov_b32 s94, L_code_end-L_main_kernel_pc2
v_mfma_f32_16x16x32_bf16 a[8:11], a[196:199], a[152:155], a[8:11]
buffer_load_dwordx4 a[164:167], v1, s[8:11], s43 offen offset:1024
v_mfma_f32_16x16x32_bf16 a[12:15], a[196:199], a[156:159], a[12:15]
ds_read_b64_tr_b16 a[222:223], v241 offset:33280
s_bfe_u32 s80, s2, 0x30003
v_mfma_f32_16x16x32_bf16 a[12:15], a[192:195], a[140:143], a[12:15]
s_waitcnt lgkmcnt(8)
v_mfma_f32_16x16x32_bf16 a[28:31], a[200:203], a[140:143], a[28:31]
ds_read_b64_tr_b16 a[192:193], v241 offset:16384
s_lshl_b32 s80, s80, 13
v_mfma_f32_16x16x32_bf16 a[28:31], a[204:207], a[156:159], a[28:31]
buffer_load_dwordx4 a[168:171], v1, s[8:11], s43 offen offset:2048
v_mfma_f32_16x16x32_bf16 a[24:27], a[204:207], a[152:155], a[24:27]
ds_read_b64_tr_b16 a[194:195], v241 offset:16896
v_lshlrev_b32 v254, 7, v0
v_mfma_f32_16x16x32_bf16 a[24:27], a[200:203], a[136:139], a[24:27]
s_cmp_lg_u32 s40, 3
s_cselect_b32 s94, 0, s94
v_mfma_f32_16x16x32_bf16 a[20:23], a[200:203], a[132:135], a[20:23]
ds_read_b64_tr_b16 a[196:197], v241 offset:40960
s_or_b32 s81, s40, s78
v_mfma_f32_16x16x32_bf16 a[20:23], a[204:207], a[148:151], a[20:23]
buffer_load_dwordx4 a[172:175], v1, s[8:11], s43 offen offset:3072
v_mfma_f32_16x16x32_bf16 a[16:19], a[204:207], a[144:147], a[16:19]
ds_read_b64_tr_b16 a[198:199], v241 offset:41472
v_mfma_f32_16x16x32_bf16 a[16:19], a[200:203], a[128:131], a[16:19]
s_waitcnt lgkmcnt(8)
v_mfma_f32_16x16x32_bf16 a[32:35], a[208:211], a[128:131], a[32:35]
ds_read_b64_tr_b16 a[200:201], v240 offset:8192
v_mfma_f32_16x16x32_bf16 a[32:35], a[212:215], a[144:147], a[32:35]
buffer_load_dwordx4 a[176:179], v1, s[8:11], s3 offen offset:0
v_mfma_f32_16x16x32_bf16 a[36:39], a[212:215], a[148:151], a[36:39]
ds_read_b64_tr_b16 a[202:203], v240 offset:8704
v_mfma_f32_16x16x32_bf16 a[36:39], a[208:211], a[132:135], a[36:39]
s_cmp_eq_u32 s81, 0
s_cselect_b32 s81, 1, 0
v_mfma_f32_16x16x32_bf16 a[40:43], a[208:211], a[136:139], a[40:43]
ds_read_b64_tr_b16 a[204:205], v240 offset:32768
s_and_b32 s55, s2, 7
v_mfma_f32_16x16x32_bf16 a[40:43], a[212:215], a[152:155], a[40:43]
buffer_load_dwordx4 a[180:183], v1, s[8:11], s3 offen offset:1024
v_mfma_f32_16x16x32_bf16 a[44:47], a[212:215], a[156:159], a[44:47]
ds_read_b64_tr_b16 a[206:207], v240 offset:33280
s_lshl_b32 s55, s55, 3
v_mfma_f32_16x16x32_bf16 a[44:47], a[208:211], a[140:143], a[44:47]
s_waitcnt lgkmcnt(8)
v_mfma_f32_16x16x32_bf16 v[60:63], a[216:219], a[140:143], v[60:63]
ds_read_b64_tr_b16 a[208:209], v240 offset:16384
s_lshl_b64 s[22:23], 1, s55
v_mfma_f32_16x16x32_bf16 v[60:63], a[220:223], a[156:159], v[60:63]
buffer_load_dwordx4 a[184:187], v1, s[8:11], s3 offen offset:2048
v_mfma_f32_16x16x32_bf16 v[56:59], a[220:223], a[152:155], v[56:59]
ds_read_b64_tr_b16 a[210:211], v240 offset:16896
s_or_b32 s5, s55, 0x80000
v_mfma_f32_16x16x32_bf16 v[56:59], a[216:219], a[136:139], v[56:59]
s_mov_b64 s[12:13], s[68:69]
s_mov_b32 s14, 7340032
v_mfma_f32_16x16x32_bf16 v[52:55], a[216:219], a[132:135], v[52:55]
ds_read_b64_tr_b16 a[212:213], v240 offset:40960
s_mov_b64 s[16:17], s[64:65]
v_mfma_f32_16x16x32_bf16 v[52:55], a[220:223], a[148:151], v[52:55]
buffer_load_dwordx4 a[188:191], v1, s[8:11], s3 offen offset:3072
v_mfma_f32_16x16x32_bf16 v[48:51], a[220:223], a[144:147], v[48:51]
ds_read_b64_tr_b16 a[214:215], v240 offset:41472
s_mov_b32 s18, 8388608
v_mfma_f32_16x16x32_bf16 v[48:51], a[216:219], a[128:131], v[48:51]
s_waitcnt lgkmcnt(8)
v_mfma_f32_16x16x32_bf16 v[64:67], a[192:195], a[128:131], v[64:67]
ds_read_b64_tr_b16 a[216:217], v243 offset:8192
v_mfma_f32_16x16x32_bf16 v[64:67], a[196:199], a[144:147], v[64:67]
buffer_load_dword a255, v254, s[92:95], s80 offen
v_mfma_f32_16x16x32_bf16 v[68:71], a[196:199], a[148:151], v[68:71]
ds_read_b64_tr_b16 a[218:219], v243 offset:8704
v_mfma_f32_16x16x32_bf16 v[68:71], a[192:195], a[132:135], v[68:71]
v_mfma_f32_16x16x32_bf16 v[72:75], a[192:195], a[136:139], v[72:75]
ds_read_b64_tr_b16 a[220:221], v243 offset:32768
s_add_u32 m0, s57, 98304
v_mfma_f32_16x16x32_bf16 v[72:75], a[196:199], a[152:155], v[72:75]
buffer_load_dwordx4 v6, s[24:27], s73 offen offset:0  lds
v_mfma_f32_16x16x32_bf16 v[76:79], a[196:199], a[156:159], v[76:79]
ds_read_b64_tr_b16 a[222:223], v243 offset:33280
v_mfma_f32_16x16x32_bf16 v[76:79], a[192:195], a[140:143], v[76:79]
s_waitcnt lgkmcnt(8)
v_mfma_f32_16x16x32_bf16 v[28:31], a[200:203], a[140:143], v[28:31]
ds_read_b64_tr_b16 a[192:193], v243 offset:16384
v_mfma_f32_16x16x32_bf16 v[28:31], a[204:207], a[156:159], v[28:31]
buffer_load_dwordx4 v7, s[24:27], s73 offen offset:1024  lds
v_mfma_f32_16x16x32_bf16 v[24:27], a[204:207], a[152:155], v[24:27]
ds_read_b64_tr_b16 a[194:195], v243 offset:16896
v_mfma_f32_16x16x32_bf16 v[24:27], a[200:203], a[136:139], v[24:27]
s_add_u32 s8, s60, 54525952
s_addc_u32 s9, s61, 0
v_mfma_f32_16x16x32_bf16 v[20:23], a[200:203], a[132:135], v[20:23]
ds_read_b64_tr_b16 a[196:197], v243 offset:40960
s_mov_b32 s10, 0x1000000
v_mfma_f32_16x16x32_bf16 v[20:23], a[204:207], a[148:151], v[20:23]
buffer_load_dwordx4 v8, s[24:27], s73 offen offset:2048  lds
v_mfma_f32_16x16x32_bf16 v[16:19], a[204:207], a[144:147], v[16:19]
ds_read_b64_tr_b16 a[198:199], v243 offset:41472
s_mov_b32 s43, s52
v_mfma_f32_16x16x32_bf16 v[16:19], a[200:203], a[128:131], v[16:19]
s_waitcnt lgkmcnt(8)
v_mfma_f32_16x16x32_bf16 v[32:35], a[208:211], a[128:131], v[32:35]
ds_read_b64_tr_b16 a[200:201], v242 offset:8192
s_mov_b32 s44, s53
v_mfma_f32_16x16x32_bf16 v[32:35], a[212:215], a[144:147], v[32:35]
buffer_load_dwordx4 v9, s[24:27], s73 offen offset:3072  lds
v_mfma_f32_16x16x32_bf16 v[36:39], a[212:215], a[148:151], v[36:39]
ds_read_b64_tr_b16 a[202:203], v242 offset:8704
s_mov_b32 s45, 0x1c0000
v_mfma_f32_16x16x32_bf16 v[36:39], a[208:211], a[132:135], v[36:39]
s_mov_b32 s3, 0x1c000
s_add_u32 s4, s62, 0x600000
v_mfma_f32_16x16x32_bf16 v[40:43], a[208:211], a[136:139], v[40:43]
ds_read_b64_tr_b16 a[204:205], v242 offset:32768
s_add_u32 m0, s57, 114688
v_mfma_f32_16x16x32_bf16 v[40:43], a[212:215], a[152:155], v[40:43]
buffer_load_dwordx4 v6, s[24:27], s74 offen offset:0  lds
v_mfma_f32_16x16x32_bf16 v[44:47], a[212:215], a[156:159], v[44:47]
ds_read_b64_tr_b16 a[206:207], v242 offset:33280
s_lshl_b32 s79, s40, 11
v_mfma_f32_16x16x32_bf16 v[44:47], a[208:211], a[140:143], v[44:47]
s_waitcnt lgkmcnt(8)
v_mfma_f32_16x16x32_bf16 v[124:127], a[216:219], a[140:143], v[124:127]
ds_read_b64_tr_b16 a[208:209], v242 offset:16384
v_accvgpr_read_b32 v2, a250
v_mfma_f32_16x16x32_bf16 v[124:127], a[220:223], a[156:159], v[124:127]
buffer_load_dwordx4 v7, s[24:27], s74 offen offset:1024  lds
v_mfma_f32_16x16x32_bf16 v[120:123], a[220:223], a[152:155], v[120:123]
ds_read_b64_tr_b16 a[210:211], v242 offset:16896
v_accvgpr_read_b32 v0, a250
v_mfma_f32_16x16x32_bf16 v[120:123], a[216:219], a[136:139], v[120:123]
v_accvgpr_read_b32 v3, a251
v_accvgpr_read_b32 v1, a251
v_mfma_f32_16x16x32_bf16 v[116:119], a[216:219], a[132:135], v[116:119]
ds_read_b64_tr_b16 a[212:213], v242 offset:40960
v_accvgpr_read_b32 v4, a252
v_mfma_f32_16x16x32_bf16 v[116:119], a[220:223], a[148:151], v[116:119]
buffer_load_dwordx4 v8, s[24:27], s74 offen offset:2048  lds
v_mfma_f32_16x16x32_bf16 v[112:115], a[220:223], a[144:147], v[112:115]
ds_read_b64_tr_b16 a[214:215], v242 offset:41472
v_accvgpr_read_b32 v255, a252
v_mfma_f32_16x16x32_bf16 v[112:115], a[216:219], a[128:131], v[112:115]
s_waitcnt lgkmcnt(8)
v_mfma_f32_16x16x32_bf16 v[128:131], a[192:195], a[128:131], v[128:131]
ds_read_b64_tr_b16 a[216:217], v242 offset:12288
v_permlane32_swap_b32 v2, v0
v_mfma_f32_16x16x32_bf16 v[128:131], a[196:199], a[144:147], v[128:131]
buffer_load_dwordx4 v9, s[24:27], s74 offen offset:3072  lds
v_mfma_f32_16x16x32_bf16 v[132:135], a[196:199], a[148:151], v[132:135]
ds_read_b64_tr_b16 a[218:219], v242 offset:12800
v_permlane32_swap_b32 v3, v1
v_mfma_f32_16x16x32_bf16 v[132:135], a[192:195], a[132:135], v[132:135]
v_permlane32_swap_b32 v4, v255
v_mov_b32 v14, v2
v_mfma_f32_16x16x32_bf16 v[136:139], a[192:195], a[136:139], v[136:139]
ds_read_b64_tr_b16 a[220:221], v242 offset:36864
s_add_u32 m0, s57, 131072
v_mfma_f32_16x16x32_bf16 v[136:139], a[196:199], a[152:155], v[136:139]
buffer_load_dwordx4 v6, s[24:27], s75 offen offset:0  lds
v_mfma_f32_16x16x32_bf16 v[140:143], a[196:199], a[156:159], v[140:143]
ds_read_b64_tr_b16 a[222:223], v242 offset:37376
v_mov_b32 v15, v3
v_mfma_f32_16x16x32_bf16 v[140:143], a[192:195], a[140:143], v[140:143]
s_waitcnt lgkmcnt(8)
v_mfma_f32_16x16x32_bf16 v[92:95], a[200:203], a[140:143], v[92:95]
ds_read_b64_tr_b16 a[192:193], v242 offset:20480
v_mov_b32 v13, v4
v_mfma_f32_16x16x32_bf16 v[92:95], a[204:207], a[156:159], v[92:95]
buffer_load_dwordx4 v7, s[24:27], s75 offen offset:1024  lds
v_mfma_f32_16x16x32_bf16 v[88:91], a[204:207], a[152:155], v[88:91]
ds_read_b64_tr_b16 a[194:195], v242 offset:20992
v_permlane16_swap_b32 v2, v14
v_mfma_f32_16x16x32_bf16 v[88:91], a[200:203], a[136:139], v[88:91]
v_permlane16_swap_b32 v3, v15
v_permlane16_swap_b32 v4, v13
v_mfma_f32_16x16x32_bf16 v[84:87], a[200:203], a[132:135], v[84:87]
ds_read_b64_tr_b16 a[196:197], v242 offset:45056
s_mov_b64 s[92:93], s[60:61]
v_mfma_f32_16x16x32_bf16 v[84:87], a[204:207], a[148:151], v[84:87]
buffer_load_dwordx4 v8, s[24:27], s75 offen offset:2048  lds
v_mfma_f32_16x16x32_bf16 v[80:83], a[204:207], a[144:147], v[80:83]
ds_read_b64_tr_b16 a[198:199], v242 offset:45568
s_mov_b32 s94, 37748736
v_mfma_f32_16x16x32_bf16 v[80:83], a[200:203], a[128:131], v[80:83]
s_waitcnt vmcnt(20)
s_barrier
s_waitcnt lgkmcnt(8)
v_mfma_f32_16x16x32_bf16 v[96:99], a[208:211], a[128:131], v[96:99]
ds_read_b64_tr_b16 a[200:201], v245 offset:8192
s_and_b32 s80, s2, 7
v_mfma_f32_16x16x32_bf16 v[96:99], a[212:215], a[144:147], v[96:99]
buffer_load_dwordx4 v9, s[24:27], s75 offen offset:3072  lds
v_mfma_f32_16x16x32_bf16 v[100:103], a[212:215], a[148:151], v[100:103]
ds_read_b64_tr_b16 a[202:203], v245 offset:8704
s_lshl_b32 s80, s80, 5
v_mfma_f32_16x16x32_bf16 v[100:103], a[208:211], a[132:135], v[100:103]
s_add_u32 s80, s80, 16
s_lshr_b32 s46, s2, 3
v_mfma_f32_16x16x32_bf16 v[104:107], a[208:211], a[136:139], v[104:107]
ds_read_b64_tr_b16 a[204:205], v245 offset:32768
s_add_u32 m0, s57, 147456
v_mfma_f32_16x16x32_bf16 v[104:107], a[212:215], a[152:155], v[104:107]
buffer_load_dwordx4 v6, s[24:27], s82 offen offset:0  lds
v_mfma_f32_16x16x32_bf16 v[108:111], a[212:215], a[156:159], v[108:111]
ds_read_b64_tr_b16 a[206:207], v245 offset:33280
s_xor_b32 s46, s46, s2
v_mfma_f32_16x16x32_bf16 v[108:111], a[208:211], a[140:143], v[108:111]
s_waitcnt lgkmcnt(8)
v_mfma_f32_16x16x32_bf16 v[220:223], a[216:219], a[140:143], v[220:223]
ds_read_b64_tr_b16 a[208:209], v245 offset:16384
s_lshl_b32 s46, s46, 11
v_mfma_f32_16x16x32_bf16 v[220:223], a[220:223], a[156:159], v[220:223]
buffer_load_dwordx4 v7, s[24:27], s82 offen offset:1024  lds
v_mfma_f32_16x16x32_bf16 v[216:219], a[220:223], a[152:155], v[216:219]
ds_read_b64_tr_b16 a[210:211], v245 offset:16896
s_and_b32 s46, s46, 114688
v_mfma_f32_16x16x32_bf16 v[216:219], a[216:219], a[136:139], v[216:219]
v_mfma_f32_16x16x4_4b_bf16 v[48:63], a[230:231], a[238:239], v[48:63] cbsz:2 abid:1
v_mfma_f32_16x16x32_bf16 v[212:215], a[216:219], a[132:135], v[212:215]
ds_read_b64_tr_b16 a[212:213], v245 offset:40960
v_mfma_f32_16x16x32_bf16 v[212:215], a[220:223], a[148:151], v[212:215]
buffer_load_dwordx4 v8, s[24:27], s82 offen offset:2048  lds
v_mfma_f32_16x16x32_bf16 v[208:211], a[220:223], a[144:147], v[208:211]
ds_read_b64_tr_b16 a[214:215], v245 offset:41472
v_mfma_f32_16x16x32_bf16 v[208:211], a[216:219], a[128:131], v[208:211]
s_waitcnt lgkmcnt(8)
v_mfma_f32_16x16x32_bf16 v[224:227], a[192:195], a[128:131], v[224:227]
ds_read_b64_tr_b16 a[216:217], v244 offset:8192
v_mfma_f32_16x16x32_bf16 v[224:227], a[196:199], a[144:147], v[224:227]
buffer_load_dwordx4 v9, s[24:27], s82 offen offset:3072  lds
v_mfma_f32_16x16x32_bf16 v[228:231], a[196:199], a[148:151], v[228:231]
ds_read_b64_tr_b16 a[218:219], v244 offset:8704
v_mfma_f32_16x16x32_bf16 v[228:231], a[192:195], a[132:135], v[228:231]
v_mfma_f32_16x16x4_4b_bf16 v[64:79], a[230:231], a[242:243], v[64:79] cbsz:2 abid:1
v_mfma_f32_16x16x32_bf16 v[232:235], a[192:195], a[136:139], v[232:235]
ds_read_b64_tr_b16 a[220:221], v244 offset:32768
v_mfma_f32_16x16x32_bf16 v[232:235], a[196:199], a[152:155], v[232:235]
v_mfma_f32_16x16x32_bf16 v[236:239], a[196:199], a[156:159], v[236:239]
ds_read_b64_tr_b16 a[222:223], v244 offset:33280
v_mfma_f32_16x16x32_bf16 v[236:239], a[192:195], a[140:143], v[236:239]
s_waitcnt vmcnt(17) lgkmcnt(8)
v_mfma_f32_16x16x32_bf16 v[60:63], a[200:203], a[172:175], v[60:63]
ds_read_b64_tr_b16 a[192:193], v244 offset:16384
v_mov_b32 v8, v0
v_mfma_f32_16x16x32_bf16 v[60:63], a[204:207], a[188:191], v[60:63]
v_mov_b32 v9, v1
v_mov_b32 v6, v255
v_mfma_f32_16x16x32_bf16 v[56:59], a[204:207], a[184:187], v[56:59]
ds_read_b64_tr_b16 a[194:195], v244 offset:16896
v_mov_b32 v7, v255
v_mfma_f32_16x16x32_bf16 v[56:59], a[200:203], a[168:171], v[56:59]
v_permlane16_swap_b32 v0, v8
v_permlane16_swap_b32 v1, v9
v_mfma_f32_16x16x32_bf16 v[52:55], a[200:203], a[164:167], v[52:55]
ds_read_b64_tr_b16 a[196:197], v244 offset:40960
v_permlane16_swap_b32 v6, v7
v_mfma_f32_16x16x32_bf16 v[52:55], a[204:207], a[180:183], v[52:55]
v_mfma_f32_16x16x32_bf16 v[48:51], a[204:207], a[176:179], v[48:51]
ds_read_b64_tr_b16 a[198:199], v244 offset:41472
v_mfma_f32_16x16x32_bf16 v[48:51], a[200:203], a[160:163], v[48:51]
s_waitcnt lgkmcnt(8)
v_mfma_f32_16x16x32_bf16 v[64:67], a[208:211], a[160:163], v[64:67]
ds_read_b64_tr_b16 a[200:201], v247 offset:8192
v_mfma_f32_16x16x32_bf16 v[64:67], a[212:215], a[176:179], v[64:67]
v_mfma_f32_16x16x32_bf16 v[68:71], a[212:215], a[180:183], v[68:71]
ds_read_b64_tr_b16 a[202:203], v247 offset:8704
v_mfma_f32_16x16x32_bf16 v[68:71], a[208:211], a[164:167], v[68:71]
v_mfma_f32_16x16x32_bf16 v[72:75], a[208:211], a[168:171], v[72:75]
ds_read_b64_tr_b16 a[204:205], v247 offset:32768
v_mfma_f32_16x16x32_bf16 v[72:75], a[212:215], a[184:187], v[72:75]
v_mfma_f32_16x16x32_bf16 v[76:79], a[212:215], a[188:191], v[76:79]
ds_read_b64_tr_b16 a[206:207], v247 offset:33280
v_mfma_f32_16x16x32_bf16 v[76:79], a[208:211], a[172:175], v[76:79]
s_waitcnt lgkmcnt(8)
v_mfma_f32_16x16x32_bf16 v[28:31], a[216:219], a[172:175], v[28:31]
ds_read_b64_tr_b16 a[208:209], v247 offset:16384
v_mfma_f32_16x16x32_bf16 v[28:31], a[220:223], a[188:191], v[28:31]
v_mfma_f32_16x16x32_bf16 v[24:27], a[220:223], a[184:187], v[24:27]
ds_read_b64_tr_b16 a[210:211], v247 offset:16896
v_pk_mul_f32 v[252:253], v[48:49], v[48:49]
v_pk_mul_f32 v[254:255], v[50:51], v[50:51]
v_pk_fma_f32 v[252:253], v[252:253], v[2:3], v[2:3] op_sel:[0,0,1] op_sel_hi:[1,0,1]
v_pk_fma_f32 v[254:255], v[254:255], v[2:3], v[2:3] op_sel:[0,0,1] op_sel_hi:[1,0,1]
v_pk_mul_f32 v[64:65], v[48:49], v[64:65]
v_pk_mul_f32 v[66:67], v[50:51], v[66:67]
v_pk_mul_f32 v[48:49], v[48:49], v[252:253]
v_pk_mul_f32 v[50:51], v[50:51], v[254:255]
v_pk_mul_f32 v[252:253], v[52:53], v[52:53]
v_pk_mul_f32 v[254:255], v[54:55], v[54:55]
v_pk_fma_f32 v[252:253], v[252:253], v[14:15], v[14:15] op_sel:[0,0,1] op_sel_hi:[1,0,1]
v_pk_fma_f32 v[254:255], v[254:255], v[14:15], v[14:15] op_sel:[0,0,1] op_sel_hi:[1,0,1]
v_pk_mul_f32 v[68:69], v[52:53], v[68:69]
v_pk_mul_f32 v[70:71], v[54:55], v[70:71]
v_pk_mul_f32 v[52:53], v[52:53], v[252:253]
v_pk_mul_f32 v[54:55], v[54:55], v[254:255]
v_pk_mul_f32 v[252:253], v[56:57], v[56:57]
v_pk_mul_f32 v[254:255], v[58:59], v[58:59]
v_pk_fma_f32 v[252:253], v[252:253], v[0:1], v[0:1] op_sel:[0,0,1] op_sel_hi:[1,0,1]
v_pk_fma_f32 v[254:255], v[254:255], v[0:1], v[0:1] op_sel:[0,0,1] op_sel_hi:[1,0,1]
v_pk_mul_f32 v[72:73], v[56:57], v[72:73]
v_pk_mul_f32 v[74:75], v[58:59], v[74:75]
v_pk_mul_f32 v[56:57], v[56:57], v[252:253]
v_pk_mul_f32 v[58:59], v[58:59], v[254:255]
v_pk_mul_f32 v[252:253], v[60:61], v[60:61]
v_pk_mul_f32 v[254:255], v[62:63], v[62:63]
v_pk_fma_f32 v[252:253], v[252:253], v[8:9], v[8:9] op_sel:[0,0,1] op_sel_hi:[1,0,1]
v_pk_fma_f32 v[254:255], v[254:255], v[8:9], v[8:9] op_sel:[0,0,1] op_sel_hi:[1,0,1]
v_pk_mul_f32 v[76:77], v[60:61], v[76:77]
v_pk_mul_f32 v[78:79], v[62:63], v[78:79]
v_pk_mul_f32 v[60:61], v[60:61], v[252:253]
v_pk_mul_f32 v[62:63], v[62:63], v[254:255]
v_mfma_f32_16x16x32_bf16 v[24:27], a[216:219], a[168:171], v[24:27]
v_exp_f32 v48, v48
v_mfma_f32_16x16x32_bf16 v[20:23], a[216:219], a[164:167], v[20:23]
ds_read_b64_tr_b16 a[212:213], v247 offset:40960
ds_read_b64_tr_b16 a[214:215], v247 offset:41472
v_mfma_f32_16x16x32_bf16 v[20:23], a[220:223], a[180:183], v[20:23]
v_exp_f32 v49, v49
v_mfma_f32_16x16x32_bf16 v[16:19], a[220:223], a[176:179], v[16:19]
v_exp_f32 v50, v50
v_mfma_f32_16x16x32_bf16 v[16:19], a[216:219], a[160:163], v[16:19]
v_exp_f32 v51, v51
s_waitcnt lgkmcnt(8)
v_mfma_f32_16x16x32_bf16 v[32:35], a[192:195], a[160:163], v[32:35]
ds_read_b64_tr_b16 a[216:217], v240 offset:12288
ds_read_b64_tr_b16 a[218:219], v240 offset:12800
v_mfma_f32_16x16x32_bf16 v[32:35], a[196:199], a[176:179], v[32:35]
v_exp_f32 v52, v52
v_mfma_f32_16x16x32_bf16 v[36:39], a[196:199], a[180:183], v[36:39]
v_exp_f32 v53, v53
v_mfma_f32_16x16x32_bf16 v[36:39], a[192:195], a[164:167], v[36:39]
v_exp_f32 v54, v54
v_mfma_f32_16x16x4_4b_bf16 v[16:31], a[230:231], a[238:239], v[16:31] cbsz:2 abid:0
v_exp_f32 v55, v55
v_exp_f32 v56, v56
v_exp_f32 v57, v57
v_mfma_f32_16x16x32_bf16 v[40:43], a[192:195], a[168:171], v[40:43]
ds_read_b64_tr_b16 a[220:221], v240 offset:36864
ds_read_b64_tr_b16 a[222:223], v240 offset:37376
v_mfma_f32_16x16x32_bf16 v[40:43], a[196:199], a[184:187], v[40:43]
v_exp_f32 v58, v58
v_mfma_f32_16x16x32_bf16 v[44:47], a[196:199], a[188:191], v[44:47]
v_exp_f32 v59, v59
v_mfma_f32_16x16x32_bf16 v[44:47], a[192:195], a[172:175], v[44:47]
v_exp_f32 v60, v60
s_waitcnt lgkmcnt(8)
v_mfma_f32_16x16x32_bf16 v[124:127], a[200:203], a[172:175], v[124:127]
ds_read_b64_tr_b16 a[192:193], v240 offset:20480
ds_read_b64_tr_b16 a[194:195], v240 offset:20992
v_mfma_f32_16x16x32_bf16 v[124:127], a[204:207], a[188:191], v[124:127]
v_exp_f32 v61, v61
v_mfma_f32_16x16x32_bf16 v[120:123], a[204:207], a[184:187], v[120:123]
v_exp_f32 v62, v62
v_mfma_f32_16x16x32_bf16 v[120:123], a[200:203], a[168:171], v[120:123]
v_exp_f32 v63, v63
v_mfma_f32_16x16x4_4b_bf16 v[32:47], a[230:231], a[242:243], v[32:47] cbsz:2 abid:0
v_mfma_f32_16x16x32_bf16 v[116:119], a[200:203], a[164:167], v[116:119]
ds_read_b64_tr_b16 a[196:197], v240 offset:45056
v_mfma_f32_16x16x32_bf16 v[116:119], a[204:207], a[180:183], v[116:119]
v_mfma_f32_16x16x32_bf16 v[112:115], a[204:207], a[176:179], v[112:115]
ds_read_b64_tr_b16 a[198:199], v240 offset:45568
v_mfma_f32_16x16x32_bf16 v[112:115], a[200:203], a[160:163], v[112:115]
v_pk_fma_f32 v[48:49], v[48:49], v[4:5], v[4:5] op_sel:[0,0,0] op_sel_hi:[1,0,0]
v_pk_fma_f32 v[50:51], v[50:51], v[4:5], v[4:5] op_sel:[0,0,0] op_sel_hi:[1,0,0]
v_pk_fma_f32 v[52:53], v[52:53], v[12:13], v[12:13] op_sel:[0,1,1] op_sel_hi:[1,1,1]
v_pk_fma_f32 v[54:55], v[54:55], v[12:13], v[12:13] op_sel:[0,1,1] op_sel_hi:[1,1,1]
v_pk_fma_f32 v[56:57], v[56:57], v[6:7], v[6:7] op_sel:[0,0,0] op_sel_hi:[1,0,0]
v_pk_fma_f32 v[58:59], v[58:59], v[6:7], v[6:7] op_sel:[0,0,0] op_sel_hi:[1,0,0]
v_pk_fma_f32 v[60:61], v[60:61], v[6:7], v[6:7] op_sel:[0,1,1] op_sel_hi:[1,1,1]
v_pk_fma_f32 v[62:63], v[62:63], v[6:7], v[6:7] op_sel:[0,1,1] op_sel_hi:[1,1,1]
v_pk_mul_f32 v[252:253], v[16:17], v[16:17]
v_pk_mul_f32 v[254:255], v[18:19], v[18:19]
v_pk_fma_f32 v[252:253], v[252:253], v[2:3], v[2:3] op_sel:[0,0,1] op_sel_hi:[1,0,1]
v_pk_fma_f32 v[254:255], v[254:255], v[2:3], v[2:3] op_sel:[0,0,1] op_sel_hi:[1,0,1]
v_pk_mul_f32 v[32:33], v[16:17], v[32:33]
v_pk_mul_f32 v[34:35], v[18:19], v[34:35]
v_pk_mul_f32 v[16:17], v[16:17], v[252:253]
v_pk_mul_f32 v[18:19], v[18:19], v[254:255]
v_pk_mul_f32 v[252:253], v[20:21], v[20:21]
v_pk_mul_f32 v[254:255], v[22:23], v[22:23]
v_pk_fma_f32 v[252:253], v[252:253], v[14:15], v[14:15] op_sel:[0,0,1] op_sel_hi:[1,0,1]
v_pk_fma_f32 v[254:255], v[254:255], v[14:15], v[14:15] op_sel:[0,0,1] op_sel_hi:[1,0,1]
v_pk_mul_f32 v[36:37], v[20:21], v[36:37]
v_pk_mul_f32 v[38:39], v[22:23], v[38:39]
v_pk_mul_f32 v[20:21], v[20:21], v[252:253]
v_pk_mul_f32 v[22:23], v[22:23], v[254:255]
v_pk_mul_f32 v[252:253], v[24:25], v[24:25]
v_pk_mul_f32 v[254:255], v[26:27], v[26:27]
v_pk_fma_f32 v[252:253], v[252:253], v[0:1], v[0:1] op_sel:[0,0,1] op_sel_hi:[1,0,1]
v_pk_fma_f32 v[254:255], v[254:255], v[0:1], v[0:1] op_sel:[0,0,1] op_sel_hi:[1,0,1]
v_pk_mul_f32 v[40:41], v[24:25], v[40:41]
v_pk_mul_f32 v[42:43], v[26:27], v[42:43]
v_pk_mul_f32 v[24:25], v[24:25], v[252:253]
v_pk_mul_f32 v[26:27], v[26:27], v[254:255]
v_pk_mul_f32 v[252:253], v[28:29], v[28:29]
v_pk_mul_f32 v[254:255], v[30:31], v[30:31]
v_pk_fma_f32 v[252:253], v[252:253], v[8:9], v[8:9] op_sel:[0,0,1] op_sel_hi:[1,0,1]
v_pk_fma_f32 v[254:255], v[254:255], v[8:9], v[8:9] op_sel:[0,0,1] op_sel_hi:[1,0,1]
v_pk_mul_f32 v[44:45], v[28:29], v[44:45]
v_pk_mul_f32 v[46:47], v[30:31], v[46:47]
v_pk_mul_f32 v[28:29], v[28:29], v[252:253]
v_pk_mul_f32 v[30:31], v[30:31], v[254:255]
s_waitcnt lgkmcnt(8)
v_mfma_f32_16x16x32_bf16 v[128:131], a[208:211], a[160:163], v[128:131]
ds_read_b64_tr_b16 a[200:201], v241 offset:12288
ds_read_b64_tr_b16 a[202:203], v241 offset:12800
v_mfma_f32_16x16x32_bf16 v[128:131], a[212:215], a[176:179], v[128:131]
v_rcp_f32 v48, v48
v_mfma_f32_16x16x32_bf16 v[132:135], a[212:215], a[180:183], v[132:135]
v_rcp_f32 v49, v49
v_mfma_f32_16x16x32_bf16 v[132:135], a[208:211], a[164:167], v[132:135]
v_rcp_f32 v50, v50
v_mfma_f32_16x16x4_4b_bf16 v[112:127], a[230:231], a[238:239], v[112:127] cbsz:2 abid:3
v_rcp_f32 v51, v51
v_rcp_f32 v52, v52
v_rcp_f32 v53, v53
v_mfma_f32_16x16x32_bf16 v[136:139], a[208:211], a[168:171], v[136:139]
ds_read_b64_tr_b16 a[204:205], v241 offset:36864
ds_read_b64_tr_b16 a[206:207], v241 offset:37376
v_mfma_f32_16x16x32_bf16 v[136:139], a[212:215], a[184:187], v[136:139]
v_rcp_f32 v54, v54
v_mfma_f32_16x16x32_bf16 v[140:143], a[212:215], a[188:191], v[140:143]
v_rcp_f32 v55, v55
v_mfma_f32_16x16x32_bf16 v[140:143], a[208:211], a[172:175], v[140:143]
v_rcp_f32 v56, v56
s_waitcnt lgkmcnt(8)
v_mfma_f32_16x16x32_bf16 v[156:159], a[216:219], a[140:143], v[156:159]
ds_read_b64_tr_b16 a[208:209], v241 offset:20480
ds_read_b64_tr_b16 a[210:211], v241 offset:20992
v_mfma_f32_16x16x32_bf16 v[156:159], a[220:223], a[156:159], v[156:159]
v_rcp_f32 v57, v57
v_mfma_f32_16x16x32_bf16 v[152:155], a[220:223], a[152:155], v[152:155]
v_rcp_f32 v58, v58
v_mfma_f32_16x16x32_bf16 v[152:155], a[216:219], a[136:139], v[152:155]
v_rcp_f32 v59, v59
v_mfma_f32_16x16x4_4b_bf16 v[128:143], a[230:231], a[242:243], v[128:143] cbsz:2 abid:3
v_rcp_f32 v60, v60
v_rcp_f32 v61, v61
v_rcp_f32 v62, v62
v_mfma_f32_16x16x32_bf16 v[148:151], a[216:219], a[132:135], v[148:151]
ds_read_b64_tr_b16 a[212:213], v241 offset:45056
ds_read_b64_tr_b16 a[214:215], v241 offset:45568
v_mfma_f32_16x16x32_bf16 v[148:151], a[220:223], a[148:151], v[148:151]
v_rcp_f32 v63, v63
v_mfma_f32_16x16x32_bf16 v[144:147], a[220:223], a[144:147], v[144:147]
v_exp_f32 v16, v16
v_mfma_f32_16x16x32_bf16 v[144:147], a[216:219], a[128:131], v[144:147]
v_exp_f32 v17, v17
s_waitcnt lgkmcnt(8)
v_mfma_f32_16x16x32_bf16 v[160:163], a[192:195], a[128:131], v[160:163]
ds_read_b64_tr_b16 a[216:217], v246 offset:8192
ds_read_b64_tr_b16 a[218:219], v246 offset:8704
v_mfma_f32_16x16x32_bf16 v[160:163], a[196:199], a[144:147], v[160:163]
v_exp_f32 v18, v18
v_mfma_f32_16x16x32_bf16 v[164:167], a[196:199], a[148:151], v[164:167]
v_exp_f32 v19, v19
v_mfma_f32_16x16x32_bf16 v[164:167], a[192:195], a[132:135], v[164:167]
v_exp_f32 v20, v20
v_mfma_f32_16x16x4_4b_bf16 v[80:95], a[230:231], a[238:239], v[80:95] cbsz:2 abid:2
v_exp_f32 v21, v21
v_exp_f32 v22, v22
v_exp_f32 v23, v23
v_mfma_f32_16x16x32_bf16 v[168:171], a[192:195], a[136:139], v[168:171]
ds_read_b64_tr_b16 a[220:221], v246 offset:32768
ds_read_b64_tr_b16 a[222:223], v246 offset:33280
v_mfma_f32_16x16x32_bf16 v[168:171], a[196:199], a[152:155], v[168:171]
v_exp_f32 v24, v24
v_mfma_f32_16x16x32_bf16 v[172:175], a[196:199], a[156:159], v[172:175]
v_exp_f32 v25, v25
v_mfma_f32_16x16x32_bf16 v[172:175], a[192:195], a[140:143], v[172:175]
v_exp_f32 v26, v26
s_waitcnt lgkmcnt(8)
v_mfma_f32_16x16x32_bf16 v[188:191], a[200:203], a[140:143], v[188:191]
ds_read_b64_tr_b16 a[192:193], v246 offset:16384
ds_read_b64_tr_b16 a[194:195], v246 offset:16896
v_mfma_f32_16x16x32_bf16 v[188:191], a[204:207], a[156:159], v[188:191]
v_exp_f32 v27, v27
v_mfma_f32_16x16x32_bf16 v[184:187], a[204:207], a[152:155], v[184:187]
v_exp_f32 v28, v28
v_mfma_f32_16x16x32_bf16 v[184:187], a[200:203], a[136:139], v[184:187]
v_exp_f32 v29, v29
v_mfma_f32_16x16x32_bf16 v[180:183], a[200:203], a[132:135], v[180:183]
ds_read_b64_tr_b16 a[196:197], v246 offset:40960
ds_read_b64_tr_b16 a[198:199], v246 offset:41472
v_mfma_f32_16x16x32_bf16 v[180:183], a[204:207], a[148:151], v[180:183]
v_exp_f32 v30, v30
v_mfma_f32_16x16x32_bf16 v[176:179], a[204:207], a[144:147], v[176:179]
v_exp_f32 v31, v31
v_mfma_f32_16x16x32_bf16 v[176:179], a[200:203], a[128:131], v[176:179]
s_nop 0
v_pk_mul_f32 v[64:65], v[64:65], v[48:49]
v_pk_mul_f32 v[66:67], v[66:67], v[50:51]
v_pk_mul_f32 v[68:69], v[68:69], v[52:53]
v_pk_mul_f32 v[70:71], v[70:71], v[54:55]
v_pk_mul_f32 v[72:73], v[72:73], v[56:57]
v_pk_mul_f32 v[74:75], v[74:75], v[58:59]
v_pk_mul_f32 v[76:77], v[76:77], v[60:61]
v_pk_mul_f32 v[78:79], v[78:79], v[62:63]
v_pk_fma_f32 v[16:17], v[16:17], v[4:5], v[4:5] op_sel:[0,0,0] op_sel_hi:[1,0,0]
v_pk_fma_f32 v[18:19], v[18:19], v[4:5], v[4:5] op_sel:[0,0,0] op_sel_hi:[1,0,0]
v_pk_fma_f32 v[20:21], v[20:21], v[12:13], v[12:13] op_sel:[0,1,1] op_sel_hi:[1,1,1]
v_pk_fma_f32 v[22:23], v[22:23], v[12:13], v[12:13] op_sel:[0,1,1] op_sel_hi:[1,1,1]
v_pk_fma_f32 v[24:25], v[24:25], v[6:7], v[6:7] op_sel:[0,0,0] op_sel_hi:[1,0,0]
v_pk_fma_f32 v[26:27], v[26:27], v[6:7], v[6:7] op_sel:[0,0,0] op_sel_hi:[1,0,0]
v_pk_fma_f32 v[28:29], v[28:29], v[6:7], v[6:7] op_sel:[0,1,1] op_sel_hi:[1,1,1]
v_pk_fma_f32 v[30:31], v[30:31], v[6:7], v[6:7] op_sel:[0,1,1] op_sel_hi:[1,1,1]
v_pk_mul_f32 v[252:253], v[112:113], v[112:113]
v_pk_mul_f32 v[254:255], v[114:115], v[114:115]
v_pk_fma_f32 v[252:253], v[252:253], v[2:3], v[2:3] op_sel:[0,0,1] op_sel_hi:[1,0,1]
v_pk_fma_f32 v[254:255], v[254:255], v[2:3], v[2:3] op_sel:[0,0,1] op_sel_hi:[1,0,1]
v_pk_mul_f32 v[128:129], v[112:113], v[128:129]
v_pk_mul_f32 v[130:131], v[114:115], v[130:131]
v_pk_mul_f32 v[112:113], v[112:113], v[252:253]
v_pk_mul_f32 v[114:115], v[114:115], v[254:255]
v_pk_mul_f32 v[252:253], v[116:117], v[116:117]
v_pk_mul_f32 v[254:255], v[118:119], v[118:119]
v_pk_fma_f32 v[252:253], v[252:253], v[14:15], v[14:15] op_sel:[0,0,1] op_sel_hi:[1,0,1]
v_pk_fma_f32 v[254:255], v[254:255], v[14:15], v[14:15] op_sel:[0,0,1] op_sel_hi:[1,0,1]
v_pk_mul_f32 v[132:133], v[116:117], v[132:133]
v_pk_mul_f32 v[134:135], v[118:119], v[134:135]
v_pk_mul_f32 v[116:117], v[116:117], v[252:253]
v_pk_mul_f32 v[118:119], v[118:119], v[254:255]
v_pk_mul_f32 v[252:253], v[120:121], v[120:121]
v_pk_mul_f32 v[254:255], v[122:123], v[122:123]
v_pk_fma_f32 v[252:253], v[252:253], v[0:1], v[0:1] op_sel:[0,0,1] op_sel_hi:[1,0,1]
v_pk_fma_f32 v[254:255], v[254:255], v[0:1], v[0:1] op_sel:[0,0,1] op_sel_hi:[1,0,1]
v_pk_mul_f32 v[136:137], v[120:121], v[136:137]
v_pk_mul_f32 v[138:139], v[122:123], v[138:139]
v_pk_mul_f32 v[120:121], v[120:121], v[252:253]
v_pk_mul_f32 v[122:123], v[122:123], v[254:255]
v_pk_mul_f32 v[252:253], v[124:125], v[124:125]
v_pk_mul_f32 v[254:255], v[126:127], v[126:127]
v_pk_fma_f32 v[252:253], v[252:253], v[8:9], v[8:9] op_sel:[0,0,1] op_sel_hi:[1,0,1]
v_pk_fma_f32 v[254:255], v[254:255], v[8:9], v[8:9] op_sel:[0,0,1] op_sel_hi:[1,0,1]
v_pk_mul_f32 v[140:141], v[124:125], v[140:141]
v_pk_mul_f32 v[142:143], v[126:127], v[142:143]
v_pk_mul_f32 v[124:125], v[124:125], v[252:253]
v_pk_mul_f32 v[126:127], v[126:127], v[254:255]
s_waitcnt lgkmcnt(8)
v_mfma_f32_16x16x32_bf16 v[192:195], a[208:211], a[128:131], v[192:195]
ds_read_b64_tr_b16 a[200:201], v246 offset:12288
v_cvt_pk_bf16_f32 v50, v64, v65
v_mfma_f32_16x16x32_bf16 v[192:195], a[212:215], a[144:147], v[192:195]
v_rcp_f32 v16, v16
v_mfma_f32_16x16x32_bf16 v[196:199], a[212:215], a[148:151], v[196:199]
ds_read_b64_tr_b16 a[202:203], v246 offset:12800
v_cvt_pk_bf16_f32 v51, v66, v67
v_mfma_f32_16x16x32_bf16 v[196:199], a[208:211], a[132:135], v[196:199]
v_rcp_f32 v17, v17
v_mfma_f32_16x16x4_4b_bf16 v[96:111], a[230:231], a[242:243], v[96:111] cbsz:2 abid:2
v_rcp_f32 v18, v18
v_rcp_f32 v19, v19
v_rcp_f32 v20, v20
v_mfma_f32_16x16x32_bf16 v[200:203], a[208:211], a[136:139], v[200:203]
ds_read_b64_tr_b16 a[204:205], v246 offset:36864
v_cvt_pk_bf16_f32 v54, v68, v69
v_mfma_f32_16x16x32_bf16 v[200:203], a[212:215], a[152:155], v[200:203]
v_rcp_f32 v21, v21
v_mfma_f32_16x16x32_bf16 v[204:207], a[212:215], a[156:159], v[204:207]
ds_read_b64_tr_b16 a[206:207], v246 offset:37376
v_cvt_pk_bf16_f32 v55, v70, v71
v_mfma_f32_16x16x32_bf16 v[204:207], a[208:211], a[140:143], v[204:207]
v_rcp_f32 v22, v22
s_waitcnt lgkmcnt(8)
v_mfma_f32_16x16x32_bf16 v[92:95], a[216:219], a[172:175], v[92:95]
ds_read_b64_tr_b16 a[208:209], v246 offset:20480
v_cvt_pk_bf16_f32 v58, v72, v73
v_mfma_f32_16x16x32_bf16 v[92:95], a[220:223], a[188:191], v[92:95]
v_rcp_f32 v23, v23
v_mfma_f32_16x16x32_bf16 v[88:91], a[220:223], a[184:187], v[88:91]
ds_read_b64_tr_b16 a[210:211], v246 offset:20992
v_cvt_pk_bf16_f32 v59, v74, v75
v_mfma_f32_16x16x32_bf16 v[88:91], a[216:219], a[168:171], v[88:91]
v_rcp_f32 v24, v24
v_mfma_f32_16x16x4_4b_bf16 v[208:223], a[234:235], a[238:239], v[208:223] cbsz:2 abid:2
v_rcp_f32 v25, v25
v_rcp_f32 v26, v26
v_rcp_f32 v27, v27
v_mfma_f32_16x16x32_bf16 v[84:87], a[216:219], a[164:167], v[84:87]
ds_read_b64_tr_b16 a[212:213], v246 offset:45056
v_cvt_pk_bf16_f32 v62, v76, v77
v_mfma_f32_16x16x32_bf16 v[84:87], a[220:223], a[180:183], v[84:87]
v_rcp_f32 v28, v28
v_mfma_f32_16x16x32_bf16 v[80:83], a[220:223], a[176:179], v[80:83]
ds_read_b64_tr_b16 a[214:215], v246 offset:45568
v_cvt_pk_bf16_f32 v63, v78, v79
v_mfma_f32_16x16x32_bf16 v[80:83], a[216:219], a[160:163], v[80:83]
v_rcp_f32 v29, v29
s_waitcnt lgkmcnt(8)
v_mfma_f32_16x16x32_bf16 v[96:99], a[192:195], a[160:163], v[96:99]
ds_read_b64_tr_b16 a[216:217], v244 offset:12288
ds_read_b64_tr_b16 a[218:219], v244 offset:12800
v_mfma_f32_16x16x32_bf16 v[96:99], a[196:199], a[176:179], v[96:99]
v_rcp_f32 v30, v30
v_mfma_f32_16x16x32_bf16 v[100:103], a[196:199], a[180:183], v[100:103]
v_rcp_f32 v31, v31
v_mfma_f32_16x16x32_bf16 v[100:103], a[192:195], a[164:167], v[100:103]
v_exp_f32 v112, v112
v_mfma_f32_16x16x4_4b_bf16 v[224:239], a[234:235], a[242:243], v[224:239] cbsz:2 abid:2
v_exp_f32 v113, v113
v_exp_f32 v114, v114
v_exp_f32 v115, v115
v_mfma_f32_16x16x32_bf16 v[104:107], a[192:195], a[168:171], v[104:107]
ds_read_b64_tr_b16 a[220:221], v244 offset:36864
ds_read_b64_tr_b16 a[222:223], v244 offset:37376
v_mfma_f32_16x16x32_bf16 v[104:107], a[196:199], a[184:187], v[104:107]
v_exp_f32 v116, v116
v_mfma_f32_16x16x32_bf16 v[108:111], a[196:199], a[188:191], v[108:111]
v_exp_f32 v117, v117
v_mfma_f32_16x16x32_bf16 v[108:111], a[192:195], a[172:175], v[108:111]
v_exp_f32 v118, v118
s_waitcnt lgkmcnt(8)
v_mfma_f32_16x16x32_bf16 v[220:223], a[200:203], a[172:175], v[220:223]
ds_read_b64_tr_b16 a[192:193], v244 offset:20480
ds_read_b64_tr_b16 a[194:195], v244 offset:20992
v_mfma_f32_16x16x32_bf16 v[220:223], a[204:207], a[188:191], v[220:223]
v_exp_f32 v119, v119
v_mfma_f32_16x16x32_bf16 v[216:219], a[204:207], a[184:187], v[216:219]
v_exp_f32 v120, v120
v_mfma_f32_16x16x32_bf16 v[216:219], a[200:203], a[168:171], v[216:219]
v_exp_f32 v121, v121
v_mfma_f32_16x16x4_4b_bf16 v[144:159], a[234:235], a[238:239], v[144:159] cbsz:2 abid:0
v_exp_f32 v122, v122
v_exp_f32 v123, v123
v_exp_f32 v124, v124
v_mfma_f32_16x16x32_bf16 v[212:215], a[200:203], a[164:167], v[212:215]
ds_read_b64_tr_b16 a[196:197], v244 offset:45056
ds_read_b64_tr_b16 a[198:199], v244 offset:45568
v_mfma_f32_16x16x32_bf16 v[212:215], a[204:207], a[180:183], v[212:215]
v_exp_f32 v125, v125
v_mfma_f32_16x16x32_bf16 v[208:211], a[204:207], a[176:179], v[208:211]
v_exp_f32 v126, v126
v_mfma_f32_16x16x32_bf16 v[208:211], a[200:203], a[160:163], v[208:211]
v_exp_f32 v127, v127
s_waitcnt lgkmcnt(8)
v_mfma_f32_16x16x32_bf16 v[224:227], a[208:211], a[160:163], v[224:227]
ds_read_b64_tr_b16 a[200:201], v245 offset:12288
v_pk_mul_f32 v[32:33], v[32:33], v[16:17]
v_pk_mul_f32 v[34:35], v[34:35], v[18:19]
v_pk_mul_f32 v[36:37], v[36:37], v[20:21]
v_pk_mul_f32 v[38:39], v[38:39], v[22:23]
v_pk_mul_f32 v[40:41], v[40:41], v[24:25]
v_pk_mul_f32 v[42:43], v[42:43], v[26:27]
v_pk_mul_f32 v[44:45], v[44:45], v[28:29]
v_pk_mul_f32 v[46:47], v[46:47], v[30:31]
v_pk_fma_f32 v[112:113], v[112:113], v[4:5], v[4:5] op_sel:[0,0,0] op_sel_hi:[1,0,0]
v_pk_fma_f32 v[114:115], v[114:115], v[4:5], v[4:5] op_sel:[0,0,0] op_sel_hi:[1,0,0]
v_pk_fma_f32 v[116:117], v[116:117], v[12:13], v[12:13] op_sel:[0,1,1] op_sel_hi:[1,1,1]
v_pk_fma_f32 v[118:119], v[118:119], v[12:13], v[12:13] op_sel:[0,1,1] op_sel_hi:[1,1,1]
v_pk_fma_f32 v[120:121], v[120:121], v[6:7], v[6:7] op_sel:[0,0,0] op_sel_hi:[1,0,0]
v_pk_fma_f32 v[122:123], v[122:123], v[6:7], v[6:7] op_sel:[0,0,0] op_sel_hi:[1,0,0]
v_pk_fma_f32 v[124:125], v[124:125], v[6:7], v[6:7] op_sel:[0,1,1] op_sel_hi:[1,1,1]
v_pk_fma_f32 v[126:127], v[126:127], v[6:7], v[6:7] op_sel:[0,1,1] op_sel_hi:[1,1,1]
v_pk_mul_f32 v[252:253], v[80:81], v[80:81]
v_pk_mul_f32 v[254:255], v[82:83], v[82:83]
v_pk_fma_f32 v[252:253], v[252:253], v[2:3], v[2:3] op_sel:[0,0,1] op_sel_hi:[1,0,1]
v_pk_fma_f32 v[254:255], v[254:255], v[2:3], v[2:3] op_sel:[0,0,1] op_sel_hi:[1,0,1]
v_pk_mul_f32 v[96:97], v[80:81], v[96:97]
v_pk_mul_f32 v[98:99], v[82:83], v[98:99]
v_pk_mul_f32 v[80:81], v[80:81], v[252:253]
v_pk_mul_f32 v[82:83], v[82:83], v[254:255]
v_pk_mul_f32 v[252:253], v[84:85], v[84:85]
v_pk_mul_f32 v[254:255], v[86:87], v[86:87]
v_pk_fma_f32 v[252:253], v[252:253], v[14:15], v[14:15] op_sel:[0,0,1] op_sel_hi:[1,0,1]
v_pk_fma_f32 v[254:255], v[254:255], v[14:15], v[14:15] op_sel:[0,0,1] op_sel_hi:[1,0,1]
v_pk_mul_f32 v[100:101], v[84:85], v[100:101]
v_pk_mul_f32 v[102:103], v[86:87], v[102:103]
v_pk_mul_f32 v[84:85], v[84:85], v[252:253]
v_pk_mul_f32 v[86:87], v[86:87], v[254:255]
v_pk_mul_f32 v[252:253], v[88:89], v[88:89]
v_pk_mul_f32 v[254:255], v[90:91], v[90:91]
v_pk_fma_f32 v[252:253], v[252:253], v[0:1], v[0:1] op_sel:[0,0,1] op_sel_hi:[1,0,1]
v_pk_fma_f32 v[254:255], v[254:255], v[0:1], v[0:1] op_sel:[0,0,1] op_sel_hi:[1,0,1]
v_pk_mul_f32 v[104:105], v[88:89], v[104:105]
v_pk_mul_f32 v[106:107], v[90:91], v[106:107]
v_pk_mul_f32 v[88:89], v[88:89], v[252:253]
v_pk_mul_f32 v[90:91], v[90:91], v[254:255]
v_pk_mul_f32 v[252:253], v[92:93], v[92:93]
v_pk_mul_f32 v[254:255], v[94:95], v[94:95]
v_pk_fma_f32 v[252:253], v[252:253], v[8:9], v[8:9] op_sel:[0,0,1] op_sel_hi:[1,0,1]
v_pk_fma_f32 v[254:255], v[254:255], v[8:9], v[8:9] op_sel:[0,0,1] op_sel_hi:[1,0,1]
v_pk_mul_f32 v[108:109], v[92:93], v[108:109]
v_pk_mul_f32 v[110:111], v[94:95], v[110:111]
v_pk_mul_f32 v[92:93], v[92:93], v[252:253]
v_pk_mul_f32 v[94:95], v[94:95], v[254:255]
v_mfma_f32_16x16x32_bf16 v[224:227], a[212:215], a[176:179], v[224:227]
v_rcp_f32 v112, v112
v_mfma_f32_16x16x32_bf16 v[228:231], a[212:215], a[180:183], v[228:231]
ds_read_b64_tr_b16 a[202:203], v245 offset:12800
v_cvt_pk_bf16_f32 v48, v32, v33
v_mfma_f32_16x16x32_bf16 v[228:231], a[208:211], a[164:167], v[228:231]
v_rcp_f32 v113, v113
v_mfma_f32_16x16x32_bf16 v[232:235], a[208:211], a[168:171], v[232:235]
ds_read_b64_tr_b16 a[204:205], v245 offset:36864
v_cvt_pk_bf16_f32 v49, v34, v35
v_mfma_f32_16x16x32_bf16 v[232:235], a[212:215], a[184:187], v[232:235]
v_rcp_f32 v114, v114
v_mfma_f32_16x16x32_bf16 v[236:239], a[212:215], a[188:191], v[236:239]
ds_read_b64_tr_b16 a[206:207], v245 offset:37376
v_cvt_pk_bf16_f32 v52, v36, v37
v_mfma_f32_16x16x32_bf16 v[236:239], a[208:211], a[172:175], v[236:239]
v_rcp_f32 v115, v115
s_waitcnt lgkmcnt(8)
v_mfma_f32_16x16x32_bf16 v[156:159], a[216:219], a[172:175], v[156:159]
ds_read_b64_tr_b16 a[208:209], v245 offset:20480
v_cvt_pk_bf16_f32 v53, v38, v39
v_mfma_f32_16x16x32_bf16 v[156:159], a[220:223], a[188:191], v[156:159]
v_rcp_f32 v116, v116
v_mfma_f32_16x16x32_bf16 v[152:155], a[220:223], a[184:187], v[152:155]
ds_read_b64_tr_b16 a[210:211], v245 offset:20992
v_cvt_pk_bf16_f32 v56, v40, v41
v_mfma_f32_16x16x32_bf16 v[152:155], a[216:219], a[168:171], v[152:155]
v_rcp_f32 v117, v117
v_mfma_f32_16x16x4_4b_bf16 v[160:175], a[234:235], a[242:243], v[160:175] cbsz:2 abid:0
v_rcp_f32 v118, v118
v_rcp_f32 v119, v119
v_rcp_f32 v120, v120
v_mfma_f32_16x16x32_bf16 v[148:151], a[216:219], a[164:167], v[148:151]
ds_read_b64_tr_b16 a[212:213], v245 offset:45056
v_cvt_pk_bf16_f32 v57, v42, v43
v_mfma_f32_16x16x32_bf16 v[148:151], a[220:223], a[180:183], v[148:151]
v_rcp_f32 v121, v121
v_mfma_f32_16x16x32_bf16 v[144:147], a[220:223], a[176:179], v[144:147]
ds_read_b64_tr_b16 a[214:215], v245 offset:45568
v_cvt_pk_bf16_f32 v60, v44, v45
v_mfma_f32_16x16x32_bf16 v[144:147], a[216:219], a[160:163], v[144:147]
v_rcp_f32 v122, v122
s_waitcnt lgkmcnt(8)
v_mfma_f32_16x16x32_bf16 v[160:163], a[192:195], a[160:163], v[160:163]
ds_read_b64_tr_b16 a[216:217], v250 offset:0
v_cvt_pk_bf16_f32 v61, v46, v47
v_mfma_f32_16x16x32_bf16 v[160:163], a[196:199], a[176:179], v[160:163]
buffer_store_dwordx4 v[48:51], v5, s[32:35], s48 offen offset:0 sc0 sc1
v_mfma_f32_16x16x32_bf16 v[164:167], a[196:199], a[180:183], v[164:167]
ds_read_b64_tr_b16 a[218:219], v250 offset:512
v_mfma_f32_16x16x32_bf16 v[164:167], a[192:195], a[164:167], v[164:167]
v_rcp_f32 v123, v123
v_mfma_f32_16x16x4_4b_bf16 v[176:191], a[234:235], a[238:239], v[176:191] cbsz:2 abid:1
v_rcp_f32 v124, v124
v_rcp_f32 v125, v125
v_rcp_f32 v126, v126
v_mfma_f32_16x16x32_bf16 v[168:171], a[192:195], a[168:171], v[168:171]
ds_read_b64_tr_b16 a[220:221], v250 offset:24576
ds_read_b64_tr_b16 a[222:223], v250 offset:25088
v_mfma_f32_16x16x32_bf16 v[168:171], a[196:199], a[184:187], v[168:171]
v_rcp_f32 v127, v127
v_mfma_f32_16x16x32_bf16 v[172:175], a[196:199], a[188:191], v[172:175]
v_exp_f32 v80, v80
v_mfma_f32_16x16x32_bf16 v[172:175], a[192:195], a[172:175], v[172:175]
v_exp_f32 v81, v81
s_waitcnt lgkmcnt(8)
v_mfma_f32_16x16x32_bf16 v[188:191], a[200:203], a[172:175], v[188:191]
ds_read_b64_tr_b16 a[192:193], v250 offset:8
ds_read_b64_tr_b16 a[194:195], v250 offset:520
v_mfma_f32_16x16x32_bf16 v[188:191], a[204:207], a[188:191], v[188:191]
v_exp_f32 v82, v82
v_mfma_f32_16x16x32_bf16 v[184:187], a[204:207], a[184:187], v[184:187]
v_exp_f32 v83, v83
v_mfma_f32_16x16x32_bf16 v[184:187], a[200:203], a[168:171], v[184:187]
v_exp_f32 v84, v84
v_mfma_f32_16x16x4_4b_bf16 v[192:207], a[234:235], a[242:243], v[192:207] cbsz:2 abid:1
v_exp_f32 v85, v85
v_exp_f32 v86, v86
v_exp_f32 v87, v87
v_mfma_f32_16x16x32_bf16 v[180:183], a[200:203], a[164:167], v[180:183]
ds_read_b64_tr_b16 a[196:197], v250 offset:24584
ds_read_b64_tr_b16 a[198:199], v250 offset:25096
v_mfma_f32_16x16x32_bf16 v[180:183], a[204:207], a[180:183], v[180:183]
v_exp_f32 v88, v88
v_mfma_f32_16x16x32_bf16 v[176:179], a[204:207], a[176:179], v[176:179]
v_exp_f32 v89, v89
v_mfma_f32_16x16x32_bf16 v[176:179], a[200:203], a[160:163], v[176:179]
v_exp_f32 v90, v90
s_waitcnt lgkmcnt(8)
v_mfma_f32_16x16x32_bf16 v[192:195], a[208:211], a[160:163], v[192:195]
ds_read_b64_tr_b16 a[200:201], v251 offset:0
ds_read_b64_tr_b16 a[202:203], v251 offset:512
v_mfma_f32_16x16x32_bf16 v[192:195], a[212:215], a[176:179], v[192:195]
buffer_store_dwordx4 v[52:55], v5, s[32:35], s48 offen offset:1024 sc0 sc1
v_mfma_f32_16x16x32_bf16 v[196:199], a[212:215], a[180:183], v[196:199]
v_exp_f32 v91, v91
v_mfma_f32_16x16x32_bf16 v[196:199], a[208:211], a[164:167], v[196:199]
v_exp_f32 v92, v92
v_mfma_f32_16x16x32_bf16 v[200:203], a[208:211], a[168:171], v[200:203]
ds_read_b64_tr_b16 a[204:205], v251 offset:24576
ds_read_b64_tr_b16 a[206:207], v251 offset:25088
v_mfma_f32_16x16x32_bf16 v[200:203], a[212:215], a[184:187], v[200:203]
v_exp_f32 v93, v93
v_mfma_f32_16x16x32_bf16 v[204:207], a[212:215], a[188:191], v[204:207]
v_exp_f32 v94, v94
v_mfma_f32_16x16x32_bf16 v[204:207], a[208:211], a[172:175], v[204:207]
v_exp_f32 v95, v95
s_waitcnt lgkmcnt(8)
v_mfma_f32_16x16x32_bf16 a[12:15], a[216:219], a[172:175], a[12:15]
ds_read_b64_tr_b16 a[208:209], v249 offset:8
v_pk_mul_f32 v[128:129], v[128:129], v[112:113]
v_pk_mul_f32 v[130:131], v[130:131], v[114:115]
v_pk_mul_f32 v[132:133], v[132:133], v[116:117]
v_pk_mul_f32 v[134:135], v[134:135], v[118:119]
v_pk_mul_f32 v[136:137], v[136:137], v[120:121]
v_pk_mul_f32 v[138:139], v[138:139], v[122:123]
v_pk_mul_f32 v[140:141], v[140:141], v[124:125]
v_pk_mul_f32 v[142:143], v[142:143], v[126:127]
v_pk_fma_f32 v[80:81], v[80:81], v[4:5], v[4:5] op_sel:[0,0,0] op_sel_hi:[1,0,0]
v_pk_fma_f32 v[82:83], v[82:83], v[4:5], v[4:5] op_sel:[0,0,0] op_sel_hi:[1,0,0]
v_pk_fma_f32 v[84:85], v[84:85], v[12:13], v[12:13] op_sel:[0,1,1] op_sel_hi:[1,1,1]
v_pk_fma_f32 v[86:87], v[86:87], v[12:13], v[12:13] op_sel:[0,1,1] op_sel_hi:[1,1,1]
v_pk_fma_f32 v[88:89], v[88:89], v[6:7], v[6:7] op_sel:[0,0,0] op_sel_hi:[1,0,0]
v_pk_fma_f32 v[90:91], v[90:91], v[6:7], v[6:7] op_sel:[0,0,0] op_sel_hi:[1,0,0]
v_pk_fma_f32 v[92:93], v[92:93], v[6:7], v[6:7] op_sel:[0,1,1] op_sel_hi:[1,1,1]
v_pk_fma_f32 v[94:95], v[94:95], v[6:7], v[6:7] op_sel:[0,1,1] op_sel_hi:[1,1,1]
v_pk_mul_f32 v[252:253], v[208:209], v[208:209]
v_pk_mul_f32 v[254:255], v[210:211], v[210:211]
v_pk_fma_f32 v[252:253], v[252:253], v[2:3], v[2:3] op_sel:[0,0,1] op_sel_hi:[1,0,1]
v_pk_fma_f32 v[254:255], v[254:255], v[2:3], v[2:3] op_sel:[0,0,1] op_sel_hi:[1,0,1]
v_pk_mul_f32 v[224:225], v[208:209], v[224:225]
v_pk_mul_f32 v[226:227], v[210:211], v[226:227]
v_pk_mul_f32 v[208:209], v[208:209], v[252:253]
v_pk_mul_f32 v[210:211], v[210:211], v[254:255]
v_pk_mul_f32 v[252:253], v[212:213], v[212:213]
v_pk_mul_f32 v[254:255], v[214:215], v[214:215]
v_pk_fma_f32 v[252:253], v[252:253], v[14:15], v[14:15] op_sel:[0,0,1] op_sel_hi:[1,0,1]
v_pk_fma_f32 v[254:255], v[254:255], v[14:15], v[14:15] op_sel:[0,0,1] op_sel_hi:[1,0,1]
v_pk_mul_f32 v[228:229], v[212:213], v[228:229]
v_pk_mul_f32 v[230:231], v[214:215], v[230:231]
v_pk_mul_f32 v[212:213], v[212:213], v[252:253]
v_pk_mul_f32 v[214:215], v[214:215], v[254:255]
v_pk_mul_f32 v[252:253], v[216:217], v[216:217]
v_pk_mul_f32 v[254:255], v[218:219], v[218:219]
v_pk_fma_f32 v[252:253], v[252:253], v[0:1], v[0:1] op_sel:[0,0,1] op_sel_hi:[1,0,1]
v_pk_fma_f32 v[254:255], v[254:255], v[0:1], v[0:1] op_sel:[0,0,1] op_sel_hi:[1,0,1]
v_pk_mul_f32 v[232:233], v[216:217], v[232:233]
v_pk_mul_f32 v[234:235], v[218:219], v[234:235]
v_pk_mul_f32 v[216:217], v[216:217], v[252:253]
v_pk_mul_f32 v[218:219], v[218:219], v[254:255]
v_pk_mul_f32 v[252:253], v[220:221], v[220:221]
v_pk_mul_f32 v[254:255], v[222:223], v[222:223]
v_pk_fma_f32 v[252:253], v[252:253], v[8:9], v[8:9] op_sel:[0,0,1] op_sel_hi:[1,0,1]
v_pk_fma_f32 v[254:255], v[254:255], v[8:9], v[8:9] op_sel:[0,0,1] op_sel_hi:[1,0,1]
v_pk_mul_f32 v[236:237], v[220:221], v[236:237]
v_pk_mul_f32 v[238:239], v[222:223], v[238:239]
v_pk_mul_f32 v[220:221], v[220:221], v[252:253]
v_pk_mul_f32 v[222:223], v[222:223], v[254:255]
v_mfma_f32_16x16x32_bf16 a[12:15], a[220:223], a[188:191], a[12:15]
buffer_store_dwordx4 v[56:59], v5, s[32:35], s48 offen offset:2048 sc0 sc1
v_mfma_f32_16x16x32_bf16 a[8:11], a[220:223], a[184:187], a[8:11]
ds_read_b64_tr_b16 a[210:211], v249 offset:520
v_cvt_pk_bf16_f32 v114, v128, v129
v_mfma_f32_16x16x32_bf16 a[8:11], a[216:219], a[168:171], a[8:11]
v_rcp_f32 v80, v80
v_mfma_f32_16x16x32_bf16 a[4:7], a[216:219], a[164:167], a[4:7]
ds_read_b64_tr_b16 a[212:213], v249 offset:24584
v_cvt_pk_bf16_f32 v115, v130, v131
v_mfma_f32_16x16x32_bf16 a[4:7], a[220:223], a[180:183], a[4:7]
v_rcp_f32 v81, v81
v_mfma_f32_16x16x32_bf16 a[0:3], a[220:223], a[176:179], a[0:3]
ds_read_b64_tr_b16 a[214:215], v249 offset:25096
v_cvt_pk_bf16_f32 v118, v132, v133
v_mfma_f32_16x16x32_bf16 a[0:3], a[216:219], a[160:163], a[0:3]
v_rcp_f32 v82, v82
s_waitcnt lgkmcnt(8)
v_mfma_f32_16x16x32_bf16 a[16:19], a[192:195], a[160:163], a[16:19]
ds_read_b64_tr_b16 a[216:217], v251 offset:8
v_cvt_pk_bf16_f32 v119, v134, v135
v_mfma_f32_16x16x32_bf16 a[16:19], a[196:199], a[176:179], a[16:19]
v_rcp_f32 v83, v83
v_mfma_f32_16x16x32_bf16 a[20:23], a[196:199], a[180:183], a[20:23]
ds_read_b64_tr_b16 a[218:219], v251 offset:520
v_cvt_pk_bf16_f32 v122, v136, v137
v_mfma_f32_16x16x32_bf16 a[20:23], a[192:195], a[164:167], a[20:23]
v_rcp_f32 v84, v84
v_mfma_f32_16x16x4_4b_bf16 a[0:15], a[226:227], a[238:239], a[0:15] cbsz:2 abid:0
v_rcp_f32 v85, v85
v_rcp_f32 v86, v86
v_rcp_f32 v87, v87
v_mfma_f32_16x16x32_bf16 a[24:27], a[192:195], a[168:171], a[24:27]
ds_read_b64_tr_b16 a[220:221], v251 offset:24584
v_cvt_pk_bf16_f32 v123, v138, v139
v_mfma_f32_16x16x32_bf16 a[24:27], a[196:199], a[184:187], a[24:27]
v_rcp_f32 v88, v88
v_mfma_f32_16x16x32_bf16 a[28:31], a[196:199], a[188:191], a[28:31]
ds_read_b64_tr_b16 a[222:223], v251 offset:25096
v_cvt_pk_bf16_f32 v126, v140, v141
v_mfma_f32_16x16x32_bf16 a[28:31], a[192:195], a[172:175], a[28:31]
v_rcp_f32 v89, v89
s_waitcnt lgkmcnt(8)
v_mfma_f32_16x16x32_bf16 a[44:47], a[200:203], a[172:175], a[44:47]
ds_read_b64_tr_b16 a[192:193], v248 offset:4096
v_cvt_pk_bf16_f32 v127, v142, v143
v_mfma_f32_16x16x32_bf16 a[44:47], a[204:207], a[188:191], a[44:47]
buffer_store_dwordx4 v[60:63], v5, s[32:35], s48 offen offset:3072 sc0 sc1
v_mfma_f32_16x16x32_bf16 a[40:43], a[204:207], a[184:187], a[40:43]
ds_read_b64_tr_b16 a[194:195], v248 offset:4608
v_mfma_f32_16x16x32_bf16 a[40:43], a[200:203], a[168:171], a[40:43]
v_rcp_f32 v90, v90
v_mfma_f32_16x16x4_4b_bf16 a[16:31], a[226:227], a[238:239], a[16:31] cbsz:2 abid:1
v_rcp_f32 v91, v91
v_rcp_f32 v92, v92
v_rcp_f32 v93, v93
v_mfma_f32_16x16x32_bf16 a[36:39], a[200:203], a[164:167], a[36:39]
ds_read_b64_tr_b16 a[196:197], v248 offset:28672
ds_read_b64_tr_b16 a[198:199], v248 offset:29184
v_mfma_f32_16x16x32_bf16 a[36:39], a[204:207], a[180:183], a[36:39]
v_rcp_f32 v94, v94
v_mfma_f32_16x16x32_bf16 a[32:35], a[204:207], a[176:179], a[32:35]
v_rcp_f32 v95, v95
v_mfma_f32_16x16x32_bf16 a[32:35], a[200:203], a[160:163], a[32:35]
v_exp_f32 v208, v208
s_waitcnt lgkmcnt(8)
v_mfma_f32_16x16x32_bf16 a[48:51], a[208:211], a[128:131], a[48:51]
ds_read_b64_tr_b16 a[200:201], v250 offset:4096
ds_read_b64_tr_b16 a[202:203], v250 offset:4608
v_mfma_f32_16x16x32_bf16 a[48:51], a[212:215], a[144:147], a[48:51]
v_exp_f32 v209, v209
v_mfma_f32_16x16x32_bf16 a[52:55], a[212:215], a[148:151], a[52:55]
v_exp_f32 v210, v210
v_mfma_f32_16x16x32_bf16 a[52:55], a[208:211], a[132:135], a[52:55]
v_exp_f32 v211, v211
v_mfma_f32_16x16x4_4b_bf16 a[32:47], a[226:227], a[238:239], a[32:47] cbsz:2 abid:2
v_exp_f32 v212, v212
v_exp_f32 v213, v213
v_exp_f32 v214, v214
v_mfma_f32_16x16x32_bf16 a[56:59], a[208:211], a[136:139], a[56:59]
ds_read_b64_tr_b16 a[204:205], v250 offset:28672
ds_read_b64_tr_b16 a[206:207], v250 offset:29184
v_mfma_f32_16x16x32_bf16 a[56:59], a[212:215], a[152:155], a[56:59]
v_exp_f32 v215, v215
v_mfma_f32_16x16x32_bf16 a[60:63], a[212:215], a[156:159], a[60:63]
v_exp_f32 v216, v216
v_mfma_f32_16x16x32_bf16 a[60:63], a[208:211], a[140:143], a[60:63]
v_exp_f32 v217, v217
s_waitcnt lgkmcnt(8)
v_mfma_f32_16x16x32_bf16 a[60:63], a[216:219], a[172:175], a[60:63]
ds_read_b64_tr_b16 a[208:209], v248 offset:4104
ds_read_b64_tr_b16 a[210:211], v248 offset:4616
v_mfma_f32_16x16x32_bf16 a[60:63], a[220:223], a[188:191], a[60:63]
v_exp_f32 v218, v218
v_mfma_f32_16x16x32_bf16 a[56:59], a[220:223], a[184:187], a[56:59]
v_exp_f32 v219, v219
v_mfma_f32_16x16x32_bf16 a[56:59], a[216:219], a[168:171], a[56:59]
v_exp_f32 v220, v220
v_mfma_f32_16x16x4_4b_bf16 a[64:79], a[226:227], a[242:243], a[64:79] cbsz:2 abid:0
v_exp_f32 v221, v221
v_exp_f32 v222, v222
v_exp_f32 v223, v223
v_mfma_f32_16x16x32_bf16 a[52:55], a[216:219], a[164:167], a[52:55]
ds_read_b64_tr_b16 a[212:213], v248 offset:28680
v_pk_mul_f32 v[96:97], v[96:97], v[80:81]
v_pk_mul_f32 v[98:99], v[98:99], v[82:83]
v_pk_mul_f32 v[100:101], v[100:101], v[84:85]
v_pk_mul_f32 v[102:103], v[102:103], v[86:87]
v_pk_mul_f32 v[104:105], v[104:105], v[88:89]
v_pk_mul_f32 v[106:107], v[106:107], v[90:91]
v_pk_mul_f32 v[108:109], v[108:109], v[92:93]
v_pk_mul_f32 v[110:111], v[110:111], v[94:95]
v_pk_fma_f32 v[208:209], v[208:209], v[4:5], v[4:5] op_sel:[0,0,0] op_sel_hi:[1,0,0]
v_pk_fma_f32 v[210:211], v[210:211], v[4:5], v[4:5] op_sel:[0,0,0] op_sel_hi:[1,0,0]
v_pk_fma_f32 v[212:213], v[212:213], v[12:13], v[12:13] op_sel:[0,1,1] op_sel_hi:[1,1,1]
v_pk_fma_f32 v[214:215], v[214:215], v[12:13], v[12:13] op_sel:[0,1,1] op_sel_hi:[1,1,1]
v_pk_fma_f32 v[216:217], v[216:217], v[6:7], v[6:7] op_sel:[0,0,0] op_sel_hi:[1,0,0]
v_pk_fma_f32 v[218:219], v[218:219], v[6:7], v[6:7] op_sel:[0,0,0] op_sel_hi:[1,0,0]
v_pk_fma_f32 v[220:221], v[220:221], v[6:7], v[6:7] op_sel:[0,1,1] op_sel_hi:[1,1,1]
v_pk_fma_f32 v[222:223], v[222:223], v[6:7], v[6:7] op_sel:[0,1,1] op_sel_hi:[1,1,1]
v_pk_mul_f32 v[252:253], v[144:145], v[144:145]
v_pk_mul_f32 v[254:255], v[146:147], v[146:147]
v_pk_fma_f32 v[252:253], v[252:253], v[2:3], v[2:3] op_sel:[0,0,1] op_sel_hi:[1,0,1]
v_pk_fma_f32 v[254:255], v[254:255], v[2:3], v[2:3] op_sel:[0,0,1] op_sel_hi:[1,0,1]
v_pk_mul_f32 v[160:161], v[144:145], v[160:161]
v_pk_mul_f32 v[162:163], v[146:147], v[162:163]
v_pk_mul_f32 v[144:145], v[144:145], v[252:253]
v_pk_mul_f32 v[146:147], v[146:147], v[254:255]
v_pk_mul_f32 v[252:253], v[148:149], v[148:149]
v_pk_mul_f32 v[254:255], v[150:151], v[150:151]
v_pk_fma_f32 v[252:253], v[252:253], v[14:15], v[14:15] op_sel:[0,0,1] op_sel_hi:[1,0,1]
v_pk_fma_f32 v[254:255], v[254:255], v[14:15], v[14:15] op_sel:[0,0,1] op_sel_hi:[1,0,1]
v_pk_mul_f32 v[164:165], v[148:149], v[164:165]
v_pk_mul_f32 v[166:167], v[150:151], v[166:167]
v_pk_mul_f32 v[148:149], v[148:149], v[252:253]
v_pk_mul_f32 v[150:151], v[150:151], v[254:255]
v_pk_mul_f32 v[252:253], v[152:153], v[152:153]
v_pk_mul_f32 v[254:255], v[154:155], v[154:155]
v_pk_fma_f32 v[252:253], v[252:253], v[0:1], v[0:1] op_sel:[0,0,1] op_sel_hi:[1,0,1]
v_pk_fma_f32 v[254:255], v[254:255], v[0:1], v[0:1] op_sel:[0,0,1] op_sel_hi:[1,0,1]
v_pk_mul_f32 v[168:169], v[152:153], v[168:169]
v_pk_mul_f32 v[170:171], v[154:155], v[170:171]
v_pk_mul_f32 v[152:153], v[152:153], v[252:253]
v_pk_mul_f32 v[154:155], v[154:155], v[254:255]
v_pk_mul_f32 v[252:253], v[156:157], v[156:157]
v_pk_mul_f32 v[254:255], v[158:159], v[158:159]
v_pk_fma_f32 v[252:253], v[252:253], v[8:9], v[8:9] op_sel:[0,0,1] op_sel_hi:[1,0,1]
v_pk_fma_f32 v[254:255], v[254:255], v[8:9], v[8:9] op_sel:[0,0,1] op_sel_hi:[1,0,1]
v_pk_mul_f32 v[172:173], v[156:157], v[172:173]
v_pk_mul_f32 v[174:175], v[158:159], v[174:175]
v_pk_mul_f32 v[156:157], v[156:157], v[252:253]
v_pk_mul_f32 v[158:159], v[158:159], v[254:255]
v_mfma_f32_16x16x32_bf16 a[52:55], a[220:223], a[180:183], a[52:55]
v_rcp_f32 v208, v208
v_mfma_f32_16x16x32_bf16 a[48:51], a[220:223], a[176:179], a[48:51]
ds_read_b64_tr_b16 a[214:215], v248 offset:29192
v_cvt_pk_bf16_f32 v112, v96, v97
v_mfma_f32_16x16x32_bf16 a[48:51], a[216:219], a[160:163], a[48:51]
v_rcp_f32 v209, v209
s_waitcnt lgkmcnt(8)
v_mfma_f32_16x16x32_bf16 a[64:67], a[192:195], a[128:131], a[64:67]
ds_read_b64_tr_b16 a[216:217], v250 offset:4104
v_cvt_pk_bf16_f32 v113, v98, v99
v_mfma_f32_16x16x32_bf16 a[64:67], a[196:199], a[144:147], a[64:67]
v_rcp_f32 v210, v210
v_mfma_f32_16x16x32_bf16 a[68:71], a[196:199], a[148:151], a[68:71]
ds_read_b64_tr_b16 a[218:219], v250 offset:4616
v_cvt_pk_bf16_f32 v116, v100, v101
v_mfma_f32_16x16x32_bf16 a[68:71], a[192:195], a[132:135], a[68:71]
v_rcp_f32 v211, v211
v_mfma_f32_16x16x4_4b_bf16 a[48:63], a[226:227], a[238:239], a[48:63] cbsz:2 abid:3
v_rcp_f32 v212, v212
v_rcp_f32 v213, v213
v_rcp_f32 v214, v214
v_mfma_f32_16x16x32_bf16 a[72:75], a[192:195], a[136:139], a[72:75]
ds_read_b64_tr_b16 a[220:221], v250 offset:28680
v_cvt_pk_bf16_f32 v117, v102, v103
v_mfma_f32_16x16x32_bf16 a[72:75], a[196:199], a[152:155], a[72:75]
v_rcp_f32 v215, v215
v_mfma_f32_16x16x32_bf16 a[76:79], a[196:199], a[156:159], a[76:79]
ds_read_b64_tr_b16 a[222:223], v250 offset:29192
v_cvt_pk_bf16_f32 v120, v104, v105
v_mfma_f32_16x16x32_bf16 a[76:79], a[192:195], a[140:143], a[76:79]
v_rcp_f32 v216, v216
s_waitcnt lgkmcnt(8)
v_mfma_f32_16x16x32_bf16 a[76:79], a[200:203], a[172:175], a[76:79]
ds_read_b64_tr_b16 a[192:193], v249 offset:4096
v_cvt_pk_bf16_f32 v121, v106, v107
v_mfma_f32_16x16x32_bf16 a[76:79], a[204:207], a[188:191], a[76:79]
v_rcp_f32 v217, v217
v_mfma_f32_16x16x32_bf16 a[72:75], a[204:207], a[184:187], a[72:75]
ds_read_b64_tr_b16 a[194:195], v249 offset:4608
v_cvt_pk_bf16_f32 v124, v108, v109
v_mfma_f32_16x16x32_bf16 a[72:75], a[200:203], a[168:171], a[72:75]
v_rcp_f32 v218, v218
v_mfma_f32_16x16x4_4b_bf16 a[80:95], a[226:227], a[242:243], a[80:95] cbsz:2 abid:1
v_rcp_f32 v219, v219
v_rcp_f32 v220, v220
v_rcp_f32 v221, v221
v_mfma_f32_16x16x32_bf16 a[68:71], a[200:203], a[164:167], a[68:71]
ds_read_b64_tr_b16 a[196:197], v249 offset:28672
v_cvt_pk_bf16_f32 v125, v110, v111
v_mfma_f32_16x16x32_bf16 a[68:71], a[204:207], a[180:183], a[68:71]
buffer_store_dwordx4 v[112:115], v5, s[32:35], s49 offen offset:0 sc0 sc1
v_mfma_f32_16x16x32_bf16 a[64:67], a[204:207], a[176:179], a[64:67]
ds_read_b64_tr_b16 a[198:199], v249 offset:29184
v_mfma_f32_16x16x32_bf16 a[64:67], a[200:203], a[160:163], a[64:67]
v_rcp_f32 v222, v222
s_waitcnt lgkmcnt(8)
v_mfma_f32_16x16x32_bf16 a[80:83], a[208:211], a[128:131], a[80:83]
ds_read_b64_tr_b16 a[200:201], v251 offset:4096
ds_read_b64_tr_b16 a[202:203], v251 offset:4608
v_mfma_f32_16x16x32_bf16 a[80:83], a[212:215], a[144:147], a[80:83]
v_rcp_f32 v223, v223
v_mfma_f32_16x16x32_bf16 a[84:87], a[212:215], a[148:151], a[84:87]
v_exp_f32 v144, v144
v_mfma_f32_16x16x32_bf16 a[84:87], a[208:211], a[132:135], a[84:87]
v_exp_f32 v145, v145
v_mfma_f32_16x16x4_4b_bf16 a[96:111], a[226:227], a[242:243], a[96:111] cbsz:2 abid:2
v_exp_f32 v146, v146
v_exp_f32 v147, v147
v_exp_f32 v148, v148
v_mfma_f32_16x16x32_bf16 a[88:91], a[208:211], a[136:139], a[88:91]
ds_read_b64_tr_b16 a[204:205], v251 offset:28672
ds_read_b64_tr_b16 a[206:207], v251 offset:29184
v_mfma_f32_16x16x32_bf16 a[88:91], a[212:215], a[152:155], a[88:91]
v_exp_f32 v149, v149
v_mfma_f32_16x16x32_bf16 a[92:95], a[212:215], a[156:159], a[92:95]
v_exp_f32 v150, v150
v_mfma_f32_16x16x32_bf16 a[92:95], a[208:211], a[140:143], a[92:95]
v_exp_f32 v151, v151
s_waitcnt lgkmcnt(8)
v_mfma_f32_16x16x32_bf16 a[92:95], a[216:219], a[172:175], a[92:95]
ds_read_b64_tr_b16 a[208:209], v249 offset:4104
ds_read_b64_tr_b16 a[210:211], v249 offset:4616
v_mfma_f32_16x16x32_bf16 a[92:95], a[220:223], a[188:191], a[92:95]
v_exp_f32 v152, v152
v_mfma_f32_16x16x32_bf16 a[88:91], a[220:223], a[184:187], a[88:91]
v_exp_f32 v153, v153
v_mfma_f32_16x16x32_bf16 a[88:91], a[216:219], a[168:171], a[88:91]
v_exp_f32 v154, v154
v_mfma_f32_16x16x4_4b_bf16 a[112:127], a[226:227], a[242:243], a[112:127] cbsz:2 abid:3
v_exp_f32 v155, v155
v_exp_f32 v156, v156
v_exp_f32 v157, v157
v_mfma_f32_16x16x32_bf16 a[84:87], a[216:219], a[164:167], a[84:87]
ds_read_b64_tr_b16 a[212:213], v249 offset:28680
ds_read_b64_tr_b16 a[214:215], v249 offset:29192
v_mfma_f32_16x16x32_bf16 a[84:87], a[220:223], a[180:183], a[84:87]
buffer_store_dwordx4 v[116:119], v5, s[32:35], s49 offen offset:1024 sc0 sc1
v_mfma_f32_16x16x32_bf16 a[80:83], a[220:223], a[176:179], a[80:83]
v_exp_f32 v158, v158
v_mfma_f32_16x16x32_bf16 a[80:83], a[216:219], a[160:163], a[80:83]
v_exp_f32 v159, v159
s_waitcnt lgkmcnt(8)
v_mfma_f32_16x16x32_bf16 a[96:99], a[192:195], a[128:131], a[96:99]
ds_read_b64_tr_b16 a[216:217], v251 offset:4104
v_pk_mul_f32 v[224:225], v[224:225], v[208:209]
v_pk_mul_f32 v[226:227], v[226:227], v[210:211]
v_pk_mul_f32 v[228:229], v[228:229], v[212:213]
v_pk_mul_f32 v[230:231], v[230:231], v[214:215]
v_pk_mul_f32 v[232:233], v[232:233], v[216:217]
v_pk_mul_f32 v[234:235], v[234:235], v[218:219]
v_pk_mul_f32 v[236:237], v[236:237], v[220:221]
v_pk_mul_f32 v[238:239], v[238:239], v[222:223]
v_pk_fma_f32 v[144:145], v[144:145], v[4:5], v[4:5] op_sel:[0,0,0] op_sel_hi:[1,0,0]
v_pk_fma_f32 v[146:147], v[146:147], v[4:5], v[4:5] op_sel:[0,0,0] op_sel_hi:[1,0,0]
v_pk_fma_f32 v[148:149], v[148:149], v[12:13], v[12:13] op_sel:[0,1,1] op_sel_hi:[1,1,1]
v_pk_fma_f32 v[150:151], v[150:151], v[12:13], v[12:13] op_sel:[0,1,1] op_sel_hi:[1,1,1]
v_pk_fma_f32 v[152:153], v[152:153], v[6:7], v[6:7] op_sel:[0,0,0] op_sel_hi:[1,0,0]
v_pk_fma_f32 v[154:155], v[154:155], v[6:7], v[6:7] op_sel:[0,0,0] op_sel_hi:[1,0,0]
v_pk_fma_f32 v[156:157], v[156:157], v[6:7], v[6:7] op_sel:[0,1,1] op_sel_hi:[1,1,1]
v_pk_fma_f32 v[158:159], v[158:159], v[6:7], v[6:7] op_sel:[0,1,1] op_sel_hi:[1,1,1]
v_pk_mul_f32 v[252:253], v[176:177], v[176:177]
v_pk_mul_f32 v[254:255], v[178:179], v[178:179]
v_pk_fma_f32 v[252:253], v[252:253], v[2:3], v[2:3] op_sel:[0,0,1] op_sel_hi:[1,0,1]
v_pk_fma_f32 v[254:255], v[254:255], v[2:3], v[2:3] op_sel:[0,0,1] op_sel_hi:[1,0,1]
v_pk_mul_f32 v[192:193], v[176:177], v[192:193]
v_pk_mul_f32 v[194:195], v[178:179], v[194:195]
v_pk_mul_f32 v[176:177], v[176:177], v[252:253]
v_pk_mul_f32 v[178:179], v[178:179], v[254:255]
v_pk_mul_f32 v[252:253], v[180:181], v[180:181]
v_pk_mul_f32 v[254:255], v[182:183], v[182:183]
v_pk_fma_f32 v[252:253], v[252:253], v[14:15], v[14:15] op_sel:[0,0,1] op_sel_hi:[1,0,1]
v_pk_fma_f32 v[254:255], v[254:255], v[14:15], v[14:15] op_sel:[0,0,1] op_sel_hi:[1,0,1]
v_pk_mul_f32 v[196:197], v[180:181], v[196:197]
v_pk_mul_f32 v[198:199], v[182:183], v[198:199]
v_pk_mul_f32 v[180:181], v[180:181], v[252:253]
v_pk_mul_f32 v[182:183], v[182:183], v[254:255]
v_pk_mul_f32 v[252:253], v[184:185], v[184:185]
v_pk_mul_f32 v[254:255], v[186:187], v[186:187]
v_pk_fma_f32 v[252:253], v[252:253], v[0:1], v[0:1] op_sel:[0,0,1] op_sel_hi:[1,0,1]
v_pk_fma_f32 v[254:255], v[254:255], v[0:1], v[0:1] op_sel:[0,0,1] op_sel_hi:[1,0,1]
v_pk_mul_f32 v[200:201], v[184:185], v[200:201]
v_pk_mul_f32 v[202:203], v[186:187], v[202:203]
v_pk_mul_f32 v[184:185], v[184:185], v[252:253]
v_pk_mul_f32 v[186:187], v[186:187], v[254:255]
v_pk_mul_f32 v[252:253], v[188:189], v[188:189]
v_pk_mul_f32 v[254:255], v[190:191], v[190:191]
v_pk_fma_f32 v[252:253], v[252:253], v[8:9], v[8:9] op_sel:[0,0,1] op_sel_hi:[1,0,1]
v_pk_fma_f32 v[254:255], v[254:255], v[8:9], v[8:9] op_sel:[0,0,1] op_sel_hi:[1,0,1]
v_pk_mul_f32 v[204:205], v[188:189], v[204:205]
v_pk_mul_f32 v[206:207], v[190:191], v[206:207]
v_pk_mul_f32 v[188:189], v[188:189], v[252:253]
v_pk_mul_f32 v[190:191], v[190:191], v[254:255]
v_mfma_f32_16x16x32_bf16 a[96:99], a[196:199], a[144:147], a[96:99]
buffer_store_dwordx4 v[120:123], v5, s[32:35], s49 offen offset:2048 sc0 sc1
v_mfma_f32_16x16x32_bf16 a[100:103], a[196:199], a[148:151], a[100:103]
ds_read_b64_tr_b16 a[218:219], v251 offset:4616
v_cvt_pk_bf16_f32 v208, v224, v225
v_mfma_f32_16x16x32_bf16 a[100:103], a[192:195], a[132:135], a[100:103]
v_rcp_f32 v144, v144
v_mfma_f32_16x16x32_bf16 a[104:107], a[192:195], a[136:139], a[104:107]
ds_read_b64_tr_b16 a[220:221], v251 offset:28680
v_cvt_pk_bf16_f32 v209, v226, v227
v_mfma_f32_16x16x32_bf16 a[104:107], a[196:199], a[152:155], a[104:107]
v_rcp_f32 v145, v145
v_mfma_f32_16x16x32_bf16 a[108:111], a[196:199], a[156:159], a[108:111]
ds_read_b64_tr_b16 a[222:223], v251 offset:29192
v_cvt_pk_bf16_f32 v210, v228, v229
v_mfma_f32_16x16x32_bf16 a[108:111], a[192:195], a[140:143], a[108:111]
v_rcp_f32 v146, v146
s_waitcnt lgkmcnt(8)
v_mfma_f32_16x16x32_bf16 a[108:111], a[200:203], a[172:175], a[108:111]
v_rcp_f32 v147, v147
v_mfma_f32_16x16x32_bf16 a[108:111], a[204:207], a[188:191], a[108:111]
v_rcp_f32 v148, v148
v_mfma_f32_16x16x32_bf16 a[104:107], a[204:207], a[184:187], a[104:107]
v_rcp_f32 v149, v149
v_mfma_f32_16x16x32_bf16 a[104:107], a[200:203], a[168:171], a[104:107]
v_rcp_f32 v150, v150
v_mfma_f32_16x16x32_bf16 a[100:103], a[200:203], a[164:167], a[100:103]
v_rcp_f32 v151, v151
v_mfma_f32_16x16x32_bf16 a[100:103], a[204:207], a[180:183], a[100:103]
v_rcp_f32 v152, v152
v_mfma_f32_16x16x32_bf16 a[96:99], a[204:207], a[176:179], a[96:99]
v_rcp_f32 v153, v153
v_mfma_f32_16x16x32_bf16 a[96:99], a[200:203], a[160:163], a[96:99]
v_rcp_f32 v154, v154
s_waitcnt vmcnt(7) lgkmcnt(0)
s_barrier
v_mfma_f32_16x16x32_bf16 a[112:115], a[208:211], a[128:131], a[112:115]
v_cvt_pk_bf16_f32 v211, v230, v231
v_cvt_pk_bf16_f32 v212, v232, v233
v_mfma_f32_16x16x32_bf16 a[112:115], a[212:215], a[144:147], a[112:115]
buffer_store_dwordx4 v[124:127], v5, s[32:35], s49 offen offset:3072 sc0 sc1
v_mfma_f32_16x16x32_bf16 a[116:119], a[212:215], a[148:151], a[116:119]
v_rcp_f32 v155, v155
v_mfma_f32_16x16x32_bf16 a[116:119], a[208:211], a[132:135], a[116:119]
v_rcp_f32 v156, v156
v_mfma_f32_16x16x32_bf16 a[120:123], a[208:211], a[136:139], a[120:123]
v_rcp_f32 v157, v157
v_mfma_f32_16x16x32_bf16 a[120:123], a[212:215], a[152:155], a[120:123]
v_rcp_f32 v158, v158
v_mfma_f32_16x16x32_bf16 a[124:127], a[212:215], a[156:159], a[124:127]
v_rcp_f32 v159, v159
v_mfma_f32_16x16x32_bf16 a[124:127], a[208:211], a[140:143], a[124:127]
v_exp_f32 v176, v176
v_mfma_f32_16x16x32_bf16 a[124:127], a[216:219], a[172:175], a[124:127]
v_exp_f32 v177, v177
v_mfma_f32_16x16x32_bf16 a[124:127], a[220:223], a[188:191], a[124:127]
v_exp_f32 v178, v178
v_mfma_f32_16x16x32_bf16 a[120:123], a[220:223], a[184:187], a[120:123]
v_exp_f32 v179, v179
v_mfma_f32_16x16x32_bf16 a[120:123], a[216:219], a[168:171], a[120:123]
v_exp_f32 v180, v180
v_mfma_f32_16x16x32_bf16 a[116:119], a[216:219], a[164:167], a[116:119]
v_exp_f32 v181, v181
v_mfma_f32_16x16x32_bf16 a[116:119], a[220:223], a[180:183], a[116:119]
v_exp_f32 v182, v182
v_mfma_f32_16x16x32_bf16 a[112:115], a[220:223], a[176:179], a[112:115]
v_exp_f32 v183, v183
v_mfma_f32_16x16x32_bf16 a[112:115], a[216:219], a[160:163], a[112:115]
v_exp_f32 v184, v184
v_cvt_pk_bf16_f32 v213, v234, v235
s_add_u32 m0, s57, 0
s_nop 0
buffer_load_dwordx4 v10, s[28:31], s73 offen offset:0  lds
v_cvt_pk_bf16_f32 v214, v236, v237
v_cvt_pk_bf16_f32 v215, v238, v239
v_and_b32 v216, 0x10f0, v5
v_bfe_u32 v217, v5, 8, 1
v_lshl_add_u32 v216, v217, 10, v216
v_bfe_u32 v217, v5, 9, 1
v_lshl_add_u32 v216, v217, 8, v216
v_permlane16_swap_b32 v208, v210
v_permlane16_swap_b32 v209, v211
v_permlane16_swap_b32 v212, v214
v_permlane16_swap_b32 v213, v215
v_exp_f32 v185, v185
v_exp_f32 v186, v186
v_exp_f32 v187, v187
v_exp_f32 v188, v188
v_exp_f32 v189, v189
buffer_load_dwordx4 v11, s[28:31], s73 offen offset:1024  lds
v_exp_f32 v190, v190
v_exp_f32 v191, v191
s_nop 0
v_pk_mul_f32 v[160:161], v[160:161], v[144:145]
v_pk_mul_f32 v[162:163], v[162:163], v[146:147]
v_pk_mul_f32 v[164:165], v[164:165], v[148:149]
v_pk_mul_f32 v[166:167], v[166:167], v[150:151]
v_pk_mul_f32 v[168:169], v[168:169], v[152:153]
v_pk_mul_f32 v[170:171], v[170:171], v[154:155]
v_pk_mul_f32 v[172:173], v[172:173], v[156:157]
v_pk_mul_f32 v[174:175], v[174:175], v[158:159]
v_pk_fma_f32 v[176:177], v[176:177], v[4:5], v[4:5] op_sel:[0,0,0] op_sel_hi:[1,0,0]
v_pk_fma_f32 v[178:179], v[178:179], v[4:5], v[4:5] op_sel:[0,0,0] op_sel_hi:[1,0,0]
v_pk_fma_f32 v[180:181], v[180:181], v[12:13], v[12:13] op_sel:[0,1,1] op_sel_hi:[1,1,1]
v_pk_fma_f32 v[182:183], v[182:183], v[12:13], v[12:13] op_sel:[0,1,1] op_sel_hi:[1,1,1]
v_pk_fma_f32 v[184:185], v[184:185], v[6:7], v[6:7] op_sel:[0,0,0] op_sel_hi:[1,0,0]
buffer_store_dwordx4 v[208:211], v216, s[32:35], s51 offen offset:0 sc0 sc1
v_pk_fma_f32 v[186:187], v[186:187], v[6:7], v[6:7] op_sel:[0,0,0] op_sel_hi:[1,0,0]
v_pk_fma_f32 v[188:189], v[188:189], v[6:7], v[6:7] op_sel:[0,1,1] op_sel_hi:[1,1,1]
v_pk_fma_f32 v[190:191], v[190:191], v[6:7], v[6:7] op_sel:[0,1,1] op_sel_hi:[1,1,1]
v_cvt_pk_bf16_f32 v148, v160, v161
v_cvt_pk_bf16_f32 v149, v162, v163
v_cvt_pk_bf16_f32 v152, v164, v165
v_cvt_pk_bf16_f32 v153, v166, v167
v_cvt_pk_bf16_f32 v156, v168, v169
v_cvt_pk_bf16_f32 v157, v170, v171
v_cvt_pk_bf16_f32 v160, v172, v173
v_cvt_pk_bf16_f32 v161, v174, v175
v_rcp_f32 v176, v176
v_rcp_f32 v177, v177
v_rcp_f32 v178, v178
buffer_load_dwordx4 v10, s[28:31], s73 offen offset:2048  lds
v_rcp_f32 v179, v179
v_rcp_f32 v180, v180
v_rcp_f32 v181, v181
v_rcp_f32 v182, v182
v_rcp_f32 v183, v183
v_rcp_f32 v184, v184
v_rcp_f32 v185, v185
v_rcp_f32 v186, v186
buffer_load_dwordx4 v11, s[28:31], s73 offen offset:3072  lds
v_rcp_f32 v187, v187
v_rcp_f32 v188, v188
v_rcp_f32 v189, v189
v_rcp_f32 v190, v190
v_rcp_f32 v191, v191
s_nop 0
v_pk_mul_f32 v[192:193], v[192:193], v[176:177]
v_pk_mul_f32 v[194:195], v[194:195], v[178:179]
v_pk_mul_f32 v[196:197], v[196:197], v[180:181]
v_pk_mul_f32 v[198:199], v[198:199], v[182:183]
v_pk_mul_f32 v[200:201], v[200:201], v[184:185]
s_add_u32 m0, s57, 16384
s_nop 0
buffer_load_dwordx4 v10, s[28:31], s74 offen offset:0  lds
v_pk_mul_f32 v[202:203], v[202:203], v[186:187]
v_pk_mul_f32 v[204:205], v[204:205], v[188:189]
v_pk_mul_f32 v[206:207], v[206:207], v[190:191]
v_cvt_pk_bf16_f32 v150, v192, v193
v_cvt_pk_bf16_f32 v151, v194, v195
v_cvt_pk_bf16_f32 v154, v196, v197
v_cvt_pk_bf16_f32 v155, v198, v199
v_cvt_pk_bf16_f32 v158, v200, v201
v_cvt_pk_bf16_f32 v159, v202, v203
v_cvt_pk_bf16_f32 v162, v204, v205
v_cvt_pk_bf16_f32 v163, v206, v207
v_mul_f32 v3, 0xbd62dfc5, v3
v_mul_f32 v15, 0xbd62dfc5, v15
v_mul_f32 v1, 0xbd62dfc5, v1
v_mul_f32 v9, 0xbd62dfc5, v9
v_accvgpr_read_b32 v240, a0
buffer_store_dwordx4 v[212:215], v216, s[32:35], s51 offen offset:2048 sc0 sc1
v_accvgpr_read_b32 v241, a1
v_accvgpr_read_b32 v242, a2
v_accvgpr_read_b32 v243, a3
v_accvgpr_read_b32 v244, a4
v_accvgpr_read_b32 v245, a5
v_accvgpr_read_b32 v246, a6
v_accvgpr_read_b32 v247, a7
v_accvgpr_read_b32 v248, a8
v_accvgpr_read_b32 v249, a9
v_accvgpr_read_b32 v250, a10
v_accvgpr_read_b32 v251, a11
v_accvgpr_read_b32 v252, a12
v_accvgpr_read_b32 v253, a13
v_accvgpr_read_b32 v254, a14
v_accvgpr_read_b32 v255, a15
v_pk_mul_f32 v[240:241], v[240:241], v[2:3] op_sel:[0,1] op_sel_hi:[1,1]
buffer_load_dwordx4 v11, s[28:31], s74 offen offset:1024  lds
v_pk_mul_f32 v[242:243], v[242:243], v[2:3] op_sel:[0,1] op_sel_hi:[1,1]
v_pk_mul_f32 v[244:245], v[244:245], v[14:15] op_sel:[0,1] op_sel_hi:[1,1]
v_pk_mul_f32 v[246:247], v[246:247], v[14:15] op_sel:[0,1] op_sel_hi:[1,1]
v_pk_mul_f32 v[248:249], v[248:249], v[0:1] op_sel:[0,1] op_sel_hi:[1,1]
v_pk_mul_f32 v[250:251], v[250:251], v[0:1] op_sel:[0,1] op_sel_hi:[1,1]
v_pk_mul_f32 v[252:253], v[252:253], v[8:9] op_sel:[0,1] op_sel_hi:[1,1]
v_pk_mul_f32 v[254:255], v[254:255], v[8:9] op_sel:[0,1] op_sel_hi:[1,1]
v_cvt_pk_bf16_f32 v240, v240, v241
v_cvt_pk_bf16_f32 v242, v242, v243
v_cvt_pk_bf16_f32 v244, v244, v245
v_cvt_pk_bf16_f32 v246, v246, v247
v_cvt_pk_bf16_f32 v248, v248, v249
v_cvt_pk_bf16_f32 v250, v250, v251
v_cvt_pk_bf16_f32 v252, v252, v253
v_cvt_pk_bf16_f32 v254, v254, v255
v_accvgpr_write_b32 a128, v240
buffer_load_dwordx4 v10, s[28:31], s74 offen offset:2048  lds
v_accvgpr_write_b32 a129, v242
v_accvgpr_write_b32 a144, v244
v_accvgpr_write_b32 a145, v246
v_accvgpr_write_b32 a160, v248
v_accvgpr_write_b32 a161, v250
v_accvgpr_write_b32 a176, v252
v_accvgpr_write_b32 a177, v254
v_accvgpr_read_b32 v240, a16
v_accvgpr_read_b32 v241, a17
v_accvgpr_read_b32 v242, a18
v_accvgpr_read_b32 v243, a19
v_accvgpr_read_b32 v244, a20
v_accvgpr_read_b32 v245, a21
v_accvgpr_read_b32 v246, a22
v_accvgpr_read_b32 v247, a23
v_accvgpr_read_b32 v248, a24
buffer_load_dwordx4 v11, s[28:31], s74 offen offset:3072  lds
v_accvgpr_read_b32 v249, a25
v_accvgpr_read_b32 v250, a26
v_accvgpr_read_b32 v251, a27
v_accvgpr_read_b32 v252, a28
v_accvgpr_read_b32 v253, a29
v_accvgpr_read_b32 v254, a30
v_accvgpr_read_b32 v255, a31
v_pk_mul_f32 v[240:241], v[240:241], v[2:3] op_sel:[0,1] op_sel_hi:[1,1]
v_pk_mul_f32 v[242:243], v[242:243], v[2:3] op_sel:[0,1] op_sel_hi:[1,1]
v_pk_mul_f32 v[244:245], v[244:245], v[14:15] op_sel:[0,1] op_sel_hi:[1,1]
v_pk_mul_f32 v[246:247], v[246:247], v[14:15] op_sel:[0,1] op_sel_hi:[1,1]
v_pk_mul_f32 v[248:249], v[248:249], v[0:1] op_sel:[0,1] op_sel_hi:[1,1]
v_pk_mul_f32 v[250:251], v[250:251], v[0:1] op_sel:[0,1] op_sel_hi:[1,1]
v_pk_mul_f32 v[252:253], v[252:253], v[8:9] op_sel:[0,1] op_sel_hi:[1,1]
v_pk_mul_f32 v[254:255], v[254:255], v[8:9] op_sel:[0,1] op_sel_hi:[1,1]
v_cvt_pk_bf16_f32 v240, v240, v241
buffer_store_dwordx4 v[148:151], v5, s[32:35], s50 offen offset:0 sc0 sc1
v_cvt_pk_bf16_f32 v242, v242, v243
v_cvt_pk_bf16_f32 v244, v244, v245
v_cvt_pk_bf16_f32 v246, v246, v247
v_cvt_pk_bf16_f32 v248, v248, v249
v_cvt_pk_bf16_f32 v250, v250, v251
v_cvt_pk_bf16_f32 v252, v252, v253
v_cvt_pk_bf16_f32 v254, v254, v255
v_accvgpr_write_b32 a130, v240
v_accvgpr_write_b32 a131, v242
v_accvgpr_write_b32 a146, v244
v_accvgpr_write_b32 a147, v246
v_accvgpr_write_b32 a162, v248
v_accvgpr_write_b32 a163, v250
v_accvgpr_write_b32 a178, v252
v_accvgpr_write_b32 a179, v254
v_accvgpr_read_b32 v240, a32
s_add_u32 m0, s57, 32768
s_nop 0
buffer_load_dwordx4 v10, s[28:31], s75 offen offset:0  lds
v_accvgpr_read_b32 v241, a33
v_accvgpr_read_b32 v242, a34
v_accvgpr_read_b32 v243, a35
v_accvgpr_read_b32 v244, a36
v_accvgpr_read_b32 v245, a37
v_accvgpr_read_b32 v246, a38
v_accvgpr_read_b32 v247, a39
v_accvgpr_read_b32 v248, a40
v_accvgpr_read_b32 v249, a41
v_accvgpr_read_b32 v250, a42
v_accvgpr_read_b32 v251, a43
v_accvgpr_read_b32 v252, a44
v_accvgpr_read_b32 v253, a45
v_accvgpr_read_b32 v254, a46
v_accvgpr_read_b32 v255, a47
v_pk_mul_f32 v[240:241], v[240:241], v[2:3] op_sel:[0,1] op_sel_hi:[1,1]
buffer_load_dwordx4 v11, s[28:31], s75 offen offset:1024  lds
v_pk_mul_f32 v[242:243], v[242:243], v[2:3] op_sel:[0,1] op_sel_hi:[1,1]
v_pk_mul_f32 v[244:245], v[244:245], v[14:15] op_sel:[0,1] op_sel_hi:[1,1]
v_pk_mul_f32 v[246:247], v[246:247], v[14:15] op_sel:[0,1] op_sel_hi:[1,1]
v_pk_mul_f32 v[248:249], v[248:249], v[0:1] op_sel:[0,1] op_sel_hi:[1,1]
v_pk_mul_f32 v[250:251], v[250:251], v[0:1] op_sel:[0,1] op_sel_hi:[1,1]
v_pk_mul_f32 v[252:253], v[252:253], v[8:9] op_sel:[0,1] op_sel_hi:[1,1]
v_pk_mul_f32 v[254:255], v[254:255], v[8:9] op_sel:[0,1] op_sel_hi:[1,1]
v_cvt_pk_bf16_f32 v240, v240, v241
v_cvt_pk_bf16_f32 v242, v242, v243
v_cvt_pk_bf16_f32 v244, v244, v245
v_cvt_pk_bf16_f32 v246, v246, v247
v_cvt_pk_bf16_f32 v248, v248, v249
v_cvt_pk_bf16_f32 v250, v250, v251
v_cvt_pk_bf16_f32 v252, v252, v253
v_cvt_pk_bf16_f32 v254, v254, v255
v_accvgpr_write_b32 a132, v240
buffer_load_dwordx4 v10, s[28:31], s75 offen offset:2048  lds
v_accvgpr_write_b32 a133, v242
v_accvgpr_write_b32 a148, v244
v_accvgpr_write_b32 a149, v246
v_accvgpr_write_b32 a164, v248
v_accvgpr_write_b32 a165, v250
v_accvgpr_write_b32 a180, v252
v_accvgpr_write_b32 a181, v254
v_accvgpr_read_b32 v240, a48
v_accvgpr_read_b32 v241, a49
v_accvgpr_read_b32 v242, a50
v_accvgpr_read_b32 v243, a51
v_accvgpr_read_b32 v244, a52
v_accvgpr_read_b32 v245, a53
v_accvgpr_read_b32 v246, a54
v_accvgpr_read_b32 v247, a55
v_accvgpr_read_b32 v248, a56
buffer_store_dwordx4 v[152:155], v5, s[32:35], s50 offen offset:1024 sc0 sc1
v_accvgpr_read_b32 v249, a57
v_accvgpr_read_b32 v250, a58
v_accvgpr_read_b32 v251, a59
v_accvgpr_read_b32 v252, a60
v_accvgpr_read_b32 v253, a61
v_accvgpr_read_b32 v254, a62
v_accvgpr_read_b32 v255, a63
v_pk_mul_f32 v[240:241], v[240:241], v[2:3] op_sel:[0,1] op_sel_hi:[1,1]
v_pk_mul_f32 v[242:243], v[242:243], v[2:3] op_sel:[0,1] op_sel_hi:[1,1]
v_pk_mul_f32 v[244:245], v[244:245], v[14:15] op_sel:[0,1] op_sel_hi:[1,1]
v_pk_mul_f32 v[246:247], v[246:247], v[14:15] op_sel:[0,1] op_sel_hi:[1,1]
v_pk_mul_f32 v[248:249], v[248:249], v[0:1] op_sel:[0,1] op_sel_hi:[1,1]
v_pk_mul_f32 v[250:251], v[250:251], v[0:1] op_sel:[0,1] op_sel_hi:[1,1]
v_pk_mul_f32 v[252:253], v[252:253], v[8:9] op_sel:[0,1] op_sel_hi:[1,1]
v_pk_mul_f32 v[254:255], v[254:255], v[8:9] op_sel:[0,1] op_sel_hi:[1,1]
v_cvt_pk_bf16_f32 v240, v240, v241
buffer_load_dwordx4 v11, s[28:31], s75 offen offset:3072  lds
v_cvt_pk_bf16_f32 v242, v242, v243
v_cvt_pk_bf16_f32 v244, v244, v245
v_cvt_pk_bf16_f32 v246, v246, v247
v_cvt_pk_bf16_f32 v248, v248, v249
v_cvt_pk_bf16_f32 v250, v250, v251
v_cvt_pk_bf16_f32 v252, v252, v253
v_cvt_pk_bf16_f32 v254, v254, v255
v_accvgpr_write_b32 a134, v240
v_accvgpr_write_b32 a135, v242
v_accvgpr_write_b32 a150, v244
v_accvgpr_write_b32 a151, v246
v_accvgpr_write_b32 a166, v248
v_accvgpr_write_b32 a167, v250
v_accvgpr_write_b32 a182, v252
v_accvgpr_write_b32 a183, v254
v_accvgpr_read_b32 v240, a64
s_add_u32 m0, s57, 49152
s_nop 0
buffer_load_dwordx4 v10, s[28:31], s82 offen offset:0  lds
v_accvgpr_read_b32 v241, a65
v_accvgpr_read_b32 v242, a66
v_accvgpr_read_b32 v243, a67
v_accvgpr_read_b32 v244, a68
v_accvgpr_read_b32 v245, a69
v_accvgpr_read_b32 v246, a70
v_accvgpr_read_b32 v247, a71
v_accvgpr_read_b32 v248, a72
v_accvgpr_read_b32 v249, a73
v_accvgpr_read_b32 v250, a74
v_accvgpr_read_b32 v251, a75
v_accvgpr_read_b32 v252, a76
v_accvgpr_read_b32 v253, a77
v_accvgpr_read_b32 v254, a78
v_accvgpr_read_b32 v255, a79
v_pk_mul_f32 v[240:241], v[240:241], v[2:3] op_sel:[0,1] op_sel_hi:[1,1]
buffer_load_dwordx4 v11, s[28:31], s82 offen offset:1024  lds
v_pk_mul_f32 v[242:243], v[242:243], v[2:3] op_sel:[0,1] op_sel_hi:[1,1]
v_pk_mul_f32 v[244:245], v[244:245], v[14:15] op_sel:[0,1] op_sel_hi:[1,1]
v_pk_mul_f32 v[246:247], v[246:247], v[14:15] op_sel:[0,1] op_sel_hi:[1,1]
v_pk_mul_f32 v[248:249], v[248:249], v[0:1] op_sel:[0,1] op_sel_hi:[1,1]
v_pk_mul_f32 v[250:251], v[250:251], v[0:1] op_sel:[0,1] op_sel_hi:[1,1]
v_pk_mul_f32 v[252:253], v[252:253], v[8:9] op_sel:[0,1] op_sel_hi:[1,1]
v_pk_mul_f32 v[254:255], v[254:255], v[8:9] op_sel:[0,1] op_sel_hi:[1,1]
v_cvt_pk_bf16_f32 v240, v240, v241
v_cvt_pk_bf16_f32 v242, v242, v243
v_cvt_pk_bf16_f32 v244, v244, v245
v_cvt_pk_bf16_f32 v246, v246, v247
v_cvt_pk_bf16_f32 v248, v248, v249
v_cvt_pk_bf16_f32 v250, v250, v251
v_cvt_pk_bf16_f32 v252, v252, v253
v_cvt_pk_bf16_f32 v254, v254, v255
v_accvgpr_write_b32 a136, v240
buffer_store_dwordx4 v[156:159], v5, s[32:35], s50 offen offset:2048 sc0 sc1
v_accvgpr_write_b32 a137, v242
v_accvgpr_write_b32 a152, v244
v_accvgpr_write_b32 a153, v246
v_accvgpr_write_b32 a168, v248
v_accvgpr_write_b32 a169, v250
v_accvgpr_write_b32 a184, v252
v_accvgpr_write_b32 a185, v254
v_accvgpr_read_b32 v240, a80
v_accvgpr_read_b32 v241, a81
v_accvgpr_read_b32 v242, a82
v_accvgpr_read_b32 v243, a83
v_accvgpr_read_b32 v244, a84
v_accvgpr_read_b32 v245, a85
v_accvgpr_read_b32 v246, a86
v_accvgpr_read_b32 v247, a87
v_accvgpr_read_b32 v248, a88
buffer_load_dwordx4 v10, s[28:31], s82 offen offset:2048  lds
v_accvgpr_read_b32 v249, a89
v_accvgpr_read_b32 v250, a90
v_accvgpr_read_b32 v251, a91
v_accvgpr_read_b32 v252, a92
v_accvgpr_read_b32 v253, a93
v_accvgpr_read_b32 v254, a94
v_accvgpr_read_b32 v255, a95
v_pk_mul_f32 v[240:241], v[240:241], v[2:3] op_sel:[0,1] op_sel_hi:[1,1]
v_pk_mul_f32 v[242:243], v[242:243], v[2:3] op_sel:[0,1] op_sel_hi:[1,1]
v_pk_mul_f32 v[244:245], v[244:245], v[14:15] op_sel:[0,1] op_sel_hi:[1,1]
v_pk_mul_f32 v[246:247], v[246:247], v[14:15] op_sel:[0,1] op_sel_hi:[1,1]
v_pk_mul_f32 v[248:249], v[248:249], v[0:1] op_sel:[0,1] op_sel_hi:[1,1]
v_pk_mul_f32 v[250:251], v[250:251], v[0:1] op_sel:[0,1] op_sel_hi:[1,1]
v_pk_mul_f32 v[252:253], v[252:253], v[8:9] op_sel:[0,1] op_sel_hi:[1,1]
v_pk_mul_f32 v[254:255], v[254:255], v[8:9] op_sel:[0,1] op_sel_hi:[1,1]
v_cvt_pk_bf16_f32 v240, v240, v241
buffer_load_dwordx4 v11, s[28:31], s82 offen offset:3072  lds
v_cvt_pk_bf16_f32 v242, v242, v243
v_cvt_pk_bf16_f32 v244, v244, v245
v_cvt_pk_bf16_f32 v246, v246, v247
v_cvt_pk_bf16_f32 v248, v248, v249
v_cvt_pk_bf16_f32 v250, v250, v251
v_cvt_pk_bf16_f32 v252, v252, v253
v_cvt_pk_bf16_f32 v254, v254, v255
v_accvgpr_write_b32 a138, v240
v_accvgpr_write_b32 a139, v242
v_accvgpr_write_b32 a154, v244
v_accvgpr_write_b32 a155, v246
v_accvgpr_write_b32 a170, v248
v_accvgpr_write_b32 a171, v250
v_accvgpr_write_b32 a186, v252
v_accvgpr_write_b32 a187, v254
v_accvgpr_read_b32 v240, a96
v_accvgpr_read_b32 v241, a97
v_accvgpr_read_b32 v242, a98
v_accvgpr_read_b32 v243, a99
v_accvgpr_read_b32 v244, a100
v_accvgpr_read_b32 v245, a101
v_accvgpr_read_b32 v246, a102
v_accvgpr_read_b32 v247, a103
v_accvgpr_read_b32 v248, a104
v_accvgpr_read_b32 v249, a105
v_accvgpr_read_b32 v250, a106
v_accvgpr_read_b32 v251, a107
v_accvgpr_read_b32 v252, a108
buffer_store_dwordx4 v[160:163], v5, s[32:35], s50 offen offset:3072 sc0 sc1
v_accvgpr_read_b32 v253, a109
v_accvgpr_read_b32 v254, a110
v_accvgpr_read_b32 v255, a111
v_pk_mul_f32 v[240:241], v[240:241], v[2:3] op_sel:[0,1] op_sel_hi:[1,1]
v_pk_mul_f32 v[242:243], v[242:243], v[2:3] op_sel:[0,1] op_sel_hi:[1,1]
v_pk_mul_f32 v[244:245], v[244:245], v[14:15] op_sel:[0,1] op_sel_hi:[1,1]
v_pk_mul_f32 v[246:247], v[246:247], v[14:15] op_sel:[0,1] op_sel_hi:[1,1]
v_pk_mul_f32 v[248:249], v[248:249], v[0:1] op_sel:[0,1] op_sel_hi:[1,1]
v_pk_mul_f32 v[250:251], v[250:251], v[0:1] op_sel:[0,1] op_sel_hi:[1,1]
v_pk_mul_f32 v[252:253], v[252:253], v[8:9] op_sel:[0,1] op_sel_hi:[1,1]
v_pk_mul_f32 v[254:255], v[254:255], v[8:9] op_sel:[0,1] op_sel_hi:[1,1]
v_cvt_pk_bf16_f32 v240, v240, v241
v_cvt_pk_bf16_f32 v242, v242, v243
v_cvt_pk_bf16_f32 v244, v244, v245
v_cvt_pk_bf16_f32 v246, v246, v247
v_cvt_pk_bf16_f32 v248, v248, v249
v_cvt_pk_bf16_f32 v250, v250, v251
v_cvt_pk_bf16_f32 v252, v252, v253
v_cvt_pk_bf16_f32 v254, v254, v255
v_accvgpr_write_b32 a140, v240
v_accvgpr_write_b32 a141, v242
v_accvgpr_write_b32 a156, v244
v_accvgpr_write_b32 a157, v246
v_accvgpr_write_b32 a172, v248
v_accvgpr_write_b32 a173, v250
v_accvgpr_write_b32 a188, v252
v_accvgpr_write_b32 a189, v254
v_accvgpr_read_b32 v212, a244
v_xor_b32 v213, 64, v212
v_xor_b32 v214, 128, v212
v_xor_b32 v215, 192, v212
ds_read_b128 a[192:195], v212 offset:0
ds_read_b128 a[196:199], v213 offset:0
ds_read_b128 a[200:203], v214 offset:0
ds_read_b128 a[204:207], v215 offset:0
ds_read_b128 a[208:211], v212 offset:4096
ds_read_b128 a[212:215], v213 offset:4096
ds_read_b128 a[216:219], v214 offset:4096
ds_read_b128 a[220:223], v215 offset:4096
v_accvgpr_read_b32 v240, a112
v_accvgpr_read_b32 v241, a113
v_accvgpr_read_b32 v242, a114
v_accvgpr_read_b32 v243, a115
v_accvgpr_read_b32 v244, a116
v_accvgpr_read_b32 v245, a117
v_accvgpr_read_b32 v246, a118
v_accvgpr_read_b32 v247, a119
v_accvgpr_read_b32 v248, a120
v_accvgpr_read_b32 v249, a121
v_accvgpr_read_b32 v250, a122
v_accvgpr_read_b32 v251, a123
v_accvgpr_read_b32 v252, a124
v_accvgpr_read_b32 v253, a125
v_accvgpr_read_b32 v254, a126
v_accvgpr_read_b32 v255, a127
v_pk_mul_f32 v[240:241], v[240:241], v[2:3] op_sel:[0,1] op_sel_hi:[1,1]
v_pk_mul_f32 v[242:243], v[242:243], v[2:3] op_sel:[0,1] op_sel_hi:[1,1]
v_pk_mul_f32 v[244:245], v[244:245], v[14:15] op_sel:[0,1] op_sel_hi:[1,1]
v_pk_mul_f32 v[246:247], v[246:247], v[14:15] op_sel:[0,1] op_sel_hi:[1,1]
v_pk_mul_f32 v[248:249], v[248:249], v[0:1] op_sel:[0,1] op_sel_hi:[1,1]
v_pk_mul_f32 v[250:251], v[250:251], v[0:1] op_sel:[0,1] op_sel_hi:[1,1]
v_pk_mul_f32 v[252:253], v[252:253], v[8:9] op_sel:[0,1] op_sel_hi:[1,1]
v_pk_mul_f32 v[254:255], v[254:255], v[8:9] op_sel:[0,1] op_sel_hi:[1,1]
v_cvt_pk_bf16_f32 v240, v240, v241
v_cvt_pk_bf16_f32 v242, v242, v243
v_cvt_pk_bf16_f32 v244, v244, v245
v_cvt_pk_bf16_f32 v246, v246, v247
v_cvt_pk_bf16_f32 v248, v248, v249
v_cvt_pk_bf16_f32 v250, v250, v251
v_cvt_pk_bf16_f32 v252, v252, v253
v_cvt_pk_bf16_f32 v254, v254, v255
v_accvgpr_write_b32 a142, v240
v_accvgpr_write_b32 a143, v242
v_accvgpr_write_b32 a158, v244
v_accvgpr_write_b32 a159, v246
v_accvgpr_write_b32 a174, v248
v_accvgpr_write_b32 a175, v250
v_accvgpr_write_b32 a190, v252
v_accvgpr_write_b32 a191, v254
s_cmp_lg_u32 s78, 0
s_cbranch_scc1 L_main_kernel_mx
s_waitcnt lgkmcnt(7)
v_mfma_f32_16x16x32_bf16 v[16:19], a[192:195], a[128:131], 0
v_accvgpr_read_b32 v6, a241
s_waitcnt lgkmcnt(6)
v_mfma_f32_16x16x32_bf16 v[16:19], a[196:199], a[132:135], v[16:19]
v_bfe_u32 v0, v5, 4, 6
v_add_u32 v6, 0x8000, v6
v_mfma_f32_16x16x32_bf16 v[20:23], a[196:199], a[148:151], 0
v_lshl_add_u32 v1, v0, 4, s57
v_xor_b32 v7, 64, v6
v_mfma_f32_16x16x32_bf16 v[20:23], a[192:195], a[144:147], v[20:23]
v_xor_b32 v8, 128, v6
v_xor_b32 v9, 192, v6
v_mfma_f32_16x16x32_bf16 v[24:27], a[192:195], a[160:163], 0
s_mov_b32 s56, 0x8000
v_accvgpr_read_b32 v216, a245
v_mfma_f32_16x16x32_bf16 v[24:27], a[196:199], a[164:167], v[24:27]
v_accvgpr_read_b32 v254, a246
v_xor_b32 v217, 32, v216
v_mfma_f32_16x16x32_bf16 v[28:31], a[196:199], a[180:183], 0
ds_read_b128 a[196:199], v213 offset:8192
v_xor_b32 v218, 64, v216
v_mfma_f32_16x16x32_bf16 v[28:31], a[192:195], a[176:179], v[28:31]
ds_read_b128 a[192:195], v212 offset:8192
s_waitcnt lgkmcnt(7)
v_mfma_f32_16x16x32_bf16 v[28:31], a[200:203], a[184:187], v[28:31]
v_xor_b32 v219, 96, v216
s_waitcnt lgkmcnt(6)
v_mfma_f32_16x16x32_bf16 v[28:31], a[204:207], a[188:191], v[28:31]
v_xor_b32 v220, 128, v216
v_xor_b32 v221, 160, v216
v_mfma_f32_16x16x32_bf16 v[24:27], a[204:207], a[172:175], v[24:27]
v_xor_b32 v222, 192, v216
v_xor_b32 v223, 224, v216
v_mfma_f32_16x16x32_bf16 v[24:27], a[200:203], a[168:171], v[24:27]
v_mov_b32 v144, 0x3f803f80
v_mov_b32 v145, 0x3f803f80
v_mfma_f32_16x16x32_bf16 v[20:23], a[200:203], a[152:155], v[20:23]
v_mov_b32 v146, 0x3f803f80
v_mov_b32 v147, 0x3f803f80
v_mfma_f32_16x16x32_bf16 v[20:23], a[204:207], a[156:159], v[20:23]
v_mov_b32 v249, 1
v_bfrev_b32 v252, 2
v_mfma_f32_16x16x32_bf16 v[16:19], a[204:207], a[140:143], v[16:19]
ds_read_b128 a[204:207], v215 offset:8192
v_lshl_add_u32 v248, v0, 5, s83
v_mfma_f32_16x16x32_bf16 v[16:19], a[200:203], a[136:139], v[16:19]
ds_read_b128 a[200:203], v214 offset:8192
s_waitcnt lgkmcnt(7)
v_mfma_f32_16x16x32_bf16 v[32:35], a[208:211], a[128:131], 0
v_mov_b32 v251, s80
s_waitcnt lgkmcnt(6)
v_mfma_f32_16x16x32_bf16 v[32:35], a[212:215], a[132:135], v[32:35]
v_max3_f32 v227, v28, v29, v30
v_max_f32 v227, v227, v31
v_mfma_f32_16x16x32_bf16 v[36:39], a[212:215], a[148:151], 0
v_max3_f32 v226, v24, v25, v26
v_max_f32 v226, v226, v27
v_mfma_f32_16x16x32_bf16 v[36:39], a[208:211], a[144:147], v[36:39]
v_max3_f32 v225, v20, v21, v22
v_max_f32 v225, v225, v23
v_mfma_f32_16x16x32_bf16 v[40:43], a[208:211], a[160:163], 0
v_max3_f32 v224, v16, v17, v18
v_max_f32 v224, v224, v19
v_mfma_f32_16x16x32_bf16 v[40:43], a[212:215], a[164:167], v[40:43]
v_mov_b32 v231, v227
v_mov_b32 v230, v226
v_mfma_f32_16x16x32_bf16 v[44:47], a[212:215], a[180:183], 0
ds_read_b128 a[212:215], v213 offset:12288
v_mov_b32 v229, v225
v_mfma_f32_16x16x32_bf16 v[44:47], a[208:211], a[176:179], v[44:47]
ds_read_b128 a[208:211], v212 offset:12288
s_waitcnt lgkmcnt(7)
v_mfma_f32_16x16x32_bf16 v[44:47], a[216:219], a[184:187], v[44:47]
v_mov_b32 v228, v224
s_waitcnt lgkmcnt(6)
v_mfma_f32_16x16x32_bf16 v[44:47], a[220:223], a[188:191], v[44:47]
v_permlane16_swap_b32 v231, v227
v_permlane16_swap_b32 v230, v226
v_mfma_f32_16x16x32_bf16 v[40:43], a[220:223], a[172:175], v[40:43]
v_permlane16_swap_b32 v229, v225
v_permlane16_swap_b32 v228, v224
v_mfma_f32_16x16x32_bf16 v[40:43], a[216:219], a[168:171], v[40:43]
v_max_f32 v227, v227, v231
v_max_f32 v226, v226, v230
v_mfma_f32_16x16x32_bf16 v[36:39], a[216:219], a[152:155], v[36:39]
v_max_f32 v225, v225, v229
v_max_f32 v224, v224, v228
v_mfma_f32_16x16x32_bf16 v[36:39], a[220:223], a[156:159], v[36:39]
v_mov_b32 v231, v227
v_mov_b32 v230, v226
v_mfma_f32_16x16x32_bf16 v[32:35], a[220:223], a[140:143], v[32:35]
ds_read_b128 a[220:223], v215 offset:12288
v_mov_b32 v229, v225
v_mfma_f32_16x16x32_bf16 v[32:35], a[216:219], a[136:139], v[32:35]
ds_read_b128 a[216:219], v214 offset:12288
v_mov_b32 v228, v224
v_permlane32_swap_b32 v231, v227
v_permlane32_swap_b32 v230, v226
v_permlane32_swap_b32 v229, v225
v_permlane32_swap_b32 v228, v224
v_min_f32 v140, -v227, -v231
v_min_f32 v141, -v227, -v231
v_min_f32 v142, -v227, -v231
v_min_f32 v143, -v227, -v231
v_min_f32 v136, -v226, -v230
v_min_f32 v137, -v226, -v230
v_min_f32 v138, -v226, -v230
v_min_f32 v139, -v226, -v230
v_min_f32 v132, -v225, -v229
v_min_f32 v133, -v225, -v229
v_min_f32 v134, -v225, -v229
v_min_f32 v135, -v225, -v229
v_min_f32 v128, -v224, -v228
v_min_f32 v129, -v224, -v228
v_min_f32 v130, -v224, -v228
v_min_f32 v131, -v224, -v228
L_main_kernel_havemax:
v_pk_add_f32 v[28:29], v[28:29], v[140:141]
v_pk_add_f32 v[30:31], v[30:31], v[140:141]
v_pk_add_f32 v[24:25], v[24:25], v[136:137]
v_pk_add_f32 v[26:27], v[26:27], v[136:137]
v_pk_add_f32 v[20:21], v[20:21], v[132:133]
v_pk_add_f32 v[22:23], v[22:23], v[132:133]
v_pk_add_f32 v[16:17], v[16:17], v[128:129]
v_pk_add_f32 v[18:19], v[18:19], v[128:129]
v_pk_add_f32 v[44:45], v[44:45], v[140:141]
v_pk_add_f32 v[46:47], v[46:47], v[140:141]
v_pk_add_f32 v[40:41], v[40:41], v[136:137]
v_pk_add_f32 v[42:43], v[42:43], v[136:137]
v_pk_add_f32 v[36:37], v[36:37], v[132:133]
v_pk_add_f32 v[38:39], v[38:39], v[132:133]
v_pk_add_f32 v[32:33], v[32:33], v[128:129]
v_pk_add_f32 v[34:35], v[34:35], v[128:129]
s_waitcnt vmcnt(12) lgkmcnt(0)
s_barrier
v_mfma_f32_16x16x32_bf16 v[48:51], a[192:195], a[128:131], v[128:131]
v_exp_f32 v112, v16
v_mfma_f32_16x16x32_bf16 v[48:51], a[196:199], a[132:135], v[48:51]
v_exp_f32 v113, v17
v_mfma_f32_16x16x32_bf16 v[48:51], a[200:203], a[136:139], v[48:51]
v_exp_f32 v114, v18
v_mfma_f32_16x16x32_bf16 v[48:51], a[204:207], a[140:143], v[48:51]
v_exp_f32 v115, v19
v_mfma_f32_16x16x32_bf16 v[52:55], a[204:207], a[156:159], v[132:135]
v_cvt_pk_bf16_f32 v80, v112, v113
v_cvt_pk_bf16_f32 v81, v114, v115
v_mfma_f32_16x16x32_bf16 v[52:55], a[200:203], a[152:155], v[52:55]
v_exp_f32 v116, v32
v_mfma_f32_16x16x32_bf16 v[52:55], a[196:199], a[148:151], v[52:55]
v_exp_f32 v117, v33
v_mfma_f32_16x16x32_bf16 v[52:55], a[192:195], a[144:147], v[52:55]
v_exp_f32 v118, v34
v_mfma_f32_16x16x32_bf16 v[56:59], a[192:195], a[160:163], v[136:139]
v_exp_f32 v119, v35
v_mfma_f32_16x16x32_bf16 v[56:59], a[196:199], a[164:167], v[56:59]
v_cvt_pk_bf16_f32 v82, v116, v117
v_cvt_pk_bf16_f32 v83, v118, v119
v_mfma_f32_16x16x32_bf16 v[56:59], a[200:203], a[168:171], v[56:59]
v_exp_f32 v120, v20
v_mfma_f32_16x16x32_bf16 v[56:59], a[204:207], a[172:175], v[56:59]
v_exp_f32 v121, v21
v_mfma_f32_16x16x32_bf16 v[60:63], a[204:207], a[188:191], v[140:143]
ds_read_b128 a[204:207], v215 offset:16384
v_cvt_pk_bf16_f32 v88, v120, v121
v_mfma_f32_16x16x32_bf16 v[60:63], a[200:203], a[184:187], v[60:63]
v_exp_f32 v122, v22
v_mfma_f32_16x16x32_bf16 v[60:63], a[196:199], a[180:183], v[60:63]
v_exp_f32 v123, v23
v_mfma_f32_16x16x32_bf16 v[60:63], a[192:195], a[176:179], v[60:63]
ds_read_b128 a[200:203], v214 offset:16384
v_cvt_pk_bf16_f32 v89, v122, v123
v_mfma_f32_16x16x32_bf16 v[76:79], a[208:211], a[176:179], v[140:143]
v_exp_f32 v124, v36
v_mfma_f32_16x16x32_bf16 v[76:79], a[212:215], a[180:183], v[76:79]
v_exp_f32 v125, v37
v_mfma_f32_16x16x32_bf16 v[76:79], a[216:219], a[184:187], v[76:79]
ds_read_b128 a[196:199], v213 offset:16384
v_cvt_pk_bf16_f32 v90, v124, v125
v_mfma_f32_16x16x32_bf16 v[76:79], a[220:223], a[188:191], v[76:79]
v_exp_f32 v126, v38
v_mfma_f32_16x16x32_bf16 v[72:75], a[220:223], a[172:175], v[136:139]
v_exp_f32 v127, v39
v_mfma_f32_16x16x32_bf16 v[72:75], a[216:219], a[168:171], v[72:75]
ds_read_b128 a[192:195], v212 offset:16384
v_cvt_pk_bf16_f32 v91, v126, v127
v_mfma_f32_16x16x32_bf16 v[72:75], a[212:215], a[164:167], v[72:75]
v_exp_f32 v112, v24
v_mfma_f32_16x16x32_bf16 v[72:75], a[208:211], a[160:163], v[72:75]
v_exp_f32 v113, v25
v_mfma_f32_16x16x32_bf16 v[68:71], a[208:211], a[144:147], v[132:135]
v_exp_f32 v114, v26
v_mfma_f32_16x16x32_bf16 v[68:71], a[212:215], a[148:151], v[68:71]
v_exp_f32 v115, v27
v_mfma_f32_16x16x32_bf16 v[68:71], a[216:219], a[152:155], v[68:71]
v_cvt_pk_bf16_f32 v96, v112, v113
v_cvt_pk_bf16_f32 v97, v114, v115
v_mfma_f32_16x16x32_bf16 v[68:71], a[220:223], a[156:159], v[68:71]
v_exp_f32 v116, v40
v_mfma_f32_16x16x32_bf16 v[64:67], a[220:223], a[140:143], v[128:131]
v_exp_f32 v117, v41
v_mfma_f32_16x16x32_bf16 v[64:67], a[216:219], a[136:139], v[64:67]
ds_read_b128 a[220:223], v215 offset:20480
v_cvt_pk_bf16_f32 v98, v116, v117
v_mfma_f32_16x16x32_bf16 v[64:67], a[212:215], a[132:135], v[64:67]
v_exp_f32 v118, v42
v_mfma_f32_16x16x32_bf16 v[64:67], a[208:211], a[128:131], v[64:67]
ds_read_b128 a[216:219], v214 offset:20480
ds_read_b128 a[212:215], v213 offset:20480
ds_read_b128 a[208:211], v212 offset:20480
v_exp_f32 v119, v43
v_exp_f32 v120, v28
v_exp_f32 v121, v29
v_exp_f32 v122, v30
s_nop 0
v_cvt_pk_bf16_f32 v99, v118, v119
v_cvt_pk_bf16_f32 v104, v120, v121
v_exp_f32 v123, v31
v_exp_f32 v124, v44
v_exp_f32 v125, v45
v_exp_f32 v126, v46
s_nop 0
v_cvt_pk_bf16_f32 v105, v122, v123
v_cvt_pk_bf16_f32 v106, v124, v125
v_exp_f32 v127, v47
s_nop 0
v_cvt_pk_bf16_f32 v107, v126, v127
s_waitcnt lgkmcnt(4)
v_mfma_f32_16x16x32_bf16 v[16:19], a[192:195], a[128:131], v[128:131]
v_exp_f32 v112, v48
v_mfma_f32_16x16x32_bf16 v[16:19], a[196:199], a[132:135], v[16:19]
v_exp_f32 v113, v49
v_mfma_f32_16x16x32_bf16 v[16:19], a[200:203], a[136:139], v[16:19]
v_exp_f32 v114, v50
v_mfma_f32_16x16x32_bf16 v[16:19], a[204:207], a[140:143], v[16:19]
s_add_u32 m0, s57, 98304
v_cvt_pk_bf16_f32 v84, v112, v113
v_mfma_f32_16x16x32_bf16 v[20:23], a[204:207], a[156:159], v[132:135]
buffer_load_dwordx4 v6, s[24:27], s56 offen offset:0  lds
v_mfma_f32_16x16x32_bf16 v[20:23], a[200:203], a[152:155], v[20:23]
v_exp_f32 v115, v51
v_mfma_f32_16x16x32_bf16 v[20:23], a[196:199], a[148:151], v[20:23]
v_exp_f32 v116, v64
v_mfma_f32_16x16x32_bf16 v[20:23], a[192:195], a[144:147], v[20:23]
v_exp_f32 v117, v65
v_mfma_f32_16x16x32_bf16 v[24:27], a[192:195], a[160:163], v[136:139]
v_cvt_pk_bf16_f32 v85, v114, v115
v_cvt_pk_bf16_f32 v86, v116, v117
v_mfma_f32_16x16x32_bf16 v[24:27], a[196:199], a[164:167], v[24:27]
v_exp_f32 v118, v66
v_mfma_f32_16x16x32_bf16 v[24:27], a[200:203], a[168:171], v[24:27]
v_exp_f32 v119, v67
v_mfma_f32_16x16x32_bf16 v[24:27], a[204:207], a[172:175], v[24:27]
v_cvt_pk_bf16_f32 v87, v118, v119
v_mfma_f32_16x16x32_bf16 v[28:31], a[204:207], a[188:191], v[140:143]
buffer_load_dwordx4 v7, s[24:27], s56 offen offset:1024  lds
v_mfma_f32_16x16x32_bf16 v[28:31], a[200:203], a[184:187], v[28:31]
v_exp_f32 v120, v52
v_mfma_f32_16x16x32_bf16 v[28:31], a[196:199], a[180:183], v[28:31]
v_exp_f32 v121, v53
v_mfma_f32_16x16x32_bf16 v[28:31], a[192:195], a[176:179], v[28:31]
ds_read_b128 a[204:207], v215 offset:24576
s_waitcnt lgkmcnt(1)
v_mfma_f32_16x16x32_bf16 v[44:47], a[208:211], a[176:179], v[140:143]
ds_read_b128 a[200:203], v214 offset:24576
v_cvt_pk_bf16_f32 v92, v120, v121
v_mfma_f32_16x16x32_bf16 v[44:47], a[212:215], a[180:183], v[44:47]
v_exp_f32 v122, v54
v_mfma_f32_16x16x32_bf16 v[44:47], a[216:219], a[184:187], v[44:47]
v_exp_f32 v123, v55
v_mfma_f32_16x16x32_bf16 v[44:47], a[220:223], a[188:191], v[44:47]
ds_read_b128 a[196:199], v213 offset:24576
v_cvt_pk_bf16_f32 v93, v122, v123
v_mfma_f32_16x16x32_bf16 v[40:43], a[220:223], a[172:175], v[136:139]
buffer_load_dwordx4 v8, s[24:27], s56 offen offset:2048  lds
v_mfma_f32_16x16x32_bf16 v[40:43], a[216:219], a[168:171], v[40:43]
ds_read_b128 a[192:195], v212 offset:24576
v_mfma_f32_16x16x32_bf16 v[40:43], a[212:215], a[164:167], v[40:43]
v_exp_f32 v124, v68
v_mfma_f32_16x16x32_bf16 v[40:43], a[208:211], a[160:163], v[40:43]
v_exp_f32 v125, v69
v_mfma_f32_16x16x32_bf16 v[36:39], a[208:211], a[144:147], v[132:135]
v_exp_f32 v126, v70
v_mfma_f32_16x16x32_bf16 v[36:39], a[212:215], a[148:151], v[36:39]
v_exp_f32 v127, v71
v_mfma_f32_16x16x32_bf16 v[36:39], a[216:219], a[152:155], v[36:39]
v_cvt_pk_bf16_f32 v94, v124, v125
v_cvt_pk_bf16_f32 v95, v126, v127
v_mfma_f32_16x16x32_bf16 v[36:39], a[220:223], a[156:159], v[36:39]
v_mfma_f32_16x16x32_bf16 v[32:35], a[220:223], a[140:143], v[128:131]
buffer_load_dwordx4 v9, s[24:27], s56 offen offset:3072  lds
v_mfma_f32_16x16x32_bf16 v[32:35], a[216:219], a[136:139], v[32:35]
ds_read_b128 a[220:223], v215 offset:28672
s_add_u32 s56, s56, 0x4000
v_mfma_f32_16x16x32_bf16 v[32:35], a[212:215], a[132:135], v[32:35]
v_exp_f32 v112, v56
v_mfma_f32_16x16x32_bf16 v[32:35], a[208:211], a[128:131], v[32:35]
ds_read_b128 a[216:219], v214 offset:28672
ds_read_b128 a[212:215], v213 offset:28672
ds_read_b128 a[208:211], v212 offset:28672
ds_read_b64_tr_b16 v[184:185], v216 offset:8192
ds_read_b64_tr_b16 v[186:187], v216 offset:12288
ds_read_b64_tr_b16 v[180:181], v216 offset:0
ds_read_b64_tr_b16 v[182:183], v216 offset:4096
ds_read_b64_tr_b16 v[192:193], v217 offset:8192
ds_read_b64_tr_b16 v[194:195], v217 offset:12288
ds_read_b64_tr_b16 v[188:189], v217 offset:0
ds_read_b64_tr_b16 v[190:191], v217 offset:4096
ds_read_b64_tr_b16 v[200:201], v218 offset:8192
ds_read_b64_tr_b16 v[202:203], v218 offset:12288
ds_read_b64_tr_b16 v[196:197], v218 offset:0
ds_read_b64_tr_b16 v[198:199], v218 offset:4096
ds_read_b64_tr_b16 v[208:209], v219 offset:8192
ds_read_b64_tr_b16 v[210:211], v219 offset:12288
ds_read_b64_tr_b16 v[204:205], v219 offset:0
ds_read_b64_tr_b16 v[206:207], v219 offset:4096
v_exp_f32 v113, v57
v_exp_f32 v114, v58
v_exp_f32 v115, v59
v_exp_f32 v116, v72
s_nop 0
v_cvt_pk_bf16_f32 v100, v112, v113
v_cvt_pk_bf16_f32 v101, v114, v115
v_exp_f32 v117, v73
v_exp_f32 v118, v74
v_exp_f32 v119, v75
v_exp_f32 v120, v60
s_nop 0
v_cvt_pk_bf16_f32 v102, v116, v117
v_cvt_pk_bf16_f32 v103, v118, v119
v_exp_f32 v121, v61
v_exp_f32 v122, v62
v_exp_f32 v123, v63
v_exp_f32 v124, v76
s_nop 0
v_cvt_pk_bf16_f32 v108, v120, v121
v_cvt_pk_bf16_f32 v109, v122, v123
v_exp_f32 v125, v77
v_exp_f32 v126, v78
v_exp_f32 v127, v79
s_nop 0
v_cvt_pk_bf16_f32 v110, v124, v125
v_cvt_pk_bf16_f32 v111, v126, v127
s_waitcnt vmcnt(5)
s_barrier
s_waitcnt lgkmcnt(15)
v_mfma_f32_16x16x32_bf16 v[48:51], a[192:195], a[128:131], v[128:131]
v_exp_f32 v112, v16
v_mfma_f32_16x16x32_bf16 v[48:51], a[196:199], a[132:135], v[48:51]
v_exp_f32 v113, v17
v_mfma_f32_16x16x32_bf16 v[48:51], a[200:203], a[136:139], v[48:51]
v_exp_f32 v114, v18
v_mfma_f32_16x16x32_bf16 v[48:51], a[204:207], a[140:143], v[48:51]
v_exp_f32 v115, v19
v_mfma_f32_16x16x32_bf16 v[52:55], a[204:207], a[156:159], v[132:135]
v_cvt_pk_bf16_f32 v148, v112, v113
v_cvt_pk_bf16_f32 v149, v114, v115
v_mfma_f32_16x16x32_bf16 v[52:55], a[200:203], a[152:155], v[52:55]
v_exp_f32 v116, v32
v_mfma_f32_16x16x32_bf16 v[52:55], a[196:199], a[148:151], v[52:55]
v_exp_f32 v117, v33
v_mfma_f32_16x16x32_bf16 v[52:55], a[192:195], a[144:147], v[52:55]
v_exp_f32 v118, v34
v_mfma_f32_16x16x32_bf16 v[56:59], a[192:195], a[160:163], v[136:139]
v_exp_f32 v119, v35
v_mfma_f32_16x16x32_bf16 v[56:59], a[196:199], a[164:167], v[56:59]
v_cvt_pk_bf16_f32 v150, v116, v117
v_cvt_pk_bf16_f32 v151, v118, v119
v_mfma_f32_16x16x32_bf16 v[56:59], a[200:203], a[168:171], v[56:59]
v_exp_f32 v120, v20
v_mfma_f32_16x16x32_bf16 v[56:59], a[204:207], a[172:175], v[56:59]
v_exp_f32 v121, v21
v_mfma_f32_16x16x32_bf16 v[60:63], a[204:207], a[188:191], v[140:143]
ds_read_b128 a[204:207], v215 offset:32768
v_cvt_pk_bf16_f32 v156, v120, v121
v_mfma_f32_16x16x32_bf16 v[60:63], a[200:203], a[184:187], v[60:63]
v_exp_f32 v122, v22
v_mfma_f32_16x16x32_bf16 v[60:63], a[196:199], a[180:183], v[60:63]
v_exp_f32 v123, v23
v_mfma_f32_16x16x32_bf16 v[60:63], a[192:195], a[176:179], v[60:63]
ds_read_b128 a[200:203], v214 offset:32768
v_cvt_pk_bf16_f32 v157, v122, v123
v_mfma_f32_16x16x32_bf16 v[76:79], a[208:211], a[176:179], v[140:143]
v_exp_f32 v124, v36
v_mfma_f32_16x16x32_bf16 v[76:79], a[212:215], a[180:183], v[76:79]
v_exp_f32 v125, v37
v_mfma_f32_16x16x32_bf16 v[76:79], a[216:219], a[184:187], v[76:79]
ds_read_b128 a[196:199], v213 offset:32768
v_cvt_pk_bf16_f32 v158, v124, v125
v_mfma_f32_16x16x32_bf16 v[76:79], a[220:223], a[188:191], v[76:79]
v_exp_f32 v126, v38
v_mfma_f32_16x16x32_bf16 v[72:75], a[220:223], a[172:175], v[136:139]
v_exp_f32 v127, v39
v_mfma_f32_16x16x32_bf16 v[72:75], a[216:219], a[168:171], v[72:75]
ds_read_b128 a[192:195], v212 offset:32768
v_cvt_pk_bf16_f32 v159, v126, v127
v_mfma_f32_16x16x32_bf16 v[72:75], a[212:215], a[164:167], v[72:75]
v_exp_f32 v112, v24
v_mfma_f32_16x16x32_bf16 v[72:75], a[208:211], a[160:163], v[72:75]
v_exp_f32 v113, v25
v_mfma_f32_16x16x32_bf16 v[68:71], a[208:211], a[144:147], v[132:135]
v_exp_f32 v114, v26
v_mfma_f32_16x16x32_bf16 v[68:71], a[212:215], a[148:151], v[68:71]
v_exp_f32 v115, v27
v_mfma_f32_16x16x32_bf16 v[68:71], a[216:219], a[152:155], v[68:71]
v_cvt_pk_bf16_f32 v164, v112, v113
v_cvt_pk_bf16_f32 v165, v114, v115
v_mfma_f32_16x16x32_bf16 v[68:71], a[220:223], a[156:159], v[68:71]
v_exp_f32 v116, v40
v_mfma_f32_16x16x32_bf16 v[64:67], a[220:223], a[140:143], v[128:131]
v_exp_f32 v117, v41
v_mfma_f32_16x16x32_bf16 v[64:67], a[216:219], a[136:139], v[64:67]
ds_read_b128 a[220:223], v215 offset:36864
v_cvt_pk_bf16_f32 v166, v116, v117
v_mfma_f32_16x16x32_bf16 v[64:67], a[212:215], a[132:135], v[64:67]
v_exp_f32 v118, v42
v_mfma_f32_16x16x32_bf16 v[64:67], a[208:211], a[128:131], v[64:67]
ds_read_b128 a[216:219], v214 offset:36864
s_waitcnt lgkmcnt(15)
v_mfma_f32_16x16x32_bf16 a[0:3], v[180:183], v[80:83], 0
v_exp_f32 v119, v43
v_mfma_f32_16x16x32_bf16 a[0:3], v[184:187], v[84:87], a[0:3]
ds_read_b128 a[212:215], v213 offset:36864
v_cvt_pk_bf16_f32 v167, v118, v119
v_mfma_f32_16x16x32_bf16 a[32:35], v[184:187], v[92:95], 0
v_exp_f32 v120, v28
v_mfma_f32_16x16x32_bf16 a[32:35], v[180:183], v[88:91], a[32:35]
v_exp_f32 v121, v29
v_mfma_f32_16x16x32_bf16 a[64:67], v[180:183], v[96:99], 0
ds_read_b128 a[208:211], v212 offset:36864
v_cvt_pk_bf16_f32 v172, v120, v121
v_mfma_f32_16x16x32_bf16 a[64:67], v[184:187], v[100:103], a[64:67]
v_exp_f32 v122, v30
v_mfma_f32_16x16x32_bf16 a[96:99], v[184:187], v[108:111], 0
v_exp_f32 v123, v31
v_mfma_f32_16x16x32_bf16 a[96:99], v[180:183], v[104:107], a[96:99]
ds_read_b64_tr_b16 v[184:185], v220 offset:8192
s_waitcnt lgkmcnt(15)
v_mfma_f32_16x16x32_bf16 a[100:103], v[188:191], v[104:107], 0
ds_read_b64_tr_b16 v[186:187], v220 offset:12288
v_cvt_pk_bf16_f32 v173, v122, v123
v_mfma_f32_16x16x32_bf16 a[100:103], v[192:195], v[108:111], a[100:103]
v_exp_f32 v124, v44
v_mfma_f32_16x16x32_bf16 a[68:71], v[192:195], v[100:103], 0
v_exp_f32 v125, v45
v_mfma_f32_16x16x32_bf16 a[68:71], v[188:191], v[96:99], a[68:71]
ds_read_b64_tr_b16 v[180:181], v220 offset:0
v_cvt_pk_bf16_f32 v174, v124, v125
v_mfma_f32_16x16x32_bf16 a[36:39], v[188:191], v[88:91], 0
v_exp_f32 v126, v46
v_mfma_f32_16x16x32_bf16 a[36:39], v[192:195], v[92:95], a[36:39]
ds_read_b64_tr_b16 v[182:183], v220 offset:4096
v_accvgpr_read_b32 v228, a247
v_mfma_f32_16x16x32_bf16 a[4:7], v[192:195], v[84:87], 0
v_exp_f32 v127, v47
v_mfma_f32_16x16x32_bf16 a[4:7], v[188:191], v[80:83], a[4:7]
ds_read_b64_tr_b16 v[192:193], v221 offset:8192
s_waitcnt lgkmcnt(15)
v_mfma_f32_16x16x32_bf16 a[8:11], v[196:199], v[80:83], 0
ds_read_b64_tr_b16 v[194:195], v221 offset:12288
v_cvt_pk_bf16_f32 v175, v126, v127
v_mfma_f32_16x16x32_bf16 a[8:11], v[200:203], v[84:87], a[8:11]
ds_read_b64_tr_b16 v[188:189], v221 offset:0
s_add_u32 m0, s57, 83968
v_mfma_f32_16x16x32_bf16 a[40:43], v[200:203], v[92:95], 0
buffer_load_dwordx4 v228, s[16:19], s4 offen offset:0  lds
v_mfma_f32_16x16x32_bf16 a[40:43], v[196:199], v[88:91], a[40:43]
ds_read_b64_tr_b16 v[190:191], v221 offset:4096
v_accvgpr_read_b32 v230, a254
v_mfma_f32_16x16x32_bf16 a[72:75], v[196:199], v[96:99], 0
v_and_b32 v227, s77, v228
v_add_u32 v227, v227, v228
v_mfma_f32_16x16x32_bf16 a[72:75], v[200:203], v[100:103], a[72:75]
v_xor_b32 v231, 32, v230
v_subrev_u32 v229, s79, v1
v_mfma_f32_16x16x32_bf16 a[104:107], v[200:203], v[108:111], 0
ds_read_b64_tr_b16 v[200:201], v222 offset:8192
ds_read_b64_tr_b16 v[202:203], v222 offset:12288
v_mfma_f32_16x16x32_bf16 a[104:107], v[196:199], v[104:107], a[104:107]
ds_read_b64_tr_b16 v[196:197], v222 offset:0
s_waitcnt lgkmcnt(15)
v_mfma_f32_16x16x32_bf16 a[108:111], v[204:207], v[104:107], 0
ds_read_b64_tr_b16 v[198:199], v222 offset:4096
v_mfma_f32_16x16x32_bf16 a[108:111], v[208:211], v[108:111], a[108:111]
s_add_u32 s32, s60, 73400320
s_addc_u32 s33, s61, 0
v_mfma_f32_16x16x32_bf16 a[76:79], v[208:211], v[100:103], 0
s_mov_b32 s34, 262144
v_mov_b32 v2, s22
v_mfma_f32_16x16x32_bf16 a[76:79], v[204:207], v[96:99], a[76:79]
s_add_u32 m0, s57, 84864
v_mov_b32 v3, s23
v_mfma_f32_16x16x32_bf16 a[44:47], v[204:207], v[88:91], 0
buffer_load_dwordx4 v228, s[16:19], s4 offen offset:128  lds
v_mfma_f32_16x16x32_bf16 a[44:47], v[208:211], v[92:95], a[44:47]
v_mfma_f32_16x16x32_bf16 a[12:15], v[208:211], v[84:87], 0
ds_read_b64_tr_b16 v[208:209], v223 offset:8192
ds_read_b64_tr_b16 v[210:211], v223 offset:12288
v_mfma_f32_16x16x32_bf16 a[12:15], v[204:207], v[80:83], a[12:15]
ds_read_b64_tr_b16 v[204:205], v223 offset:0
v_smfmac_f32_16x16x64_bf16 a[224:227], v[144:147], v[80:87], v254
ds_read_b64_tr_b16 v[206:207], v223 offset:4096
v_smfmac_f32_16x16x64_bf16 a[228:231], v[144:147], v[88:95], v254
v_mfma_f32_16x16x32_bf16 v[16:19], a[192:195], a[128:131], v[128:131]
v_exp_f32 v112, v48
v_mfma_f32_16x16x32_bf16 v[16:19], a[196:199], a[132:135], v[16:19]
v_exp_f32 v113, v49
v_mfma_f32_16x16x32_bf16 v[16:19], a[200:203], a[136:139], v[16:19]
v_exp_f32 v114, v50
v_mfma_f32_16x16x32_bf16 v[16:19], a[204:207], a[140:143], v[16:19]
v_exp_f32 v115, v51
v_mfma_f32_16x16x32_bf16 v[20:23], a[204:207], a[156:159], v[132:135]
v_cvt_pk_bf16_f32 v152, v112, v113
v_cvt_pk_bf16_f32 v153, v114, v115
v_mfma_f32_16x16x32_bf16 v[20:23], a[200:203], a[152:155], v[20:23]
s_movk_i32 s101, 0x1000
v_mfma_f32_16x16x32_bf16 v[20:23], a[196:199], a[148:151], v[20:23]
buffer_store_dword v4, v251, s[88:91], s101 offen sc0 sc1
v_mfma_f32_16x16x32_bf16 v[20:23], a[192:195], a[144:147], v[20:23]
v_exp_f32 v116, v64
v_mfma_f32_16x16x32_bf16 v[24:27], a[192:195], a[160:163], v[136:139]
v_exp_f32 v117, v65
v_mfma_f32_16x16x32_bf16 v[24:27], a[196:199], a[164:167], v[24:27]
v_exp_f32 v118, v66
v_mfma_f32_16x16x32_bf16 v[24:27], a[200:203], a[168:171], v[24:27]
v_exp_f32 v119, v67
v_mfma_f32_16x16x32_bf16 v[24:27], a[204:207], a[172:175], v[24:27]
v_cvt_pk_bf16_f32 v154, v116, v117
v_cvt_pk_bf16_f32 v155, v118, v119
v_mfma_f32_16x16x32_bf16 v[28:31], a[204:207], a[188:191], v[140:143]
v_exp_f32 v120, v52
v_mfma_f32_16x16x32_bf16 v[28:31], a[200:203], a[184:187], v[28:31]
v_exp_f32 v121, v53
v_mfma_f32_16x16x32_bf16 v[28:31], a[196:199], a[180:183], v[28:31]
ds_read_b128 a[204:207], v215 offset:40960
v_cvt_pk_bf16_f32 v160, v120, v121
v_mfma_f32_16x16x32_bf16 v[28:31], a[192:195], a[176:179], v[28:31]
ds_read_b128 a[200:203], v214 offset:40960
s_waitcnt lgkmcnt(15)
v_mfma_f32_16x16x32_bf16 v[44:47], a[208:211], a[176:179], v[140:143]
v_exp_f32 v122, v54
v_mfma_f32_16x16x32_bf16 v[44:47], a[212:215], a[180:183], v[44:47]
v_exp_f32 v123, v55
v_mfma_f32_16x16x32_bf16 v[44:47], a[216:219], a[184:187], v[44:47]
ds_read_b128 a[196:199], v213 offset:40960
s_add_u32 m0, s57, 114688
v_mfma_f32_16x16x32_bf16 v[44:47], a[220:223], a[188:191], v[44:47]
buffer_load_dwordx4 v6, s[24:27], s56 offen offset:0  lds
v_mfma_f32_16x16x32_bf16 v[40:43], a[220:223], a[172:175], v[136:139]
ds_read_b128 a[192:195], v212 offset:40960
v_cvt_pk_bf16_f32 v161, v122, v123
v_mfma_f32_16x16x32_bf16 v[40:43], a[216:219], a[168:171], v[40:43]
v_exp_f32 v124, v68
v_mfma_f32_16x16x32_bf16 v[40:43], a[212:215], a[164:167], v[40:43]
v_exp_f32 v125, v69
v_mfma_f32_16x16x32_bf16 v[40:43], a[208:211], a[160:163], v[40:43]
v_exp_f32 v126, v70
v_mfma_f32_16x16x32_bf16 v[36:39], a[208:211], a[144:147], v[132:135]
v_exp_f32 v127, v71
v_mfma_f32_16x16x32_bf16 v[36:39], a[212:215], a[148:151], v[36:39]
v_cvt_pk_bf16_f32 v162, v124, v125
v_cvt_pk_bf16_f32 v163, v126, v127
v_mfma_f32_16x16x32_bf16 v[36:39], a[216:219], a[152:155], v[36:39]
v_exp_f32 v112, v56
v_mfma_f32_16x16x32_bf16 v[36:39], a[220:223], a[156:159], v[36:39]
v_exp_f32 v113, v57
v_mfma_f32_16x16x32_bf16 v[32:35], a[220:223], a[140:143], v[128:131]
ds_read_b128 a[220:223], v215 offset:45056
v_cvt_pk_bf16_f32 v168, v112, v113
v_mfma_f32_16x16x32_bf16 v[32:35], a[216:219], a[136:139], v[32:35]
v_exp_f32 v114, v58
v_mfma_f32_16x16x32_bf16 v[32:35], a[212:215], a[132:135], v[32:35]
v_exp_f32 v115, v59
v_mfma_f32_16x16x32_bf16 v[32:35], a[208:211], a[128:131], v[32:35]
ds_read_b128 a[216:219], v214 offset:45056
s_waitcnt lgkmcnt(15)
v_mfma_f32_16x16x32_bf16 a[16:19], v[180:183], v[80:83], 0
ds_read_b128 a[212:215], v213 offset:45056
v_cvt_pk_bf16_f32 v169, v114, v115
v_mfma_f32_16x16x32_bf16 a[16:19], v[184:187], v[84:87], a[16:19]
buffer_load_dwordx4 v7, s[24:27], s56 offen offset:1024  lds
v_mfma_f32_16x16x32_bf16 a[48:51], v[184:187], v[92:95], 0
v_exp_f32 v116, v72
v_mfma_f32_16x16x32_bf16 a[48:51], v[180:183], v[88:91], a[48:51]
v_exp_f32 v117, v73
v_mfma_f32_16x16x32_bf16 a[80:83], v[180:183], v[96:99], 0
ds_read_b128 a[208:211], v212 offset:45056
v_cvt_pk_bf16_f32 v170, v116, v117
v_mfma_f32_16x16x32_bf16 a[80:83], v[184:187], v[100:103], a[80:83]
v_exp_f32 v118, v74
v_mfma_f32_16x16x32_bf16 a[112:115], v[184:187], v[108:111], 0
v_exp_f32 v119, v75
v_mfma_f32_16x16x32_bf16 a[112:115], v[180:183], v[104:107], a[112:115]
ds_read_b64_tr_b16 v[184:185], v216 offset:24576
s_waitcnt lgkmcnt(15)
v_mfma_f32_16x16x32_bf16 a[116:119], v[188:191], v[104:107], 0
ds_read_b64_tr_b16 v[186:187], v216 offset:28672
v_cvt_pk_bf16_f32 v171, v118, v119
v_mfma_f32_16x16x32_bf16 a[116:119], v[192:195], v[108:111], a[116:119]
v_exp_f32 v120, v60
v_mfma_f32_16x16x32_bf16 a[84:87], v[192:195], v[100:103], 0
v_exp_f32 v121, v61
v_mfma_f32_16x16x32_bf16 a[84:87], v[188:191], v[96:99], a[84:87]
ds_read_b64_tr_b16 v[180:181], v216 offset:16384
v_cvt_pk_bf16_f32 v176, v120, v121
v_mfma_f32_16x16x32_bf16 a[52:55], v[188:191], v[88:91], 0
v_exp_f32 v122, v62
v_mfma_f32_16x16x32_bf16 a[52:55], v[192:195], v[92:95], a[52:55]
ds_read_b64_tr_b16 v[182:183], v216 offset:20480
v_mfma_f32_16x16x32_bf16 a[20:23], v[192:195], v[84:87], 0
buffer_load_dwordx4 v8, s[24:27], s56 offen offset:2048  lds
v_mfma_f32_16x16x32_bf16 a[20:23], v[188:191], v[80:83], a[20:23]
ds_read_b64_tr_b16 v[192:193], v217 offset:24576
s_waitcnt lgkmcnt(15)
v_mfma_f32_16x16x32_bf16 a[24:27], v[196:199], v[80:83], 0
v_exp_f32 v123, v63
v_mfma_f32_16x16x32_bf16 a[24:27], v[200:203], v[84:87], a[24:27]
ds_read_b64_tr_b16 v[194:195], v217 offset:28672
v_cvt_pk_bf16_f32 v177, v122, v123
v_mfma_f32_16x16x32_bf16 a[56:59], v[200:203], v[92:95], 0
v_exp_f32 v124, v76
v_mfma_f32_16x16x32_bf16 a[56:59], v[196:199], v[88:91], a[56:59]
v_exp_f32 v125, v77
v_mfma_f32_16x16x32_bf16 a[88:91], v[196:199], v[96:99], 0
ds_read_b64_tr_b16 v[188:189], v217 offset:16384
v_cvt_pk_bf16_f32 v178, v124, v125
v_mfma_f32_16x16x32_bf16 a[88:91], v[200:203], v[100:103], a[88:91]
ds_read_b64_tr_b16 v[190:191], v217 offset:20480
v_mfma_f32_16x16x32_bf16 a[120:123], v[200:203], v[108:111], 0
v_exp_f32 v126, v78
v_mfma_f32_16x16x32_bf16 a[120:123], v[196:199], v[104:107], a[120:123]
ds_read_b64_tr_b16 v[200:201], v218 offset:24576
s_waitcnt lgkmcnt(15)
v_mfma_f32_16x16x32_bf16 a[124:127], v[204:207], v[104:107], 0
v_exp_f32 v127, v79
v_mfma_f32_16x16x32_bf16 a[124:127], v[208:211], v[108:111], a[124:127]
ds_read_b64_tr_b16 v[202:203], v218 offset:28672
v_cvt_pk_bf16_f32 v179, v126, v127
v_mfma_f32_16x16x32_bf16 a[92:95], v[208:211], v[100:103], 0
ds_read_b64_tr_b16 v[196:197], v218 offset:16384
ds_read_b64_tr_b16 v[198:199], v218 offset:20480
v_mfma_f32_16x16x32_bf16 a[92:95], v[204:207], v[96:99], a[92:95]
buffer_load_dwordx4 v9, s[24:27], s56 offen offset:3072  lds
v_mfma_f32_16x16x32_bf16 a[60:63], v[204:207], v[88:91], 0
s_add_u32 s56, s56, 0x4000
v_mfma_f32_16x16x32_bf16 a[60:63], v[208:211], v[92:95], a[60:63]
v_mfma_f32_16x16x32_bf16 a[28:31], v[208:211], v[84:87], 0
ds_read_b64_tr_b16 v[208:209], v219 offset:24576
ds_read_b64_tr_b16 v[210:211], v219 offset:28672
v_mfma_f32_16x16x32_bf16 a[28:31], v[204:207], v[80:83], a[28:31]
ds_read_b64_tr_b16 v[204:205], v219 offset:16384
v_smfmac_f32_16x16x64_bf16 a[232:235], v[144:147], v[96:103], v254
ds_read_b64_tr_b16 v[206:207], v219 offset:20480
v_smfmac_f32_16x16x64_bf16 a[236:239], v[144:147], v[104:111], v254
s_mov_b32 s47, 7
.p2align 6
L_main_kernel_a:
s_cmp_eq_u32 s47, 3
s_cbranch_scc1 L_main_kernel_hk
L_main_kernel_hkb:
s_waitcnt vmcnt(17) lgkmcnt(15)
s_barrier
v_mfma_f32_16x16x32_bf16 v[48:51], a[192:195], a[128:131], v[128:131]
v_exp_f32 v112, v16
v_mfma_f32_16x16x32_bf16 v[48:51], a[196:199], a[132:135], v[48:51]
v_exp_f32 v113, v17
v_mfma_f32_16x16x32_bf16 v[48:51], a[200:203], a[136:139], v[48:51]
v_exp_f32 v114, v18
v_mfma_f32_16x16x32_bf16 v[48:51], a[204:207], a[140:143], v[48:51]
v_exp_f32 v115, v19
v_mfma_f32_16x16x32_bf16 v[52:55], a[204:207], a[156:159], v[132:135]
s_add_u32 m0, s57, 0
v_cvt_pk_bf16_f32 v80, v112, v113
v_mfma_f32_16x16x32_bf16 v[52:55], a[200:203], a[152:155], v[52:55]
buffer_load_dwordx4 v10, s[28:31], s56 offen offset:0  lds
v_mfma_f32_16x16x32_bf16 v[52:55], a[196:199], a[148:151], v[52:55]
v_exp_f32 v116, v32
v_mfma_f32_16x16x32_bf16 v[52:55], a[192:195], a[144:147], v[52:55]
v_exp_f32 v117, v33
v_mfma_f32_16x16x32_bf16 v[56:59], a[192:195], a[160:163], v[136:139]
v_cvt_pk_bf16_f32 v81, v114, v115
v_cvt_pk_bf16_f32 v82, v116, v117
v_mfma_f32_16x16x32_bf16 v[56:59], a[196:199], a[164:167], v[56:59]
v_exp_f32 v118, v34
v_mfma_f32_16x16x32_bf16 v[56:59], a[200:203], a[168:171], v[56:59]
v_exp_f32 v119, v35
v_mfma_f32_16x16x32_bf16 v[56:59], a[204:207], a[172:175], v[56:59]
v_exp_f32 v120, v20
v_mfma_f32_16x16x32_bf16 v[60:63], a[204:207], a[188:191], v[140:143]
ds_read_b128 a[204:207], v215 offset:49152
v_cvt_pk_bf16_f32 v83, v118, v119
v_mfma_f32_16x16x32_bf16 v[60:63], a[200:203], a[184:187], v[60:63]
v_exp_f32 v121, v21
v_mfma_f32_16x16x32_bf16 v[60:63], a[196:199], a[180:183], v[60:63]
ds_read_b128 a[200:203], v214 offset:49152
v_cvt_pk_bf16_f32 v88, v120, v121
v_mfma_f32_16x16x32_bf16 v[60:63], a[192:195], a[176:179], v[60:63]
ds_read_b128 a[196:199], v213 offset:49152
ds_read_b128 a[192:195], v212 offset:49152
v_mfma_f32_16x16x32_bf16 v[76:79], a[208:211], a[176:179], v[140:143]
buffer_load_dwordx4 v11, s[28:31], s56 offen offset:1024  lds
v_mfma_f32_16x16x32_bf16 v[76:79], a[212:215], a[180:183], v[76:79]
v_exp_f32 v122, v22
v_mfma_f32_16x16x32_bf16 v[76:79], a[216:219], a[184:187], v[76:79]
v_exp_f32 v123, v23
v_mfma_f32_16x16x32_bf16 v[76:79], a[220:223], a[188:191], v[76:79]
v_exp_f32 v124, v36
v_mfma_f32_16x16x32_bf16 v[72:75], a[220:223], a[172:175], v[136:139]
v_exp_f32 v125, v37
v_mfma_f32_16x16x32_bf16 v[72:75], a[216:219], a[168:171], v[72:75]
v_cvt_pk_bf16_f32 v89, v122, v123
v_cvt_pk_bf16_f32 v90, v124, v125
v_mfma_f32_16x16x32_bf16 v[72:75], a[212:215], a[164:167], v[72:75]
v_exp_f32 v126, v38
v_mfma_f32_16x16x32_bf16 v[72:75], a[208:211], a[160:163], v[72:75]
v_exp_f32 v127, v39
v_mfma_f32_16x16x32_bf16 v[68:71], a[208:211], a[144:147], v[132:135]
v_exp_f32 v112, v24
v_mfma_f32_16x16x32_bf16 v[68:71], a[212:215], a[148:151], v[68:71]
v_cvt_pk_bf16_f32 v91, v126, v127
v_readfirstlane_b32 s77, v250
v_mfma_f32_16x16x32_bf16 v[68:71], a[216:219], a[152:155], v[68:71]
buffer_load_dwordx4 v10, s[28:31], s56 offen offset:2048  lds
v_mfma_f32_16x16x32_bf16 v[68:71], a[220:223], a[156:159], v[68:71]
v_exp_f32 v113, v25
v_mfma_f32_16x16x32_bf16 v[64:67], a[220:223], a[140:143], v[128:131]
ds_read_b128 a[220:223], v215 offset:53248
v_cvt_pk_bf16_f32 v96, v112, v113
v_mfma_f32_16x16x32_bf16 v[64:67], a[216:219], a[136:139], v[64:67]
v_exp_f32 v114, v26
v_mfma_f32_16x16x32_bf16 v[64:67], a[212:215], a[132:135], v[64:67]
v_exp_f32 v115, v27
v_mfma_f32_16x16x32_bf16 v[64:67], a[208:211], a[128:131], v[64:67]
ds_read_b128 a[216:219], v214 offset:53248
s_waitcnt lgkmcnt(15)
v_mfma_f32_16x16x32_bf16 a[0:3], v[180:183], v[148:151], a[0:3]
ds_read_b128 a[212:215], v213 offset:53248
v_cvt_pk_bf16_f32 v97, v114, v115
v_mfma_f32_16x16x32_bf16 a[0:3], v[184:187], v[152:155], a[0:3]
v_exp_f32 v116, v40
v_mfma_f32_16x16x32_bf16 a[32:35], v[184:187], v[160:163], a[32:35]
v_exp_f32 v117, v41
v_mfma_f32_16x16x32_bf16 a[32:35], v[180:183], v[156:159], a[32:35]
ds_read_b128 a[208:211], v212 offset:53248
v_cvt_pk_bf16_f32 v98, v116, v117
v_mfma_f32_16x16x32_bf16 a[64:67], v[180:183], v[164:167], a[64:67]
s_andn2_b32 s65, s2, 7
s_and_b32 s55, s77, 7
v_mfma_f32_16x16x32_bf16 a[64:67], v[184:187], v[168:171], a[64:67]
buffer_load_dwordx4 v11, s[28:31], s56 offen offset:3072  lds
v_mfma_f32_16x16x32_bf16 a[96:99], v[184:187], v[176:179], a[96:99]
v_exp_f32 v118, v42
v_mfma_f32_16x16x32_bf16 a[96:99], v[180:183], v[172:175], a[96:99]
ds_read_b64_tr_b16 v[184:185], v220 offset:24576
s_waitcnt lgkmcnt(15)
v_mfma_f32_16x16x32_bf16 a[100:103], v[188:191], v[172:175], a[100:103]
v_exp_f32 v119, v43
v_mfma_f32_16x16x32_bf16 a[100:103], v[192:195], v[176:179], a[100:103]
ds_read_b64_tr_b16 v[186:187], v220 offset:28672
v_cvt_pk_bf16_f32 v99, v118, v119
v_mfma_f32_16x16x32_bf16 a[68:71], v[192:195], v[168:171], a[68:71]
v_exp_f32 v120, v28
v_mfma_f32_16x16x32_bf16 a[68:71], v[188:191], v[164:167], a[68:71]
v_exp_f32 v121, v29
v_mfma_f32_16x16x32_bf16 a[36:39], v[188:191], v[156:159], a[36:39]
ds_read_b64_tr_b16 v[180:181], v220 offset:16384
v_cvt_pk_bf16_f32 v104, v120, v121
v_mfma_f32_16x16x32_bf16 a[36:39], v[192:195], v[160:163], a[36:39]
ds_read_b64_tr_b16 v[182:183], v220 offset:20480
s_or_b32 s65, s65, s55
v_mfma_f32_16x16x32_bf16 a[4:7], v[192:195], v[152:155], a[4:7]
v_exp_f32 v122, v30
v_mfma_f32_16x16x32_bf16 a[4:7], v[188:191], v[148:151], a[4:7]
ds_read_b64_tr_b16 v[192:193], v221 offset:24576
s_waitcnt lgkmcnt(15)
v_mfma_f32_16x16x32_bf16 a[8:11], v[196:199], v[148:151], a[8:11]
v_exp_f32 v123, v31
v_mfma_f32_16x16x32_bf16 a[8:11], v[200:203], v[152:155], a[8:11]
ds_read_b64_tr_b16 v[194:195], v221 offset:28672
s_add_u32 m0, s57, 81920
v_mfma_f32_16x16x32_bf16 a[40:43], v[200:203], v[160:163], a[40:43]
buffer_load_dwordx4 v227, s[12:15], s43 offen offset:0  lds
v_mfma_f32_16x16x32_bf16 a[40:43], v[196:199], v[156:159], a[40:43]
ds_read_b64_tr_b16 v[188:189], v221 offset:16384
v_cvt_pk_bf16_f32 v105, v122, v123
v_mfma_f32_16x16x32_bf16 a[72:75], v[196:199], v[164:167], a[72:75]
v_exp_f32 v124, v44
v_mfma_f32_16x16x32_bf16 a[72:75], v[200:203], v[168:171], a[72:75]
ds_read_b64_tr_b16 v[190:191], v221 offset:20480
s_lshr_b32 s41, s65, 1
v_mfma_f32_16x16x32_bf16 a[104:107], v[200:203], v[176:179], a[104:107]
v_exp_f32 v125, v45
v_mfma_f32_16x16x32_bf16 a[104:107], v[196:199], v[172:175], a[104:107]
ds_read_b64_tr_b16 v[200:201], v222 offset:24576
s_waitcnt lgkmcnt(15)
v_mfma_f32_16x16x32_bf16 a[108:111], v[204:207], v[172:175], a[108:111]
ds_read_b64_tr_b16 v[202:203], v222 offset:28672
v_cvt_pk_bf16_f32 v106, v124, v125
v_mfma_f32_16x16x32_bf16 a[108:111], v[208:211], v[176:179], a[108:111]
v_exp_f32 v126, v46
v_mfma_f32_16x16x32_bf16 a[76:79], v[208:211], v[168:171], a[76:79]
v_exp_f32 v127, v47
v_mfma_f32_16x16x32_bf16 a[76:79], v[204:207], v[164:167], a[76:79]
ds_read_b64_tr_b16 v[196:197], v222 offset:16384
s_add_u32 m0, s57, 82816
v_mfma_f32_16x16x32_bf16 a[44:47], v[204:207], v[156:159], a[44:47]
buffer_load_dwordx4 v227, s[12:15], s43 offen offset:128  lds
v_mfma_f32_16x16x32_bf16 a[44:47], v[208:211], v[160:163], a[44:47]
ds_read_b64_tr_b16 v[198:199], v222 offset:20480
s_add_u32 s43, s43, s45
v_mfma_f32_16x16x32_bf16 a[12:15], v[208:211], v[152:155], a[12:15]
ds_read_b64_tr_b16 v[208:209], v223 offset:24576
v_cvt_pk_bf16_f32 v107, v126, v127
v_mfma_f32_16x16x32_bf16 a[12:15], v[204:207], v[148:151], a[12:15]
ds_read_b64_tr_b16 v[210:211], v223 offset:28672
ds_read_b64_tr_b16 v[204:205], v223 offset:16384
v_smfmac_f32_16x16x64_bf16 a[224:227], v[144:147], v[148:155], v254
ds_read_b64_tr_b16 v[206:207], v223 offset:20480
s_lshl_b32 s41, s41, 7
v_smfmac_f32_16x16x64_bf16 a[228:231], v[144:147], v[156:163], v254
s_add_u32 s41, s41, 163840
s_waitcnt lgkmcnt(15)
v_mfma_f32_16x16x32_bf16 v[16:19], a[192:195], a[128:131], v[128:131]
v_exp_f32 v112, v48
v_mfma_f32_16x16x32_bf16 v[16:19], a[196:199], a[132:135], v[16:19]
v_exp_f32 v113, v49
v_mfma_f32_16x16x32_bf16 v[16:19], a[200:203], a[136:139], v[16:19]
v_exp_f32 v114, v50
v_mfma_f32_16x16x32_bf16 v[16:19], a[204:207], a[140:143], v[16:19]
v_exp_f32 v115, v51
v_mfma_f32_16x16x32_bf16 v[20:23], a[204:207], a[156:159], v[132:135]
v_cvt_pk_bf16_f32 v84, v112, v113
v_cvt_pk_bf16_f32 v85, v114, v115
v_mfma_f32_16x16x32_bf16 v[20:23], a[200:203], a[152:155], v[20:23]
v_exp_f32 v116, v64
v_mfma_f32_16x16x32_bf16 v[20:23], a[196:199], a[148:151], v[20:23]
v_exp_f32 v117, v65
v_mfma_f32_16x16x32_bf16 v[20:23], a[192:195], a[144:147], v[20:23]
s_add_u32 m0, s57, 131072
v_cvt_pk_bf16_f32 v86, v116, v117
v_mfma_f32_16x16x32_bf16 v[24:27], a[192:195], a[160:163], v[136:139]
buffer_load_dwordx4 v6, s[24:27], s56 offen offset:0  lds
v_mfma_f32_16x16x32_bf16 v[24:27], a[196:199], a[164:167], v[24:27]
v_exp_f32 v118, v66
v_mfma_f32_16x16x32_bf16 v[24:27], a[200:203], a[168:171], v[24:27]
v_exp_f32 v119, v67
v_mfma_f32_16x16x32_bf16 v[24:27], a[204:207], a[172:175], v[24:27]
v_exp_f32 v120, v52
v_mfma_f32_16x16x32_bf16 v[28:31], a[204:207], a[188:191], v[140:143]
ds_read_b128 a[204:207], v215 offset:57344
v_cvt_pk_bf16_f32 v87, v118, v119
v_mfma_f32_16x16x32_bf16 v[28:31], a[200:203], a[184:187], v[28:31]
v_exp_f32 v121, v53
v_mfma_f32_16x16x32_bf16 v[28:31], a[196:199], a[180:183], v[28:31]
ds_read_b128 a[200:203], v214 offset:57344
v_cvt_pk_bf16_f32 v92, v120, v121
v_mfma_f32_16x16x32_bf16 v[28:31], a[192:195], a[176:179], v[28:31]
v_exp_f32 v122, v54
v_mfma_f32_16x16x32_bf16 v[44:47], a[208:211], a[176:179], v[140:143]
v_exp_f32 v123, v55
v_mfma_f32_16x16x32_bf16 v[44:47], a[212:215], a[180:183], v[44:47]
ds_read_b128 a[196:199], v213 offset:57344
v_cvt_pk_bf16_f32 v93, v122, v123
v_mfma_f32_16x16x32_bf16 v[44:47], a[216:219], a[184:187], v[44:47]
v_exp_f32 v124, v68
v_mfma_f32_16x16x32_bf16 v[44:47], a[220:223], a[188:191], v[44:47]
v_exp_f32 v125, v69
v_mfma_f32_16x16x32_bf16 v[40:43], a[220:223], a[172:175], v[136:139]
ds_read_b128 a[192:195], v212 offset:57344
v_cvt_pk_bf16_f32 v94, v124, v125
v_mfma_f32_16x16x32_bf16 v[40:43], a[216:219], a[168:171], v[40:43]
v_exp_f32 v126, v70
v_mfma_f32_16x16x32_bf16 v[40:43], a[212:215], a[164:167], v[40:43]
v_exp_f32 v127, v71
v_mfma_f32_16x16x32_bf16 v[40:43], a[208:211], a[160:163], v[40:43]
v_cvt_pk_bf16_f32 v95, v126, v127
s_and_b32 s72, s65, 1
v_mfma_f32_16x16x32_bf16 v[36:39], a[208:211], a[144:147], v[132:135]
buffer_load_dwordx4 v7, s[24:27], s56 offen offset:1024  lds
v_mfma_f32_16x16x32_bf16 v[36:39], a[212:215], a[148:151], v[36:39]
v_exp_f32 v112, v56
v_mfma_f32_16x16x32_bf16 v[36:39], a[216:219], a[152:155], v[36:39]
v_exp_f32 v113, v57
v_mfma_f32_16x16x32_bf16 v[36:39], a[220:223], a[156:159], v[36:39]
v_exp_f32 v114, v58
v_mfma_f32_16x16x32_bf16 v[32:35], a[220:223], a[140:143], v[128:131]
ds_read_b128 a[220:223], v215 offset:61440
v_cvt_pk_bf16_f32 v100, v112, v113
v_mfma_f32_16x16x32_bf16 v[32:35], a[216:219], a[136:139], v[32:35]
v_exp_f32 v115, v59
v_mfma_f32_16x16x32_bf16 v[32:35], a[212:215], a[132:135], v[32:35]
ds_read_b128 a[216:219], v214 offset:61440
v_cvt_pk_bf16_f32 v101, v114, v115
v_mfma_f32_16x16x32_bf16 v[32:35], a[208:211], a[128:131], v[32:35]
ds_read_b128 a[212:215], v213 offset:61440
s_waitcnt lgkmcnt(15)
v_mfma_f32_16x16x32_bf16 a[16:19], v[180:183], v[148:151], a[16:19]
v_exp_f32 v116, v72
v_mfma_f32_16x16x32_bf16 a[16:19], v[184:187], v[152:155], a[16:19]
v_exp_f32 v117, v73
v_mfma_f32_16x16x32_bf16 a[48:51], v[184:187], v[160:163], a[48:51]
ds_read_b128 a[208:211], v212 offset:61440
v_cvt_pk_bf16_f32 v102, v116, v117
v_mfma_f32_16x16x32_bf16 a[48:51], v[180:183], v[156:159], a[48:51]
v_exp_f32 v118, v74
v_mfma_f32_16x16x32_bf16 a[80:83], v[180:183], v[164:167], a[80:83]
v_exp_f32 v119, v75
v_mfma_f32_16x16x32_bf16 a[80:83], v[184:187], v[168:171], a[80:83]
v_exp_f32 v120, v60
v_mfma_f32_16x16x32_bf16 a[112:115], v[184:187], v[176:179], a[112:115]
ds_read_b64_tr_b16 v[184:185], v216 offset:40960
v_cvt_pk_bf16_f32 v103, v118, v119
v_mfma_f32_16x16x32_bf16 a[112:115], v[180:183], v[172:175], a[112:115]
ds_read_b64_tr_b16 v[186:187], v216 offset:45056
v_mfma_f32_16x16x32_bf16 a[116:119], v[188:191], v[172:175], a[116:119]
ds_read_b64_tr_b16 v[180:181], v216 offset:32768
ds_read_b64_tr_b16 v[182:183], v216 offset:36864
v_mfma_f32_16x16x32_bf16 a[116:119], v[192:195], v[176:179], a[116:119]
buffer_load_dwordx4 v8, s[24:27], s56 offen offset:2048  lds
v_mfma_f32_16x16x32_bf16 a[84:87], v[192:195], v[168:171], a[84:87]
v_exp_f32 v121, v61
v_mfma_f32_16x16x32_bf16 a[84:87], v[188:191], v[164:167], a[84:87]
v_exp_f32 v122, v62
v_mfma_f32_16x16x32_bf16 a[52:55], v[188:191], v[156:159], a[52:55]
v_exp_f32 v123, v63
v_mfma_f32_16x16x32_bf16 a[52:55], v[192:195], v[160:163], a[52:55]
v_cvt_pk_bf16_f32 v108, v120, v121
v_cvt_pk_bf16_f32 v109, v122, v123
v_mfma_f32_16x16x32_bf16 a[20:23], v[192:195], v[152:155], a[20:23]
v_exp_f32 v124, v76
v_mfma_f32_16x16x32_bf16 a[20:23], v[188:191], v[148:151], a[20:23]
ds_read_b64_tr_b16 v[192:193], v217 offset:40960
s_waitcnt lgkmcnt(15)
v_mfma_f32_16x16x32_bf16 a[24:27], v[196:199], v[148:151], a[24:27]
v_exp_f32 v125, v77
v_mfma_f32_16x16x32_bf16 a[24:27], v[200:203], v[152:155], a[24:27]
ds_read_b64_tr_b16 v[194:195], v217 offset:45056
v_cvt_pk_bf16_f32 v110, v124, v125
v_mfma_f32_16x16x32_bf16 a[56:59], v[200:203], v[160:163], a[56:59]
v_exp_f32 v126, v78
v_mfma_f32_16x16x32_bf16 a[56:59], v[196:199], v[156:159], a[56:59]
v_exp_f32 v127, v79
v_mfma_f32_16x16x32_bf16 a[88:91], v[196:199], v[164:167], a[88:91]
ds_read_b64_tr_b16 v[188:189], v217 offset:32768
v_cvt_pk_bf16_f32 v111, v126, v127
v_mfma_f32_16x16x32_bf16 a[88:91], v[200:203], v[168:171], a[88:91]
ds_read_b64_tr_b16 v[190:191], v217 offset:36864
s_bfe_u32 s74, s65, 0x10002
v_mfma_f32_16x16x32_bf16 a[120:123], v[200:203], v[176:179], a[120:123]
ds_read_b64_tr_b16 v[200:201], v218 offset:40960
ds_read_b64_tr_b16 v[202:203], v218 offset:45056
v_mfma_f32_16x16x32_bf16 a[120:123], v[196:199], v[172:175], a[120:123]
ds_read_b64_tr_b16 v[196:197], v218 offset:32768
s_waitcnt lgkmcnt(15)
v_mfma_f32_16x16x32_bf16 a[124:127], v[204:207], v[172:175], a[124:127]
ds_read_b64_tr_b16 v[198:199], v218 offset:36864
s_lshl_b32 s74, s74, 2
v_mfma_f32_16x16x32_bf16 a[124:127], v[208:211], v[176:179], a[124:127]
buffer_load_dwordx4 v9, s[24:27], s56 offen offset:3072  lds
v_mfma_f32_16x16x32_bf16 a[92:95], v[208:211], v[168:171], a[92:95]
s_add_u32 s56, s56, 0x4000
s_lshr_b32 s75, s65, 6
v_mfma_f32_16x16x32_bf16 a[92:95], v[204:207], v[164:167], a[92:95]
s_add_u32 s74, s74, s75
s_mul_i32 s75, s72, 901120
v_mfma_f32_16x16x32_bf16 a[60:63], v[204:207], v[156:159], a[60:63]
s_lshl_b32 s64, s72, 15
s_sub_u32 s64, 0x4000, s64
v_mfma_f32_16x16x32_bf16 a[60:63], v[208:211], v[160:163], a[60:63]
s_lshl_b32 s58, s74, 20
s_add_u32 s7, s58, s75
v_mfma_f32_16x16x32_bf16 a[28:31], v[208:211], v[152:155], a[28:31]
ds_read_b64_tr_b16 v[208:209], v219 offset:40960
ds_read_b64_tr_b16 v[210:211], v219 offset:45056
v_mfma_f32_16x16x32_bf16 a[28:31], v[204:207], v[148:151], a[28:31]
ds_read_b64_tr_b16 v[204:205], v219 offset:32768
s_add_u32 s7, s7, 0x800000
v_smfmac_f32_16x16x64_bf16 a[232:235], v[144:147], v[164:171], v254
ds_read_b64_tr_b16 v[206:207], v219 offset:36864
s_lshl_b32 s75, s72, 12
v_smfmac_f32_16x16x64_bf16 a[236:239], v[144:147], v[172:179], v254
s_waitcnt vmcnt(17) lgkmcnt(15)
s_barrier
v_mfma_f32_16x16x32_bf16 v[48:51], a[192:195], a[128:131], v[128:131]
v_exp_f32 v112, v16
v_mfma_f32_16x16x32_bf16 v[48:51], a[196:199], a[132:135], v[48:51]
v_exp_f32 v113, v17
v_mfma_f32_16x16x32_bf16 v[48:51], a[200:203], a[136:139], v[48:51]
v_exp_f32 v114, v18
v_mfma_f32_16x16x32_bf16 v[48:51], a[204:207], a[140:143], v[48:51]
v_exp_f32 v115, v19
v_mfma_f32_16x16x32_bf16 v[52:55], a[204:207], a[156:159], v[132:135]
s_add_u32 m0, s57, 16384
v_cvt_pk_bf16_f32 v148, v112, v113
v_mfma_f32_16x16x32_bf16 v[52:55], a[200:203], a[152:155], v[52:55]
buffer_load_dwordx4 v10, s[28:31], s56 offen offset:0  lds
v_mfma_f32_16x16x32_bf16 v[52:55], a[196:199], a[148:151], v[52:55]
v_exp_f32 v116, v32
v_mfma_f32_16x16x32_bf16 v[52:55], a[192:195], a[144:147], v[52:55]
v_exp_f32 v117, v33
v_mfma_f32_16x16x32_bf16 v[56:59], a[192:195], a[160:163], v[136:139]
v_cvt_pk_bf16_f32 v149, v114, v115
v_cvt_pk_bf16_f32 v150, v116, v117
v_mfma_f32_16x16x32_bf16 v[56:59], a[196:199], a[164:167], v[56:59]
v_exp_f32 v118, v34
v_mfma_f32_16x16x32_bf16 v[56:59], a[200:203], a[168:171], v[56:59]
v_exp_f32 v119, v35
v_mfma_f32_16x16x32_bf16 v[56:59], a[204:207], a[172:175], v[56:59]
v_exp_f32 v120, v20
v_mfma_f32_16x16x32_bf16 v[60:63], a[204:207], a[188:191], v[140:143]
ds_read_b128 a[204:207], v215 offset:0
v_cvt_pk_bf16_f32 v151, v118, v119
v_mfma_f32_16x16x32_bf16 v[60:63], a[200:203], a[184:187], v[60:63]
v_exp_f32 v121, v21
v_mfma_f32_16x16x32_bf16 v[60:63], a[196:199], a[180:183], v[60:63]
ds_read_b128 a[200:203], v214 offset:0
v_cvt_pk_bf16_f32 v156, v120, v121
v_mfma_f32_16x16x32_bf16 v[60:63], a[192:195], a[176:179], v[60:63]
ds_read_b128 a[196:199], v213 offset:0
ds_read_b128 a[192:195], v212 offset:0
v_mfma_f32_16x16x32_bf16 v[76:79], a[208:211], a[176:179], v[140:143]
buffer_load_dwordx4 v11, s[28:31], s56 offen offset:1024  lds
v_mfma_f32_16x16x32_bf16 v[76:79], a[212:215], a[180:183], v[76:79]
v_exp_f32 v122, v22
v_mfma_f32_16x16x32_bf16 v[76:79], a[216:219], a[184:187], v[76:79]
v_exp_f32 v123, v23
v_mfma_f32_16x16x32_bf16 v[76:79], a[220:223], a[188:191], v[76:79]
v_exp_f32 v124, v36
v_mfma_f32_16x16x32_bf16 v[72:75], a[220:223], a[172:175], v[136:139]
v_exp_f32 v125, v37
v_mfma_f32_16x16x32_bf16 v[72:75], a[216:219], a[168:171], v[72:75]
v_cvt_pk_bf16_f32 v157, v122, v123
v_cvt_pk_bf16_f32 v158, v124, v125
v_mfma_f32_16x16x32_bf16 v[72:75], a[212:215], a[164:167], v[72:75]
v_exp_f32 v126, v38
v_mfma_f32_16x16x32_bf16 v[72:75], a[208:211], a[160:163], v[72:75]
v_exp_f32 v127, v39
v_mfma_f32_16x16x32_bf16 v[68:71], a[208:211], a[144:147], v[132:135]
v_exp_f32 v112, v24
v_mfma_f32_16x16x32_bf16 v[68:71], a[212:215], a[148:151], v[68:71]
v_cvt_pk_bf16_f32 v159, v126, v127
s_xor_b32 s75, s75, 0x1000
v_mfma_f32_16x16x32_bf16 v[68:71], a[216:219], a[152:155], v[68:71]
buffer_load_dwordx4 v10, s[28:31], s56 offen offset:2048  lds
v_mfma_f32_16x16x32_bf16 v[68:71], a[220:223], a[156:159], v[68:71]
v_exp_f32 v113, v25
v_mfma_f32_16x16x32_bf16 v[64:67], a[220:223], a[140:143], v[128:131]
ds_read_b128 a[220:223], v215 offset:4096
v_cvt_pk_bf16_f32 v164, v112, v113
v_mfma_f32_16x16x32_bf16 v[64:67], a[216:219], a[136:139], v[64:67]
v_exp_f32 v114, v26
v_mfma_f32_16x16x32_bf16 v[64:67], a[212:215], a[132:135], v[64:67]
v_exp_f32 v115, v27
v_mfma_f32_16x16x32_bf16 v[64:67], a[208:211], a[128:131], v[64:67]
ds_read_b128 a[216:219], v214 offset:4096
s_waitcnt lgkmcnt(15)
v_mfma_f32_16x16x32_bf16 a[0:3], v[180:183], v[80:83], a[0:3]
ds_read_b128 a[212:215], v213 offset:4096
v_cvt_pk_bf16_f32 v165, v114, v115
v_mfma_f32_16x16x32_bf16 a[0:3], v[184:187], v[84:87], a[0:3]
v_exp_f32 v116, v40
v_mfma_f32_16x16x32_bf16 a[32:35], v[184:187], v[92:95], a[32:35]
v_exp_f32 v117, v41
v_mfma_f32_16x16x32_bf16 a[32:35], v[180:183], v[88:91], a[32:35]
ds_read_b128 a[208:211], v212 offset:4096
v_cvt_pk_bf16_f32 v166, v116, v117
v_mfma_f32_16x16x32_bf16 a[64:67], v[180:183], v[96:99], a[64:67]
v_xor_b32 v253, s75, v1
s_mul_i32 s75, s72, 901120
v_mfma_f32_16x16x32_bf16 a[64:67], v[184:187], v[100:103], a[64:67]
buffer_load_dwordx4 v11, s[28:31], s56 offen offset:3072  lds
v_mfma_f32_16x16x32_bf16 a[96:99], v[184:187], v[108:111], a[96:99]
v_exp_f32 v118, v42
v_mfma_f32_16x16x32_bf16 a[96:99], v[180:183], v[104:107], a[96:99]
ds_read_b64_tr_b16 v[184:185], v220 offset:40960
s_waitcnt lgkmcnt(15)
v_mfma_f32_16x16x32_bf16 a[100:103], v[188:191], v[104:107], a[100:103]
v_exp_f32 v119, v43
v_mfma_f32_16x16x32_bf16 a[100:103], v[192:195], v[108:111], a[100:103]
ds_read_b64_tr_b16 v[186:187], v220 offset:45056
v_cvt_pk_bf16_f32 v167, v118, v119
v_mfma_f32_16x16x32_bf16 a[68:71], v[192:195], v[100:103], a[68:71]
v_exp_f32 v120, v28
v_mfma_f32_16x16x32_bf16 a[68:71], v[188:191], v[96:99], a[68:71]
v_exp_f32 v121, v29
v_mfma_f32_16x16x32_bf16 a[36:39], v[188:191], v[88:91], a[36:39]
ds_read_b64_tr_b16 v[180:181], v220 offset:32768
v_cvt_pk_bf16_f32 v172, v120, v121
v_mfma_f32_16x16x32_bf16 a[36:39], v[192:195], v[92:95], a[36:39]
ds_read_b64_tr_b16 v[182:183], v220 offset:36864
s_bfe_u32 s73, s65, 0x10001
v_mfma_f32_16x16x32_bf16 a[4:7], v[192:195], v[84:87], a[4:7]
v_exp_f32 v122, v30
v_mfma_f32_16x16x32_bf16 a[4:7], v[188:191], v[80:83], a[4:7]
ds_read_b64_tr_b16 v[192:193], v221 offset:40960
s_waitcnt lgkmcnt(15)
v_mfma_f32_16x16x32_bf16 a[8:11], v[196:199], v[80:83], a[8:11]
v_exp_f32 v123, v31
v_mfma_f32_16x16x32_bf16 a[8:11], v[200:203], v[84:87], a[8:11]
ds_read_b64_tr_b16 v[194:195], v221 offset:45056
s_lshr_b32 s83, 0xf8000, s47
v_mfma_f32_16x16x32_bf16 a[40:43], v[200:203], v[92:95], a[40:43]
ds_read_b64_tr_b16 v[188:189], v221 offset:32768
s_and_b32 s83, s83, 0x1000
v_mfma_f32_16x16x32_bf16 a[40:43], v[196:199], v[88:91], a[40:43]
buffer_load_dword v250, v251, s[88:91], s83 offen sc0 sc1
v_mfma_f32_16x16x32_bf16 a[72:75], v[196:199], v[96:99], a[72:75]
ds_read_b64_tr_b16 v[190:191], v221 offset:36864
v_cvt_pk_bf16_f32 v173, v122, v123
v_mfma_f32_16x16x32_bf16 a[72:75], v[200:203], v[100:103], a[72:75]
v_exp_f32 v124, v44
v_mfma_f32_16x16x32_bf16 a[104:107], v[200:203], v[108:111], a[104:107]
v_exp_f32 v125, v45
v_mfma_f32_16x16x32_bf16 a[104:107], v[196:199], v[104:107], a[104:107]
ds_read_b64_tr_b16 v[200:201], v222 offset:40960
s_waitcnt lgkmcnt(15)
v_mfma_f32_16x16x32_bf16 a[108:111], v[204:207], v[104:107], a[108:111]
ds_read_b64_tr_b16 v[202:203], v222 offset:45056
v_cvt_pk_bf16_f32 v174, v124, v125
v_mfma_f32_16x16x32_bf16 a[108:111], v[208:211], v[108:111], a[108:111]
v_exp_f32 v126, v46
v_mfma_f32_16x16x32_bf16 a[76:79], v[208:211], v[100:103], a[76:79]
v_exp_f32 v127, v47
v_mfma_f32_16x16x32_bf16 a[76:79], v[204:207], v[96:99], a[76:79]
ds_read_b64_tr_b16 v[196:197], v222 offset:32768
v_cvt_pk_bf16_f32 v175, v126, v127
v_mfma_f32_16x16x32_bf16 a[44:47], v[204:207], v[88:91], a[44:47]
ds_read_b64_tr_b16 v[198:199], v222 offset:36864
s_lshl_b32 s73, s73, 3
v_mfma_f32_16x16x32_bf16 a[44:47], v[208:211], v[92:95], a[44:47]
s_bfe_u32 s6, s65, 0x30003
s_add_u32 s73, s73, s6
v_mfma_f32_16x16x32_bf16 a[12:15], v[208:211], v[84:87], a[12:15]
ds_read_b64_tr_b16 v[208:209], v223 offset:40960
ds_read_b64_tr_b16 v[210:211], v223 offset:45056
v_mfma_f32_16x16x32_bf16 a[12:15], v[204:207], v[80:83], a[12:15]
ds_read_b64_tr_b16 v[204:205], v223 offset:32768
s_mul_i32 s6, s73, 917504
v_smfmac_f32_16x16x64_bf16 a[224:227], v[144:147], v[80:87], v254
ds_read_b64_tr_b16 v[206:207], v223 offset:36864
s_add_u32 s6, s6, s75
v_smfmac_f32_16x16x64_bf16 a[228:231], v[144:147], v[88:95], v254
s_add_u32 s6, s6, 4194304
s_waitcnt lgkmcnt(15)
v_mfma_f32_16x16x32_bf16 v[16:19], a[192:195], a[128:131], v[128:131]
v_exp_f32 v112, v48
v_mfma_f32_16x16x32_bf16 v[16:19], a[196:199], a[132:135], v[16:19]
v_exp_f32 v113, v49
v_mfma_f32_16x16x32_bf16 v[16:19], a[200:203], a[136:139], v[16:19]
v_exp_f32 v114, v50
v_mfma_f32_16x16x32_bf16 v[16:19], a[204:207], a[140:143], v[16:19]
v_exp_f32 v115, v51
v_mfma_f32_16x16x32_bf16 v[20:23], a[204:207], a[156:159], v[132:135]
v_cvt_pk_bf16_f32 v152, v112, v113
v_cvt_pk_bf16_f32 v153, v114, v115
v_mfma_f32_16x16x32_bf16 v[20:23], a[200:203], a[152:155], v[20:23]
v_exp_f32 v116, v64
v_mfma_f32_16x16x32_bf16 v[20:23], a[196:199], a[148:151], v[20:23]
v_exp_f32 v117, v65
v_mfma_f32_16x16x32_bf16 v[20:23], a[192:195], a[144:147], v[20:23]
s_add_u32 m0, s57, 147456
v_cvt_pk_bf16_f32 v154, v116, v117
v_mfma_f32_16x16x32_bf16 v[24:27], a[192:195], a[160:163], v[136:139]
buffer_load_dwordx4 v6, s[24:27], s56 offen offset:0  lds
v_mfma_f32_16x16x32_bf16 v[24:27], a[196:199], a[164:167], v[24:27]
v_exp_f32 v118, v66
v_mfma_f32_16x16x32_bf16 v[24:27], a[200:203], a[168:171], v[24:27]
v_exp_f32 v119, v67
v_mfma_f32_16x16x32_bf16 v[24:27], a[204:207], a[172:175], v[24:27]
v_exp_f32 v120, v52
v_mfma_f32_16x16x32_bf16 v[28:31], a[204:207], a[188:191], v[140:143]
ds_read_b128 a[204:207], v215 offset:8192
v_cvt_pk_bf16_f32 v155, v118, v119
v_mfma_f32_16x16x32_bf16 v[28:31], a[200:203], a[184:187], v[28:31]
v_exp_f32 v121, v53
v_mfma_f32_16x16x32_bf16 v[28:31], a[196:199], a[180:183], v[28:31]
ds_read_b128 a[200:203], v214 offset:8192
v_cvt_pk_bf16_f32 v160, v120, v121
v_mfma_f32_16x16x32_bf16 v[28:31], a[192:195], a[176:179], v[28:31]
v_exp_f32 v122, v54
v_mfma_f32_16x16x32_bf16 v[44:47], a[208:211], a[176:179], v[140:143]
v_exp_f32 v123, v55
v_mfma_f32_16x16x32_bf16 v[44:47], a[212:215], a[180:183], v[44:47]
ds_read_b128 a[196:199], v213 offset:8192
v_cvt_pk_bf16_f32 v161, v122, v123
v_mfma_f32_16x16x32_bf16 v[44:47], a[216:219], a[184:187], v[44:47]
v_exp_f32 v124, v68
v_mfma_f32_16x16x32_bf16 v[44:47], a[220:223], a[188:191], v[44:47]
v_exp_f32 v125, v69
v_mfma_f32_16x16x32_bf16 v[40:43], a[220:223], a[172:175], v[136:139]
ds_read_b128 a[192:195], v212 offset:8192
v_cvt_pk_bf16_f32 v162, v124, v125
v_mfma_f32_16x16x32_bf16 v[40:43], a[216:219], a[168:171], v[40:43]
v_exp_f32 v126, v70
v_mfma_f32_16x16x32_bf16 v[40:43], a[212:215], a[164:167], v[40:43]
v_exp_f32 v127, v71
v_mfma_f32_16x16x32_bf16 v[40:43], a[208:211], a[160:163], v[40:43]
v_cvt_pk_bf16_f32 v163, v126, v127
s_mul_i32 s75, s72, 1032192
v_mfma_f32_16x16x32_bf16 v[36:39], a[208:211], a[144:147], v[132:135]
buffer_load_dwordx4 v7, s[24:27], s56 offen offset:1024  lds
v_mfma_f32_16x16x32_bf16 v[36:39], a[212:215], a[148:151], v[36:39]
v_exp_f32 v112, v56
v_mfma_f32_16x16x32_bf16 v[36:39], a[216:219], a[152:155], v[36:39]
v_exp_f32 v113, v57
v_mfma_f32_16x16x32_bf16 v[36:39], a[220:223], a[156:159], v[36:39]
v_exp_f32 v114, v58
v_mfma_f32_16x16x32_bf16 v[32:35], a[220:223], a[140:143], v[128:131]
ds_read_b128 a[220:223], v215 offset:12288
v_cvt_pk_bf16_f32 v168, v112, v113
v_mfma_f32_16x16x32_bf16 v[32:35], a[216:219], a[136:139], v[32:35]
v_exp_f32 v115, v59
v_mfma_f32_16x16x32_bf16 v[32:35], a[212:215], a[132:135], v[32:35]
ds_read_b128 a[216:219], v214 offset:12288
v_cvt_pk_bf16_f32 v169, v114, v115
v_mfma_f32_16x16x32_bf16 v[32:35], a[208:211], a[128:131], v[32:35]
ds_read_b128 a[212:215], v213 offset:12288
s_waitcnt lgkmcnt(15)
v_mfma_f32_16x16x32_bf16 a[16:19], v[180:183], v[80:83], a[16:19]
v_exp_f32 v116, v72
v_mfma_f32_16x16x32_bf16 a[16:19], v[184:187], v[84:87], a[16:19]
v_exp_f32 v117, v73
v_mfma_f32_16x16x32_bf16 a[48:51], v[184:187], v[92:95], a[48:51]
ds_read_b128 a[208:211], v212 offset:12288
v_cvt_pk_bf16_f32 v170, v116, v117
v_mfma_f32_16x16x32_bf16 a[48:51], v[180:183], v[88:91], a[48:51]
v_exp_f32 v118, v74
v_mfma_f32_16x16x32_bf16 a[80:83], v[180:183], v[96:99], a[80:83]
v_exp_f32 v119, v75
v_mfma_f32_16x16x32_bf16 a[80:83], v[184:187], v[100:103], a[80:83]
v_exp_f32 v120, v60
v_mfma_f32_16x16x32_bf16 a[112:115], v[184:187], v[108:111], a[112:115]
ds_read_b64_tr_b16 v[184:185], v216 offset:57344
v_cvt_pk_bf16_f32 v171, v118, v119
v_mfma_f32_16x16x32_bf16 a[112:115], v[180:183], v[104:107], a[112:115]
ds_read_b64_tr_b16 v[186:187], v216 offset:61440
v_mfma_f32_16x16x32_bf16 a[116:119], v[188:191], v[104:107], a[116:119]
ds_read_b64_tr_b16 v[180:181], v216 offset:49152
ds_read_b64_tr_b16 v[182:183], v216 offset:53248
v_mfma_f32_16x16x32_bf16 a[116:119], v[192:195], v[108:111], a[116:119]
buffer_load_dwordx4 v8, s[24:27], s56 offen offset:2048  lds
v_mfma_f32_16x16x32_bf16 a[84:87], v[192:195], v[100:103], a[84:87]
v_exp_f32 v121, v61
v_mfma_f32_16x16x32_bf16 a[84:87], v[188:191], v[96:99], a[84:87]
v_exp_f32 v122, v62
v_mfma_f32_16x16x32_bf16 a[52:55], v[188:191], v[88:91], a[52:55]
v_exp_f32 v123, v63
v_mfma_f32_16x16x32_bf16 a[52:55], v[192:195], v[92:95], a[52:55]
v_cvt_pk_bf16_f32 v176, v120, v121
v_cvt_pk_bf16_f32 v177, v122, v123
v_mfma_f32_16x16x32_bf16 a[20:23], v[192:195], v[84:87], a[20:23]
v_exp_f32 v124, v76
v_mfma_f32_16x16x32_bf16 a[20:23], v[188:191], v[80:83], a[20:23]
ds_read_b64_tr_b16 v[192:193], v217 offset:57344
s_waitcnt lgkmcnt(15)
v_mfma_f32_16x16x32_bf16 a[24:27], v[196:199], v[80:83], a[24:27]
v_exp_f32 v125, v77
v_mfma_f32_16x16x32_bf16 a[24:27], v[200:203], v[84:87], a[24:27]
ds_read_b64_tr_b16 v[194:195], v217 offset:61440
v_cvt_pk_bf16_f32 v178, v124, v125
v_mfma_f32_16x16x32_bf16 a[56:59], v[200:203], v[92:95], a[56:59]
v_exp_f32 v126, v78
v_mfma_f32_16x16x32_bf16 a[56:59], v[196:199], v[88:91], a[56:59]
v_exp_f32 v127, v79
v_mfma_f32_16x16x32_bf16 a[88:91], v[196:199], v[96:99], a[88:91]
ds_read_b64_tr_b16 v[188:189], v217 offset:49152
v_cvt_pk_bf16_f32 v179, v126, v127
v_mfma_f32_16x16x32_bf16 a[88:91], v[200:203], v[100:103], a[88:91]
ds_read_b64_tr_b16 v[190:191], v217 offset:53248
s_lshl_b32 s54, s73, 20
v_mfma_f32_16x16x32_bf16 a[120:123], v[200:203], v[108:111], a[120:123]
ds_read_b64_tr_b16 v[200:201], v218 offset:57344
ds_read_b64_tr_b16 v[202:203], v218 offset:61440
v_mfma_f32_16x16x32_bf16 a[120:123], v[196:199], v[104:107], a[120:123]
ds_read_b64_tr_b16 v[196:197], v218 offset:49152
s_waitcnt lgkmcnt(15)
v_mfma_f32_16x16x32_bf16 a[124:127], v[204:207], v[104:107], a[124:127]
ds_read_b64_tr_b16 v[198:199], v218 offset:53248
s_add_u32 s54, s54, s75
v_mfma_f32_16x16x32_bf16 a[124:127], v[208:211], v[108:111], a[124:127]
buffer_load_dwordx4 v9, s[24:27], s56 offen offset:3072  lds
v_mfma_f32_16x16x32_bf16 a[92:95], v[208:211], v[100:103], a[92:95]
s_add_u32 s56, s56, 0x4000
s_add_u32 s54, s54, 20971520
v_mfma_f32_16x16x32_bf16 a[92:95], v[204:207], v[96:99], a[92:95]
s_add_u32 s58, s58, s75
v_mfma_f32_16x16x32_bf16 a[60:63], v[204:207], v[88:91], a[60:63]
s_cmp_lg_u32 s81, 0
s_cselect_b32 s55, s41, 0x40000000
v_mfma_f32_16x16x32_bf16 a[60:63], v[208:211], v[92:95], a[60:63]
s_lshl_b32 s59, s72, 3
s_lshl_b32 s59, 1, s59
v_mfma_f32_16x16x32_bf16 a[28:31], v[208:211], v[84:87], a[28:31]
ds_read_b64_tr_b16 v[208:209], v219 offset:57344
ds_read_b64_tr_b16 v[210:211], v219 offset:61440
v_mfma_f32_16x16x32_bf16 a[28:31], v[204:207], v[80:83], a[28:31]
ds_read_b64_tr_b16 v[204:205], v219 offset:49152
v_writelane_b32 v252, s55, 0
v_smfmac_f32_16x16x64_bf16 a[232:235], v[144:147], v[96:103], v254
ds_read_b64_tr_b16 v[206:207], v219 offset:53248
v_mov_b32 v255, s59
v_smfmac_f32_16x16x64_bf16 a[236:239], v[144:147], v[104:111], v254
s_waitcnt vmcnt(15) lgkmcnt(15)
s_barrier
v_mfma_f32_16x16x32_bf16 v[48:51], a[192:195], a[128:131], v[128:131]
v_exp_f32 v112, v16
v_mfma_f32_16x16x32_bf16 v[48:51], a[196:199], a[132:135], v[48:51]
v_exp_f32 v113, v17
v_mfma_f32_16x16x32_bf16 v[48:51], a[200:203], a[136:139], v[48:51]
v_exp_f32 v114, v18
v_mfma_f32_16x16x32_bf16 v[48:51], a[204:207], a[140:143], v[48:51]
v_exp_f32 v115, v19
v_mfma_f32_16x16x32_bf16 v[52:55], a[204:207], a[156:159], v[132:135]
s_add_u32 m0, s57, 32768
v_cvt_pk_bf16_f32 v80, v112, v113
v_mfma_f32_16x16x32_bf16 v[52:55], a[200:203], a[152:155], v[52:55]
buffer_load_dwordx4 v10, s[28:31], s56 offen offset:0  lds
v_mfma_f32_16x16x32_bf16 v[52:55], a[196:199], a[148:151], v[52:55]
v_exp_f32 v116, v32
v_mfma_f32_16x16x32_bf16 v[52:55], a[192:195], a[144:147], v[52:55]
v_exp_f32 v117, v33
v_mfma_f32_16x16x32_bf16 v[56:59], a[192:195], a[160:163], v[136:139]
v_cvt_pk_bf16_f32 v81, v114, v115
v_cvt_pk_bf16_f32 v82, v116, v117
v_mfma_f32_16x16x32_bf16 v[56:59], a[196:199], a[164:167], v[56:59]
v_exp_f32 v118, v34
v_mfma_f32_16x16x32_bf16 v[56:59], a[200:203], a[168:171], v[56:59]
v_exp_f32 v119, v35
v_mfma_f32_16x16x32_bf16 v[56:59], a[204:207], a[172:175], v[56:59]
v_exp_f32 v120, v20
v_mfma_f32_16x16x32_bf16 v[60:63], a[204:207], a[188:191], v[140:143]
ds_read_b128 a[204:207], v215 offset:16384
v_cvt_pk_bf16_f32 v83, v118, v119
v_mfma_f32_16x16x32_bf16 v[60:63], a[200:203], a[184:187], v[60:63]
v_exp_f32 v121, v21
v_mfma_f32_16x16x32_bf16 v[60:63], a[196:199], a[180:183], v[60:63]
ds_read_b128 a[200:203], v214 offset:16384
v_cvt_pk_bf16_f32 v88, v120, v121
v_mfma_f32_16x16x32_bf16 v[60:63], a[192:195], a[176:179], v[60:63]
ds_read_b128 a[196:199], v213 offset:16384
ds_read_b128 a[192:195], v212 offset:16384
v_mfma_f32_16x16x32_bf16 v[76:79], a[208:211], a[176:179], v[140:143]
buffer_load_dwordx4 v11, s[28:31], s56 offen offset:1024  lds
v_mfma_f32_16x16x32_bf16 v[76:79], a[212:215], a[180:183], v[76:79]
v_exp_f32 v122, v22
v_mfma_f32_16x16x32_bf16 v[76:79], a[216:219], a[184:187], v[76:79]
v_exp_f32 v123, v23
v_mfma_f32_16x16x32_bf16 v[76:79], a[220:223], a[188:191], v[76:79]
v_exp_f32 v124, v36
v_mfma_f32_16x16x32_bf16 v[72:75], a[220:223], a[172:175], v[136:139]
v_exp_f32 v125, v37
v_mfma_f32_16x16x32_bf16 v[72:75], a[216:219], a[168:171], v[72:75]
v_cvt_pk_bf16_f32 v89, v122, v123
v_cvt_pk_bf16_f32 v90, v124, v125
v_mfma_f32_16x16x32_bf16 v[72:75], a[212:215], a[164:167], v[72:75]
v_exp_f32 v126, v38
v_mfma_f32_16x16x32_bf16 v[72:75], a[208:211], a[160:163], v[72:75]
v_exp_f32 v127, v39
v_mfma_f32_16x16x32_bf16 v[68:71], a[208:211], a[144:147], v[132:135]
v_exp_f32 v112, v24
v_mfma_f32_16x16x32_bf16 v[68:71], a[212:215], a[148:151], v[68:71]
v_cvt_pk_bf16_f32 v91, v126, v127
v_readfirstlane_b32 s96, v2
v_mfma_f32_16x16x32_bf16 v[68:71], a[216:219], a[152:155], v[68:71]
buffer_load_dwordx4 v10, s[28:31], s56 offen offset:2048  lds
v_mfma_f32_16x16x32_bf16 v[68:71], a[220:223], a[156:159], v[68:71]
v_exp_f32 v113, v25
v_mfma_f32_16x16x32_bf16 v[64:67], a[220:223], a[140:143], v[128:131]
ds_read_b128 a[220:223], v215 offset:20480
v_cvt_pk_bf16_f32 v96, v112, v113
v_mfma_f32_16x16x32_bf16 v[64:67], a[216:219], a[136:139], v[64:67]
v_exp_f32 v114, v26
v_mfma_f32_16x16x32_bf16 v[64:67], a[212:215], a[132:135], v[64:67]
v_exp_f32 v115, v27
v_mfma_f32_16x16x32_bf16 v[64:67], a[208:211], a[128:131], v[64:67]
ds_read_b128 a[216:219], v214 offset:20480
s_waitcnt lgkmcnt(15)
v_mfma_f32_16x16x32_bf16 a[0:3], v[180:183], v[148:151], a[0:3]
ds_read_b128 a[212:215], v213 offset:20480
v_cvt_pk_bf16_f32 v97, v114, v115
v_mfma_f32_16x16x32_bf16 a[0:3], v[184:187], v[152:155], a[0:3]
v_exp_f32 v116, v40
v_mfma_f32_16x16x32_bf16 a[32:35], v[184:187], v[160:163], a[32:35]
v_exp_f32 v117, v41
v_mfma_f32_16x16x32_bf16 a[32:35], v[180:183], v[156:159], a[32:35]
ds_read_b128 a[208:211], v212 offset:20480
v_cvt_pk_bf16_f32 v98, v116, v117
v_mfma_f32_16x16x32_bf16 a[64:67], v[180:183], v[164:167], a[64:67]
v_readfirstlane_b32 s97, v3
s_nop 0
v_mfma_f32_16x16x32_bf16 a[64:67], v[184:187], v[168:171], a[64:67]
buffer_load_dwordx4 v11, s[28:31], s56 offen offset:3072  lds
v_mfma_f32_16x16x32_bf16 a[96:99], v[184:187], v[176:179], a[96:99]
v_exp_f32 v118, v42
v_mfma_f32_16x16x32_bf16 a[96:99], v[180:183], v[172:175], a[96:99]
ds_read_b64_tr_b16 v[184:185], v220 offset:57344
s_waitcnt lgkmcnt(15)
v_mfma_f32_16x16x32_bf16 a[100:103], v[188:191], v[172:175], a[100:103]
v_exp_f32 v119, v43
v_mfma_f32_16x16x32_bf16 a[100:103], v[192:195], v[176:179], a[100:103]
ds_read_b64_tr_b16 v[186:187], v220 offset:61440
v_cvt_pk_bf16_f32 v99, v118, v119
v_mfma_f32_16x16x32_bf16 a[68:71], v[192:195], v[168:171], a[68:71]
v_exp_f32 v120, v28
v_mfma_f32_16x16x32_bf16 a[68:71], v[188:191], v[164:167], a[68:71]
v_exp_f32 v121, v29
v_mfma_f32_16x16x32_bf16 a[36:39], v[188:191], v[156:159], a[36:39]
ds_read_b64_tr_b16 v[180:181], v220 offset:49152
v_cvt_pk_bf16_f32 v104, v120, v121
v_mfma_f32_16x16x32_bf16 a[36:39], v[192:195], v[160:163], a[36:39]
ds_read_b64_tr_b16 v[182:183], v220 offset:53248
s_bfe_u64 s[98:99], s[96:97], s5
v_mfma_f32_16x16x32_bf16 a[4:7], v[192:195], v[152:155], a[4:7]
v_exp_f32 v122, v30
v_mfma_f32_16x16x32_bf16 a[4:7], v[188:191], v[148:151], a[4:7]
ds_read_b64_tr_b16 v[192:193], v221 offset:57344
s_waitcnt lgkmcnt(15)
v_mfma_f32_16x16x32_bf16 a[8:11], v[196:199], v[148:151], a[8:11]
v_exp_f32 v123, v31
v_mfma_f32_16x16x32_bf16 a[8:11], v[200:203], v[152:155], a[8:11]
ds_read_b64_tr_b16 v[194:195], v221 offset:61440
s_xor_b32 s80, s47, 3
v_mfma_f32_16x16x32_bf16 a[40:43], v[200:203], v[160:163], a[40:43]
ds_read_b64_tr_b16 v[188:189], v221 offset:49152
s_lshl_b32 s80, s80, 12
v_mfma_f32_16x16x32_bf16 a[40:43], v[196:199], v[156:159], a[40:43]
buffer_atomic_add v249, v248, s[88:91], s80 offen offset:20 sc1
v_mfma_f32_16x16x32_bf16 a[72:75], v[196:199], v[164:167], a[72:75]
ds_read_b64_tr_b16 v[190:191], v221 offset:53248
v_cvt_pk_bf16_f32 v105, v122, v123
v_mfma_f32_16x16x32_bf16 a[72:75], v[200:203], v[168:171], a[72:75]
v_exp_f32 v124, v44
v_mfma_f32_16x16x32_bf16 a[104:107], v[200:203], v[176:179], a[104:107]
v_exp_f32 v125, v45
v_mfma_f32_16x16x32_bf16 a[104:107], v[196:199], v[172:175], a[104:107]
ds_read_b64_tr_b16 v[200:201], v222 offset:57344
s_waitcnt lgkmcnt(15)
v_mfma_f32_16x16x32_bf16 a[108:111], v[204:207], v[172:175], a[108:111]
ds_read_b64_tr_b16 v[202:203], v222 offset:61440
v_cvt_pk_bf16_f32 v106, v124, v125
v_mfma_f32_16x16x32_bf16 a[108:111], v[208:211], v[176:179], a[108:111]
v_exp_f32 v126, v46
v_mfma_f32_16x16x32_bf16 a[76:79], v[208:211], v[168:171], a[76:79]
v_exp_f32 v127, v47
v_mfma_f32_16x16x32_bf16 a[76:79], v[204:207], v[164:167], a[76:79]
ds_read_b64_tr_b16 v[196:197], v222 offset:49152
v_cvt_pk_bf16_f32 v107, v126, v127
v_mfma_f32_16x16x32_bf16 a[44:47], v[204:207], v[156:159], a[44:47]
buffer_load_dword v14, v251, s[88:91], s83 offen offset:4 sc0 sc1
v_mfma_f32_16x16x32_bf16 a[44:47], v[208:211], v[160:163], a[44:47]
ds_read_b64_tr_b16 v[198:199], v222 offset:53248
v_mfma_f32_16x16x32_bf16 a[12:15], v[208:211], v[152:155], a[12:15]
ds_read_b64_tr_b16 v[208:209], v223 offset:57344
ds_read_b64_tr_b16 v[210:211], v223 offset:61440
v_mfma_f32_16x16x32_bf16 a[12:15], v[204:207], v[148:151], a[12:15]
ds_read_b64_tr_b16 v[204:205], v223 offset:49152
v_smfmac_f32_16x16x64_bf16 a[224:227], v[144:147], v[148:155], v254
ds_read_b64_tr_b16 v[206:207], v223 offset:53248
v_smfmac_f32_16x16x64_bf16 a[228:231], v[144:147], v[156:163], v254
s_waitcnt lgkmcnt(15)
v_mfma_f32_16x16x32_bf16 v[16:19], a[192:195], a[128:131], v[128:131]
v_exp_f32 v112, v48
v_mfma_f32_16x16x32_bf16 v[16:19], a[196:199], a[132:135], v[16:19]
v_exp_f32 v113, v49
v_mfma_f32_16x16x32_bf16 v[16:19], a[200:203], a[136:139], v[16:19]
v_exp_f32 v114, v50
v_mfma_f32_16x16x32_bf16 v[16:19], a[204:207], a[140:143], v[16:19]
v_exp_f32 v115, v51
v_mfma_f32_16x16x32_bf16 v[20:23], a[204:207], a[156:159], v[132:135]
v_cvt_pk_bf16_f32 v84, v112, v113
v_cvt_pk_bf16_f32 v85, v114, v115
v_mfma_f32_16x16x32_bf16 v[20:23], a[200:203], a[152:155], v[20:23]
v_exp_f32 v116, v64
v_mfma_f32_16x16x32_bf16 v[20:23], a[196:199], a[148:151], v[20:23]
v_exp_f32 v117, v65
v_mfma_f32_16x16x32_bf16 v[20:23], a[192:195], a[144:147], v[20:23]
s_add_u32 m0, s57, 98304
v_cvt_pk_bf16_f32 v86, v116, v117
v_mfma_f32_16x16x32_bf16 v[24:27], a[192:195], a[160:163], v[136:139]
buffer_load_dwordx4 v6, s[24:27], s56 offen offset:0  lds
v_mfma_f32_16x16x32_bf16 v[24:27], a[196:199], a[164:167], v[24:27]
v_exp_f32 v118, v66
v_mfma_f32_16x16x32_bf16 v[24:27], a[200:203], a[168:171], v[24:27]
v_exp_f32 v119, v67
v_mfma_f32_16x16x32_bf16 v[24:27], a[204:207], a[172:175], v[24:27]
v_exp_f32 v120, v52
v_mfma_f32_16x16x32_bf16 v[28:31], a[204:207], a[188:191], v[140:143]
ds_read_b128 a[204:207], v215 offset:24576
v_cvt_pk_bf16_f32 v87, v118, v119
v_mfma_f32_16x16x32_bf16 v[28:31], a[200:203], a[184:187], v[28:31]
v_exp_f32 v121, v53
v_mfma_f32_16x16x32_bf16 v[28:31], a[196:199], a[180:183], v[28:31]
ds_read_b128 a[200:203], v214 offset:24576
v_cvt_pk_bf16_f32 v92, v120, v121
v_mfma_f32_16x16x32_bf16 v[28:31], a[192:195], a[176:179], v[28:31]
v_exp_f32 v122, v54
v_mfma_f32_16x16x32_bf16 v[44:47], a[208:211], a[176:179], v[140:143]
v_exp_f32 v123, v55
v_mfma_f32_16x16x32_bf16 v[44:47], a[212:215], a[180:183], v[44:47]
ds_read_b128 a[196:199], v213 offset:24576
v_cvt_pk_bf16_f32 v93, v122, v123
v_mfma_f32_16x16x32_bf16 v[44:47], a[216:219], a[184:187], v[44:47]
v_exp_f32 v124, v68
v_mfma_f32_16x16x32_bf16 v[44:47], a[220:223], a[188:191], v[44:47]
v_exp_f32 v125, v69
v_mfma_f32_16x16x32_bf16 v[40:43], a[220:223], a[172:175], v[136:139]
ds_read_b128 a[192:195], v212 offset:24576
v_cvt_pk_bf16_f32 v94, v124, v125
v_mfma_f32_16x16x32_bf16 v[40:43], a[216:219], a[168:171], v[40:43]
v_exp_f32 v126, v70
v_mfma_f32_16x16x32_bf16 v[40:43], a[212:215], a[164:167], v[40:43]
v_exp_f32 v127, v71
v_mfma_f32_16x16x32_bf16 v[40:43], a[208:211], a[160:163], v[40:43]
v_cvt_pk_bf16_f32 v95, v126, v127
v_mfma_f32_16x16x32_bf16 v[36:39], a[208:211], a[144:147], v[132:135]
buffer_load_dwordx4 v7, s[24:27], s56 offen offset:1024  lds
v_mfma_f32_16x16x32_bf16 v[36:39], a[212:215], a[148:151], v[36:39]
v_exp_f32 v112, v56
v_mfma_f32_16x16x32_bf16 v[36:39], a[216:219], a[152:155], v[36:39]
v_exp_f32 v113, v57
v_mfma_f32_16x16x32_bf16 v[36:39], a[220:223], a[156:159], v[36:39]
v_exp_f32 v114, v58
v_mfma_f32_16x16x32_bf16 v[32:35], a[220:223], a[140:143], v[128:131]
ds_read_b128 a[220:223], v215 offset:28672
v_cvt_pk_bf16_f32 v100, v112, v113
v_mfma_f32_16x16x32_bf16 v[32:35], a[216:219], a[136:139], v[32:35]
v_exp_f32 v115, v59
v_mfma_f32_16x16x32_bf16 v[32:35], a[212:215], a[132:135], v[32:35]
ds_read_b128 a[216:219], v214 offset:28672
v_cvt_pk_bf16_f32 v101, v114, v115
v_mfma_f32_16x16x32_bf16 v[32:35], a[208:211], a[128:131], v[32:35]
ds_read_b128 a[212:215], v213 offset:28672
s_waitcnt lgkmcnt(15)
v_mfma_f32_16x16x32_bf16 a[16:19], v[180:183], v[148:151], a[16:19]
v_exp_f32 v116, v72
v_mfma_f32_16x16x32_bf16 a[16:19], v[184:187], v[152:155], a[16:19]
v_exp_f32 v117, v73
v_mfma_f32_16x16x32_bf16 a[48:51], v[184:187], v[160:163], a[48:51]
ds_read_b128 a[208:211], v212 offset:28672
v_cvt_pk_bf16_f32 v102, v116, v117
v_mfma_f32_16x16x32_bf16 a[48:51], v[180:183], v[156:159], a[48:51]
v_exp_f32 v118, v74
v_mfma_f32_16x16x32_bf16 a[80:83], v[180:183], v[164:167], a[80:83]
v_exp_f32 v119, v75
v_mfma_f32_16x16x32_bf16 a[80:83], v[184:187], v[168:171], a[80:83]
v_exp_f32 v120, v60
v_mfma_f32_16x16x32_bf16 a[112:115], v[184:187], v[176:179], a[112:115]
ds_read_b64_tr_b16 v[184:185], v216 offset:8192
v_cvt_pk_bf16_f32 v103, v118, v119
v_mfma_f32_16x16x32_bf16 a[112:115], v[180:183], v[172:175], a[112:115]
ds_read_b64_tr_b16 v[186:187], v216 offset:12288
v_mfma_f32_16x16x32_bf16 a[116:119], v[188:191], v[172:175], a[116:119]
ds_read_b64_tr_b16 v[180:181], v216 offset:0
ds_read_b64_tr_b16 v[182:183], v216 offset:4096
v_mfma_f32_16x16x32_bf16 a[116:119], v[192:195], v[176:179], a[116:119]
buffer_load_dwordx4 v8, s[24:27], s56 offen offset:2048  lds
v_mfma_f32_16x16x32_bf16 a[84:87], v[192:195], v[168:171], a[84:87]
v_exp_f32 v121, v61
v_mfma_f32_16x16x32_bf16 a[84:87], v[188:191], v[164:167], a[84:87]
v_exp_f32 v122, v62
v_mfma_f32_16x16x32_bf16 a[52:55], v[188:191], v[156:159], a[52:55]
v_exp_f32 v123, v63
v_mfma_f32_16x16x32_bf16 a[52:55], v[192:195], v[160:163], a[52:55]
v_cvt_pk_bf16_f32 v108, v120, v121
v_cvt_pk_bf16_f32 v109, v122, v123
v_mfma_f32_16x16x32_bf16 a[20:23], v[192:195], v[152:155], a[20:23]
v_exp_f32 v124, v76
v_mfma_f32_16x16x32_bf16 a[20:23], v[188:191], v[148:151], a[20:23]
ds_read_b64_tr_b16 v[192:193], v217 offset:8192
s_waitcnt lgkmcnt(15)
v_mfma_f32_16x16x32_bf16 a[24:27], v[196:199], v[148:151], a[24:27]
v_exp_f32 v125, v77
v_mfma_f32_16x16x32_bf16 a[24:27], v[200:203], v[152:155], a[24:27]
ds_read_b64_tr_b16 v[194:195], v217 offset:12288
v_cvt_pk_bf16_f32 v110, v124, v125
v_mfma_f32_16x16x32_bf16 a[56:59], v[200:203], v[160:163], a[56:59]
v_exp_f32 v126, v78
v_mfma_f32_16x16x32_bf16 a[56:59], v[196:199], v[156:159], a[56:59]
v_exp_f32 v127, v79
v_mfma_f32_16x16x32_bf16 a[88:91], v[196:199], v[164:167], a[88:91]
ds_read_b64_tr_b16 v[188:189], v217 offset:0
v_cvt_pk_bf16_f32 v111, v126, v127
v_mfma_f32_16x16x32_bf16 a[88:91], v[200:203], v[168:171], a[88:91]
ds_read_b64_tr_b16 v[190:191], v217 offset:4096
v_mfma_f32_16x16x32_bf16 a[120:123], v[200:203], v[176:179], a[120:123]
ds_read_b64_tr_b16 v[200:201], v218 offset:8192
ds_read_b64_tr_b16 v[202:203], v218 offset:12288
v_mfma_f32_16x16x32_bf16 a[120:123], v[196:199], v[172:175], a[120:123]
ds_read_b64_tr_b16 v[196:197], v218 offset:0
s_waitcnt lgkmcnt(15)
v_mfma_f32_16x16x32_bf16 a[124:127], v[204:207], v[172:175], a[124:127]
ds_read_b64_tr_b16 v[198:199], v218 offset:4096
v_mfma_f32_16x16x32_bf16 a[124:127], v[208:211], v[176:179], a[124:127]
buffer_load_dwordx4 v9, s[24:27], s56 offen offset:3072  lds
v_mfma_f32_16x16x32_bf16 a[92:95], v[208:211], v[168:171], a[92:95]
s_add_u32 s56, s56, 0x4000
v_mfma_f32_16x16x32_bf16 a[92:95], v[204:207], v[164:167], a[92:95]
s_cmp_eq_u32 s98, 15
s_cselect_b32 s101, 0, 0x1000
v_mfma_f32_16x16x32_bf16 a[60:63], v[204:207], v[156:159], a[60:63]
s_lshr_b64 s[98:99], s[96:97], 1
s_or_b64 s[96:97], s[96:97], s[98:99]
v_mfma_f32_16x16x32_bf16 a[60:63], v[208:211], v[160:163], a[60:63]
s_and_b32 s96, s96, 0x10101010
s_and_b32 s97, s97, 0x10101010
v_mfma_f32_16x16x32_bf16 a[28:31], v[208:211], v[152:155], a[28:31]
ds_read_b64_tr_b16 v[208:209], v219 offset:8192
ds_read_b64_tr_b16 v[210:211], v219 offset:12288
v_mfma_f32_16x16x32_bf16 a[28:31], v[204:207], v[148:151], a[28:31]
ds_read_b64_tr_b16 v[204:205], v219 offset:0
s_bcnt1_i32_b64 s55, s[96:97]
v_smfmac_f32_16x16x64_bf16 a[232:235], v[144:147], v[164:171], v254
ds_read_b64_tr_b16 v[206:207], v219 offset:4096
s_lshl_b32 s55, s55, 2
v_smfmac_f32_16x16x64_bf16 a[236:239], v[144:147], v[172:179], v254
s_waitcnt vmcnt(15) lgkmcnt(15)
s_barrier
v_mfma_f32_16x16x32_bf16 v[48:51], a[192:195], a[128:131], v[128:131]
v_exp_f32 v112, v16
v_mfma_f32_16x16x32_bf16 v[48:51], a[196:199], a[132:135], v[48:51]
v_exp_f32 v113, v17
v_mfma_f32_16x16x32_bf16 v[48:51], a[200:203], a[136:139], v[48:51]
ds_read_b64_tr_b16 v[232:233], v230 offset:0
v_cvt_pk_bf16_f32 v148, v112, v113
v_mfma_f32_16x16x32_bf16 v[48:51], a[204:207], a[140:143], v[48:51]
v_exp_f32 v114, v18
v_mfma_f32_16x16x32_bf16 v[52:55], a[204:207], a[156:159], v[132:135]
ds_read_b64_tr_b16 v[234:235], v230 offset:8192
s_add_u32 m0, s57, 49152
v_mfma_f32_16x16x32_bf16 v[52:55], a[200:203], a[152:155], v[52:55]
buffer_load_dwordx4 v10, s[28:31], s56 offen offset:0  lds
v_mfma_f32_16x16x32_bf16 v[52:55], a[196:199], a[148:151], v[52:55]
ds_read_b64_tr_b16 v[236:237], v231 offset:0
ds_read_b64_tr_b16 v[238:239], v231 offset:8192
v_mfma_f32_16x16x32_bf16 v[52:55], a[192:195], a[144:147], v[52:55]
v_exp_f32 v115, v19
v_mfma_f32_16x16x32_bf16 v[56:59], a[192:195], a[160:163], v[136:139]
v_exp_f32 v116, v32
v_mfma_f32_16x16x32_bf16 v[56:59], a[196:199], a[164:167], v[56:59]
v_exp_f32 v117, v33
v_mfma_f32_16x16x32_bf16 v[56:59], a[200:203], a[168:171], v[56:59]
v_cvt_pk_bf16_f32 v149, v114, v115
v_cvt_pk_bf16_f32 v150, v116, v117
v_mfma_f32_16x16x32_bf16 v[56:59], a[204:207], a[172:175], v[56:59]
v_exp_f32 v118, v34
v_mfma_f32_16x16x32_bf16 v[60:63], a[204:207], a[188:191], v[140:143]
v_exp_f32 v119, v35
v_mfma_f32_16x16x32_bf16 v[60:63], a[200:203], a[184:187], v[60:63]
ds_read_b128 a[204:207], v215 offset:32768
v_cvt_pk_bf16_f32 v151, v118, v119
v_mfma_f32_16x16x32_bf16 v[60:63], a[196:199], a[180:183], v[60:63]
v_exp_f32 v120, v20
v_mfma_f32_16x16x32_bf16 v[60:63], a[192:195], a[176:179], v[60:63]
ds_read_b128 a[200:203], v214 offset:32768
ds_read_b128 a[196:199], v213 offset:32768
v_mfma_f32_16x16x32_bf16 v[76:79], a[208:211], a[176:179], v[140:143]
buffer_load_dwordx4 v11, s[28:31], s56 offen offset:1024  lds
v_mfma_f32_16x16x32_bf16 v[76:79], a[212:215], a[180:183], v[76:79]
v_exp_f32 v121, v21
v_mfma_f32_16x16x32_bf16 v[76:79], a[216:219], a[184:187], v[76:79]
ds_read_b128 a[192:195], v212 offset:32768
v_cvt_pk_bf16_f32 v156, v120, v121
v_mfma_f32_16x16x32_bf16 v[76:79], a[220:223], a[188:191], v[76:79]
v_exp_f32 v122, v22
v_mfma_f32_16x16x32_bf16 v[72:75], a[220:223], a[172:175], v[136:139]
v_exp_f32 v123, v23
v_mfma_f32_16x16x32_bf16 v[72:75], a[216:219], a[168:171], v[72:75]
v_exp_f32 v124, v36
v_mfma_f32_16x16x32_bf16 v[72:75], a[212:215], a[164:167], v[72:75]
v_exp_f32 v125, v37
v_mfma_f32_16x16x32_bf16 v[72:75], a[208:211], a[160:163], v[72:75]
v_cvt_pk_bf16_f32 v157, v122, v123
v_cvt_pk_bf16_f32 v158, v124, v125
v_mfma_f32_16x16x32_bf16 v[68:71], a[208:211], a[144:147], v[132:135]
v_exp_f32 v126, v38
v_mfma_f32_16x16x32_bf16 v[68:71], a[212:215], a[148:151], v[68:71]
s_lshr_b32 s55, 0x9bdfeca8, s55
v_and_b32_e64 v4, 15, s55
v_mfma_f32_16x16x32_bf16 v[68:71], a[216:219], a[152:155], v[68:71]
buffer_load_dwordx4 v10, s[28:31], s56 offen offset:2048  lds
v_mfma_f32_16x16x32_bf16 v[68:71], a[220:223], a[156:159], v[68:71]
v_exp_f32 v127, v39
v_mfma_f32_16x16x32_bf16 v[64:67], a[220:223], a[140:143], v[128:131]
ds_read_b128 a[220:223], v215 offset:36864
v_cvt_pk_bf16_f32 v159, v126, v127
v_mfma_f32_16x16x32_bf16 v[64:67], a[216:219], a[136:139], v[64:67]
v_exp_f32 v112, v24
v_mfma_f32_16x16x32_bf16 v[64:67], a[212:215], a[132:135], v[64:67]
v_exp_f32 v113, v25
v_mfma_f32_16x16x32_bf16 v[64:67], a[208:211], a[128:131], v[64:67]
ds_read_b128 a[216:219], v214 offset:36864
s_waitcnt lgkmcnt(15)
v_mfma_f32_16x16x32_bf16 a[0:3], v[180:183], v[80:83], a[0:3]
ds_read_b128 a[212:215], v213 offset:36864
v_cvt_pk_bf16_f32 v164, v112, v113
v_mfma_f32_16x16x32_bf16 a[0:3], v[184:187], v[84:87], a[0:3]
v_exp_f32 v114, v26
v_mfma_f32_16x16x32_bf16 a[32:35], v[184:187], v[92:95], a[32:35]
v_exp_f32 v115, v27
v_mfma_f32_16x16x32_bf16 a[32:35], v[180:183], v[88:91], a[32:35]
ds_read_b128 a[208:211], v212 offset:36864
v_cvt_pk_bf16_f32 v165, v114, v115
v_mfma_f32_16x16x32_bf16 a[64:67], v[180:183], v[96:99], a[64:67]
v_mfma_f32_16x16x32_bf16 a[64:67], v[184:187], v[100:103], a[64:67]
buffer_load_dwordx4 v11, s[28:31], s56 offen offset:3072  lds
v_mfma_f32_16x16x32_bf16 a[96:99], v[184:187], v[108:111], a[96:99]
v_exp_f32 v116, v40
v_mfma_f32_16x16x32_bf16 a[96:99], v[180:183], v[104:107], a[96:99]
v_exp_f32 v117, v41
v_mfma_f32_16x16x32_bf16 a[100:103], v[188:191], v[104:107], a[100:103]
ds_read_b64_tr_b16 v[184:185], v220 offset:8192
v_cvt_pk_bf16_f32 v166, v116, v117
v_mfma_f32_16x16x32_bf16 a[100:103], v[192:195], v[108:111], a[100:103]
v_exp_f32 v118, v42
v_mfma_f32_16x16x32_bf16 a[68:71], v[192:195], v[100:103], a[68:71]
v_exp_f32 v119, v43
v_mfma_f32_16x16x32_bf16 a[68:71], v[188:191], v[96:99], a[68:71]
ds_read_b64_tr_b16 v[186:187], v220 offset:12288
v_cvt_pk_bf16_f32 v167, v118, v119
v_mfma_f32_16x16x32_bf16 a[36:39], v[188:191], v[88:91], a[36:39]
v_exp_f32 v120, v28
v_mfma_f32_16x16x32_bf16 a[36:39], v[192:195], v[92:95], a[36:39]
ds_read_b64_tr_b16 v[180:181], v220 offset:0
ds_read_b64_tr_b16 v[182:183], v220 offset:4096
v_mfma_f32_16x16x32_bf16 a[4:7], v[192:195], v[84:87], a[4:7]
v_exp_f32 v121, v29
v_mfma_f32_16x16x32_bf16 a[4:7], v[188:191], v[80:83], a[4:7]
ds_read_b64_tr_b16 v[192:193], v221 offset:8192
s_waitcnt lgkmcnt(15)
v_mfma_f32_16x16x32_bf16 a[8:11], v[196:199], v[80:83], a[8:11]
ds_read_b64_tr_b16 v[194:195], v221 offset:12288
v_cvt_pk_bf16_f32 v172, v120, v121
v_mfma_f32_16x16x32_bf16 a[8:11], v[200:203], v[84:87], a[8:11]
v_exp_f32 v122, v30
v_mfma_f32_16x16x32_bf16 a[40:43], v[200:203], v[92:95], a[40:43]
v_exp_f32 v123, v31
v_mfma_f32_16x16x32_bf16 a[40:43], v[196:199], v[88:91], a[40:43]
ds_read_b64_tr_b16 v[188:189], v221 offset:0
v_cvt_pk_bf16_f32 v173, v122, v123
v_mfma_f32_16x16x32_bf16 a[72:75], v[196:199], v[96:99], a[72:75]
v_exp_f32 v124, v44
v_mfma_f32_16x16x32_bf16 a[72:75], v[200:203], v[100:103], a[72:75]
ds_read_b64_tr_b16 v[190:191], v221 offset:4096
v_mfma_f32_16x16x32_bf16 a[104:107], v[200:203], v[108:111], a[104:107]
v_exp_f32 v125, v45
v_mfma_f32_16x16x32_bf16 a[104:107], v[196:199], v[104:107], a[104:107]
ds_read_b64_tr_b16 v[200:201], v222 offset:8192
v_cvt_pk_bf16_f32 v174, v124, v125
v_mfma_f32_16x16x32_bf16 a[108:111], v[204:207], v[104:107], a[108:111]
v_exp_f32 v126, v46
v_mfma_f32_16x16x32_bf16 a[108:111], v[208:211], v[108:111], a[108:111]
v_exp_f32 v127, v47
v_mfma_f32_16x16x32_bf16 a[76:79], v[208:211], v[100:103], a[76:79]
ds_read_b64_tr_b16 v[202:203], v222 offset:12288
v_cvt_pk_bf16_f32 v175, v126, v127
v_mfma_f32_16x16x32_bf16 a[76:79], v[204:207], v[96:99], a[76:79]
ds_read_b64_tr_b16 v[196:197], v222 offset:0
ds_read_b64_tr_b16 v[198:199], v222 offset:4096
v_mfma_f32_16x16x32_bf16 a[44:47], v[204:207], v[88:91], a[44:47]
v_mfma_f32_16x16x32_bf16 a[44:47], v[208:211], v[92:95], a[44:47]
v_mfma_f32_16x16x32_bf16 a[12:15], v[208:211], v[84:87], a[12:15]
ds_read_b64_tr_b16 v[208:209], v223 offset:8192
ds_read_b64_tr_b16 v[210:211], v223 offset:12288
v_mfma_f32_16x16x32_bf16 a[12:15], v[204:207], v[80:83], a[12:15]
ds_read_b64_tr_b16 v[204:205], v223 offset:0
v_smfmac_f32_16x16x64_bf16 a[224:227], v[144:147], v[80:87], v254
ds_read_b64_tr_b16 v[206:207], v223 offset:4096
v_smfmac_f32_16x16x64_bf16 a[228:231], v[144:147], v[88:95], v254
s_waitcnt lgkmcnt(15)
v_mfma_f32_16x16x32_bf16 v[16:19], a[192:195], a[128:131], v[128:131]
v_exp_f32 v112, v48
v_mfma_f32_16x16x32_bf16 v[16:19], a[196:199], a[132:135], v[16:19]
v_exp_f32 v113, v49
v_mfma_f32_16x16x32_bf16 v[16:19], a[200:203], a[136:139], v[16:19]
v_exp_f32 v114, v50
v_mfma_f32_16x16x32_bf16 v[16:19], a[204:207], a[140:143], v[16:19]
v_cvt_pk_bf16_f32 v152, v112, v113
v_mfma_f32_16x16x32_bf16 v[20:23], a[204:207], a[156:159], v[132:135]
buffer_store_dword v4, v251, s[88:91], s101 offen sc0 sc1
v_mfma_f32_16x16x32_bf16 v[20:23], a[200:203], a[152:155], v[20:23]
v_exp_f32 v115, v51
v_mfma_f32_16x16x32_bf16 v[20:23], a[196:199], a[148:151], v[20:23]
v_exp_f32 v116, v64
v_mfma_f32_16x16x32_bf16 v[20:23], a[192:195], a[144:147], v[20:23]
v_exp_f32 v117, v65
v_mfma_f32_16x16x32_bf16 v[24:27], a[192:195], a[160:163], v[136:139]
v_cvt_pk_bf16_f32 v153, v114, v115
v_cvt_pk_bf16_f32 v154, v116, v117
v_mfma_f32_16x16x32_bf16 v[24:27], a[196:199], a[164:167], v[24:27]
v_exp_f32 v118, v66
v_mfma_f32_16x16x32_bf16 v[24:27], a[200:203], a[168:171], v[24:27]
v_exp_f32 v119, v67
v_mfma_f32_16x16x32_bf16 v[24:27], a[204:207], a[172:175], v[24:27]
v_exp_f32 v120, v52
v_mfma_f32_16x16x32_bf16 v[28:31], a[204:207], a[188:191], v[140:143]
ds_read_b128 a[204:207], v215 offset:40960
v_cvt_pk_bf16_f32 v155, v118, v119
v_mfma_f32_16x16x32_bf16 v[28:31], a[200:203], a[184:187], v[28:31]
ds_read_b128 a[200:203], v214 offset:40960
s_add_u32 m0, s57, 114688
v_mfma_f32_16x16x32_bf16 v[28:31], a[196:199], a[180:183], v[28:31]
buffer_load_dwordx4 v6, s[24:27], s56 offen offset:0  lds
v_mfma_f32_16x16x32_bf16 v[28:31], a[192:195], a[176:179], v[28:31]
v_exp_f32 v121, v53
v_mfma_f32_16x16x32_bf16 v[44:47], a[208:211], a[176:179], v[140:143]
ds_read_b128 a[196:199], v213 offset:40960
v_cvt_pk_bf16_f32 v160, v120, v121
v_mfma_f32_16x16x32_bf16 v[44:47], a[212:215], a[180:183], v[44:47]
v_exp_f32 v122, v54
v_mfma_f32_16x16x32_bf16 v[44:47], a[216:219], a[184:187], v[44:47]
v_exp_f32 v123, v55
v_mfma_f32_16x16x32_bf16 v[44:47], a[220:223], a[188:191], v[44:47]
ds_read_b128 a[192:195], v212 offset:40960
v_cvt_pk_bf16_f32 v161, v122, v123
v_mfma_f32_16x16x32_bf16 v[40:43], a[220:223], a[172:175], v[136:139]
v_exp_f32 v124, v68
v_mfma_f32_16x16x32_bf16 v[40:43], a[216:219], a[168:171], v[40:43]
v_exp_f32 v125, v69
v_mfma_f32_16x16x32_bf16 v[40:43], a[212:215], a[164:167], v[40:43]
v_cvt_pk_bf16_f32 v162, v124, v125
v_mfma_f32_16x16x32_bf16 v[40:43], a[208:211], a[160:163], v[40:43]
buffer_store_dwordx4 v[232:235], v229, s[8:11], s44 offen offset:0 sc0 sc1
v_mfma_f32_16x16x32_bf16 v[36:39], a[208:211], a[144:147], v[132:135]
v_exp_f32 v126, v70
v_mfma_f32_16x16x32_bf16 v[36:39], a[212:215], a[148:151], v[36:39]
v_exp_f32 v127, v71
v_mfma_f32_16x16x32_bf16 v[36:39], a[216:219], a[152:155], v[36:39]
v_exp_f32 v112, v56
v_mfma_f32_16x16x32_bf16 v[36:39], a[220:223], a[156:159], v[36:39]
v_exp_f32 v113, v57
v_mfma_f32_16x16x32_bf16 v[32:35], a[220:223], a[140:143], v[128:131]
ds_read_b128 a[220:223], v215 offset:45056
v_cvt_pk_bf16_f32 v163, v126, v127
v_mfma_f32_16x16x32_bf16 v[32:35], a[216:219], a[136:139], v[32:35]
ds_read_b128 a[216:219], v214 offset:45056
v_cvt_pk_bf16_f32 v168, v112, v113
v_mfma_f32_16x16x32_bf16 v[32:35], a[212:215], a[132:135], v[32:35]
v_exp_f32 v114, v58
v_mfma_f32_16x16x32_bf16 v[32:35], a[208:211], a[128:131], v[32:35]
ds_read_b128 a[212:215], v213 offset:45056
s_waitcnt lgkmcnt(15)
v_mfma_f32_16x16x32_bf16 a[16:19], v[180:183], v[80:83], a[16:19]
ds_read_b128 a[208:211], v212 offset:45056
v_mfma_f32_16x16x32_bf16 a[16:19], v[184:187], v[84:87], a[16:19]
buffer_load_dwordx4 v7, s[24:27], s56 offen offset:1024  lds
v_mfma_f32_16x16x32_bf16 a[48:51], v[184:187], v[92:95], a[48:51]
v_exp_f32 v115, v59
v_mfma_f32_16x16x32_bf16 a[48:51], v[180:183], v[88:91], a[48:51]
v_exp_f32 v116, v72
v_mfma_f32_16x16x32_bf16 a[80:83], v[180:183], v[96:99], a[80:83]
v_exp_f32 v117, v73
v_mfma_f32_16x16x32_bf16 a[80:83], v[184:187], v[100:103], a[80:83]
v_cvt_pk_bf16_f32 v169, v114, v115
v_cvt_pk_bf16_f32 v170, v116, v117
v_mfma_f32_16x16x32_bf16 a[112:115], v[184:187], v[108:111], a[112:115]
v_exp_f32 v118, v74
v_mfma_f32_16x16x32_bf16 a[112:115], v[180:183], v[104:107], a[112:115]
ds_read_b64_tr_b16 v[184:185], v216 offset:24576
v_mfma_f32_16x16x32_bf16 a[116:119], v[188:191], v[104:107], a[116:119]
v_exp_f32 v119, v75
v_mfma_f32_16x16x32_bf16 a[116:119], v[192:195], v[108:111], a[116:119]
ds_read_b64_tr_b16 v[186:187], v216 offset:28672
v_cvt_pk_bf16_f32 v171, v118, v119
v_mfma_f32_16x16x32_bf16 a[84:87], v[192:195], v[100:103], a[84:87]
buffer_load_dwordx4 v8, s[24:27], s56 offen offset:2048  lds
v_mfma_f32_16x16x32_bf16 a[84:87], v[188:191], v[96:99], a[84:87]
v_exp_f32 v120, v60
v_mfma_f32_16x16x32_bf16 a[52:55], v[188:191], v[88:91], a[52:55]
v_exp_f32 v121, v61
v_mfma_f32_16x16x32_bf16 a[52:55], v[192:195], v[92:95], a[52:55]
ds_read_b64_tr_b16 v[180:181], v216 offset:16384
v_cvt_pk_bf16_f32 v176, v120, v121
v_mfma_f32_16x16x32_bf16 a[20:23], v[192:195], v[84:87], a[20:23]
ds_read_b64_tr_b16 v[182:183], v216 offset:20480
ds_read_b64_tr_b16 v[192:193], v217 offset:24576
v_mfma_f32_16x16x32_bf16 a[20:23], v[188:191], v[80:83], a[20:23]
ds_read_b64_tr_b16 v[194:195], v217 offset:28672
s_waitcnt lgkmcnt(15)
v_mfma_f32_16x16x32_bf16 a[24:27], v[196:199], v[80:83], a[24:27]
v_exp_f32 v122, v62
v_mfma_f32_16x16x32_bf16 a[24:27], v[200:203], v[84:87], a[24:27]
v_exp_f32 v123, v63
v_mfma_f32_16x16x32_bf16 a[56:59], v[200:203], v[92:95], a[56:59]
ds_read_b64_tr_b16 v[188:189], v217 offset:16384
v_cvt_pk_bf16_f32 v177, v122, v123
v_mfma_f32_16x16x32_bf16 a[56:59], v[196:199], v[88:91], a[56:59]
buffer_store_dwordx4 v[236:239], v229, s[8:11], s44 offen offset:1024 sc0 sc1
v_mfma_f32_16x16x32_bf16 a[88:91], v[196:199], v[96:99], a[88:91]
ds_read_b64_tr_b16 v[190:191], v217 offset:20480
s_add_u32 s44, s44, s3
v_mfma_f32_16x16x32_bf16 a[88:91], v[200:203], v[100:103], a[88:91]
v_exp_f32 v124, v76
v_mfma_f32_16x16x32_bf16 a[120:123], v[200:203], v[108:111], a[120:123]
v_exp_f32 v125, v77
v_mfma_f32_16x16x32_bf16 a[120:123], v[196:199], v[104:107], a[120:123]
ds_read_b64_tr_b16 v[200:201], v218 offset:24576
s_waitcnt lgkmcnt(15)
v_mfma_f32_16x16x32_bf16 a[124:127], v[204:207], v[104:107], a[124:127]
ds_read_b64_tr_b16 v[202:203], v218 offset:28672
v_cvt_pk_bf16_f32 v178, v124, v125
v_mfma_f32_16x16x32_bf16 a[124:127], v[208:211], v[108:111], a[124:127]
v_exp_f32 v126, v78
v_mfma_f32_16x16x32_bf16 a[92:95], v[208:211], v[100:103], a[92:95]
v_exp_f32 v127, v79
v_mfma_f32_16x16x32_bf16 a[92:95], v[204:207], v[96:99], a[92:95]
ds_read_b64_tr_b16 v[196:197], v218 offset:16384
v_cvt_pk_bf16_f32 v179, v126, v127
v_mfma_f32_16x16x32_bf16 a[60:63], v[204:207], v[88:91], a[60:63]
ds_read_b64_tr_b16 v[198:199], v218 offset:20480
v_mfma_f32_16x16x32_bf16 a[60:63], v[208:211], v[92:95], a[60:63]
buffer_load_dwordx4 v9, s[24:27], s56 offen offset:3072  lds
v_mfma_f32_16x16x32_bf16 a[28:31], v[208:211], v[84:87], a[28:31]
ds_read_b64_tr_b16 v[208:209], v219 offset:24576
s_add_u32 s56, s56, 0x4000
v_mfma_f32_16x16x32_bf16 a[28:31], v[204:207], v[80:83], a[28:31]
ds_read_b64_tr_b16 v[210:211], v219 offset:28672
ds_read_b64_tr_b16 v[204:205], v219 offset:16384
v_smfmac_f32_16x16x64_bf16 a[232:235], v[144:147], v[96:103], v254
ds_read_b64_tr_b16 v[206:207], v219 offset:20480
v_smfmac_f32_16x16x64_bf16 a[236:239], v[144:147], v[104:111], v254
s_sub_u32 s47, s47, 1
s_cmp_lg_u32 s47, 0
s_cbranch_scc1 L_main_kernel_a
L_main_kernel_t30:
s_waitcnt vmcnt(17) lgkmcnt(15)
s_barrier
s_waitcnt vmcnt(15)
v_readfirstlane_b32 s55, v14
s_cmp_eq_u32 s77, 0
s_cselect_b32 s55, 0, s55
s_cmp_lt_u32 s55, 256
s_cbranch_scc1 L_main_kernel_g1
L_main_kernel_g1b:
v_mfma_f32_16x16x32_bf16 v[48:51], a[192:195], a[128:131], v[128:131]
ds_read_b64_tr_b16 v[232:233], v230 offset:2048
v_mov_b32 v8, 1
v_mfma_f32_16x16x32_bf16 v[48:51], a[196:199], a[132:135], v[48:51]
ds_read_b64_tr_b16 v[234:235], v230 offset:10240
v_mov_b32 v9, 0
v_mfma_f32_16x16x32_bf16 v[48:51], a[200:203], a[136:139], v[48:51]
buffer_atomic_add_x2 v[8:9], v252, s[32:35], 0 offen sc0 sc1
v_mfma_f32_16x16x32_bf16 v[48:51], a[204:207], a[140:143], v[48:51]
v_exp_f32 v112, v16
v_mfma_f32_16x16x32_bf16 v[52:55], a[204:207], a[156:159], v[132:135]
ds_read_b64_tr_b16 v[236:237], v231 offset:2048
s_xor_b32 s69, s7, s46
v_mfma_f32_16x16x32_bf16 v[52:55], a[200:203], a[152:155], v[52:55]
ds_read_b64_tr_b16 v[238:239], v231 offset:10240
s_add_u32 m0, s57, 98304
v_mfma_f32_16x16x32_bf16 v[52:55], a[196:199], a[148:151], v[52:55]
buffer_load_dwordx4 v253, s[8:11], s69 offen offset:0 sc1 lds
v_mfma_f32_16x16x32_bf16 v[52:55], a[192:195], a[144:147], v[52:55]
v_exp_f32 v113, v17
v_mfma_f32_16x16x32_bf16 v[56:59], a[192:195], a[160:163], v[136:139]
v_cvt_pk_bf16_f32 v80, v112, v113
s_lshl_b32 s75, s40, 11
v_mfma_f32_16x16x32_bf16 v[56:59], a[196:199], a[164:167], v[56:59]
buffer_load_dwordx4 v253, s[8:11], s69 offen offset:1024 sc1 lds
v_mfma_f32_16x16x32_bf16 v[56:59], a[200:203], a[168:171], v[56:59]
v_exp_f32 v114, v18
v_mfma_f32_16x16x32_bf16 v[56:59], a[204:207], a[172:175], v[56:59]
v_exp_f32 v115, v19
v_mfma_f32_16x16x32_bf16 v[60:63], a[204:207], a[188:191], v[140:143]
ds_read_b128 a[204:207], v215 offset:49152
v_cvt_pk_bf16_f32 v81, v114, v115
v_mfma_f32_16x16x32_bf16 v[60:63], a[200:203], a[184:187], v[60:63]
buffer_load_dwordx4 v253, s[8:11], s69 offen offset:2048 sc1 lds
v_mfma_f32_16x16x32_bf16 v[60:63], a[196:199], a[180:183], v[60:63]
v_exp_f32 v116, v32
v_mfma_f32_16x16x32_bf16 v[60:63], a[192:195], a[176:179], v[60:63]
v_exp_f32 v117, v33
v_mfma_f32_16x16x32_bf16 v[76:79], a[208:211], a[176:179], v[140:143]
ds_read_b128 a[200:203], v214 offset:49152
v_cvt_pk_bf16_f32 v82, v116, v117
v_mfma_f32_16x16x32_bf16 v[76:79], a[212:215], a[180:183], v[76:79]
buffer_atomic_add v255, v252, s[32:35], 0 offen offset:4 sc1
v_mfma_f32_16x16x32_bf16 v[76:79], a[216:219], a[184:187], v[76:79]
v_exp_f32 v118, v34
v_mfma_f32_16x16x32_bf16 v[76:79], a[220:223], a[188:191], v[76:79]
v_exp_f32 v119, v35
v_mfma_f32_16x16x32_bf16 v[72:75], a[220:223], a[172:175], v[136:139]
ds_read_b128 a[196:199], v213 offset:49152
v_cvt_pk_bf16_f32 v83, v118, v119
v_mfma_f32_16x16x32_bf16 v[72:75], a[216:219], a[168:171], v[72:75]
buffer_load_dwordx4 v253, s[8:11], s69 offen offset:3072 sc1 lds
v_mfma_f32_16x16x32_bf16 v[72:75], a[212:215], a[164:167], v[72:75]
ds_read_b128 a[192:195], v212 offset:49152
s_add_u32 s7, s7, s64
v_mfma_f32_16x16x32_bf16 v[72:75], a[208:211], a[160:163], v[72:75]
v_exp_f32 v120, v20
v_mfma_f32_16x16x32_bf16 v[68:71], a[208:211], a[144:147], v[132:135]
s_xor_b32 s69, s7, s46
s_add_u32 m0, s57, 114688
v_mfma_f32_16x16x32_bf16 v[68:71], a[212:215], a[148:151], v[68:71]
buffer_load_dwordx4 v253, s[8:11], s69 offen offset:0 sc1 lds
v_mfma_f32_16x16x32_bf16 v[68:71], a[216:219], a[152:155], v[68:71]
v_exp_f32 v121, v21
v_mfma_f32_16x16x32_bf16 v[68:71], a[220:223], a[156:159], v[68:71]
v_exp_f32 v122, v22
v_mfma_f32_16x16x32_bf16 v[64:67], a[220:223], a[140:143], v[128:131]
ds_read_b128 a[220:223], v215 offset:53248
v_cvt_pk_bf16_f32 v88, v120, v121
v_mfma_f32_16x16x32_bf16 v[64:67], a[216:219], a[136:139], v[64:67]
buffer_load_dwordx4 v253, s[8:11], s69 offen offset:1024 sc1 lds
v_mfma_f32_16x16x32_bf16 v[64:67], a[212:215], a[132:135], v[64:67]
v_exp_f32 v123, v23
v_mfma_f32_16x16x32_bf16 v[64:67], a[208:211], a[128:131], v[64:67]
ds_read_b128 a[216:219], v214 offset:53248
s_waitcnt lgkmcnt(15)
v_mfma_f32_16x16x32_bf16 a[0:3], v[180:183], v[148:151], a[0:3]
ds_read_b128 a[212:215], v213 offset:53248
v_cvt_pk_bf16_f32 v89, v122, v123
v_mfma_f32_16x16x32_bf16 a[0:3], v[184:187], v[152:155], a[0:3]
buffer_load_dwordx4 v253, s[8:11], s69 offen offset:2048 sc1 lds
v_mfma_f32_16x16x32_bf16 a[32:35], v[184:187], v[160:163], a[32:35]
v_exp_f32 v124, v36
v_mfma_f32_16x16x32_bf16 a[32:35], v[180:183], v[156:159], a[32:35]
v_exp_f32 v125, v37
v_mfma_f32_16x16x32_bf16 a[64:67], v[180:183], v[164:167], a[64:67]
ds_read_b128 a[208:211], v212 offset:53248
v_cvt_pk_bf16_f32 v90, v124, v125
v_mfma_f32_16x16x32_bf16 a[64:67], v[184:187], v[168:171], a[64:67]
buffer_load_dwordx4 v253, s[8:11], s69 offen offset:3072 sc1 lds
v_mfma_f32_16x16x32_bf16 a[96:99], v[184:187], v[176:179], a[96:99]
ds_read_b64_tr_b16 v[184:185], v220 offset:24576
s_add_u32 s7, s7, s64
v_mfma_f32_16x16x32_bf16 a[96:99], v[180:183], v[172:175], a[96:99]
ds_read_b64_tr_b16 v[186:187], v220 offset:28672
s_xor_b32 s69, s7, s46
v_mfma_f32_16x16x32_bf16 a[100:103], v[188:191], v[172:175], a[100:103]
ds_read_b64_tr_b16 v[180:181], v220 offset:16384
s_add_u32 m0, s57, 131072
v_mfma_f32_16x16x32_bf16 a[100:103], v[192:195], v[176:179], a[100:103]
buffer_load_dwordx4 v253, s[8:11], s69 offen offset:0 sc1 lds
v_mfma_f32_16x16x32_bf16 a[68:71], v[192:195], v[168:171], a[68:71]
v_exp_f32 v126, v38
v_mfma_f32_16x16x32_bf16 a[68:71], v[188:191], v[164:167], a[68:71]
v_exp_f32 v127, v39
v_mfma_f32_16x16x32_bf16 a[36:39], v[188:191], v[156:159], a[36:39]
ds_read_b64_tr_b16 v[182:183], v220 offset:20480
v_cvt_pk_bf16_f32 v91, v126, v127
v_mfma_f32_16x16x32_bf16 a[36:39], v[192:195], v[160:163], a[36:39]
v_exp_f32 v112, v24
v_mfma_f32_16x16x32_bf16 a[4:7], v[192:195], v[152:155], a[4:7]
v_exp_f32 v113, v25
v_mfma_f32_16x16x32_bf16 a[4:7], v[188:191], v[148:151], a[4:7]
ds_read_b64_tr_b16 v[192:193], v221 offset:24576
s_waitcnt lgkmcnt(15)
v_mfma_f32_16x16x32_bf16 a[8:11], v[196:199], v[148:151], a[8:11]
ds_read_b64_tr_b16 v[194:195], v221 offset:28672
v_cvt_pk_bf16_f32 v96, v112, v113
v_mfma_f32_16x16x32_bf16 a[8:11], v[200:203], v[152:155], a[8:11]
v_exp_f32 v114, v26
v_mfma_f32_16x16x32_bf16 a[40:43], v[200:203], v[160:163], a[40:43]
v_exp_f32 v115, v27
v_mfma_f32_16x16x32_bf16 a[40:43], v[196:199], v[156:159], a[40:43]
ds_read_b64_tr_b16 v[188:189], v221 offset:16384
v_cvt_pk_bf16_f32 v97, v114, v115
v_mfma_f32_16x16x32_bf16 a[72:75], v[196:199], v[164:167], a[72:75]
v_exp_f32 v116, v40
v_mfma_f32_16x16x32_bf16 a[72:75], v[200:203], v[168:171], a[72:75]
ds_read_b64_tr_b16 v[190:191], v221 offset:20480
v_lshlrev_b32 v2, 4, v0
v_mfma_f32_16x16x32_bf16 a[104:107], v[200:203], v[176:179], a[104:107]
v_exp_f32 v117, v41
v_mfma_f32_16x16x32_bf16 a[104:107], v[196:199], v[172:175], a[104:107]
ds_read_b64_tr_b16 v[200:201], v222 offset:24576
v_cvt_pk_bf16_f32 v98, v116, v117
v_mfma_f32_16x16x32_bf16 a[108:111], v[204:207], v[172:175], a[108:111]
v_exp_f32 v118, v42
v_mfma_f32_16x16x32_bf16 a[108:111], v[208:211], v[176:179], a[108:111]
v_exp_f32 v119, v43
v_mfma_f32_16x16x32_bf16 a[76:79], v[208:211], v[168:171], a[76:79]
ds_read_b64_tr_b16 v[202:203], v222 offset:28672
v_cvt_pk_bf16_f32 v99, v118, v119
v_mfma_f32_16x16x32_bf16 a[76:79], v[204:207], v[164:167], a[76:79]
v_exp_f32 v120, v28
v_mfma_f32_16x16x32_bf16 a[44:47], v[204:207], v[156:159], a[44:47]
v_exp_f32 v121, v29
v_mfma_f32_16x16x32_bf16 a[44:47], v[208:211], v[160:163], a[44:47]
ds_read_b64_tr_b16 v[196:197], v222 offset:16384
v_cvt_pk_bf16_f32 v104, v120, v121
v_mfma_f32_16x16x32_bf16 a[12:15], v[208:211], v[152:155], a[12:15]
ds_read_b64_tr_b16 v[198:199], v222 offset:20480
ds_read_b64_tr_b16 v[208:209], v223 offset:24576
v_mfma_f32_16x16x32_bf16 a[12:15], v[204:207], v[148:151], a[12:15]
v_exp_f32 v122, v30
v_smfmac_f32_16x16x64_bf16 a[224:227], v[144:147], v[148:155], v254
v_exp_f32 v123, v31
v_smfmac_f32_16x16x64_bf16 a[228:231], v[144:147], v[156:163], v254
ds_read_b64_tr_b16 v[210:211], v223 offset:28672
ds_read_b64_tr_b16 v[204:205], v223 offset:16384
ds_read_b64_tr_b16 v[206:207], v223 offset:20480
v_exp_f32 v124, v44
v_exp_f32 v125, v45
v_exp_f32 v126, v46
v_exp_f32 v127, v47
s_nop 0
v_cvt_pk_bf16_f32 v105, v122, v123
v_cvt_pk_bf16_f32 v106, v124, v125
v_cvt_pk_bf16_f32 v107, v126, v127
s_waitcnt lgkmcnt(15)
v_mfma_f32_16x16x32_bf16 v[16:19], a[192:195], a[128:131], v[128:131]
v_exp_f32 v112, v48
v_mfma_f32_16x16x32_bf16 v[16:19], a[196:199], a[132:135], v[16:19]
v_exp_f32 v113, v49
v_mfma_f32_16x16x32_bf16 v[16:19], a[200:203], a[136:139], v[16:19]
v_cvt_pk_bf16_f32 v84, v112, v113
v_add_u32 v2, s75, v2
v_mfma_f32_16x16x32_bf16 v[16:19], a[204:207], a[140:143], v[16:19]
buffer_load_dwordx4 v253, s[8:11], s69 offen offset:1024 sc1 lds
v_mfma_f32_16x16x32_bf16 v[20:23], a[204:207], a[156:159], v[132:135]
v_exp_f32 v114, v50
v_mfma_f32_16x16x32_bf16 v[20:23], a[200:203], a[152:155], v[20:23]
v_exp_f32 v115, v51
v_mfma_f32_16x16x32_bf16 v[20:23], a[196:199], a[148:151], v[20:23]
v_exp_f32 v116, v64
v_mfma_f32_16x16x32_bf16 v[20:23], a[192:195], a[144:147], v[20:23]
v_exp_f32 v117, v65
v_mfma_f32_16x16x32_bf16 v[24:27], a[192:195], a[160:163], v[136:139]
v_cvt_pk_bf16_f32 v85, v114, v115
v_cvt_pk_bf16_f32 v86, v116, v117
v_mfma_f32_16x16x32_bf16 v[24:27], a[196:199], a[164:167], v[24:27]
buffer_load_dwordx4 v253, s[8:11], s69 offen offset:2048 sc1 lds
v_mfma_f32_16x16x32_bf16 v[24:27], a[200:203], a[168:171], v[24:27]
v_exp_f32 v118, v66
v_mfma_f32_16x16x32_bf16 v[24:27], a[204:207], a[172:175], v[24:27]
v_exp_f32 v119, v67
v_mfma_f32_16x16x32_bf16 v[28:31], a[204:207], a[188:191], v[140:143]
ds_read_b128 a[204:207], v215 offset:57344
v_cvt_pk_bf16_f32 v87, v118, v119
v_mfma_f32_16x16x32_bf16 v[28:31], a[200:203], a[184:187], v[28:31]
v_exp_f32 v120, v52
v_mfma_f32_16x16x32_bf16 v[28:31], a[196:199], a[180:183], v[28:31]
v_exp_f32 v121, v53
v_mfma_f32_16x16x32_bf16 v[28:31], a[192:195], a[176:179], v[28:31]
ds_read_b128 a[200:203], v214 offset:57344
v_cvt_pk_bf16_f32 v92, v120, v121
v_mfma_f32_16x16x32_bf16 v[44:47], a[208:211], a[176:179], v[140:143]
buffer_atomic_add v255, v252, s[32:35], 0 offen offset:4 sc1
v_mfma_f32_16x16x32_bf16 v[44:47], a[212:215], a[180:183], v[44:47]
v_exp_f32 v122, v54
v_mfma_f32_16x16x32_bf16 v[44:47], a[216:219], a[184:187], v[44:47]
v_exp_f32 v123, v55
v_mfma_f32_16x16x32_bf16 v[44:47], a[220:223], a[188:191], v[44:47]
ds_read_b128 a[196:199], v213 offset:57344
v_cvt_pk_bf16_f32 v93, v122, v123
v_mfma_f32_16x16x32_bf16 v[40:43], a[220:223], a[172:175], v[136:139]
v_exp_f32 v124, v68
v_mfma_f32_16x16x32_bf16 v[40:43], a[216:219], a[168:171], v[40:43]
ds_read_b128 a[192:195], v212 offset:57344
v_xor_b32 v3, 0x400, v2
v_mfma_f32_16x16x32_bf16 v[40:43], a[212:215], a[164:167], v[40:43]
v_add_u32 v4, 0x2000, v2
v_add_u32 v13, 0x2000, v3
v_mfma_f32_16x16x32_bf16 v[40:43], a[208:211], a[160:163], v[40:43]
buffer_load_dwordx4 v253, s[8:11], s69 offen offset:3072 sc1 lds
v_mfma_f32_16x16x32_bf16 v[36:39], a[208:211], a[144:147], v[132:135]
v_exp_f32 v125, v69
v_mfma_f32_16x16x32_bf16 v[36:39], a[212:215], a[148:151], v[36:39]
s_add_u32 s7, s7, s64
v_cvt_pk_bf16_f32 v94, v124, v125
v_mfma_f32_16x16x32_bf16 v[36:39], a[216:219], a[152:155], v[36:39]
v_exp_f32 v126, v70
v_mfma_f32_16x16x32_bf16 v[36:39], a[220:223], a[156:159], v[36:39]
v_exp_f32 v127, v71
v_mfma_f32_16x16x32_bf16 v[32:35], a[220:223], a[140:143], v[128:131]
ds_read_b128 a[220:223], v215 offset:61440
v_cvt_pk_bf16_f32 v95, v126, v127
v_mfma_f32_16x16x32_bf16 v[32:35], a[216:219], a[136:139], v[32:35]
buffer_store_dwordx4 v[232:235], v229, s[8:11], s44 offen offset:0 sc0 sc1
v_mfma_f32_16x16x32_bf16 v[32:35], a[212:215], a[132:135], v[32:35]
v_exp_f32 v112, v56
v_mfma_f32_16x16x32_bf16 v[32:35], a[208:211], a[128:131], v[32:35]
ds_read_b128 a[216:219], v214 offset:61440
s_waitcnt lgkmcnt(15)
v_mfma_f32_16x16x32_bf16 a[16:19], v[180:183], v[148:151], a[16:19]
v_exp_f32 v113, v57
v_mfma_f32_16x16x32_bf16 a[16:19], v[184:187], v[152:155], a[16:19]
ds_read_b128 a[212:215], v213 offset:61440
v_cvt_pk_bf16_f32 v100, v112, v113
v_mfma_f32_16x16x32_bf16 a[48:51], v[184:187], v[160:163], a[48:51]
v_exp_f32 v114, v58
v_mfma_f32_16x16x32_bf16 a[48:51], v[180:183], v[156:159], a[48:51]
ds_read_b128 a[208:211], v212 offset:61440
s_xor_b32 s69, s7, s46
v_mfma_f32_16x16x32_bf16 a[80:83], v[180:183], v[164:167], a[80:83]
s_add_u32 m0, s57, 0
v_mfma_f32_16x16x32_bf16 a[80:83], v[184:187], v[168:171], a[80:83]
buffer_load_dwordx4 v253, s[8:11], s69 offen offset:0 sc1 lds
v_mfma_f32_16x16x32_bf16 a[112:115], v[184:187], v[176:179], a[112:115]
v_exp_f32 v115, v59
v_mfma_f32_16x16x32_bf16 a[112:115], v[180:183], v[172:175], a[112:115]
ds_read_b64_tr_b16 v[184:185], v216 offset:40960
s_waitcnt lgkmcnt(15)
v_mfma_f32_16x16x32_bf16 a[116:119], v[188:191], v[172:175], a[116:119]
ds_read_b64_tr_b16 v[186:187], v216 offset:45056
v_cvt_pk_bf16_f32 v101, v114, v115
v_mfma_f32_16x16x32_bf16 a[116:119], v[192:195], v[176:179], a[116:119]
ds_read_b64_tr_b16 v[180:181], v216 offset:32768
ds_read_b64_tr_b16 v[182:183], v216 offset:36864
v_mfma_f32_16x16x32_bf16 a[84:87], v[192:195], v[168:171], a[84:87]
buffer_load_dwordx4 v253, s[8:11], s69 offen offset:1024 sc1 lds
v_mfma_f32_16x16x32_bf16 a[84:87], v[188:191], v[164:167], a[84:87]
v_exp_f32 v116, v72
v_mfma_f32_16x16x32_bf16 a[52:55], v[188:191], v[156:159], a[52:55]
v_exp_f32 v117, v73
v_mfma_f32_16x16x32_bf16 a[52:55], v[192:195], v[160:163], a[52:55]
v_exp_f32 v118, v74
v_mfma_f32_16x16x32_bf16 a[20:23], v[192:195], v[152:155], a[20:23]
ds_read_b64_tr_b16 v[192:193], v217 offset:40960
v_cvt_pk_bf16_f32 v102, v116, v117
v_mfma_f32_16x16x32_bf16 a[20:23], v[188:191], v[148:151], a[20:23]
ds_read_b64_tr_b16 v[194:195], v217 offset:45056
s_waitcnt lgkmcnt(15)
v_mfma_f32_16x16x32_bf16 a[24:27], v[196:199], v[148:151], a[24:27]
ds_read_b64_tr_b16 v[188:189], v217 offset:32768
ds_read_b64_tr_b16 v[190:191], v217 offset:36864
v_mfma_f32_16x16x32_bf16 a[24:27], v[200:203], v[152:155], a[24:27]
buffer_store_dwordx4 v[236:239], v229, s[8:11], s44 offen offset:1024 sc0 sc1
v_mfma_f32_16x16x32_bf16 a[56:59], v[200:203], v[160:163], a[56:59]
v_exp_f32 v119, v75
v_mfma_f32_16x16x32_bf16 a[56:59], v[196:199], v[156:159], a[56:59]
v_exp_f32 v120, v60
v_mfma_f32_16x16x32_bf16 a[88:91], v[196:199], v[164:167], a[88:91]
v_exp_f32 v121, v61
v_mfma_f32_16x16x32_bf16 a[88:91], v[200:203], v[168:171], a[88:91]
v_cvt_pk_bf16_f32 v103, v118, v119
v_cvt_pk_bf16_f32 v108, v120, v121
v_mfma_f32_16x16x32_bf16 a[120:123], v[200:203], v[176:179], a[120:123]
v_exp_f32 v122, v62
v_mfma_f32_16x16x32_bf16 a[120:123], v[196:199], v[172:175], a[120:123]
ds_read_b64_tr_b16 v[200:201], v218 offset:40960
s_waitcnt lgkmcnt(15)
v_mfma_f32_16x16x32_bf16 a[124:127], v[204:207], v[172:175], a[124:127]
buffer_load_dwordx4 v253, s[8:11], s69 offen offset:2048 sc1 lds
v_mfma_f32_16x16x32_bf16 a[124:127], v[208:211], v[176:179], a[124:127]
v_exp_f32 v123, v63
v_mfma_f32_16x16x32_bf16 a[92:95], v[208:211], v[168:171], a[92:95]
ds_read_b64_tr_b16 v[202:203], v218 offset:45056
v_cvt_pk_bf16_f32 v109, v122, v123
v_mfma_f32_16x16x32_bf16 a[92:95], v[204:207], v[164:167], a[92:95]
v_exp_f32 v124, v76
v_mfma_f32_16x16x32_bf16 a[60:63], v[204:207], v[156:159], a[60:63]
v_exp_f32 v125, v77
v_mfma_f32_16x16x32_bf16 a[60:63], v[208:211], v[160:163], a[60:63]
ds_read_b64_tr_b16 v[196:197], v218 offset:32768
v_cvt_pk_bf16_f32 v110, v124, v125
v_mfma_f32_16x16x32_bf16 a[28:31], v[208:211], v[152:155], a[28:31]
buffer_load_dwordx4 v253, s[8:11], s69 offen offset:3072 sc1 lds
v_mfma_f32_16x16x32_bf16 a[28:31], v[204:207], v[148:151], a[28:31]
ds_read_b64_tr_b16 v[198:199], v218 offset:36864
s_add_u32 s7, s7, s64
v_smfmac_f32_16x16x64_bf16 a[232:235], v[144:147], v[164:171], v254
v_exp_f32 v126, v78
v_smfmac_f32_16x16x64_bf16 a[236:239], v[144:147], v[172:179], v254
ds_read_b64_tr_b16 v[208:209], v219 offset:40960
ds_read_b64_tr_b16 v[210:211], v219 offset:45056
ds_read_b64_tr_b16 v[204:205], v219 offset:32768
ds_read_b64_tr_b16 v[206:207], v219 offset:36864
v_exp_f32 v127, v79
s_nop 0
v_cvt_pk_bf16_f32 v111, v126, v127
s_waitcnt vmcnt(28) lgkmcnt(15)
s_barrier
v_mfma_f32_16x16x32_bf16 v[48:51], a[192:195], a[128:131], v[128:131]
v_exp_f32 v112, v16
v_mfma_f32_16x16x32_bf16 v[48:51], a[196:199], a[132:135], v[48:51]
s_xor_b32 s69, s7, s46
s_add_u32 m0, s57, 147456
v_mfma_f32_16x16x32_bf16 v[48:51], a[200:203], a[136:139], v[48:51]
buffer_load_dwordx4 v253, s[8:11], s69 offen offset:0 sc1 lds
v_mfma_f32_16x16x32_bf16 v[48:51], a[204:207], a[140:143], v[48:51]
v_mfma_f32_16x16x32_bf16 v[52:55], a[204:207], a[156:159], v[132:135]
buffer_atomic_add v255, v252, s[32:35], 0 offen offset:4 sc1
v_mfma_f32_16x16x32_bf16 v[52:55], a[200:203], a[152:155], v[52:55]
v_mfma_f32_16x16x32_bf16 v[52:55], a[196:199], a[148:151], v[52:55]
buffer_load_dwordx4 v253, s[8:11], s69 offen offset:1024 sc1 lds
v_mfma_f32_16x16x32_bf16 v[52:55], a[192:195], a[144:147], v[52:55]
v_exp_f32 v113, v17
v_mfma_f32_16x16x32_bf16 v[56:59], a[192:195], a[160:163], v[136:139]
v_exp_f32 v114, v18
v_mfma_f32_16x16x32_bf16 v[56:59], a[196:199], a[164:167], v[56:59]
v_cvt_pk_bf16_f32 v148, v112, v113
v_mfma_f32_16x16x32_bf16 v[56:59], a[200:203], a[168:171], v[56:59]
buffer_load_dwordx4 v253, s[8:11], s69 offen offset:2048 sc1 lds
v_mfma_f32_16x16x32_bf16 v[56:59], a[204:207], a[172:175], v[56:59]
v_exp_f32 v115, v19
v_mfma_f32_16x16x32_bf16 v[60:63], a[204:207], a[188:191], v[140:143]
v_exp_f32 v116, v32
v_mfma_f32_16x16x32_bf16 v[60:63], a[200:203], a[184:187], v[60:63]
v_cvt_pk_bf16_f32 v149, v114, v115
v_mfma_f32_16x16x32_bf16 v[60:63], a[196:199], a[180:183], v[60:63]
buffer_load_dwordx4 v253, s[8:11], s69 offen offset:3072 sc1 lds
v_mfma_f32_16x16x32_bf16 v[60:63], a[192:195], a[176:179], v[60:63]
v_exp_f32 v117, v33
v_mfma_f32_16x16x32_bf16 v[76:79], a[208:211], a[176:179], v[140:143]
s_add_u32 s7, s7, s64
v_cvt_pk_bf16_f32 v150, v116, v117
v_mfma_f32_16x16x32_bf16 v[76:79], a[212:215], a[180:183], v[76:79]
s_xor_b32 s69, s7, s46
s_add_u32 m0, s57, 16384
v_mfma_f32_16x16x32_bf16 v[76:79], a[216:219], a[184:187], v[76:79]
buffer_load_dwordx4 v253, s[8:11], s69 offen offset:0 sc1 lds
v_mfma_f32_16x16x32_bf16 v[76:79], a[220:223], a[188:191], v[76:79]
v_exp_f32 v118, v34
v_mfma_f32_16x16x32_bf16 v[72:75], a[220:223], a[172:175], v[136:139]
v_exp_f32 v119, v35
v_mfma_f32_16x16x32_bf16 v[72:75], a[216:219], a[168:171], v[72:75]
v_cvt_pk_bf16_f32 v151, v118, v119
v_mfma_f32_16x16x32_bf16 v[72:75], a[212:215], a[164:167], v[72:75]
buffer_load_dwordx4 v253, s[8:11], s69 offen offset:1024 sc1 lds
v_mfma_f32_16x16x32_bf16 v[72:75], a[208:211], a[160:163], v[72:75]
v_exp_f32 v120, v20
v_mfma_f32_16x16x32_bf16 v[68:71], a[208:211], a[144:147], v[132:135]
v_exp_f32 v121, v21
v_mfma_f32_16x16x32_bf16 v[68:71], a[212:215], a[148:151], v[68:71]
v_cvt_pk_bf16_f32 v156, v120, v121
v_mfma_f32_16x16x32_bf16 v[68:71], a[216:219], a[152:155], v[68:71]
buffer_load_dwordx4 v253, s[8:11], s69 offen offset:2048 sc1 lds
v_mfma_f32_16x16x32_bf16 v[68:71], a[220:223], a[156:159], v[68:71]
v_exp_f32 v122, v22
v_mfma_f32_16x16x32_bf16 v[64:67], a[220:223], a[140:143], v[128:131]
v_exp_f32 v123, v23
v_mfma_f32_16x16x32_bf16 v[64:67], a[216:219], a[136:139], v[64:67]
v_cvt_pk_bf16_f32 v157, v122, v123
v_mfma_f32_16x16x32_bf16 v[64:67], a[212:215], a[132:135], v[64:67]
buffer_load_dwordx4 v253, s[8:11], s69 offen offset:3072 sc1 lds
v_mfma_f32_16x16x32_bf16 v[64:67], a[208:211], a[128:131], v[64:67]
s_add_u32 s7, s7, s64
s_waitcnt lgkmcnt(12)
v_mfma_f32_16x16x32_bf16 a[0:3], v[180:183], v[80:83], a[0:3]
s_xor_b32 s68, s6, s46
v_mfma_f32_16x16x32_bf16 a[0:3], v[184:187], v[84:87], a[0:3]
buffer_load_dwordx4 a[192:195], v2, s[92:95], s68 offen sc1
v_mfma_f32_16x16x32_bf16 a[32:35], v[184:187], v[92:95], a[32:35]
v_exp_f32 v124, v36
v_mfma_f32_16x16x32_bf16 a[32:35], v[180:183], v[88:91], a[32:35]
v_exp_f32 v125, v37
v_mfma_f32_16x16x32_bf16 a[64:67], v[180:183], v[96:99], a[64:67]
v_cvt_pk_bf16_f32 v158, v124, v125
v_mfma_f32_16x16x32_bf16 a[64:67], v[184:187], v[100:103], a[64:67]
buffer_load_dwordx4 a[196:199], v3, s[92:95], s68 offen sc1
v_mfma_f32_16x16x32_bf16 a[96:99], v[184:187], v[108:111], a[96:99]
v_exp_f32 v126, v38
v_mfma_f32_16x16x32_bf16 a[96:99], v[180:183], v[104:107], a[96:99]
ds_read_b64_tr_b16 v[184:185], v220 offset:40960
s_waitcnt lgkmcnt(9)
v_mfma_f32_16x16x32_bf16 a[100:103], v[188:191], v[104:107], a[100:103]
ds_read_b64_tr_b16 v[186:187], v220 offset:45056
ds_read_b64_tr_b16 v[180:181], v220 offset:32768
v_mfma_f32_16x16x32_bf16 a[100:103], v[192:195], v[108:111], a[100:103]
buffer_load_dwordx4 a[200:203], v4, s[92:95], s68 offen sc1
v_mfma_f32_16x16x32_bf16 a[68:71], v[192:195], v[100:103], a[68:71]
v_exp_f32 v127, v39
v_mfma_f32_16x16x32_bf16 a[68:71], v[188:191], v[96:99], a[68:71]
ds_read_b64_tr_b16 v[182:183], v220 offset:36864
v_cvt_pk_bf16_f32 v159, v126, v127
v_mfma_f32_16x16x32_bf16 a[36:39], v[188:191], v[88:91], a[36:39]
v_mfma_f32_16x16x32_bf16 a[36:39], v[192:195], v[92:95], a[36:39]
buffer_load_dwordx4 a[204:207], v13, s[92:95], s68 offen sc1
v_mfma_f32_16x16x32_bf16 a[4:7], v[192:195], v[84:87], a[4:7]
ds_read_b64_tr_b16 v[192:193], v221 offset:40960
s_add_u32 s6, s6, s64
v_mfma_f32_16x16x32_bf16 a[4:7], v[188:191], v[80:83], a[4:7]
ds_read_b64_tr_b16 v[194:195], v221 offset:45056
s_waitcnt lgkmcnt(10)
v_mfma_f32_16x16x32_bf16 a[8:11], v[196:199], v[80:83], a[8:11]
ds_read_b64_tr_b16 v[188:189], v221 offset:32768
s_xor_b32 s68, s6, s46
v_mfma_f32_16x16x32_bf16 a[8:11], v[200:203], v[84:87], a[8:11]
buffer_load_dwordx4 a[208:211], v2, s[92:95], s68 offen sc1
v_mfma_f32_16x16x32_bf16 a[40:43], v[200:203], v[92:95], a[40:43]
ds_read_b64_tr_b16 v[190:191], v221 offset:36864
v_mfma_f32_16x16x32_bf16 a[40:43], v[196:199], v[88:91], a[40:43]
buffer_atomic_add v255, v252, s[32:35], 0 offen offset:4 sc1
v_mfma_f32_16x16x32_bf16 a[72:75], v[196:199], v[96:99], a[72:75]
v_mfma_f32_16x16x32_bf16 a[72:75], v[200:203], v[100:103], a[72:75]
buffer_load_dwordx4 a[212:215], v3, s[92:95], s68 offen sc1
v_mfma_f32_16x16x32_bf16 a[104:107], v[200:203], v[108:111], a[104:107]
v_exp_f32 v112, v24
v_mfma_f32_16x16x32_bf16 a[104:107], v[196:199], v[104:107], a[104:107]
ds_read_b64_tr_b16 v[200:201], v222 offset:40960
s_waitcnt lgkmcnt(9)
v_mfma_f32_16x16x32_bf16 a[108:111], v[204:207], v[104:107], a[108:111]
v_exp_f32 v113, v25
v_mfma_f32_16x16x32_bf16 a[108:111], v[208:211], v[108:111], a[108:111]
ds_read_b64_tr_b16 v[202:203], v222 offset:45056
v_cvt_pk_bf16_f32 v164, v112, v113
v_mfma_f32_16x16x32_bf16 a[76:79], v[208:211], v[100:103], a[76:79]
v_exp_f32 v114, v26
v_mfma_f32_16x16x32_bf16 a[76:79], v[204:207], v[96:99], a[76:79]
v_exp_f32 v115, v27
v_mfma_f32_16x16x32_bf16 a[44:47], v[204:207], v[88:91], a[44:47]
ds_read_b64_tr_b16 v[196:197], v222 offset:32768
v_cvt_pk_bf16_f32 v165, v114, v115
v_mfma_f32_16x16x32_bf16 a[44:47], v[208:211], v[92:95], a[44:47]
ds_read_b64_tr_b16 v[198:199], v222 offset:36864
v_mfma_f32_16x16x32_bf16 a[12:15], v[208:211], v[84:87], a[12:15]
v_exp_f32 v116, v40
v_mfma_f32_16x16x32_bf16 a[12:15], v[204:207], v[80:83], a[12:15]
v_exp_f32 v117, v41
v_smfmac_f32_16x16x64_bf16 a[224:227], v[144:147], v[80:87], v254
ds_read_b64_tr_b16 v[208:209], v223 offset:40960
v_cvt_pk_bf16_f32 v166, v116, v117
v_smfmac_f32_16x16x64_bf16 a[228:231], v[144:147], v[88:95], v254
ds_read_b64_tr_b16 v[210:211], v223 offset:45056
ds_read_b64_tr_b16 v[204:205], v223 offset:32768
ds_read_b64_tr_b16 v[206:207], v223 offset:36864
v_exp_f32 v118, v42
v_exp_f32 v119, v43
v_exp_f32 v120, v28
v_exp_f32 v121, v29
s_nop 0
v_cvt_pk_bf16_f32 v167, v118, v119
v_cvt_pk_bf16_f32 v172, v120, v121
v_exp_f32 v122, v30
v_exp_f32 v123, v31
v_exp_f32 v124, v44
v_exp_f32 v125, v45
s_nop 0
v_cvt_pk_bf16_f32 v173, v122, v123
v_cvt_pk_bf16_f32 v174, v124, v125
v_exp_f32 v126, v46
v_exp_f32 v127, v47
s_nop 0
v_cvt_pk_bf16_f32 v175, v126, v127
s_waitcnt lgkmcnt(12)
v_mfma_f32_16x16x32_bf16 a[16:19], v[180:183], v[80:83], a[16:19]
v_exp_f32 v112, v48
v_mfma_f32_16x16x32_bf16 a[16:19], v[184:187], v[84:87], a[16:19]
v_exp_f32 v113, v49
v_mfma_f32_16x16x32_bf16 a[48:51], v[184:187], v[92:95], a[48:51]
v_exp_f32 v114, v50
v_mfma_f32_16x16x32_bf16 a[48:51], v[180:183], v[88:91], a[48:51]
v_exp_f32 v115, v51
v_mfma_f32_16x16x32_bf16 a[80:83], v[180:183], v[96:99], a[80:83]
v_cvt_pk_bf16_f32 v152, v112, v113
v_cvt_pk_bf16_f32 v153, v114, v115
v_mfma_f32_16x16x32_bf16 a[80:83], v[184:187], v[100:103], a[80:83]
v_exp_f32 v116, v64
v_mfma_f32_16x16x32_bf16 a[112:115], v[184:187], v[108:111], a[112:115]
v_exp_f32 v117, v65
v_mfma_f32_16x16x32_bf16 a[112:115], v[180:183], v[104:107], a[112:115]
ds_read_b64_tr_b16 v[184:185], v216 offset:57344
s_waitcnt lgkmcnt(9)
v_mfma_f32_16x16x32_bf16 a[116:119], v[188:191], v[104:107], a[116:119]
buffer_load_dwordx4 a[216:219], v4, s[92:95], s68 offen sc1
v_mfma_f32_16x16x32_bf16 a[116:119], v[192:195], v[108:111], a[116:119]
ds_read_b64_tr_b16 v[186:187], v216 offset:61440
v_cvt_pk_bf16_f32 v154, v116, v117
v_mfma_f32_16x16x32_bf16 a[84:87], v[192:195], v[100:103], a[84:87]
v_exp_f32 v118, v66
v_mfma_f32_16x16x32_bf16 a[84:87], v[188:191], v[96:99], a[84:87]
v_exp_f32 v119, v67
v_mfma_f32_16x16x32_bf16 a[52:55], v[188:191], v[88:91], a[52:55]
ds_read_b64_tr_b16 v[180:181], v216 offset:49152
v_cvt_pk_bf16_f32 v155, v118, v119
v_mfma_f32_16x16x32_bf16 a[52:55], v[192:195], v[92:95], a[52:55]
ds_read_b64_tr_b16 v[182:183], v216 offset:53248
v_mfma_f32_16x16x32_bf16 a[20:23], v[192:195], v[84:87], a[20:23]
v_exp_f32 v120, v52
v_mfma_f32_16x16x32_bf16 a[20:23], v[188:191], v[80:83], a[20:23]
ds_read_b64_tr_b16 v[192:193], v217 offset:57344
s_waitcnt lgkmcnt(9)
v_mfma_f32_16x16x32_bf16 a[24:27], v[196:199], v[80:83], a[24:27]
v_exp_f32 v121, v53
v_mfma_f32_16x16x32_bf16 a[24:27], v[200:203], v[84:87], a[24:27]
ds_read_b64_tr_b16 v[194:195], v217 offset:61440
v_cvt_pk_bf16_f32 v160, v120, v121
v_mfma_f32_16x16x32_bf16 a[56:59], v[200:203], v[92:95], a[56:59]
v_exp_f32 v122, v54
v_mfma_f32_16x16x32_bf16 a[56:59], v[196:199], v[88:91], a[56:59]
v_exp_f32 v123, v55
v_mfma_f32_16x16x32_bf16 a[88:91], v[196:199], v[96:99], a[88:91]
ds_read_b64_tr_b16 v[188:189], v217 offset:49152
v_cvt_pk_bf16_f32 v161, v122, v123
v_mfma_f32_16x16x32_bf16 a[88:91], v[200:203], v[100:103], a[88:91]
ds_read_b64_tr_b16 v[190:191], v217 offset:53248
v_mfma_f32_16x16x32_bf16 a[120:123], v[200:203], v[108:111], a[120:123]
v_exp_f32 v124, v68
v_mfma_f32_16x16x32_bf16 a[120:123], v[196:199], v[104:107], a[120:123]
ds_read_b64_tr_b16 v[200:201], v218 offset:57344
s_waitcnt lgkmcnt(9)
v_mfma_f32_16x16x32_bf16 a[124:127], v[204:207], v[104:107], a[124:127]
ds_read_b64_tr_b16 v[202:203], v218 offset:61440
ds_read_b64_tr_b16 v[196:197], v218 offset:49152
v_mfma_f32_16x16x32_bf16 a[124:127], v[208:211], v[108:111], a[124:127]
buffer_load_dwordx4 a[220:223], v13, s[92:95], s68 offen sc1
v_mfma_f32_16x16x32_bf16 a[92:95], v[208:211], v[100:103], a[92:95]
ds_read_b64_tr_b16 v[198:199], v218 offset:53248
s_add_u32 s6, s6, s64
v_mfma_f32_16x16x32_bf16 a[92:95], v[204:207], v[96:99], a[92:95]
v_exp_f32 v125, v69
v_mfma_f32_16x16x32_bf16 a[60:63], v[204:207], v[88:91], a[60:63]
v_exp_f32 v126, v70
v_mfma_f32_16x16x32_bf16 a[60:63], v[208:211], v[92:95], a[60:63]
v_exp_f32 v127, v71
v_mfma_f32_16x16x32_bf16 a[28:31], v[208:211], v[84:87], a[28:31]
ds_read_b64_tr_b16 v[208:209], v219 offset:57344
v_cvt_pk_bf16_f32 v162, v124, v125
v_mfma_f32_16x16x32_bf16 a[28:31], v[204:207], v[80:83], a[28:31]
ds_read_b64_tr_b16 v[210:211], v219 offset:61440
v_cvt_pk_bf16_f32 v163, v126, v127
v_smfmac_f32_16x16x64_bf16 a[232:235], v[144:147], v[96:103], v254
v_exp_f32 v112, v56
v_smfmac_f32_16x16x64_bf16 a[236:239], v[144:147], v[104:111], v254
ds_read_b64_tr_b16 v[204:205], v219 offset:49152
ds_read_b64_tr_b16 v[206:207], v219 offset:53248
v_exp_f32 v113, v57
v_exp_f32 v114, v58
v_exp_f32 v115, v59
v_exp_f32 v116, v72
s_nop 0
v_cvt_pk_bf16_f32 v168, v112, v113
v_cvt_pk_bf16_f32 v169, v114, v115
v_exp_f32 v117, v73
v_exp_f32 v118, v74
v_exp_f32 v119, v75
v_exp_f32 v120, v60
s_nop 0
v_cvt_pk_bf16_f32 v170, v116, v117
v_cvt_pk_bf16_f32 v171, v118, v119
v_exp_f32 v121, v61
v_exp_f32 v122, v62
v_exp_f32 v123, v63
v_exp_f32 v124, v76
s_nop 0
v_cvt_pk_bf16_f32 v176, v120, v121
v_cvt_pk_bf16_f32 v177, v122, v123
v_exp_f32 v125, v77
v_exp_f32 v126, v78
v_exp_f32 v127, v79
s_nop 0
v_cvt_pk_bf16_f32 v178, v124, v125
v_cvt_pk_bf16_f32 v179, v126, v127
v_smfmac_f32_16x16x64_bf16 a[224:227], v[144:147], v[148:155], v254
s_xor_b32 s68, s6, s46
v_smfmac_f32_16x16x64_bf16 a[228:231], v[144:147], v[156:163], v254
buffer_load_dwordx4 a[128:131], v2, s[92:95], s68 offen sc1
v_smfmac_f32_16x16x64_bf16 a[232:235], v[144:147], v[164:171], v254
v_smfmac_f32_16x16x64_bf16 a[236:239], v[144:147], v[172:179], v254
s_waitcnt lgkmcnt(12)
v_mfma_f32_16x16x32_bf16 a[0:3], v[180:183], v[148:151], a[0:3]
v_mfma_f32_16x16x32_bf16 a[0:3], v[184:187], v[152:155], a[0:3]
buffer_load_dwordx4 a[132:135], v3, s[92:95], s68 offen sc1
v_mfma_f32_16x16x32_bf16 a[32:35], v[184:187], v[160:163], a[32:35]
v_mfma_f32_16x16x32_bf16 a[32:35], v[180:183], v[156:159], a[32:35]
v_mfma_f32_16x16x32_bf16 a[64:67], v[180:183], v[164:167], a[64:67]
v_accvgpr_read_b32 v224, a224
v_accvgpr_read_b32 v225, a228
v_accvgpr_read_b32 v226, a232
v_accvgpr_read_b32 v227, a236
v_mfma_f32_16x16x32_bf16 a[64:67], v[184:187], v[168:171], a[64:67]
buffer_atomic_add v255, v252, s[32:35], 0 offen offset:4 sc1
v_mfma_f32_16x16x32_bf16 a[96:99], v[184:187], v[176:179], a[96:99]
ds_read_b64_tr_b16 v[184:185], v220 offset:57344
ds_read_b64_tr_b16 v[186:187], v220 offset:61440
v_accvgpr_read_b32 v228, a225
v_accvgpr_read_b32 v229, a229
v_mfma_f32_16x16x32_bf16 a[96:99], v[180:183], v[172:175], a[96:99]
ds_read_b64_tr_b16 v[180:181], v220 offset:49152
v_accvgpr_read_b32 v230, a233
v_accvgpr_read_b32 v231, a237
s_waitcnt lgkmcnt(11)
v_mfma_f32_16x16x32_bf16 a[100:103], v[188:191], v[172:175], a[100:103]
buffer_load_dwordx4 a[136:139], v4, s[92:95], s68 offen sc1
v_mfma_f32_16x16x32_bf16 a[100:103], v[192:195], v[176:179], a[100:103]
ds_read_b64_tr_b16 v[182:183], v220 offset:53248
v_add_f32 v224, v224, v228
v_add_f32 v225, v225, v229
v_add_f32 v226, v226, v230
v_mfma_f32_16x16x32_bf16 a[68:71], v[192:195], v[168:171], a[68:71]
v_add_f32 v227, v227, v231
v_rcp_f32 v244, v224
v_rcp_f32 v245, v225
v_rcp_f32 v246, v226
v_mfma_f32_16x16x32_bf16 a[68:71], v[188:191], v[164:167], a[68:71]
v_rcp_f32 v247, v227
v_lshlrev_b32 v144, 4, v0
v_add_u32 v248, 98304, v144
v_mfma_f32_16x16x32_bf16 a[36:39], v[188:191], v[156:159], a[36:39]
buffer_load_dwordx4 a[140:143], v13, s[92:95], s68 offen sc1
v_mfma_f32_16x16x32_bf16 a[36:39], v[192:195], v[160:163], a[36:39]
s_add_u32 s6, s6, s64
s_waitcnt vmcnt(43)
v_readfirstlane_b32 s80, v9
v_readfirstlane_b32 s83, v8
v_mfma_f32_16x16x32_bf16 a[4:7], v[192:195], v[152:155], a[4:7]
ds_read_b64_tr_b16 v[192:193], v221 offset:57344
s_xor_b32 s68, s6, s46
s_lshl_b32 s77, s72, 3
s_xor_b32 s77, s77, 0x80008
v_mfma_f32_16x16x32_bf16 a[4:7], v[188:191], v[148:151], a[4:7]
ds_read_b64_tr_b16 v[194:195], v221 offset:61440
s_bfe_u32 s80, s80, s77
s_min_u32 s80, s80, 14
s_waitcnt lgkmcnt(10)
v_mfma_f32_16x16x32_bf16 a[8:11], v[196:199], v[148:151], a[8:11]
buffer_load_dwordx4 a[144:147], v2, s[92:95], s68 offen sc1
v_mfma_f32_16x16x32_bf16 a[8:11], v[200:203], v[152:155], a[8:11]
ds_read_b64_tr_b16 v[188:189], v221 offset:49152
ds_read_b64_tr_b16 v[190:191], v221 offset:53248
s_sub_u32 s77, 28, s80
s_add_u32 s80, s80, 28
v_mfma_f32_16x16x32_bf16 a[40:43], v[200:203], v[160:163], a[40:43]
s_cmp_eq_u32 s72, 0
s_cselect_b32 s80, s77, s80
v_mov_b32 v117, s80
v_mfma_f32_16x16x32_bf16 a[40:43], v[196:199], v[156:159], a[40:43]
buffer_load_dwordx4 a[148:151], v3, s[92:95], s68 offen sc1
v_mfma_f32_16x16x32_bf16 a[72:75], v[196:199], v[164:167], a[72:75]
s_cmp_eq_u32 s83, 0
s_cselect_b32 s77, 1, s77
s_cselect_b32 s83, 0x40000000, 0
v_mfma_f32_16x16x32_bf16 a[72:75], v[200:203], v[168:171], a[72:75]
s_cmp_eq_u32 s81, 0
s_cselect_b32 s77, 0, s77
s_lshl_b32 s77, s77, 8
buffer_store_dword v117, v252, s[32:35], s83 offen offset:64 sc0 sc1
v_mfma_f32_16x16x32_bf16 a[104:107], v[200:203], v[176:179], a[104:107]
ds_read_b64_tr_b16 v[200:201], v222 offset:57344
ds_read_b64_tr_b16 v[202:203], v222 offset:61440
s_movk_i32 s20, 0x2000
v_accvgpr_read_b32 v48, a0
v_mfma_f32_16x16x32_bf16 a[104:107], v[196:199], v[172:175], a[104:107]
ds_read_b64_tr_b16 v[196:197], v222 offset:49152
v_accvgpr_read_b32 v49, a1
v_accvgpr_read_b32 v50, a2
s_waitcnt lgkmcnt(11)
v_mfma_f32_16x16x32_bf16 a[108:111], v[204:207], v[172:175], a[108:111]
buffer_load_dwordx4 a[152:155], v4, s[92:95], s68 offen sc1
v_mfma_f32_16x16x32_bf16 a[108:111], v[208:211], v[176:179], a[108:111]
ds_read_b64_tr_b16 v[198:199], v222 offset:53248
v_accvgpr_read_b32 v51, a3
v_accvgpr_read_b32 v52, a4
v_accvgpr_read_b32 v53, a5
v_mfma_f32_16x16x32_bf16 a[76:79], v[208:211], v[168:171], a[76:79]
buffer_load_dwordx4 a[156:159], v13, s[92:95], s68 offen sc1
v_mfma_f32_16x16x32_bf16 a[76:79], v[204:207], v[164:167], a[76:79]
s_add_u32 s6, s6, s64
v_accvgpr_read_b32 v54, a6
v_accvgpr_read_b32 v55, a7
v_mul_f32 v48, v48, v244
v_mfma_f32_16x16x32_bf16 a[44:47], v[204:207], v[156:159], a[44:47]
v_mul_f32 v49, v49, v244
v_mul_f32 v50, v50, v244
v_mul_f32 v51, v51, v244
v_mul_f32 v52, v52, v244
v_mfma_f32_16x16x32_bf16 a[44:47], v[208:211], v[160:163], a[44:47]
s_xor_b32 s68, s6, s46
v_mul_f32 v53, v53, v244
v_mul_f32 v54, v54, v244
v_mul_f32 v55, v55, v244
v_mfma_f32_16x16x32_bf16 a[12:15], v[208:211], v[152:155], a[12:15]
buffer_load_dwordx4 a[160:163], v2, s[92:95], s68 offen sc1
v_mfma_f32_16x16x32_bf16 a[12:15], v[204:207], v[148:151], a[12:15]
ds_read_b64_tr_b16 v[208:209], v223 offset:57344
v_cvt_pk_bf16_f32 v16, v48, v49
v_cvt_pk_bf16_f32 v17, v50, v51
ds_read_b64_tr_b16 v[210:211], v223 offset:61440
ds_read_b64_tr_b16 v[204:205], v223 offset:49152
ds_read_b64_tr_b16 v[206:207], v223 offset:53248
s_waitcnt lgkmcnt(12)
v_mfma_f32_16x16x32_bf16 a[16:19], v[180:183], v[148:151], a[16:19]
v_cvt_pk_bf16_f32 v18, v52, v53
v_cvt_pk_bf16_f32 v19, v54, v55
buffer_store_dwordx4 v[16:19], v5, s[36:39], 0 offen offset:0 sc0 sc1
v_accvgpr_read_b32 v56, a32
v_mfma_f32_16x16x32_bf16 a[16:19], v[184:187], v[152:155], a[16:19]
buffer_load_dwordx4 a[164:167], v3, s[92:95], s68 offen sc1
v_mfma_f32_16x16x32_bf16 a[48:51], v[184:187], v[160:163], a[48:51]
v_accvgpr_read_b32 v57, a33
v_accvgpr_read_b32 v58, a34
v_accvgpr_read_b32 v59, a35
v_accvgpr_read_b32 v60, a36
v_mfma_f32_16x16x32_bf16 a[48:51], v[180:183], v[156:159], a[48:51]
v_accvgpr_read_b32 v61, a37
v_accvgpr_read_b32 v62, a38
v_accvgpr_read_b32 v63, a39
v_mul_f32 v56, v56, v245
v_mfma_f32_16x16x32_bf16 a[80:83], v[180:183], v[164:167], a[80:83]
buffer_load_dwordx4 a[168:171], v4, s[92:95], s68 offen sc1
v_mfma_f32_16x16x32_bf16 a[80:83], v[184:187], v[168:171], a[80:83]
v_mul_f32 v57, v57, v245
v_mul_f32 v58, v58, v245
v_mul_f32 v59, v59, v245
v_mul_f32 v60, v60, v245
v_mfma_f32_16x16x32_bf16 a[112:115], v[184:187], v[176:179], a[112:115]
v_mul_f32 v61, v61, v245
v_mul_f32 v62, v62, v245
v_mul_f32 v63, v63, v245
v_cvt_pk_bf16_f32 v20, v56, v57
v_mfma_f32_16x16x32_bf16 a[112:115], v[180:183], v[172:175], a[112:115]
v_cvt_pk_bf16_f32 v21, v58, v59
v_cvt_pk_bf16_f32 v22, v60, v61
v_cvt_pk_bf16_f32 v23, v62, v63
s_waitcnt lgkmcnt(8)
v_mfma_f32_16x16x32_bf16 a[116:119], v[188:191], v[172:175], a[116:119]
buffer_load_dwordx4 a[172:175], v13, s[92:95], s68 offen sc1
v_mfma_f32_16x16x32_bf16 a[116:119], v[192:195], v[176:179], a[116:119]
s_add_u32 s6, s6, s64
buffer_store_dwordx4 v[20:23], v5, s[36:39], 0 offen offset:1024 sc0 sc1
v_accvgpr_read_b32 v64, a64
v_accvgpr_read_b32 v65, a65
v_mfma_f32_16x16x32_bf16 a[84:87], v[192:195], v[168:171], a[84:87]
buffer_atomic_add v255, v252, s[32:35], 0 offen offset:4 sc1
v_mfma_f32_16x16x32_bf16 a[84:87], v[188:191], v[164:167], a[84:87]
s_xor_b32 s68, s6, s46
v_accvgpr_read_b32 v66, a66
v_accvgpr_read_b32 v67, a67
v_accvgpr_read_b32 v68, a68
v_mfma_f32_16x16x32_bf16 a[52:55], v[188:191], v[156:159], a[52:55]
buffer_load_dwordx4 a[176:179], v2, s[92:95], s68 offen sc1
v_mfma_f32_16x16x32_bf16 a[52:55], v[192:195], v[160:163], a[52:55]
v_accvgpr_read_b32 v69, a69
v_accvgpr_read_b32 v70, a70
v_accvgpr_read_b32 v71, a71
v_mul_f32 v64, v64, v246
v_mfma_f32_16x16x32_bf16 a[20:23], v[192:195], v[152:155], a[20:23]
v_mul_f32 v65, v65, v246
v_mul_f32 v66, v66, v246
v_mul_f32 v67, v67, v246
v_mul_f32 v68, v68, v246
v_mfma_f32_16x16x32_bf16 a[20:23], v[188:191], v[148:151], a[20:23]
v_mul_f32 v69, v69, v246
v_mul_f32 v70, v70, v246
v_mul_f32 v71, v71, v246
s_waitcnt lgkmcnt(4)
v_mfma_f32_16x16x32_bf16 a[24:27], v[196:199], v[148:151], a[24:27]
buffer_load_dwordx4 a[180:183], v3, s[92:95], s68 offen sc1
v_mfma_f32_16x16x32_bf16 a[24:27], v[200:203], v[152:155], a[24:27]
v_cvt_pk_bf16_f32 v24, v64, v65
v_cvt_pk_bf16_f32 v25, v66, v67
v_cvt_pk_bf16_f32 v26, v68, v69
v_cvt_pk_bf16_f32 v27, v70, v71
v_mfma_f32_16x16x32_bf16 a[56:59], v[200:203], v[160:163], a[56:59]
buffer_load_dwordx4 a[184:187], v4, s[92:95], s68 offen sc1
v_mfma_f32_16x16x32_bf16 a[56:59], v[196:199], v[156:159], a[56:59]
buffer_store_dwordx4 v[24:27], v5, s[36:39], 0 offen offset:2048 sc0 sc1
v_accvgpr_read_b32 v72, a96
v_accvgpr_read_b32 v73, a97
v_accvgpr_read_b32 v74, a98
v_mfma_f32_16x16x32_bf16 a[88:91], v[196:199], v[164:167], a[88:91]
v_accvgpr_read_b32 v75, a99
v_accvgpr_read_b32 v76, a100
v_accvgpr_read_b32 v77, a101
v_accvgpr_read_b32 v78, a102
v_mfma_f32_16x16x32_bf16 a[88:91], v[200:203], v[168:171], a[88:91]
buffer_load_dwordx4 a[188:191], v13, s[92:95], s68 offen sc1
v_mfma_f32_16x16x32_bf16 a[120:123], v[200:203], v[176:179], a[120:123]
s_add_u32 s6, s6, s64
v_accvgpr_read_b32 v79, a103
v_mul_f32 v72, v72, v247
v_mul_f32 v73, v73, v247
v_mfma_f32_16x16x32_bf16 a[120:123], v[196:199], v[172:175], a[120:123]
v_mul_f32 v74, v74, v247
v_mul_f32 v75, v75, v247
v_mul_f32 v76, v76, v247
s_waitcnt lgkmcnt(0)
v_mfma_f32_16x16x32_bf16 a[124:127], v[204:207], v[172:175], a[124:127]
v_mul_f32 v77, v77, v247
v_mul_f32 v78, v78, v247
v_mul_f32 v79, v79, v247
v_cvt_pk_bf16_f32 v28, v72, v73
v_mfma_f32_16x16x32_bf16 a[124:127], v[208:211], v[176:179], a[124:127]
v_cvt_pk_bf16_f32 v29, v74, v75
v_cvt_pk_bf16_f32 v30, v76, v77
v_cvt_pk_bf16_f32 v31, v78, v79
buffer_store_dwordx4 v[28:31], v5, s[36:39], 0 offen offset:3072 sc0 sc1
v_mfma_f32_16x16x32_bf16 a[92:95], v[208:211], v[168:171], a[92:95]
v_add_f32 v229, v224, v225
v_add_f32 v230, v226, v227
v_add_f32 v228, v229, v230
s_mov_b32 s79, 0x4e800000
v_mfma_f32_16x16x32_bf16 a[92:95], v[204:207], v[164:167], a[92:95]
v_cmp_ngt_f32 s[48:49], s79, v228
v_mov_b32 v230, s40
v_lshlrev_b32 v230, 2, v230
v_add_u32 v230, 65536, v230
v_mfma_f32_16x16x32_bf16 a[60:63], v[204:207], v[156:159], a[60:63]
s_cmp_lg_u64 s[48:49], 0
s_cselect_b32 s79, 1, 0
s_andn2_b32 s79, s79, s78
s_or_b32 s79, s79, s77
v_mfma_f32_16x16x32_bf16 a[60:63], v[208:211], v[160:163], a[60:63]
v_mov_b32 v229, s79
ds_write_b32 v230, v229
v_mov_b32 v231, 65536
v_accvgpr_read_b32 v48, a8
v_mfma_f32_16x16x32_bf16 a[28:31], v[208:211], v[152:155], a[28:31]
v_accvgpr_read_b32 v49, a9
v_accvgpr_read_b32 v50, a10
v_accvgpr_read_b32 v51, a11
v_accvgpr_read_b32 v52, a12
v_mfma_f32_16x16x32_bf16 a[28:31], v[204:207], v[148:151], a[28:31]
v_accvgpr_read_b32 v53, a13
v_accvgpr_read_b32 v54, a14
v_accvgpr_read_b32 v55, a15
v_mul_f32 v48, v48, v244
v_mul_f32 v49, v49, v244
v_mul_f32 v50, v50, v244
v_mul_f32 v51, v51, v244
v_mul_f32 v52, v52, v244
v_mul_f32 v53, v53, v244
v_mul_f32 v54, v54, v244
v_mul_f32 v55, v55, v244
v_cvt_pk_bf16_f32 v32, v48, v49
v_cvt_pk_bf16_f32 v33, v50, v51
v_cvt_pk_bf16_f32 v34, v52, v53
v_cvt_pk_bf16_f32 v35, v54, v55
buffer_store_dwordx4 v[32:35], v5, s[36:39], s20 offen offset:0 sc0 sc1
v_accvgpr_read_b32 v56, a40
v_accvgpr_read_b32 v57, a41
v_accvgpr_read_b32 v58, a42
v_accvgpr_read_b32 v59, a43
v_accvgpr_read_b32 v60, a44
v_accvgpr_read_b32 v61, a45
v_accvgpr_read_b32 v62, a46
v_accvgpr_read_b32 v63, a47
v_mul_f32 v56, v56, v245
v_mul_f32 v57, v57, v245
v_mul_f32 v58, v58, v245
v_mul_f32 v59, v59, v245
v_mul_f32 v60, v60, v245
v_mul_f32 v61, v61, v245
v_mul_f32 v62, v62, v245
v_mul_f32 v63, v63, v245
v_cvt_pk_bf16_f32 v36, v56, v57
v_cvt_pk_bf16_f32 v37, v58, v59
v_cvt_pk_bf16_f32 v38, v60, v61
v_cvt_pk_bf16_f32 v39, v62, v63
buffer_store_dwordx4 v[36:39], v5, s[36:39], s20 offen offset:1024 sc0 sc1
v_accvgpr_read_b32 v64, a72
v_accvgpr_read_b32 v65, a73
v_accvgpr_read_b32 v66, a74
v_accvgpr_read_b32 v67, a75
v_accvgpr_read_b32 v68, a76
v_accvgpr_read_b32 v69, a77
v_accvgpr_read_b32 v70, a78
v_accvgpr_read_b32 v71, a79
v_mul_f32 v64, v64, v246
v_mul_f32 v65, v65, v246
v_mul_f32 v66, v66, v246
v_mul_f32 v67, v67, v246
v_mul_f32 v68, v68, v246
v_mul_f32 v69, v69, v246
v_mul_f32 v70, v70, v246
v_mul_f32 v71, v71, v246
v_cvt_pk_bf16_f32 v40, v64, v65
v_cvt_pk_bf16_f32 v41, v66, v67
v_cvt_pk_bf16_f32 v42, v68, v69
v_cvt_pk_bf16_f32 v43, v70, v71
buffer_store_dwordx4 v[40:43], v5, s[36:39], s20 offen offset:2048 sc0 sc1
v_accvgpr_read_b32 v72, a104
v_accvgpr_read_b32 v73, a105
v_accvgpr_read_b32 v74, a106
v_accvgpr_read_b32 v75, a107
v_accvgpr_read_b32 v76, a108
v_accvgpr_read_b32 v77, a109
v_accvgpr_read_b32 v78, a110
v_accvgpr_read_b32 v79, a111
v_mul_f32 v72, v72, v247
v_mul_f32 v73, v73, v247
v_mul_f32 v74, v74, v247
v_mul_f32 v75, v75, v247
v_mul_f32 v76, v76, v247
v_mul_f32 v77, v77, v247
v_mul_f32 v78, v78, v247
v_mul_f32 v79, v79, v247
v_cvt_pk_bf16_f32 v44, v72, v73
v_cvt_pk_bf16_f32 v45, v74, v75
v_cvt_pk_bf16_f32 v46, v76, v77
v_cvt_pk_bf16_f32 v47, v78, v79
buffer_store_dwordx4 v[44:47], v5, s[36:39], s20 offen offset:3072 sc0 sc1
s_waitcnt vmcnt(60) lgkmcnt(0)
s_barrier
ds_read_b128 v[232:235], v231
ds_read_b128 v[148:151], v248 offset:0
ds_read_b128 v[152:155], v248 offset:8192
ds_read_b128 v[156:159], v248 offset:1024
ds_read_b128 v[160:163], v248 offset:9216
ds_read_b128 v[164:167], v248 offset:2048
ds_read_b128 v[168:171], v248 offset:10240
s_waitcnt lgkmcnt(6)
v_or_b32 v232, v232, v233
v_or_b32 v234, v234, v235
v_or_b32 v232, v232, v234
s_mov_b32 s48, 0
s_mov_b32 s49, 0x2000
s_mov_b32 s50, 0x4000
s_mov_b32 s51, 0x6000
v_readfirstlane_b32 s79, v232
s_nop 1
s_bitcmp1_b32 s79, 0
s_cbranch_scc1 L_main_kernel_fb
s_waitcnt vmcnt(32) lgkmcnt(4)
v_mfma_f32_16x16x32_bf16 v[112:115], v[148:151], a[192:195], 0
ds_read_b128 v[172:175], v248 offset:3072
s_xor_b32 s68, s6, s46
v_accvgpr_read_b32 v196, a16
v_accvgpr_read_b32 v197, a17
v_accvgpr_read_b32 v198, a18
v_mfma_f32_16x16x32_bf16 v[112:115], v[152:155], a[200:203], v[112:115]
buffer_load_dwordx4 v[16:19], v2, s[92:95], s68 offen sc1
v_mfma_f32_16x16x32_bf16 v[128:131], v[152:155], a[204:207], 0
ds_read_b128 v[176:179], v248 offset:11264
v_accvgpr_read_b32 v199, a19
v_accvgpr_read_b32 v200, a20
v_mfma_f32_16x16x32_bf16 v[128:131], v[148:151], a[196:199], v[128:131]
v_accvgpr_read_b32 v201, a21
v_accvgpr_read_b32 v202, a22
s_waitcnt lgkmcnt(4)
v_mfma_f32_16x16x32_bf16 v[132:135], v[156:159], a[196:199], 0
ds_read_b128 v[148:151], v248 offset:4096
v_accvgpr_read_b32 v203, a23
v_mul_f32 v196, v196, v244
v_mul_f32 v197, v197, v244
v_mfma_f32_16x16x32_bf16 v[132:135], v[160:163], a[204:207], v[132:135]
buffer_load_dwordx4 v[20:23], v3, s[92:95], s68 offen sc1
v_mfma_f32_16x16x32_bf16 v[116:119], v[160:163], a[200:203], 0
ds_read_b128 v[152:155], v248 offset:12288
v_mul_f32 v198, v198, v244
v_mul_f32 v199, v199, v244
v_mfma_f32_16x16x32_bf16 v[116:119], v[156:159], a[192:195], v[116:119]
v_mul_f32 v200, v200, v244
v_mul_f32 v201, v201, v244
s_waitcnt lgkmcnt(4)
v_mfma_f32_16x16x32_bf16 v[120:123], v[164:167], a[192:195], 0
ds_read_b128 v[156:159], v248 offset:5120
v_mul_f32 v202, v202, v244
v_mul_f32 v203, v203, v244
v_cvt_pk_bf16_f32 v220, v196, v197
buffer_atomic_add v255, v252, s[32:35], 0 offen offset:4 sc1
v_mfma_f32_16x16x32_bf16 v[120:123], v[168:171], a[200:203], v[120:123]
buffer_load_dwordx4 v[24:27], v4, s[92:95], s68 offen sc1
v_mfma_f32_16x16x32_bf16 v[136:139], v[168:171], a[204:207], 0
ds_read_b128 v[160:163], v248 offset:13312
v_cvt_pk_bf16_f32 v221, v198, v199
v_cvt_pk_bf16_f32 v222, v200, v201
v_mfma_f32_16x16x32_bf16 v[136:139], v[164:167], a[196:199], v[136:139]
v_cvt_pk_bf16_f32 v223, v202, v203
buffer_store_dwordx4 v[220:223], v5, s[36:39], s50 offen offset:0 sc0 sc1
s_waitcnt lgkmcnt(4)
v_mfma_f32_16x16x32_bf16 v[140:143], v[172:175], a[196:199], 0
ds_read_b128 v[164:167], v248 offset:6144
s_xor_b32 s69, s7, s46
v_accvgpr_read_b32 v204, a24
v_accvgpr_read_b32 v205, a25
v_accvgpr_read_b32 v206, a26
v_mfma_f32_16x16x32_bf16 v[140:143], v[176:179], a[204:207], v[140:143]
buffer_load_dwordx4 v[28:31], v13, s[92:95], s68 offen sc1
v_mfma_f32_16x16x32_bf16 v[124:127], v[176:179], a[200:203], 0
ds_read_b128 v[168:171], v248 offset:14336
s_add_u32 m0, s57, 32768
v_accvgpr_read_b32 v207, a27
v_accvgpr_read_b32 v208, a28
v_mfma_f32_16x16x32_bf16 v[124:127], v[172:175], a[192:195], v[124:127]
v_accvgpr_read_b32 v209, a29
v_accvgpr_read_b32 v210, a30
s_waitcnt lgkmcnt(4)
v_mfma_f32_16x16x32_bf16 v[80:83], v[148:151], a[192:195], 0
ds_read_b128 v[172:175], v248 offset:7168
s_add_u32 s6, s6, s64
v_accvgpr_read_b32 v211, a31
v_mul_f32 v204, v204, v244
v_mul_f32 v205, v205, v244
v_mfma_f32_16x16x32_bf16 v[80:83], v[152:155], a[200:203], v[80:83]
buffer_load_dwordx4 v253, s[8:11], s69 offen offset:0 sc1 lds
v_mfma_f32_16x16x32_bf16 v[96:99], v[152:155], a[204:207], 0
ds_read_b128 v[176:179], v248 offset:15360
v_mul_f32 v206, v206, v244
v_mul_f32 v207, v207, v244
v_mfma_f32_16x16x32_bf16 v[96:99], v[148:151], a[196:199], v[96:99]
v_mul_f32 v208, v208, v244
v_mul_f32 v209, v209, v244
s_waitcnt lgkmcnt(4)
s_barrier
v_mfma_f32_16x16x32_bf16 v[100:103], v[156:159], a[196:199], 0
ds_read_b128 v[148:151], v248 offset:16384
v_mul_f32 v210, v210, v244
v_mul_f32 v211, v211, v244
v_cvt_pk_bf16_f32 v224, v204, v205
v_mfma_f32_16x16x32_bf16 v[100:103], v[160:163], a[204:207], v[100:103]
buffer_load_dwordx4 v253, s[8:11], s69 offen offset:1024 sc1 lds
v_mfma_f32_16x16x32_bf16 v[84:87], v[160:163], a[200:203], 0
ds_read_b128 v[152:155], v248 offset:24576
s_add_u32 s7, s7, s64
v_cvt_pk_bf16_f32 v225, v206, v207
v_cvt_pk_bf16_f32 v226, v208, v209
v_mfma_f32_16x16x32_bf16 v[84:87], v[156:159], a[192:195], v[84:87]
v_cvt_pk_bf16_f32 v227, v210, v211
buffer_store_dwordx4 v[224:227], v5, s[36:39], s51 offen offset:0 sc0 sc1
s_waitcnt lgkmcnt(4)
v_mfma_f32_16x16x32_bf16 v[88:91], v[164:167], a[192:195], 0
ds_read_b128 v[156:159], v248 offset:17408
v_accvgpr_read_b32 v196, a48
v_accvgpr_read_b32 v197, a49
v_accvgpr_read_b32 v198, a50
v_mfma_f32_16x16x32_bf16 v[88:91], v[168:171], a[200:203], v[88:91]
buffer_load_dwordx4 v253, s[8:11], s69 offen offset:2048 sc1 lds
v_mfma_f32_16x16x32_bf16 v[104:107], v[168:171], a[204:207], 0
ds_read_b128 v[160:163], v248 offset:25600
v_accvgpr_read_b32 v199, a51
v_accvgpr_read_b32 v200, a52
v_mfma_f32_16x16x32_bf16 v[104:107], v[164:167], a[196:199], v[104:107]
v_accvgpr_read_b32 v201, a53
v_accvgpr_read_b32 v202, a54
s_waitcnt lgkmcnt(4)
v_mfma_f32_16x16x32_bf16 v[108:111], v[172:175], a[196:199], 0
ds_read_b128 v[164:167], v248 offset:18432
v_accvgpr_read_b32 v203, a55
v_mul_f32 v196, v196, v245
v_mul_f32 v197, v197, v245
buffer_atomic_add v255, v252, s[32:35], 0 offen offset:4 sc1
v_mfma_f32_16x16x32_bf16 v[108:111], v[176:179], a[204:207], v[108:111]
buffer_load_dwordx4 v253, s[8:11], s69 offen offset:3072 sc1 lds
v_mfma_f32_16x16x32_bf16 v[92:95], v[176:179], a[200:203], 0
ds_read_b128 v[168:171], v248 offset:26624
v_mul_f32 v198, v198, v245
v_mul_f32 v199, v199, v245
v_mfma_f32_16x16x32_bf16 v[92:95], v[172:175], a[192:195], v[92:95]
v_mul_f32 v200, v200, v245
v_mul_f32 v201, v201, v245
s_waitcnt vmcnt(39) lgkmcnt(4)
v_mfma_f32_16x16x32_bf16 v[112:115], v[148:151], a[208:211], v[112:115]
ds_read_b128 v[172:175], v248 offset:19456
s_xor_b32 s68, s6, s46
v_mul_f32 v202, v202, v245
v_mul_f32 v203, v203, v245
v_cvt_pk_bf16_f32 v236, v196, v197
v_mfma_f32_16x16x32_bf16 v[112:115], v[152:155], a[216:219], v[112:115]
buffer_load_dwordx4 v[32:35], v2, s[92:95], s68 offen sc1
v_mfma_f32_16x16x32_bf16 v[128:131], v[152:155], a[220:223], v[128:131]
ds_read_b128 v[176:179], v248 offset:27648
v_cvt_pk_bf16_f32 v237, v198, v199
v_cvt_pk_bf16_f32 v238, v200, v201
v_mfma_f32_16x16x32_bf16 v[128:131], v[148:151], a[212:215], v[128:131]
v_cvt_pk_bf16_f32 v239, v202, v203
buffer_store_dwordx4 v[236:239], v5, s[36:39], s50 offen offset:1024 sc0 sc1
s_waitcnt lgkmcnt(4)
v_mfma_f32_16x16x32_bf16 v[132:135], v[156:159], a[212:215], v[132:135]
ds_read_b128 v[148:151], v248 offset:20480
v_accvgpr_read_b32 v204, a56
v_accvgpr_read_b32 v205, a57
v_accvgpr_read_b32 v206, a58
v_mfma_f32_16x16x32_bf16 v[132:135], v[160:163], a[220:223], v[132:135]
buffer_load_dwordx4 v[36:39], v3, s[92:95], s68 offen sc1
v_mfma_f32_16x16x32_bf16 v[116:119], v[160:163], a[216:219], v[116:119]
ds_read_b128 v[152:155], v248 offset:28672
v_accvgpr_read_b32 v207, a59
v_accvgpr_read_b32 v208, a60
v_mfma_f32_16x16x32_bf16 v[116:119], v[156:159], a[208:211], v[116:119]
v_accvgpr_read_b32 v209, a61
v_accvgpr_read_b32 v210, a62
s_waitcnt lgkmcnt(4)
v_mfma_f32_16x16x32_bf16 v[120:123], v[164:167], a[208:211], v[120:123]
ds_read_b128 v[156:159], v248 offset:21504
v_accvgpr_read_b32 v211, a63
v_mul_f32 v204, v204, v245
v_mul_f32 v205, v205, v245
v_mfma_f32_16x16x32_bf16 v[120:123], v[168:171], a[216:219], v[120:123]
buffer_load_dwordx4 v[40:43], v4, s[92:95], s68 offen sc1
v_mfma_f32_16x16x32_bf16 v[136:139], v[168:171], a[220:223], v[136:139]
ds_read_b128 v[160:163], v248 offset:29696
v_mul_f32 v206, v206, v245
v_mul_f32 v207, v207, v245
v_mfma_f32_16x16x32_bf16 v[136:139], v[164:167], a[212:215], v[136:139]
v_mul_f32 v208, v208, v245
v_mul_f32 v209, v209, v245
s_waitcnt lgkmcnt(4)
v_mfma_f32_16x16x32_bf16 v[140:143], v[172:175], a[212:215], v[140:143]
ds_read_b128 v[164:167], v248 offset:22528
s_xor_b32 s69, s7, s46
v_mul_f32 v210, v210, v245
v_mul_f32 v211, v211, v245
v_cvt_pk_bf16_f32 v240, v204, v205
v_mfma_f32_16x16x32_bf16 v[140:143], v[176:179], a[220:223], v[140:143]
buffer_load_dwordx4 v[44:47], v13, s[92:95], s68 offen sc1
v_mfma_f32_16x16x32_bf16 v[124:127], v[176:179], a[216:219], v[124:127]
ds_read_b128 v[168:171], v248 offset:30720
s_add_u32 m0, s57, 49152
v_cvt_pk_bf16_f32 v241, v206, v207
v_cvt_pk_bf16_f32 v242, v208, v209
v_mfma_f32_16x16x32_bf16 v[124:127], v[172:175], a[208:211], v[124:127]
v_cvt_pk_bf16_f32 v243, v210, v211
buffer_store_dwordx4 v[240:243], v5, s[36:39], s51 offen offset:1024 sc0 sc1
s_waitcnt lgkmcnt(4)
v_mfma_f32_16x16x32_bf16 v[80:83], v[148:151], a[208:211], v[80:83]
ds_read_b128 v[172:175], v248 offset:23552
s_add_u32 s6, s6, s64
v_accvgpr_read_b32 v196, a80
v_accvgpr_read_b32 v197, a81
v_accvgpr_read_b32 v198, a82
buffer_atomic_add v255, v252, s[32:35], 0 offen offset:4 sc1
v_mfma_f32_16x16x32_bf16 v[80:83], v[152:155], a[216:219], v[80:83]
buffer_load_dwordx4 v253, s[8:11], s69 offen offset:0 sc1 lds
v_mfma_f32_16x16x32_bf16 v[96:99], v[152:155], a[220:223], v[96:99]
ds_read_b128 v[176:179], v248 offset:31744
v_accvgpr_read_b32 v199, a83
v_accvgpr_read_b32 v200, a84
v_mfma_f32_16x16x32_bf16 v[96:99], v[148:151], a[212:215], v[96:99]
v_accvgpr_read_b32 v201, a85
v_accvgpr_read_b32 v202, a86
s_waitcnt lgkmcnt(4)
s_barrier
v_mfma_f32_16x16x32_bf16 v[100:103], v[156:159], a[212:215], v[100:103]
ds_read_b128 v[148:151], v248 offset:32768
v_accvgpr_read_b32 v203, a87
v_mul_f32 v196, v196, v246
v_mul_f32 v197, v197, v246
v_mfma_f32_16x16x32_bf16 v[100:103], v[160:163], a[220:223], v[100:103]
buffer_load_dwordx4 v253, s[8:11], s69 offen offset:1024 sc1 lds
v_mfma_f32_16x16x32_bf16 v[84:87], v[160:163], a[216:219], v[84:87]
ds_read_b128 v[152:155], v248 offset:40960
s_add_u32 s7, s7, s64
v_mul_f32 v198, v198, v246
v_mul_f32 v199, v199, v246
v_mfma_f32_16x16x32_bf16 v[84:87], v[156:159], a[208:211], v[84:87]
v_mul_f32 v200, v200, v246
v_mul_f32 v201, v201, v246
s_waitcnt lgkmcnt(4)
v_mfma_f32_16x16x32_bf16 v[88:91], v[164:167], a[208:211], v[88:91]
ds_read_b128 v[156:159], v248 offset:33792
v_mul_f32 v202, v202, v246
v_mul_f32 v203, v203, v246
v_cvt_pk_bf16_f32 v220, v196, v197
v_mfma_f32_16x16x32_bf16 v[88:91], v[168:171], a[216:219], v[88:91]
buffer_load_dwordx4 v253, s[8:11], s69 offen offset:2048 sc1 lds
v_mfma_f32_16x16x32_bf16 v[104:107], v[168:171], a[220:223], v[104:107]
ds_read_b128 v[160:163], v248 offset:41984
v_cvt_pk_bf16_f32 v221, v198, v199
v_cvt_pk_bf16_f32 v222, v200, v201
v_mfma_f32_16x16x32_bf16 v[104:107], v[164:167], a[212:215], v[104:107]
v_cvt_pk_bf16_f32 v223, v202, v203
buffer_store_dwordx4 v[220:223], v5, s[36:39], s50 offen offset:2048 sc0 sc1
s_waitcnt lgkmcnt(4)
v_mfma_f32_16x16x32_bf16 v[108:111], v[172:175], a[212:215], v[108:111]
ds_read_b128 v[164:167], v248 offset:34816
v_accvgpr_read_b32 v204, a88
v_accvgpr_read_b32 v205, a89
v_accvgpr_read_b32 v206, a90
v_mfma_f32_16x16x32_bf16 v[108:111], v[176:179], a[220:223], v[108:111]
buffer_load_dwordx4 v253, s[8:11], s69 offen offset:3072 sc1 lds
v_mfma_f32_16x16x32_bf16 v[92:95], v[176:179], a[216:219], v[92:95]
ds_read_b128 v[168:171], v248 offset:43008
v_accvgpr_read_b32 v207, a91
v_accvgpr_read_b32 v208, a92
v_mfma_f32_16x16x32_bf16 v[92:95], v[172:175], a[208:211], v[92:95]
v_accvgpr_read_b32 v209, a93
v_accvgpr_read_b32 v210, a94
s_waitcnt vmcnt(46) lgkmcnt(4)
v_mfma_f32_16x16x32_bf16 v[112:115], v[148:151], a[128:131], v[112:115]
ds_read_b128 v[172:175], v248 offset:35840
s_xor_b32 s68, s6, s46
v_accvgpr_read_b32 v211, a95
v_mul_f32 v204, v204, v246
v_mul_f32 v205, v205, v246
buffer_atomic_add v255, v252, s[32:35], 0 offen offset:4 sc1
v_mfma_f32_16x16x32_bf16 v[112:115], v[152:155], a[136:139], v[112:115]
buffer_load_dwordx4 a[192:195], v2, s[92:95], s68 offen sc1
v_mfma_f32_16x16x32_bf16 v[128:131], v[152:155], a[140:143], v[128:131]
ds_read_b128 v[176:179], v248 offset:44032
v_mul_f32 v206, v206, v246
v_mul_f32 v207, v207, v246
v_mfma_f32_16x16x32_bf16 v[128:131], v[148:151], a[132:135], v[128:131]
v_mul_f32 v208, v208, v246
v_mul_f32 v209, v209, v246
s_waitcnt lgkmcnt(4)
v_mfma_f32_16x16x32_bf16 v[132:135], v[156:159], a[132:135], v[132:135]
ds_read_b128 v[148:151], v248 offset:36864
v_mul_f32 v210, v210, v246
v_mul_f32 v211, v211, v246
v_cvt_pk_bf16_f32 v224, v204, v205
v_mfma_f32_16x16x32_bf16 v[132:135], v[160:163], a[140:143], v[132:135]
buffer_load_dwordx4 a[196:199], v3, s[92:95], s68 offen sc1
v_mfma_f32_16x16x32_bf16 v[116:119], v[160:163], a[136:139], v[116:119]
ds_read_b128 v[152:155], v248 offset:45056
v_cvt_pk_bf16_f32 v225, v206, v207
v_cvt_pk_bf16_f32 v226, v208, v209
v_mfma_f32_16x16x32_bf16 v[116:119], v[156:159], a[128:131], v[116:119]
v_cvt_pk_bf16_f32 v227, v210, v211
buffer_store_dwordx4 v[224:227], v5, s[36:39], s51 offen offset:2048 sc0 sc1
s_waitcnt lgkmcnt(4)
v_mfma_f32_16x16x32_bf16 v[120:123], v[164:167], a[128:131], v[120:123]
ds_read_b128 v[156:159], v248 offset:37888
v_accvgpr_read_b32 v196, a112
v_accvgpr_read_b32 v197, a113
v_accvgpr_read_b32 v198, a114
v_mfma_f32_16x16x32_bf16 v[120:123], v[168:171], a[136:139], v[120:123]
buffer_load_dwordx4 a[200:203], v4, s[92:95], s68 offen sc1
v_mfma_f32_16x16x32_bf16 v[136:139], v[168:171], a[140:143], v[136:139]
ds_read_b128 v[160:163], v248 offset:46080
v_accvgpr_read_b32 v199, a115
v_accvgpr_read_b32 v200, a116
v_mfma_f32_16x16x32_bf16 v[136:139], v[164:167], a[132:135], v[136:139]
v_accvgpr_read_b32 v201, a117
v_accvgpr_read_b32 v202, a118
s_waitcnt lgkmcnt(4)
v_mfma_f32_16x16x32_bf16 v[140:143], v[172:175], a[132:135], v[140:143]
ds_read_b128 v[164:167], v248 offset:38912
s_xor_b32 s69, s7, s46
v_accvgpr_read_b32 v203, a119
v_mul_f32 v196, v196, v247
v_mul_f32 v197, v197, v247
v_mfma_f32_16x16x32_bf16 v[140:143], v[176:179], a[140:143], v[140:143]
buffer_load_dwordx4 a[204:207], v13, s[92:95], s68 offen sc1
v_mfma_f32_16x16x32_bf16 v[124:127], v[176:179], a[136:139], v[124:127]
ds_read_b128 v[168:171], v248 offset:47104
s_add_u32 m0, s57, 98304
v_mul_f32 v198, v198, v247
v_mul_f32 v199, v199, v247
v_mfma_f32_16x16x32_bf16 v[124:127], v[172:175], a[128:131], v[124:127]
v_mul_f32 v200, v200, v247
v_mul_f32 v201, v201, v247
s_waitcnt lgkmcnt(4)
v_mfma_f32_16x16x32_bf16 v[80:83], v[148:151], a[128:131], v[80:83]
ds_read_b128 v[172:175], v248 offset:39936
s_add_u32 s6, s6, s64
v_mul_f32 v202, v202, v247
v_mul_f32 v203, v203, v247
v_cvt_pk_bf16_f32 v236, v196, v197
buffer_atomic_add v255, v252, s[32:35], 0 offen offset:4 sc1
v_mfma_f32_16x16x32_bf16 v[80:83], v[152:155], a[136:139], v[80:83]
buffer_load_dwordx4 v253, s[8:11], s69 offen offset:0 sc1 lds
v_mfma_f32_16x16x32_bf16 v[96:99], v[152:155], a[140:143], v[96:99]
ds_read_b128 v[176:179], v248 offset:48128
v_cvt_pk_bf16_f32 v237, v198, v199
v_cvt_pk_bf16_f32 v238, v200, v201
v_mfma_f32_16x16x32_bf16 v[96:99], v[148:151], a[132:135], v[96:99]
v_cvt_pk_bf16_f32 v239, v202, v203
buffer_store_dwordx4 v[236:239], v5, s[36:39], s50 offen offset:3072 sc0 sc1
s_waitcnt lgkmcnt(4)
s_barrier
v_mfma_f32_16x16x32_bf16 v[100:103], v[156:159], a[132:135], v[100:103]
ds_read_b128 v[148:151], v144 offset:0
v_accvgpr_read_b32 v204, a120
v_accvgpr_read_b32 v205, a121
v_accvgpr_read_b32 v206, a122
v_mfma_f32_16x16x32_bf16 v[100:103], v[160:163], a[140:143], v[100:103]
buffer_load_dwordx4 v253, s[8:11], s69 offen offset:1024 sc1 lds
v_mfma_f32_16x16x32_bf16 v[84:87], v[160:163], a[136:139], v[84:87]
ds_read_b128 v[152:155], v144 offset:8192
s_add_u32 s7, s7, s64
v_accvgpr_read_b32 v207, a123
v_accvgpr_read_b32 v208, a124
v_mfma_f32_16x16x32_bf16 v[84:87], v[156:159], a[128:131], v[84:87]
v_accvgpr_read_b32 v209, a125
v_accvgpr_read_b32 v210, a126
s_waitcnt lgkmcnt(4)
v_mfma_f32_16x16x32_bf16 v[88:91], v[164:167], a[128:131], v[88:91]
ds_read_b128 v[156:159], v144 offset:1024
v_accvgpr_read_b32 v211, a127
v_mul_f32 v204, v204, v247
v_mul_f32 v205, v205, v247
v_mfma_f32_16x16x32_bf16 v[88:91], v[168:171], a[136:139], v[88:91]
buffer_load_dwordx4 v253, s[8:11], s69 offen offset:2048 sc1 lds
v_mfma_f32_16x16x32_bf16 v[104:107], v[168:171], a[140:143], v[104:107]
ds_read_b128 v[160:163], v144 offset:9216
v_mul_f32 v206, v206, v247
v_mul_f32 v207, v207, v247
v_mfma_f32_16x16x32_bf16 v[104:107], v[164:167], a[132:135], v[104:107]
v_mul_f32 v208, v208, v247
v_mul_f32 v209, v209, v247
s_waitcnt lgkmcnt(4)
v_mfma_f32_16x16x32_bf16 v[108:111], v[172:175], a[132:135], v[108:111]
ds_read_b128 v[164:167], v144 offset:2048
v_mul_f32 v210, v210, v247
v_mul_f32 v211, v211, v247
v_cvt_pk_bf16_f32 v240, v204, v205
v_mfma_f32_16x16x32_bf16 v[108:111], v[176:179], a[140:143], v[108:111]
buffer_load_dwordx4 v253, s[8:11], s69 offen offset:3072 sc1 lds
v_mfma_f32_16x16x32_bf16 v[92:95], v[176:179], a[136:139], v[92:95]
ds_read_b128 v[168:171], v144 offset:10240
v_cvt_pk_bf16_f32 v241, v206, v207
v_cvt_pk_bf16_f32 v242, v208, v209
v_mfma_f32_16x16x32_bf16 v[92:95], v[172:175], a[128:131], v[92:95]
v_cvt_pk_bf16_f32 v243, v210, v211
buffer_store_dwordx4 v[240:243], v5, s[36:39], s51 offen offset:3072 sc0 sc1
s_waitcnt vmcnt(54) lgkmcnt(4)
v_mfma_f32_16x16x32_bf16 v[112:115], v[148:151], a[144:147], v[112:115]
ds_read_b128 v[172:175], v144 offset:3072
s_xor_b32 s68, s6, s46
s_getpc_b64 s[52:53]
L_main_kernel_p3pc:
v_mfma_f32_16x16x32_bf16 v[112:115], v[152:155], a[152:155], v[112:115]
buffer_load_dwordx4 a[208:211], v2, s[92:95], s68 offen sc1
v_mfma_f32_16x16x32_bf16 v[128:131], v[152:155], a[156:159], v[128:131]
ds_read_b128 v[176:179], v144 offset:11264
s_add_u32 s52, s52, L_main_kernel_p3b-L_main_kernel_p3pc
s_addc_u32 s53, s53, 0
v_mfma_f32_16x16x32_bf16 v[128:131], v[148:151], a[148:151], v[128:131]
s_waitcnt lgkmcnt(4)
v_mfma_f32_16x16x32_bf16 v[132:135], v[156:159], a[148:151], v[132:135]
ds_read_b128 v[148:151], v144 offset:4096
s_lshl_b32 s55, s65, 16
buffer_atomic_add v255, v252, s[32:35], 0 offen offset:4 sc1
v_mfma_f32_16x16x32_bf16 v[132:135], v[160:163], a[156:159], v[132:135]
buffer_load_dwordx4 a[212:215], v3, s[92:95], s68 offen sc1
v_mfma_f32_16x16x32_bf16 v[116:119], v[160:163], a[152:155], v[116:119]
ds_read_b128 v[152:155], v144 offset:12288
s_add_u32 s55, s55, 37748736
v_mfma_f32_16x16x32_bf16 v[116:119], v[156:159], a[144:147], v[116:119]
s_waitcnt lgkmcnt(4)
v_mfma_f32_16x16x32_bf16 v[120:123], v[164:167], a[144:147], v[120:123]
ds_read_b128 v[156:159], v144 offset:5120
s_add_u32 s84, s60, s55
s_addc_u32 s85, s61, 0
v_mfma_f32_16x16x32_bf16 v[120:123], v[168:171], a[152:155], v[120:123]
buffer_load_dwordx4 a[216:219], v4, s[92:95], s68 offen sc1
v_mfma_f32_16x16x32_bf16 v[136:139], v[168:171], a[156:159], v[136:139]
ds_read_b128 v[160:163], v144 offset:13312
s_mov_b32 s86, 0x10000
v_mfma_f32_16x16x32_bf16 v[136:139], v[164:167], a[148:151], v[136:139]
s_waitcnt lgkmcnt(4)
v_mfma_f32_16x16x32_bf16 v[140:143], v[172:175], a[148:151], v[140:143]
ds_read_b128 v[164:167], v144 offset:6144
s_xor_b32 s69, s7, s46
s_mov_b32 s87, 0x20000
v_mfma_f32_16x16x32_bf16 v[140:143], v[176:179], a[156:159], v[140:143]
buffer_load_dwordx4 a[220:223], v13, s[92:95], s68 offen sc1
v_mfma_f32_16x16x32_bf16 v[124:127], v[176:179], a[152:155], v[124:127]
ds_read_b128 v[168:171], v144 offset:14336
s_add_u32 m0, s57, 114688
s_xor_b32 s55, s55, 0x10000
v_mfma_f32_16x16x32_bf16 v[124:127], v[172:175], a[144:147], v[124:127]
s_waitcnt lgkmcnt(4)
v_mfma_f32_16x16x32_bf16 v[80:83], v[148:151], a[144:147], v[80:83]
ds_read_b128 v[172:175], v144 offset:7168
s_add_u32 s6, s6, s64
s_add_u32 s88, s60, s55
s_addc_u32 s89, s61, 0
v_mfma_f32_16x16x32_bf16 v[80:83], v[152:155], a[152:155], v[80:83]
buffer_load_dwordx4 v253, s[8:11], s69 offen offset:0 sc1 lds
v_mfma_f32_16x16x32_bf16 v[96:99], v[152:155], a[156:159], v[96:99]
ds_read_b128 v[176:179], v144 offset:15360
s_mov_b32 s90, 0x10000
v_mfma_f32_16x16x32_bf16 v[96:99], v[148:151], a[148:151], v[96:99]
s_waitcnt lgkmcnt(4)
s_barrier
v_mfma_f32_16x16x32_bf16 v[100:103], v[156:159], a[148:151], v[100:103]
ds_read_b128 v[148:151], v248 offset:49152
s_mov_b32 s91, 0x20000
v_mfma_f32_16x16x32_bf16 v[100:103], v[160:163], a[156:159], v[100:103]
buffer_load_dwordx4 v253, s[8:11], s69 offen offset:1024 sc1 lds
v_mfma_f32_16x16x32_bf16 v[84:87], v[160:163], a[152:155], v[84:87]
ds_read_b128 v[152:155], v248 offset:57344
s_add_u32 s7, s7, s64
s_lshl_b32 s59, s65, 2
v_mfma_f32_16x16x32_bf16 v[84:87], v[156:159], a[144:147], v[84:87]
s_waitcnt lgkmcnt(4)
v_mfma_f32_16x16x32_bf16 v[88:91], v[164:167], a[144:147], v[88:91]
ds_read_b128 v[156:159], v248 offset:50176
s_add_u32 s59, s59, s40
v_mfma_f32_16x16x32_bf16 v[88:91], v[168:171], a[152:155], v[88:91]
buffer_load_dwordx4 v253, s[8:11], s69 offen offset:2048 sc1 lds
v_mfma_f32_16x16x32_bf16 v[104:107], v[168:171], a[156:159], v[104:107]
ds_read_b128 v[160:163], v248 offset:58368
s_lshl_b32 s82, s59, 7
v_mfma_f32_16x16x32_bf16 v[104:107], v[164:167], a[148:151], v[104:107]
s_waitcnt lgkmcnt(4)
v_mfma_f32_16x16x32_bf16 v[108:111], v[172:175], a[148:151], v[108:111]
ds_read_b128 v[164:167], v248 offset:51200
s_lshl_b32 s55, s73, 18
v_mfma_f32_16x16x32_bf16 v[108:111], v[176:179], a[156:159], v[108:111]
buffer_load_dwordx4 v253, s[8:11], s69 offen offset:3072 sc1 lds
v_mfma_f32_16x16x32_bf16 v[92:95], v[176:179], a[152:155], v[92:95]
ds_read_b128 v[168:171], v248 offset:59392
s_lshl_b32 s59, s74, 8
v_mfma_f32_16x16x32_bf16 v[92:95], v[172:175], a[144:147], v[92:95]
s_waitcnt vmcnt(58) lgkmcnt(4)
v_mfma_f32_16x16x32_bf16 v[112:115], v[148:151], a[160:163], v[112:115]
ds_read_b128 v[172:175], v248 offset:52224
s_xor_b32 s68, s6, s46
s_add_u32 s55, s55, s59
buffer_atomic_add v255, v252, s[32:35], 0 offen offset:4 sc1
v_mfma_f32_16x16x32_bf16 v[112:115], v[152:155], a[168:171], v[112:115]
buffer_load_dwordx4 a[128:131], v2, s[92:95], s68 offen sc1
v_mfma_f32_16x16x32_bf16 v[128:131], v[152:155], a[172:175], v[128:131]
ds_read_b128 v[176:179], v248 offset:60416
s_lshl_b32 s59, s40, 9
v_mfma_f32_16x16x32_bf16 v[128:131], v[148:151], a[164:167], v[128:131]
s_waitcnt lgkmcnt(4)
v_mfma_f32_16x16x32_bf16 v[132:135], v[156:159], a[164:167], v[132:135]
ds_read_b128 v[148:151], v248 offset:53248
s_add_u32 s59, s59, s72
v_mfma_f32_16x16x32_bf16 v[132:135], v[160:163], a[172:175], v[132:135]
buffer_load_dwordx4 a[132:135], v3, s[92:95], s68 offen sc1
v_mfma_f32_16x16x32_bf16 v[116:119], v[160:163], a[168:171], v[116:119]
ds_read_b128 v[152:155], v248 offset:61440
s_lshl_b32 s59, s59, 7
v_mfma_f32_16x16x32_bf16 v[116:119], v[156:159], a[160:163], v[116:119]
s_waitcnt lgkmcnt(4)
v_mfma_f32_16x16x32_bf16 v[120:123], v[164:167], a[160:163], v[120:123]
ds_read_b128 v[156:159], v248 offset:54272
s_add_u32 s55, s55, s59
v_mfma_f32_16x16x32_bf16 v[120:123], v[168:171], a[168:171], v[120:123]
buffer_load_dwordx4 a[136:139], v4, s[92:95], s68 offen sc1
v_mfma_f32_16x16x32_bf16 v[136:139], v[168:171], a[172:175], v[136:139]
ds_read_b128 v[160:163], v248 offset:62464
s_lshl_b32 s59, s40, 13
v_mfma_f32_16x16x32_bf16 v[136:139], v[164:167], a[164:167], v[136:139]
s_waitcnt lgkmcnt(4)
v_mfma_f32_16x16x32_bf16 v[140:143], v[172:175], a[164:167], v[140:143]
ds_read_b128 v[164:167], v248 offset:55296
s_xor_b32 s69, s7, s46
s_mov_b32 s24, s66
v_mfma_f32_16x16x32_bf16 v[140:143], v[176:179], a[172:175], v[140:143]
buffer_load_dwordx4 a[140:143], v13, s[92:95], s68 offen sc1
v_mfma_f32_16x16x32_bf16 v[124:127], v[176:179], a[168:171], v[124:127]
ds_read_b128 v[168:171], v248 offset:63488
s_add_u32 m0, s57, 131072
s_mov_b32 s25, s67
v_mfma_f32_16x16x32_bf16 v[124:127], v[172:175], a[160:163], v[124:127]
s_waitcnt lgkmcnt(4)
v_mfma_f32_16x16x32_bf16 v[80:83], v[148:151], a[160:163], v[80:83]
ds_read_b128 v[172:175], v248 offset:56320
s_add_u32 s6, s6, s64
s_mov_b32 s26, 0x400000
v_mfma_f32_16x16x32_bf16 v[80:83], v[152:155], a[168:171], v[80:83]
buffer_load_dwordx4 v253, s[8:11], s69 offen offset:0 sc1 lds
v_mfma_f32_16x16x32_bf16 v[96:99], v[152:155], a[172:175], v[96:99]
ds_read_b128 v[176:179], v248 offset:64512
s_mov_b32 s28, s70
v_mfma_f32_16x16x32_bf16 v[96:99], v[148:151], a[164:167], v[96:99]
s_waitcnt lgkmcnt(4)
s_barrier
v_mfma_f32_16x16x32_bf16 v[100:103], v[156:159], a[164:167], v[100:103]
ds_read_b128 v[148:151], v144 offset:16384
s_mov_b32 s29, s71
v_mfma_f32_16x16x32_bf16 v[100:103], v[160:163], a[172:175], v[100:103]
buffer_load_dwordx4 v253, s[8:11], s69 offen offset:1024 sc1 lds
v_mfma_f32_16x16x32_bf16 v[84:87], v[160:163], a[168:171], v[84:87]
ds_read_b128 v[152:155], v144 offset:24576
s_add_u32 s7, s7, s64
s_mov_b32 s30, 0x400000
v_mfma_f32_16x16x32_bf16 v[84:87], v[156:159], a[160:163], v[84:87]
s_waitcnt lgkmcnt(4)
v_mfma_f32_16x16x32_bf16 v[88:91], v[164:167], a[160:163], v[88:91]
ds_read_b128 v[156:159], v144 offset:17408
s_mov_b32 s72, 0
v_mfma_f32_16x16x32_bf16 v[88:91], v[168:171], a[168:171], v[88:91]
buffer_load_dwordx4 v253, s[8:11], s69 offen offset:2048 sc1 lds
v_mfma_f32_16x16x32_bf16 v[104:107], v[168:171], a[172:175], v[104:107]
ds_read_b128 v[160:163], v144 offset:25600
s_mov_b32 s73, 0x1000
v_mfma_f32_16x16x32_bf16 v[104:107], v[164:167], a[164:167], v[104:107]
s_waitcnt lgkmcnt(4)
v_mfma_f32_16x16x32_bf16 v[108:111], v[172:175], a[164:167], v[108:111]
ds_read_b128 v[164:167], v144 offset:18432
s_mov_b32 s74, 0x8000
buffer_atomic_add v255, v252, s[32:35], 0 offen offset:4 sc1
v_mfma_f32_16x16x32_bf16 v[108:111], v[176:179], a[172:175], v[108:111]
buffer_load_dwordx4 v253, s[8:11], s69 offen offset:3072 sc1 lds
v_mfma_f32_16x16x32_bf16 v[92:95], v[176:179], a[168:171], v[92:95]
ds_read_b128 v[168:171], v144 offset:26624
s_mov_b32 s75, 0x9000
v_mfma_f32_16x16x32_bf16 v[92:95], v[172:175], a[160:163], v[92:95]
s_waitcnt vmcnt(19)
s_waitcnt lgkmcnt(4)
v_mfma_f32_16x16x32_bf16 v[112:115], v[148:151], a[176:179], v[112:115]
ds_read_b128 v[172:175], v144 offset:19456
s_xor_b32 s68, s6, s46
v_and_b32 v6, 15, v0
v_mfma_f32_16x16x32_bf16 v[112:115], v[152:155], a[184:187], v[112:115]
buffer_load_dwordx4 a[144:147], v2, s[92:95], s68 offen sc1
v_mfma_f32_16x16x32_bf16 v[128:131], v[152:155], a[188:191], v[128:131]
ds_read_b128 v[176:179], v144 offset:27648
v_mfma_f32_16x16x32_bf16 v[128:131], v[148:151], a[180:183], v[128:131]
v_lshlrev_b32 v6, 11, v6
s_waitcnt lgkmcnt(4)
v_mfma_f32_16x16x32_bf16 v[132:135], v[156:159], a[180:183], v[132:135]
ds_read_b128 v[148:151], v144 offset:20480
v_mfma_f32_16x16x32_bf16 v[132:135], v[160:163], a[188:191], v[132:135]
buffer_load_dwordx4 a[148:151], v3, s[92:95], s68 offen sc1
v_mfma_f32_16x16x32_bf16 v[116:119], v[160:163], a[184:187], v[116:119]
ds_read_b128 v[152:155], v144 offset:28672
v_mfma_f32_16x16x32_bf16 v[116:119], v[156:159], a[176:179], v[116:119]
v_bfe_u32 v7, v0, 4, 1
s_waitcnt lgkmcnt(4)
v_mfma_f32_16x16x32_bf16 v[120:123], v[164:167], a[176:179], v[120:123]
ds_read_b128 v[156:159], v144 offset:21504
v_mfma_f32_16x16x32_bf16 v[120:123], v[168:171], a[184:187], v[120:123]
buffer_load_dwordx4 a[152:155], v4, s[92:95], s68 offen sc1
v_mfma_f32_16x16x32_bf16 v[136:139], v[168:171], a[188:191], v[136:139]
ds_read_b128 v[160:163], v144 offset:29696
v_mfma_f32_16x16x32_bf16 v[136:139], v[164:167], a[180:183], v[136:139]
v_lshl_add_u32 v6, v7, 5, v6
s_waitcnt lgkmcnt(4)
v_mfma_f32_16x16x32_bf16 v[140:143], v[172:175], a[180:183], v[140:143]
ds_read_b128 v[164:167], v144 offset:22528
s_xor_b32 s69, s7, s46
v_mfma_f32_16x16x32_bf16 v[140:143], v[176:179], a[188:191], v[140:143]
buffer_load_dwordx4 a[156:159], v13, s[92:95], s68 offen sc1
v_mfma_f32_16x16x32_bf16 v[124:127], v[176:179], a[184:187], v[124:127]
ds_read_b128 v[168:171], v144 offset:30720
s_add_u32 m0, s57, 0
v_lshrrev_b32 v7, 5, v0
v_mfma_f32_16x16x32_bf16 v[124:127], v[172:175], a[176:179], v[124:127]
s_waitcnt lgkmcnt(4)
v_mfma_f32_16x16x32_bf16 v[80:83], v[148:151], a[176:179], v[80:83]
ds_read_b128 v[172:175], v144 offset:23552
s_add_u32 s6, s6, s64
v_mfma_f32_16x16x32_bf16 v[80:83], v[152:155], a[184:187], v[80:83]
buffer_load_dwordx4 v253, s[8:11], s69 offen offset:0 sc1 lds
v_mfma_f32_16x16x32_bf16 v[96:99], v[152:155], a[188:191], v[96:99]
ds_read_b128 v[176:179], v144 offset:31744
v_lshl_add_u32 v6, v7, 4, v6
v_mfma_f32_16x16x32_bf16 v[96:99], v[148:151], a[180:183], v[96:99]
s_waitcnt lgkmcnt(4)
s_barrier
v_mfma_f32_16x16x32_bf16 v[100:103], v[156:159], a[180:183], v[100:103]
ds_read_b128 v[148:151], v144 offset:32768
v_mfma_f32_16x16x32_bf16 v[100:103], v[160:163], a[188:191], v[100:103]
buffer_load_dwordx4 v253, s[8:11], s69 offen offset:1024 sc1 lds
v_mfma_f32_16x16x32_bf16 v[84:87], v[160:163], a[184:187], v[84:87]
ds_read_b128 v[152:155], v144 offset:40960
s_add_u32 s7, s7, s64
v_add_u32 v255, s55, v6
v_mfma_f32_16x16x32_bf16 v[84:87], v[156:159], a[176:179], v[84:87]
s_waitcnt lgkmcnt(4)
v_mfma_f32_16x16x32_bf16 v[88:91], v[164:167], a[176:179], v[88:91]
ds_read_b128 v[156:159], v144 offset:33792
v_lshlrev_b32 v252, 4, v0
v_mfma_f32_16x16x32_bf16 v[88:91], v[168:171], a[184:187], v[88:91]
buffer_load_dwordx4 v253, s[8:11], s69 offen offset:2048 sc1 lds
v_mfma_f32_16x16x32_bf16 v[104:107], v[168:171], a[188:191], v[104:107]
ds_read_b128 v[160:163], v144 offset:41984
v_mfma_f32_16x16x32_bf16 v[104:107], v[164:167], a[180:183], v[104:107]
s_waitcnt lgkmcnt(4)
v_mfma_f32_16x16x32_bf16 v[108:111], v[172:175], a[180:183], v[108:111]
ds_read_b128 v[164:167], v144 offset:34816
v_add_u32 v252, s59, v252
v_mfma_f32_16x16x32_bf16 v[108:111], v[176:179], a[188:191], v[108:111]
buffer_load_dwordx4 v253, s[8:11], s69 offen offset:3072 sc1 lds
v_mfma_f32_16x16x32_bf16 v[92:95], v[176:179], a[184:187], v[92:95]
ds_read_b128 v[168:171], v144 offset:43008
v_mfma_f32_16x16x32_bf16 v[92:95], v[172:175], a[176:179], v[92:95]
s_cmp_lg_u32 s40, 0
s_cbranch_scc1 L_main_kernel_g2s
s_and_b32 s55, s2, 1
s_lshl_b32 s55, s55, 2
v_mov_b32 v212, 1
v_lshlrev_b32 v213, 7, v0
v_add_u32 v213, 131072, v213
s_mov_b64 exec, 0xffff
buffer_atomic_add v212, v213, s[32:35], s55 offen offset:64 sc1
s_mov_b64 exec, -1
L_main_kernel_g2s:
s_lshr_b32 s55, s79, 8
s_cmp_lt_u32 s55, 2
s_cbranch_scc1 L_main_kernel_wa
L_main_kernel_wb:
s_sub_u32 s42, s55, 14
L_main_kernel_wc:
s_cmp_eq_u32 s42, 0
s_cbranch_scc1 L_main_kernel_r0
s_swappc_b64 s[62:63], s[52:53]
L_main_kernel_r0:
buffer_load_dword v14, off, s[32:35], s76 offset:64 sc0 sc1
s_mov_b32 s42, 2
s_swappc_b64 s[62:63], s[52:53]
s_waitcnt vmcnt(16)
s_mov_b32 s59, 0x20000
L_main_kernel_w2:
v_readfirstlane_b32 s55, v14
s_sub_u32 s59, s59, 1
s_cmp_ge_u32 s55, 128
s_cbranch_scc1 L_main_kernel_w2d
s_cmp_eq_u32 s59, 0
s_cbranch_scc1 L_main_kernel_w2d
s_sleep 8
buffer_load_dword v14, off, s[32:35], s76 offset:64 sc0 sc1
s_waitcnt vmcnt(0)
s_branch L_main_kernel_w2
L_main_kernel_w2d:
s_mov_b32 s7, s58
s_mov_b32 s6, s54
s_xor_b32 s79, s82, 0x200
s_mov_b32 s42, 6
s_swappc_b64 s[62:63], s[52:53]
buffer_store_dwordx4 v[112:115], v252, s[84:87], s72 offen offset:0 sc0 sc1
v_mov_b64 v[180:181], v[80:81]
v_mov_b64 v[182:183], v[82:83]
v_mov_b64 v[80:81], 0
v_mov_b64 v[82:83], 0
buffer_store_dwordx4 v[116:119], v252, s[84:87], s72 offen offset:1024 sc0 sc1
v_mov_b64 v[184:185], v[84:85]
v_mov_b64 v[186:187], v[86:87]
v_mov_b64 v[84:85], 0
v_mov_b64 v[86:87], 0
buffer_store_dwordx4 v[120:123], v252, s[84:87], s72 offen offset:2048 sc0 sc1
v_mov_b64 v[188:189], v[88:89]
v_mov_b64 v[190:191], v[90:91]
v_mov_b64 v[88:89], 0
v_mov_b64 v[90:91], 0
buffer_store_dwordx4 v[124:127], v252, s[84:87], s72 offen offset:3072 sc0 sc1
v_mov_b64 v[192:193], v[92:93]
v_mov_b64 v[194:195], v[94:95]
v_mov_b64 v[92:93], 0
v_mov_b64 v[94:95], 0
buffer_store_dwordx4 v[128:131], v252, s[84:87], s73 offen offset:0 sc0 sc1
v_mov_b64 v[196:197], v[96:97]
v_mov_b64 v[198:199], v[98:99]
v_mov_b64 v[96:97], 0
v_mov_b64 v[98:99], 0
buffer_store_dwordx4 v[132:135], v252, s[84:87], s73 offen offset:1024 sc0 sc1
v_mov_b64 v[200:201], v[100:101]
v_mov_b64 v[202:203], v[102:103]
v_mov_b64 v[100:101], 0
v_mov_b64 v[102:103], 0
buffer_store_dwordx4 v[136:139], v252, s[84:87], s73 offen offset:2048 sc0 sc1
v_mov_b64 v[204:205], v[104:105]
v_mov_b64 v[206:207], v[106:107]
v_mov_b64 v[104:105], 0
v_mov_b64 v[106:107], 0
buffer_store_dwordx4 v[140:143], v252, s[84:87], s73 offen offset:3072 sc0 sc1
v_mov_b64 v[208:209], v[108:109]
v_mov_b64 v[210:211], v[110:111]
v_mov_b64 v[108:109], 0
v_mov_b64 v[110:111], 0
v_mov_b64 v[112:113], 0
v_mov_b64 v[114:115], 0
v_mov_b64 v[116:117], 0
v_mov_b64 v[118:119], 0
v_mov_b64 v[120:121], 0
v_mov_b64 v[122:123], 0
v_mov_b64 v[124:125], 0
v_mov_b64 v[126:127], 0
v_mov_b64 v[128:129], 0
v_mov_b64 v[130:131], 0
v_mov_b64 v[132:133], 0
v_mov_b64 v[134:135], 0
v_mov_b64 v[136:137], 0
v_mov_b64 v[138:139], 0
v_mov_b64 v[140:141], 0
v_mov_b64 v[142:143], 0
v_mov_b32 v14, 1
s_mov_b32 s42, 8
s_swappc_b64 s[62:63], s[52:53]
s_waitcnt vmcnt(48)
buffer_store_dword v14, off, s[32:35], s82 sc0 sc1
buffer_load_dwordx4 v[52:55], v255, s[24:27], 0 offen offset:0
buffer_load_dwordx4 v[60:63], v255, s[24:27], 0 offen offset:64
buffer_load_dwordx4 v[68:71], v255, s[24:27], s74 offen offset:0
buffer_load_dwordx4 v[76:79], v255, s[24:27], s74 offen offset:64
buffer_load_dword v15, off, s[32:35], s76 offset:68 sc0 sc1
s_mov_b32 s42, 2
s_swappc_b64 s[62:63], s[52:53]
s_waitcnt vmcnt(16)
s_mov_b32 s59, 0x20000
L_main_kernel_w3:
v_readfirstlane_b32 s55, v15
s_sub_u32 s59, s59, 1
s_cmp_ge_u32 s55, 128
s_cbranch_scc1 L_main_kernel_w3d
s_cmp_eq_u32 s59, 0
s_cbranch_scc1 L_main_kernel_w3d
s_sleep 8
buffer_load_dword v15, off, s[32:35], s76 offset:68 sc0 sc1
s_waitcnt vmcnt(0)
s_branch L_main_kernel_w3
L_main_kernel_w3d:
s_mov_b32 s42, 8
s_swappc_b64 s[62:63], s[52:53]
s_getpc_b64 s[96:97]
L_main_kernel_cpx:
s_sub_u32 s55, s52, s96
s_sub_u32 s55, s55, L_main_kernel_p3s+4-L_main_kernel_cpx
s_mul_i32 s55, s55, 288
s_add_u32 s55, s55, L_main_kernel_eb-L_main_kernel_cpx
s_mov_b32 s98, L_code_end-L_main_kernel_cpx
s_mov_b32 s99, 0x20000
s_cmp_eq_u32 s40, 1
s_cselect_b32 s55, 0, s55
s_cmp_gt_u32 s40, 1
s_cselect_b32 s98, 0, s98
v_lshlrev_b32 v8, 7, v0
buffer_load_dword v9, v8, s[96:99], s55 offen
buffer_load_dword v14, off, s[32:35], s79 offset:0 sc0 sc1
s_mov_b32 s42, 4
s_swappc_b64 s[62:63], s[52:53]
s_waitcnt vmcnt(32)
s_mov_b32 s59, 0x20000
L_main_kernel_wf:
v_readfirstlane_b32 s55, v14
s_sub_u32 s59, s59, 1
s_cmp_ge_u32 s55, 1
s_cbranch_scc1 L_main_kernel_wfd
s_cmp_eq_u32 s59, 0
s_cbranch_scc1 L_main_kernel_wfd
buffer_load_dword v14, off, s[32:35], s79 offset:0 sc0 sc1
s_waitcnt vmcnt(0)
s_branch L_main_kernel_wf
L_main_kernel_wfd:
v_mov_b32 v14, 1
buffer_load_dwordx4 v[212:215], v252, s[88:91], s72 offen offset:0 sc0 sc1
buffer_load_dwordx4 v[216:219], v252, s[88:91], s72 offen offset:1024 sc0 sc1
buffer_load_dwordx4 v[220:223], v252, s[88:91], s72 offen offset:2048 sc0 sc1
buffer_load_dwordx4 v[224:227], v252, s[88:91], s72 offen offset:3072 sc0 sc1
buffer_load_dwordx4 v[228:231], v252, s[88:91], s73 offen offset:0 sc0 sc1
buffer_load_dwordx4 v[232:235], v252, s[88:91], s73 offen offset:1024 sc0 sc1
buffer_load_dwordx4 v[236:239], v252, s[88:91], s73 offen offset:2048 sc0 sc1
buffer_load_dwordx4 v[240:243], v252, s[88:91], s73 offen offset:3072 sc0 sc1
s_mov_b32 s42, 4
s_swappc_b64 s[62:63], s[52:53]
s_add_u32 s52, s52, 4
s_addc_u32 s53, s53, 0
s_setpc_b64 s[52:53]
L_main_kernel_tl:
buffer_load_dword v6, off, s[32:35], s79 offset:64 sc0 sc1
v_exp_f32 v212, v212
v_exp_f32 v213, v213
v_exp_f32 v214, v214
v_exp_f32 v215, v215
v_exp_f32 v216, v216
v_exp_f32 v217, v217
v_exp_f32 v218, v218
v_exp_f32 v219, v219
v_exp_f32 v220, v220
v_exp_f32 v221, v221
v_exp_f32 v222, v222
v_exp_f32 v223, v223
v_exp_f32 v224, v224
v_exp_f32 v225, v225
v_exp_f32 v226, v226
v_exp_f32 v227, v227
buffer_load_dword v7, off, s[32:35], s79 offset:64 sc0 sc1
v_exp_f32 v228, v228
v_exp_f32 v229, v229
v_exp_f32 v230, v230
v_exp_f32 v231, v231
v_exp_f32 v232, v232
v_exp_f32 v233, v233
v_exp_f32 v234, v234
v_exp_f32 v235, v235
v_exp_f32 v236, v236
v_exp_f32 v237, v237
v_exp_f32 v238, v238
v_exp_f32 v239, v239
v_exp_f32 v240, v240
v_exp_f32 v241, v241
v_exp_f32 v242, v242
v_exp_f32 v243, v243
buffer_load_dword v8, off, s[32:35], s79 offset:64 sc0 sc1
v_pk_add_f32 v[212:213], v[212:213], 1.0 op_sel_hi:[1,0]
v_pk_add_f32 v[214:215], v[214:215], 1.0 op_sel_hi:[1,0]
v_pk_add_f32 v[216:217], v[216:217], 1.0 op_sel_hi:[1,0]
v_pk_add_f32 v[218:219], v[218:219], 1.0 op_sel_hi:[1,0]
v_pk_add_f32 v[220:221], v[220:221], 1.0 op_sel_hi:[1,0]
v_pk_add_f32 v[222:223], v[222:223], 1.0 op_sel_hi:[1,0]
v_pk_add_f32 v[224:225], v[224:225], 1.0 op_sel_hi:[1,0]
v_pk_add_f32 v[226:227], v[226:227], 1.0 op_sel_hi:[1,0]
v_pk_add_f32 v[228:229], v[228:229], 1.0 op_sel_hi:[1,0]
v_pk_add_f32 v[230:231], v[230:231], 1.0 op_sel_hi:[1,0]
v_pk_add_f32 v[232:233], v[232:233], 1.0 op_sel_hi:[1,0]
v_pk_add_f32 v[234:235], v[234:235], 1.0 op_sel_hi:[1,0]
v_pk_add_f32 v[236:237], v[236:237], 1.0 op_sel_hi:[1,0]
v_pk_add_f32 v[238:239], v[238:239], 1.0 op_sel_hi:[1,0]
v_pk_add_f32 v[240:241], v[240:241], 1.0 op_sel_hi:[1,0]
v_pk_add_f32 v[242:243], v[242:243], 1.0 op_sel_hi:[1,0]
buffer_load_dword v9, off, s[32:35], s79 offset:64 sc0 sc1
v_rcp_f32 v212, v212
v_rcp_f32 v213, v213
v_rcp_f32 v214, v214
v_rcp_f32 v215, v215
v_rcp_f32 v216, v216
v_rcp_f32 v217, v217
v_rcp_f32 v218, v218
v_rcp_f32 v219, v219
v_rcp_f32 v220, v220
v_rcp_f32 v221, v221
v_rcp_f32 v222, v222
v_rcp_f32 v223, v223
v_rcp_f32 v224, v224
v_rcp_f32 v225, v225
v_rcp_f32 v226, v226
v_rcp_f32 v227, v227
s_mov_b32 s59, 0x8000
L_main_kernel_ws:
s_waitcnt vmcnt(3)
v_cmp_ne_u32 vcc, 0, v6
s_cbranch_vccnz L_main_kernel_wsd
buffer_load_dword v6, off, s[32:35], s79 offset:64 sc0 sc1
s_sleep 1
s_waitcnt vmcnt(3)
v_cmp_ne_u32 vcc, 0, v7
s_cbranch_vccnz L_main_kernel_wsd
buffer_load_dword v7, off, s[32:35], s79 offset:64 sc0 sc1
s_sleep 1
s_waitcnt vmcnt(3)
v_cmp_ne_u32 vcc, 0, v8
s_cbranch_vccnz L_main_kernel_wsd
buffer_load_dword v8, off, s[32:35], s79 offset:64 sc0 sc1
s_sleep 1
s_waitcnt vmcnt(3)
v_cmp_ne_u32 vcc, 0, v9
s_cbranch_vccnz L_main_kernel_wsd
buffer_load_dword v9, off, s[32:35], s79 offset:64 sc0 sc1
s_sleep 1
s_sub_u32 s59, s59, 1
s_cbranch_scc0 L_main_kernel_ws
L_main_kernel_wsd:
buffer_load_dwordx4 v[16:19], v252, s[88:91], s74 offen offset:0 sc0 sc1
buffer_load_dwordx4 v[20:23], v252, s[88:91], s74 offen offset:1024 sc0 sc1
buffer_load_dwordx4 v[24:27], v252, s[88:91], s74 offen offset:2048 sc0 sc1
buffer_load_dwordx4 v[28:31], v252, s[88:91], s74 offen offset:3072 sc0 sc1
buffer_load_dwordx4 v[32:35], v252, s[88:91], s75 offen offset:0 sc0 sc1
buffer_load_dwordx4 v[36:39], v252, s[88:91], s75 offen offset:1024 sc0 sc1
buffer_load_dwordx4 v[40:43], v252, s[88:91], s75 offen offset:2048 sc0 sc1
buffer_load_dwordx4 v[44:47], v252, s[88:91], s75 offen offset:3072 sc0 sc1
v_rcp_f32 v228, v228
v_rcp_f32 v229, v229
v_rcp_f32 v230, v230
v_rcp_f32 v231, v231
v_rcp_f32 v232, v232
v_rcp_f32 v233, v233
v_rcp_f32 v234, v234
v_rcp_f32 v235, v235
v_rcp_f32 v236, v236
v_rcp_f32 v237, v237
v_rcp_f32 v238, v238
v_rcp_f32 v239, v239
v_rcp_f32 v240, v240
v_rcp_f32 v241, v241
v_rcp_f32 v242, v242
v_rcp_f32 v243, v243
v_pk_mul_f32 v[180:181], v[180:181], v[212:213]
v_pk_mul_f32 v[182:183], v[182:183], v[214:215]
v_pk_mul_f32 v[184:185], v[184:185], v[216:217]
v_pk_mul_f32 v[186:187], v[186:187], v[218:219]
v_pk_mul_f32 v[188:189], v[188:189], v[220:221]
v_pk_mul_f32 v[190:191], v[190:191], v[222:223]
v_pk_mul_f32 v[192:193], v[192:193], v[224:225]
v_pk_mul_f32 v[194:195], v[194:195], v[226:227]
v_pk_mul_f32 v[196:197], v[196:197], v[228:229]
v_pk_mul_f32 v[198:199], v[198:199], v[230:231]
v_pk_mul_f32 v[200:201], v[200:201], v[232:233]
v_pk_mul_f32 v[202:203], v[202:203], v[234:235]
v_pk_mul_f32 v[204:205], v[204:205], v[236:237]
v_pk_mul_f32 v[206:207], v[206:207], v[238:239]
v_pk_mul_f32 v[208:209], v[208:209], v[240:241]
v_pk_mul_f32 v[210:211], v[210:211], v[242:243]
v_cvt_pk_bf16_f32 v180, 0, v180
v_cvt_pk_bf16_f32 v181, 0, v181
v_cvt_pk_bf16_f32 v182, 0, v182
v_cvt_pk_bf16_f32 v183, 0, v183
v_cvt_pk_bf16_f32 v184, 0, v184
v_cvt_pk_bf16_f32 v185, 0, v185
v_cvt_pk_bf16_f32 v186, 0, v186
v_cvt_pk_bf16_f32 v187, 0, v187
v_cvt_pk_bf16_f32 v188, 0, v188
v_cvt_pk_bf16_f32 v189, 0, v189
v_cvt_pk_bf16_f32 v190, 0, v190
v_cvt_pk_bf16_f32 v191, 0, v191
v_cvt_pk_bf16_f32 v192, 0, v192
v_cvt_pk_bf16_f32 v193, 0, v193
v_cvt_pk_bf16_f32 v194, 0, v194
v_cvt_pk_bf16_f32 v195, 0, v195
v_cvt_pk_bf16_f32 v196, 0, v196
v_cvt_pk_bf16_f32 v197, 0, v197
v_cvt_pk_bf16_f32 v198, 0, v198
v_cvt_pk_bf16_f32 v199, 0, v199
v_cvt_pk_bf16_f32 v200, 0, v200
v_cvt_pk_bf16_f32 v201, 0, v201
v_cvt_pk_bf16_f32 v202, 0, v202
v_cvt_pk_bf16_f32 v203, 0, v203
v_cvt_pk_bf16_f32 v204, 0, v204
v_cvt_pk_bf16_f32 v205, 0, v205
v_cvt_pk_bf16_f32 v206, 0, v206
v_cvt_pk_bf16_f32 v207, 0, v207
v_cvt_pk_bf16_f32 v208, 0, v208
v_cvt_pk_bf16_f32 v209, 0, v209
v_cvt_pk_bf16_f32 v210, 0, v210
v_cvt_pk_bf16_f32 v211, 0, v211
s_waitcnt vmcnt(7)
v_pk_add_f32 v[80:81], v[80:81], v[16:17]
v_pk_add_f32 v[82:83], v[82:83], v[18:19]
s_waitcnt vmcnt(6)
v_pk_add_f32 v[84:85], v[84:85], v[20:21]
v_pk_add_f32 v[86:87], v[86:87], v[22:23]
v_cvt_pk_bf16_f32 v80, 0, v80
v_cvt_pk_bf16_f32 v81, 0, v81
v_cvt_pk_bf16_f32 v82, 0, v82
v_cvt_pk_bf16_f32 v83, 0, v83
v_cvt_pk_bf16_f32 v84, 0, v84
v_cvt_pk_bf16_f32 v85, 0, v85
v_cvt_pk_bf16_f32 v86, 0, v86
v_cvt_pk_bf16_f32 v87, 0, v87
v_pk_mul_f32 v[80:81], v[80:81], v[180:181]
v_pk_mul_f32 v[82:83], v[82:83], v[182:183]
v_pk_mul_f32 v[84:85], v[84:85], v[184:185]
v_pk_mul_f32 v[86:87], v[86:87], v[186:187]
v_cvt_pk_bf16_f32 v80, 0, v80
v_cvt_pk_bf16_f32 v81, 0, v81
v_cvt_pk_bf16_f32 v82, 0, v82
v_cvt_pk_bf16_f32 v83, 0, v83
v_cvt_pk_bf16_f32 v84, 0, v84
v_cvt_pk_bf16_f32 v85, 0, v85
v_cvt_pk_bf16_f32 v86, 0, v86
v_cvt_pk_bf16_f32 v87, 0, v87
v_pk_add_f32 v[80:81], v[80:81], v[48:49]
v_pk_add_f32 v[82:83], v[82:83], v[50:51]
v_pk_add_f32 v[84:85], v[84:85], v[52:53]
v_pk_add_f32 v[86:87], v[86:87], v[54:55]
v_cvt_pk_bf16_f32 v212, v80, v81
v_cvt_pk_bf16_f32 v213, v82, v83
v_cvt_pk_bf16_f32 v214, v84, v85
v_cvt_pk_bf16_f32 v215, v86, v87
s_waitcnt vmcnt(5)
v_pk_add_f32 v[88:89], v[88:89], v[24:25]
v_pk_add_f32 v[90:91], v[90:91], v[26:27]
s_waitcnt vmcnt(4)
v_pk_add_f32 v[92:93], v[92:93], v[28:29]
v_pk_add_f32 v[94:95], v[94:95], v[30:31]
v_cvt_pk_bf16_f32 v88, 0, v88
v_cvt_pk_bf16_f32 v89, 0, v89
v_cvt_pk_bf16_f32 v90, 0, v90
v_cvt_pk_bf16_f32 v91, 0, v91
v_cvt_pk_bf16_f32 v92, 0, v92
v_cvt_pk_bf16_f32 v93, 0, v93
v_cvt_pk_bf16_f32 v94, 0, v94
v_cvt_pk_bf16_f32 v95, 0, v95
v_permlane16_swap_b32 v212, v214
v_permlane16_swap_b32 v213, v215
v_pk_mul_f32 v[88:89], v[88:89], v[188:189]
v_pk_mul_f32 v[90:91], v[90:91], v[190:191]
v_pk_mul_f32 v[92:93], v[92:93], v[192:193]
v_pk_mul_f32 v[94:95], v[94:95], v[194:195]
buffer_store_dwordx4 v[212:215], v255, s[28:31], 0 offen offset:0 sc0 sc1
v_cvt_pk_bf16_f32 v88, 0, v88
v_cvt_pk_bf16_f32 v89, 0, v89
v_cvt_pk_bf16_f32 v90, 0, v90
v_cvt_pk_bf16_f32 v91, 0, v91
v_cvt_pk_bf16_f32 v92, 0, v92
v_cvt_pk_bf16_f32 v93, 0, v93
v_cvt_pk_bf16_f32 v94, 0, v94
v_cvt_pk_bf16_f32 v95, 0, v95
v_pk_add_f32 v[88:89], v[88:89], v[56:57]
v_pk_add_f32 v[90:91], v[90:91], v[58:59]
v_pk_add_f32 v[92:93], v[92:93], v[60:61]
v_pk_add_f32 v[94:95], v[94:95], v[62:63]
v_cvt_pk_bf16_f32 v216, v88, v89
v_cvt_pk_bf16_f32 v217, v90, v91
v_cvt_pk_bf16_f32 v218, v92, v93
v_cvt_pk_bf16_f32 v219, v94, v95
s_waitcnt vmcnt(4)
v_pk_add_f32 v[96:97], v[96:97], v[32:33]
v_pk_add_f32 v[98:99], v[98:99], v[34:35]
s_waitcnt vmcnt(3)
v_pk_add_f32 v[100:101], v[100:101], v[36:37]
v_pk_add_f32 v[102:103], v[102:103], v[38:39]
v_cvt_pk_bf16_f32 v96, 0, v96
v_cvt_pk_bf16_f32 v97, 0, v97
v_cvt_pk_bf16_f32 v98, 0, v98
v_cvt_pk_bf16_f32 v99, 0, v99
v_cvt_pk_bf16_f32 v100, 0, v100
v_cvt_pk_bf16_f32 v101, 0, v101
v_cvt_pk_bf16_f32 v102, 0, v102
v_cvt_pk_bf16_f32 v103, 0, v103
v_permlane16_swap_b32 v216, v218
v_permlane16_swap_b32 v217, v219
v_pk_mul_f32 v[96:97], v[96:97], v[196:197]
v_pk_mul_f32 v[98:99], v[98:99], v[198:199]
v_pk_mul_f32 v[100:101], v[100:101], v[200:201]
v_pk_mul_f32 v[102:103], v[102:103], v[202:203]
buffer_store_dwordx4 v[216:219], v255, s[28:31], 0 offen offset:64 sc0 sc1
v_cvt_pk_bf16_f32 v96, 0, v96
v_cvt_pk_bf16_f32 v97, 0, v97
v_cvt_pk_bf16_f32 v98, 0, v98
v_cvt_pk_bf16_f32 v99, 0, v99
v_cvt_pk_bf16_f32 v100, 0, v100
v_cvt_pk_bf16_f32 v101, 0, v101
v_cvt_pk_bf16_f32 v102, 0, v102
v_cvt_pk_bf16_f32 v103, 0, v103
v_pk_add_f32 v[96:97], v[96:97], v[64:65]
v_pk_add_f32 v[98:99], v[98:99], v[66:67]
v_pk_add_f32 v[100:101], v[100:101], v[68:69]
v_pk_add_f32 v[102:103], v[102:103], v[70:71]
v_cvt_pk_bf16_f32 v220, v96, v97
v_cvt_pk_bf16_f32 v221, v98, v99
v_cvt_pk_bf16_f32 v222, v100, v101
v_cvt_pk_bf16_f32 v223, v102, v103
s_waitcnt vmcnt(3)
v_pk_add_f32 v[104:105], v[104:105], v[40:41]
v_pk_add_f32 v[106:107], v[106:107], v[42:43]
s_waitcnt vmcnt(2)
v_pk_add_f32 v[108:109], v[108:109], v[44:45]
v_pk_add_f32 v[110:111], v[110:111], v[46:47]
v_cvt_pk_bf16_f32 v104, 0, v104
v_cvt_pk_bf16_f32 v105, 0, v105
v_cvt_pk_bf16_f32 v106, 0, v106
v_cvt_pk_bf16_f32 v107, 0, v107
v_cvt_pk_bf16_f32 v108, 0, v108
v_cvt_pk_bf16_f32 v109, 0, v109
v_cvt_pk_bf16_f32 v110, 0, v110
v_cvt_pk_bf16_f32 v111, 0, v111
v_permlane16_swap_b32 v220, v222
v_permlane16_swap_b32 v221, v223
v_pk_mul_f32 v[104:105], v[104:105], v[204:205]
v_pk_mul_f32 v[106:107], v[106:107], v[206:207]
v_pk_mul_f32 v[108:109], v[108:109], v[208:209]
v_pk_mul_f32 v[110:111], v[110:111], v[210:211]
buffer_store_dwordx4 v[220:223], v255, s[28:31], s74 offen offset:0 sc0 sc1
v_cvt_pk_bf16_f32 v104, 0, v104
v_cvt_pk_bf16_f32 v105, 0, v105
v_cvt_pk_bf16_f32 v106, 0, v106
v_cvt_pk_bf16_f32 v107, 0, v107
v_cvt_pk_bf16_f32 v108, 0, v108
v_cvt_pk_bf16_f32 v109, 0, v109
v_cvt_pk_bf16_f32 v110, 0, v110
v_cvt_pk_bf16_f32 v111, 0, v111
v_pk_add_f32 v[104:105], v[104:105], v[72:73]
v_pk_add_f32 v[106:107], v[106:107], v[74:75]
v_pk_add_f32 v[108:109], v[108:109], v[76:77]
v_pk_add_f32 v[110:111], v[110:111], v[78:79]
v_cvt_pk_bf16_f32 v224, v104, v105
v_cvt_pk_bf16_f32 v225, v106, v107
v_cvt_pk_bf16_f32 v226, v108, v109
v_cvt_pk_bf16_f32 v227, v110, v111
s_nop 1
v_permlane16_swap_b32 v224, v226
v_permlane16_swap_b32 v225, v227
buffer_store_dwordx4 v[224:227], v255, s[28:31], s74 offen offset:64 sc0 sc1
L_main_kernel_end:
s_endpgm
L_main_kernel_hk:
s_mov_b64 s[12:13], s[16:17]
s_mov_b32 s14, s18
s_mov_b32 s43, s62
s_mov_b32 s44, s63
s_mov_b32 s45, 0x200000
s_mov_b32 s3, 0x10000
s_bitcmp1_b32 s2, 7
s_cselect_b32 s3, 0xffff0000, s3
v_mov_b32 v227, v228
s_mov_b64 exec, 1
buffer_atomic_add_x2 v[2:3], v248, s[88:91], 0 offen offset:8 sc0 sc1
s_mov_b64 exec, -1
s_branch L_main_kernel_hkb
L_main_kernel_g1:
s_mov_b32 s59, 0x20000
v_readfirstlane_b32 s55, v250
s_nop 0
s_cmp_ge_u32 s55, 1
s_cbranch_scc1 L_main_kernel_rke
L_main_kernel_rkl:
buffer_load_dword v250, v251, s[88:91], 0 offen offset:0 sc0 sc1
s_sub_u32 s59, s59, 1
s_waitcnt vmcnt(0)
v_readfirstlane_b32 s55, v250
s_cmp_eq_u32 s59, 0
s_cbranch_scc1 L_main_kernel_rke
s_cmp_ge_u32 s55, 1
s_cbranch_scc1 L_main_kernel_rke
s_sleep 8
s_branch L_main_kernel_rkl
L_main_kernel_rke:
s_mov_b32 s59, 0x20000
v_readfirstlane_b32 s55, v14
s_nop 0
s_cmp_ge_u32 s55, 256
s_cbranch_scc1 L_main_kernel_g1e
L_main_kernel_g1l:
buffer_load_dword v14, v251, s[88:91], 0 offen offset:4 sc0 sc1
s_sub_u32 s59, s59, 1
s_waitcnt vmcnt(0)
v_readfirstlane_b32 s55, v14
s_cmp_eq_u32 s59, 0
s_cbranch_scc1 L_main_kernel_g1e
s_cmp_ge_u32 s55, 256
s_cbranch_scc1 L_main_kernel_g1e
s_sleep 8
s_branch L_main_kernel_g1l
L_main_kernel_g1e:
v_readfirstlane_b32 s77, v250
s_andn2_b32 s65, s2, 7
s_and_b32 s55, s77, 7
s_or_b32 s65, s65, s55
s_lshr_b32 s41, s65, 1
s_lshl_b32 s41, s41, 7
s_add_u32 s41, s41, 163840
s_and_b32 s72, s65, 1
s_bfe_u32 s74, s65, 0x10002
s_lshl_b32 s74, s74, 2
s_lshr_b32 s75, s65, 6
s_add_u32 s74, s74, s75
s_mul_i32 s75, s72, 901120
s_lshl_b32 s64, s72, 15
s_sub_u32 s64, 0x4000, s64
s_lshl_b32 s58, s74, 20
s_add_u32 s7, s58, s75
s_add_u32 s7, s7, 0x800000
s_lshl_b32 s75, s72, 12
s_xor_b32 s75, s75, 0x1000
v_xor_b32 v253, s75, v1
s_mul_i32 s75, s72, 901120
s_bfe_u32 s73, s65, 0x10001
s_lshl_b32 s73, s73, 3
s_bfe_u32 s6, s65, 0x30003
s_add_u32 s73, s73, s6
s_mul_i32 s6, s73, 917504
s_add_u32 s6, s6, s75
s_add_u32 s6, s6, 4194304
s_mul_i32 s75, s72, 1032192
s_lshl_b32 s54, s73, 20
s_add_u32 s54, s54, s75
s_add_u32 s54, s54, 20971520
s_add_u32 s58, s58, s75
s_cmp_lg_u32 s81, 0
s_cselect_b32 s55, s41, 0x40000000
s_lshl_b32 s59, s72, 3
s_lshl_b32 s59, 1, s59
v_writelane_b32 v252, s55, 0
v_mov_b32 v255, s59
s_branch L_main_kernel_g1b
L_main_kernel_wa:
v_mov_b32 v14, 0
s_cmp_eq_u32 s55, 0
s_cbranch_scc0 L_main_kernel_wa1
s_mov_b32 s59, 0x20000
L_main_kernel_wd:
v_readfirstlane_b32 s55, v14
s_sub_u32 s59, s59, 1
s_cmp_ge_u32 s55, 1
s_cbranch_scc1 L_main_kernel_wdd
s_cmp_eq_u32 s59, 0
s_cbranch_scc1 L_main_kernel_wdd
buffer_load_dword v14, off, s[32:35], s41 offset:64 sc0 sc1
s_waitcnt vmcnt(0)
s_branch L_main_kernel_wd
L_main_kernel_wdd:
s_sub_u32 s59, 56, s55
s_bitcmp1_b32 s65, 0
s_cselect_b32 s55, s59, s55
s_min_u32 s55, s55, 42
s_max_u32 s55, s55, 14
s_branch L_main_kernel_wb
L_main_kernel_wa1:
s_mov_b32 s42, 12
s_swappc_b64 s[62:63], s[52:53]
buffer_load_dword v14, off, s[32:35], s41 offset:64 sc0 sc1
s_mov_b32 s42, 2
s_swappc_b64 s[62:63], s[52:53]
s_waitcnt vmcnt(16)
s_mov_b32 s59, 0x20000
L_main_kernel_we:
v_readfirstlane_b32 s55, v14
s_sub_u32 s59, s59, 1
s_cmp_ge_u32 s55, 1
s_cbranch_scc1 L_main_kernel_wed
s_cmp_eq_u32 s59, 0
s_cbranch_scc1 L_main_kernel_wed
buffer_load_dword v14, off, s[32:35], s41 offset:64 sc0 sc1
s_waitcnt vmcnt(0)
s_branch L_main_kernel_we
L_main_kernel_wed:
s_sub_u32 s59, 56, s55
s_bitcmp1_b32 s65, 0
s_cselect_b32 s55, s59, s55
s_min_u32 s55, s55, 42
s_max_u32 s55, s55, 28
s_sub_u32 s42, s55, 28
s_branch L_main_kernel_wc
L_main_kernel_xw:
s_mov_b32 s99, 0x20000
L_main_kernel_xw1:
buffer_load_dword v235, off, s[88:91], s79 sc0 sc1
s_waitcnt vmcnt(0)
v_readfirstlane_b32 s98, v235
s_sub_u32 s99, s99, 1
s_cbranch_scc1 L_main_kernel_xa
s_cmp_lt_u32 s98, 32
s_cbranch_scc1 L_main_kernel_xw1
s_branch L_main_kernel_xa
L_main_kernel_xb:
s_mov_b32 s99, 0x20000
L_main_kernel_xb1:
buffer_load_dword v1, v13, s[84:87], s72 offen offset:0x3f0 sc0 sc1
s_sub_u32 s99, s99, 1
s_waitcnt vmcnt(0)
s_cbranch_scc1 L_main_kernel_xd
v_cmp_eq_u32 vcc, 0, v1
s_nop 4
s_cbranch_vccnz L_main_kernel_xb1
s_branch L_main_kernel_xd
L_main_kernel_fb:
s_mov_b32 s78, 1
v_mov_b32 v13, s40
s_waitcnt vmcnt(0) lgkmcnt(0)
s_barrier
s_branch L_main_kernel_top
L_main_kernel_mx:
s_waitcnt vmcnt(0) lgkmcnt(0)
v_accvgpr_read_b32 v6, a241
v_xor_b32 v7, 64, v6
v_xor_b32 v8, 128, v6
v_xor_b32 v9, 192, v6
v_mov_b32 v128, 0xff800000
v_mov_b32 v132, 0xff800000
v_mov_b32 v136, 0xff800000
v_mov_b32 v140, 0xff800000
s_mov_b32 s56, 0
s_mov_b32 s47, 32
L_main_kernel_fbl:
s_barrier
s_add_u32 m0, s57, 98304
s_nop 0
buffer_load_dwordx4 v6, s[24:27], s56 offen offset:0  lds
buffer_load_dwordx4 v7, s[24:27], s56 offen offset:1024  lds
buffer_load_dwordx4 v8, s[24:27], s56 offen offset:2048  lds
buffer_load_dwordx4 v9, s[24:27], s56 offen offset:3072  lds
s_add_u32 s56, s56, 0x4000
s_waitcnt vmcnt(0)
s_barrier
ds_read_b128 a[192:195], v212 offset:0
ds_read_b128 a[196:199], v213 offset:0
ds_read_b128 a[200:203], v214 offset:0
ds_read_b128 a[204:207], v215 offset:0
ds_read_b128 a[208:211], v212 offset:4096
ds_read_b128 a[212:215], v213 offset:4096
ds_read_b128 a[216:219], v214 offset:4096
ds_read_b128 a[220:223], v215 offset:4096
s_waitcnt lgkmcnt(7)
v_mfma_f32_16x16x32_bf16 v[16:19], a[192:195], a[128:131], 0
s_waitcnt lgkmcnt(6)
v_mfma_f32_16x16x32_bf16 v[16:19], a[196:199], a[132:135], v[16:19]
v_mfma_f32_16x16x32_bf16 v[20:23], a[196:199], a[148:151], 0
v_mfma_f32_16x16x32_bf16 v[20:23], a[192:195], a[144:147], v[20:23]
v_mfma_f32_16x16x32_bf16 v[24:27], a[192:195], a[160:163], 0
v_mfma_f32_16x16x32_bf16 v[24:27], a[196:199], a[164:167], v[24:27]
v_mfma_f32_16x16x32_bf16 v[28:31], a[196:199], a[180:183], 0
v_mfma_f32_16x16x32_bf16 v[28:31], a[192:195], a[176:179], v[28:31]
s_waitcnt lgkmcnt(5)
v_mfma_f32_16x16x32_bf16 v[28:31], a[200:203], a[184:187], v[28:31]
s_waitcnt lgkmcnt(4)
v_mfma_f32_16x16x32_bf16 v[28:31], a[204:207], a[188:191], v[28:31]
v_mfma_f32_16x16x32_bf16 v[24:27], a[204:207], a[172:175], v[24:27]
v_mfma_f32_16x16x32_bf16 v[24:27], a[200:203], a[168:171], v[24:27]
v_mfma_f32_16x16x32_bf16 v[20:23], a[200:203], a[152:155], v[20:23]
v_mfma_f32_16x16x32_bf16 v[20:23], a[204:207], a[156:159], v[20:23]
v_mfma_f32_16x16x32_bf16 v[16:19], a[204:207], a[140:143], v[16:19]
v_mfma_f32_16x16x32_bf16 v[16:19], a[200:203], a[136:139], v[16:19]
s_waitcnt lgkmcnt(3)
v_mfma_f32_16x16x32_bf16 v[32:35], a[208:211], a[128:131], 0
s_waitcnt lgkmcnt(2)
v_mfma_f32_16x16x32_bf16 v[32:35], a[212:215], a[132:135], v[32:35]
v_mfma_f32_16x16x32_bf16 v[36:39], a[212:215], a[148:151], 0
v_mfma_f32_16x16x32_bf16 v[36:39], a[208:211], a[144:147], v[36:39]
v_mfma_f32_16x16x32_bf16 v[40:43], a[208:211], a[160:163], 0
v_mfma_f32_16x16x32_bf16 v[40:43], a[212:215], a[164:167], v[40:43]
v_mfma_f32_16x16x32_bf16 v[44:47], a[212:215], a[180:183], 0
v_mfma_f32_16x16x32_bf16 v[44:47], a[208:211], a[176:179], v[44:47]
s_waitcnt lgkmcnt(1)
v_mfma_f32_16x16x32_bf16 v[44:47], a[216:219], a[184:187], v[44:47]
s_waitcnt lgkmcnt(0)
v_mfma_f32_16x16x32_bf16 v[44:47], a[220:223], a[188:191], v[44:47]
v_mfma_f32_16x16x32_bf16 v[40:43], a[220:223], a[172:175], v[40:43]
v_mfma_f32_16x16x32_bf16 v[40:43], a[216:219], a[168:171], v[40:43]
v_mfma_f32_16x16x32_bf16 v[36:39], a[216:219], a[152:155], v[36:39]
v_mfma_f32_16x16x32_bf16 v[36:39], a[220:223], a[156:159], v[36:39]
v_mfma_f32_16x16x32_bf16 v[32:35], a[220:223], a[140:143], v[32:35]
v_mfma_f32_16x16x32_bf16 v[32:35], a[216:219], a[136:139], v[32:35]
s_nop 7
v_max3_f32 v128, v128, v16, v17
v_max3_f32 v128, v128, v18, v19
v_max3_f32 v128, v128, v32, v33
v_max3_f32 v128, v128, v34, v35
v_max3_f32 v132, v132, v20, v21
v_max3_f32 v132, v132, v22, v23
v_max3_f32 v132, v132, v36, v37
v_max3_f32 v132, v132, v38, v39
v_max3_f32 v136, v136, v24, v25
v_max3_f32 v136, v136, v26, v27
v_max3_f32 v136, v136, v40, v41
v_max3_f32 v136, v136, v42, v43
v_max3_f32 v140, v140, v28, v29
v_max3_f32 v140, v140, v30, v31
v_max3_f32 v140, v140, v44, v45
v_max3_f32 v140, v140, v46, v47
ds_read_b128 a[192:195], v212 offset:8192
ds_read_b128 a[196:199], v213 offset:8192
ds_read_b128 a[200:203], v214 offset:8192
ds_read_b128 a[204:207], v215 offset:8192
ds_read_b128 a[208:211], v212 offset:12288
ds_read_b128 a[212:215], v213 offset:12288
ds_read_b128 a[216:219], v214 offset:12288
ds_read_b128 a[220:223], v215 offset:12288
s_waitcnt lgkmcnt(7)
v_mfma_f32_16x16x32_bf16 v[16:19], a[192:195], a[128:131], 0
s_waitcnt lgkmcnt(6)
v_mfma_f32_16x16x32_bf16 v[16:19], a[196:199], a[132:135], v[16:19]
v_mfma_f32_16x16x32_bf16 v[20:23], a[196:199], a[148:151], 0
v_mfma_f32_16x16x32_bf16 v[20:23], a[192:195], a[144:147], v[20:23]
v_mfma_f32_16x16x32_bf16 v[24:27], a[192:195], a[160:163], 0
v_mfma_f32_16x16x32_bf16 v[24:27], a[196:199], a[164:167], v[24:27]
v_mfma_f32_16x16x32_bf16 v[28:31], a[196:199], a[180:183], 0
v_mfma_f32_16x16x32_bf16 v[28:31], a[192:195], a[176:179], v[28:31]
s_waitcnt lgkmcnt(5)
v_mfma_f32_16x16x32_bf16 v[28:31], a[200:203], a[184:187], v[28:31]
s_waitcnt lgkmcnt(4)
v_mfma_f32_16x16x32_bf16 v[28:31], a[204:207], a[188:191], v[28:31]
v_mfma_f32_16x16x32_bf16 v[24:27], a[204:207], a[172:175], v[24:27]
v_mfma_f32_16x16x32_bf16 v[24:27], a[200:203], a[168:171], v[24:27]
v_mfma_f32_16x16x32_bf16 v[20:23], a[200:203], a[152:155], v[20:23]
v_mfma_f32_16x16x32_bf16 v[20:23], a[204:207], a[156:159], v[20:23]
v_mfma_f32_16x16x32_bf16 v[16:19], a[204:207], a[140:143], v[16:19]
v_mfma_f32_16x16x32_bf16 v[16:19], a[200:203], a[136:139], v[16:19]
s_waitcnt lgkmcnt(3)
v_mfma_f32_16x16x32_bf16 v[32:35], a[208:211], a[128:131], 0
s_waitcnt lgkmcnt(2)
v_mfma_f32_16x16x32_bf16 v[32:35], a[212:215], a[132:135], v[32:35]
v_mfma_f32_16x16x32_bf16 v[36:39], a[212:215], a[148:151], 0
v_mfma_f32_16x16x32_bf16 v[36:39], a[208:211], a[144:147], v[36:39]
v_mfma_f32_16x16x32_bf16 v[40:43], a[208:211], a[160:163], 0
v_mfma_f32_16x16x32_bf16 v[40:43], a[212:215], a[164:167], v[40:43]
v_mfma_f32_16x16x32_bf16 v[44:47], a[212:215], a[180:183], 0
v_mfma_f32_16x16x32_bf16 v[44:47], a[208:211], a[176:179], v[44:47]
s_waitcnt lgkmcnt(1)
v_mfma_f32_16x16x32_bf16 v[44:47], a[216:219], a[184:187], v[44:47]
s_waitcnt lgkmcnt(0)
v_mfma_f32_16x16x32_bf16 v[44:47], a[220:223], a[188:191], v[44:47]
v_mfma_f32_16x16x32_bf16 v[40:43], a[220:223], a[172:175], v[40:43]
v_mfma_f32_16x16x32_bf16 v[40:43], a[216:219], a[168:171], v[40:43]
v_mfma_f32_16x16x32_bf16 v[36:39], a[216:219], a[152:155], v[36:39]
v_mfma_f32_16x16x32_bf16 v[36:39], a[220:223], a[156:159], v[36:39]
v_mfma_f32_16x16x32_bf16 v[32:35], a[220:223], a[140:143], v[32:35]
v_mfma_f32_16x16x32_bf16 v[32:35], a[216:219], a[136:139], v[32:35]
s_nop 7
v_max3_f32 v128, v128, v16, v17
v_max3_f32 v128, v128, v18, v19
v_max3_f32 v128, v128, v32, v33
v_max3_f32 v128, v128, v34, v35
v_max3_f32 v132, v132, v20, v21
v_max3_f32 v132, v132, v22, v23
v_max3_f32 v132, v132, v36, v37
v_max3_f32 v132, v132, v38, v39
v_max3_f32 v136, v136, v24, v25
v_max3_f32 v136, v136, v26, v27
v_max3_f32 v136, v136, v40, v41
v_max3_f32 v136, v136, v42, v43
v_max3_f32 v140, v140, v28, v29
v_max3_f32 v140, v140, v30, v31
v_max3_f32 v140, v140, v44, v45
v_max3_f32 v140, v140, v46, v47
s_sub_u32 s47, s47, 1
s_cmp_lg_u32 s47, 0
s_cbranch_scc1 L_main_kernel_fbl
v_mov_b32 v224, v128
s_nop 1
v_permlane16_swap_b32 v224, v128
s_nop 1
v_max_f32 v128, v128, v224
v_mov_b32 v224, v128
s_nop 1
v_permlane32_swap_b32 v224, v128
s_nop 1
v_max_f32 v128, v128, v224
v_mov_b32 v224, v132
s_nop 1
v_permlane16_swap_b32 v224, v132
s_nop 1
v_max_f32 v132, v132, v224
v_mov_b32 v224, v132
s_nop 1
v_permlane32_swap_b32 v224, v132
s_nop 1
v_max_f32 v132, v132, v224
v_mov_b32 v224, v136
s_nop 1
v_permlane16_swap_b32 v224, v136
s_nop 1
v_max_f32 v136, v136, v224
v_mov_b32 v224, v136
s_nop 1
v_permlane32_swap_b32 v224, v136
s_nop 1
v_max_f32 v136, v136, v224
v_mov_b32 v224, v140
s_nop 1
v_permlane16_swap_b32 v224, v140
s_nop 1
v_max_f32 v140, v140, v224
v_mov_b32 v224, v140
s_nop 1
v_permlane32_swap_b32 v224, v140
s_nop 1
v_max_f32 v140, v140, v224
v_sub_f32 v128, 0, v128
v_mov_b32 v129, v128
v_mov_b32 v130, v128
v_mov_b32 v131, v128
v_sub_f32 v132, 0, v132
v_mov_b32 v133, v132
v_mov_b32 v134, v132
v_mov_b32 v135, v132
v_sub_f32 v136, 0, v136
v_mov_b32 v137, v136
v_mov_b32 v138, v136
v_mov_b32 v139, v136
v_sub_f32 v140, 0, v140
v_mov_b32 v141, v140
v_mov_b32 v142, v140
v_mov_b32 v143, v140
s_barrier
s_add_u32 m0, s57, 98304
s_nop 0
buffer_load_dwordx4 v6, s[24:27], s73 offen offset:0  lds
buffer_load_dwordx4 v7, s[24:27], s73 offen offset:1024  lds
buffer_load_dwordx4 v8, s[24:27], s73 offen offset:2048  lds
buffer_load_dwordx4 v9, s[24:27], s73 offen offset:3072  lds
s_add_u32 m0, s57, 114688
s_nop 0
buffer_load_dwordx4 v6, s[24:27], s74 offen offset:0  lds
buffer_load_dwordx4 v7, s[24:27], s74 offen offset:1024  lds
buffer_load_dwordx4 v8, s[24:27], s74 offen offset:2048  lds
buffer_load_dwordx4 v9, s[24:27], s74 offen offset:3072  lds
s_add_u32 m0, s57, 131072
s_nop 0
buffer_load_dwordx4 v6, s[24:27], s75 offen offset:0  lds
buffer_load_dwordx4 v7, s[24:27], s75 offen offset:1024  lds
buffer_load_dwordx4 v8, s[24:27], s75 offen offset:2048  lds
buffer_load_dwordx4 v9, s[24:27], s75 offen offset:3072  lds
s_add_u32 m0, s57, 147456
s_nop 0
buffer_load_dwordx4 v6, s[24:27], s82 offen offset:0  lds
buffer_load_dwordx4 v7, s[24:27], s82 offen offset:1024  lds
buffer_load_dwordx4 v8, s[24:27], s82 offen offset:2048  lds
buffer_load_dwordx4 v9, s[24:27], s82 offen offset:3072  lds
s_add_u32 m0, s57, 0
s_nop 0
buffer_load_dwordx4 v10, s[28:31], s73 offen offset:0  lds
buffer_load_dwordx4 v11, s[28:31], s73 offen offset:1024  lds
buffer_load_dwordx4 v10, s[28:31], s73 offen offset:2048  lds
buffer_load_dwordx4 v11, s[28:31], s73 offen offset:3072  lds
s_add_u32 m0, s57, 16384
s_nop 0
buffer_load_dwordx4 v10, s[28:31], s74 offen offset:0  lds
buffer_load_dwordx4 v11, s[28:31], s74 offen offset:1024  lds
buffer_load_dwordx4 v10, s[28:31], s74 offen offset:2048  lds
buffer_load_dwordx4 v11, s[28:31], s74 offen offset:3072  lds
s_add_u32 m0, s57, 32768
s_nop 0
buffer_load_dwordx4 v10, s[28:31], s75 offen offset:0  lds
buffer_load_dwordx4 v11, s[28:31], s75 offen offset:1024  lds
buffer_load_dwordx4 v10, s[28:31], s75 offen offset:2048  lds
buffer_load_dwordx4 v11, s[28:31], s75 offen offset:3072  lds
s_add_u32 m0, s57, 49152
s_nop 0
buffer_load_dwordx4 v10, s[28:31], s82 offen offset:0  lds
buffer_load_dwordx4 v11, s[28:31], s82 offen offset:1024  lds
buffer_load_dwordx4 v10, s[28:31], s82 offen offset:2048  lds
buffer_load_dwordx4 v11, s[28:31], s82 offen offset:3072  lds
s_waitcnt vmcnt(0)
s_barrier
ds_read_b128 a[192:195], v212 offset:0
ds_read_b128 a[196:199], v213 offset:0
ds_read_b128 a[200:203], v214 offset:0
ds_read_b128 a[204:207], v215 offset:0
ds_read_b128 a[208:211], v212 offset:4096
ds_read_b128 a[212:215], v213 offset:4096
ds_read_b128 a[216:219], v214 offset:4096
ds_read_b128 a[220:223], v215 offset:4096
s_waitcnt lgkmcnt(7)
v_mfma_f32_16x16x32_bf16 v[16:19], a[192:195], a[128:131], 0
v_accvgpr_read_b32 v6, a241
s_waitcnt lgkmcnt(6)
v_mfma_f32_16x16x32_bf16 v[16:19], a[196:199], a[132:135], v[16:19]
v_bfe_u32 v0, v5, 4, 6
v_add_u32 v6, 0x8000, v6
v_mfma_f32_16x16x32_bf16 v[20:23], a[196:199], a[148:151], 0
v_lshl_add_u32 v1, v0, 4, s57
v_xor_b32 v7, 64, v6
v_mfma_f32_16x16x32_bf16 v[20:23], a[192:195], a[144:147], v[20:23]
v_xor_b32 v8, 128, v6
v_xor_b32 v9, 192, v6
v_mfma_f32_16x16x32_bf16 v[24:27], a[192:195], a[160:163], 0
s_mov_b32 s56, 0x8000
v_accvgpr_read_b32 v216, a245
v_mfma_f32_16x16x32_bf16 v[24:27], a[196:199], a[164:167], v[24:27]
v_accvgpr_read_b32 v254, a246
v_xor_b32 v217, 32, v216
v_mfma_f32_16x16x32_bf16 v[28:31], a[196:199], a[180:183], 0
ds_read_b128 a[196:199], v213 offset:8192
v_xor_b32 v218, 64, v216
v_mfma_f32_16x16x32_bf16 v[28:31], a[192:195], a[176:179], v[28:31]
ds_read_b128 a[192:195], v212 offset:8192
s_waitcnt lgkmcnt(7)
v_mfma_f32_16x16x32_bf16 v[28:31], a[200:203], a[184:187], v[28:31]
v_xor_b32 v219, 96, v216
s_waitcnt lgkmcnt(6)
v_mfma_f32_16x16x32_bf16 v[28:31], a[204:207], a[188:191], v[28:31]
v_xor_b32 v220, 128, v216
v_xor_b32 v221, 160, v216
v_mfma_f32_16x16x32_bf16 v[24:27], a[204:207], a[172:175], v[24:27]
v_xor_b32 v222, 192, v216
v_xor_b32 v223, 224, v216
v_mfma_f32_16x16x32_bf16 v[24:27], a[200:203], a[168:171], v[24:27]
v_mov_b32 v144, 0x3f803f80
v_mov_b32 v145, 0x3f803f80
v_mfma_f32_16x16x32_bf16 v[20:23], a[200:203], a[152:155], v[20:23]
v_mov_b32 v146, 0x3f803f80
v_mov_b32 v147, 0x3f803f80
v_mfma_f32_16x16x32_bf16 v[20:23], a[204:207], a[156:159], v[20:23]
v_mov_b32 v249, 1
v_bfrev_b32 v252, 2
v_mfma_f32_16x16x32_bf16 v[16:19], a[204:207], a[140:143], v[16:19]
ds_read_b128 a[204:207], v215 offset:8192
v_lshl_add_u32 v248, v0, 5, s83
v_mfma_f32_16x16x32_bf16 v[16:19], a[200:203], a[136:139], v[16:19]
ds_read_b128 a[200:203], v214 offset:8192
s_waitcnt lgkmcnt(7)
v_mfma_f32_16x16x32_bf16 v[32:35], a[208:211], a[128:131], 0
v_mov_b32 v251, s80
s_waitcnt lgkmcnt(6)
v_mfma_f32_16x16x32_bf16 v[32:35], a[212:215], a[132:135], v[32:35]
v_mfma_f32_16x16x32_bf16 v[36:39], a[212:215], a[148:151], 0
v_mfma_f32_16x16x32_bf16 v[36:39], a[208:211], a[144:147], v[36:39]
v_mfma_f32_16x16x32_bf16 v[40:43], a[208:211], a[160:163], 0
v_mfma_f32_16x16x32_bf16 v[40:43], a[212:215], a[164:167], v[40:43]
v_mfma_f32_16x16x32_bf16 v[44:47], a[212:215], a[180:183], 0
ds_read_b128 a[212:215], v213 offset:12288
v_mfma_f32_16x16x32_bf16 v[44:47], a[208:211], a[176:179], v[44:47]
ds_read_b128 a[208:211], v212 offset:12288
s_waitcnt lgkmcnt(7)
v_mfma_f32_16x16x32_bf16 v[44:47], a[216:219], a[184:187], v[44:47]
s_waitcnt lgkmcnt(6)
v_mfma_f32_16x16x32_bf16 v[44:47], a[220:223], a[188:191], v[44:47]
v_mfma_f32_16x16x32_bf16 v[40:43], a[220:223], a[172:175], v[40:43]
v_mfma_f32_16x16x32_bf16 v[40:43], a[216:219], a[168:171], v[40:43]
v_mfma_f32_16x16x32_bf16 v[36:39], a[216:219], a[152:155], v[36:39]
v_mfma_f32_16x16x32_bf16 v[36:39], a[220:223], a[156:159], v[36:39]
v_mfma_f32_16x16x32_bf16 v[32:35], a[220:223], a[140:143], v[32:35]
ds_read_b128 a[220:223], v215 offset:12288
v_mfma_f32_16x16x32_bf16 v[32:35], a[216:219], a[136:139], v[32:35]
ds_read_b128 a[216:219], v214 offset:12288
s_nop 7
s_waitcnt lgkmcnt(0)
s_branch L_main_kernel_havemax
.p2align 6
L_main_kernel_p3b:
s_waitcnt lgkmcnt(4)
v_mfma_f32_16x16x32_bf16 v[112:115], v[148:151], v[16:19], v[112:115]
ds_read_b128 v[172:175], v144 offset:35840
s_xor_b32 s68, s6, s46
v_mfma_f32_16x16x32_bf16 v[112:115], v[152:155], v[24:27], v[112:115]
buffer_load_dwordx4 a[160:163], v2, s[92:95], s68 offen sc1
v_mfma_f32_16x16x32_bf16 v[128:131], v[152:155], v[28:31], v[128:131]
ds_read_b128 v[176:179], v144 offset:44032
v_mfma_f32_16x16x32_bf16 v[128:131], v[148:151], v[20:23], v[128:131]
s_waitcnt lgkmcnt(4)
v_mfma_f32_16x16x32_bf16 v[132:135], v[156:159], v[20:23], v[132:135]
ds_read_b128 v[148:151], v144 offset:36864
v_mfma_f32_16x16x32_bf16 v[132:135], v[160:163], v[28:31], v[132:135]
buffer_load_dwordx4 a[164:167], v3, s[92:95], s68 offen sc1
v_mfma_f32_16x16x32_bf16 v[116:119], v[160:163], v[24:27], v[116:119]
ds_read_b128 v[152:155], v144 offset:45056
v_mfma_f32_16x16x32_bf16 v[116:119], v[156:159], v[16:19], v[116:119]
s_waitcnt lgkmcnt(4)
v_mfma_f32_16x16x32_bf16 v[120:123], v[164:167], v[16:19], v[120:123]
ds_read_b128 v[156:159], v144 offset:37888
v_mfma_f32_16x16x32_bf16 v[120:123], v[168:171], v[24:27], v[120:123]
buffer_load_dwordx4 a[168:171], v4, s[92:95], s68 offen sc1
v_mfma_f32_16x16x32_bf16 v[136:139], v[168:171], v[28:31], v[136:139]
ds_read_b128 v[160:163], v144 offset:46080
v_mfma_f32_16x16x32_bf16 v[136:139], v[164:167], v[20:23], v[136:139]
s_waitcnt lgkmcnt(4)
v_mfma_f32_16x16x32_bf16 v[140:143], v[172:175], v[20:23], v[140:143]
ds_read_b128 v[164:167], v144 offset:38912
s_xor_b32 s69, s7, s46
v_mfma_f32_16x16x32_bf16 v[140:143], v[176:179], v[28:31], v[140:143]
buffer_load_dwordx4 a[172:175], v13, s[92:95], s68 offen sc1
v_mfma_f32_16x16x32_bf16 v[124:127], v[176:179], v[24:27], v[124:127]
ds_read_b128 v[168:171], v144 offset:47104
s_add_u32 m0, s57, 147456
v_mfma_f32_16x16x32_bf16 v[124:127], v[172:175], v[16:19], v[124:127]
s_waitcnt lgkmcnt(4)
v_mfma_f32_16x16x32_bf16 v[80:83], v[148:151], v[16:19], v[80:83]
ds_read_b128 v[172:175], v144 offset:39936
s_add_u32 s6, s6, s64
v_mfma_f32_16x16x32_bf16 v[80:83], v[152:155], v[24:27], v[80:83]
buffer_load_dwordx4 v253, s[8:11], s69 offen offset:0 sc1 lds
v_mfma_f32_16x16x32_bf16 v[96:99], v[152:155], v[28:31], v[96:99]
ds_read_b128 v[176:179], v144 offset:48128
v_mfma_f32_16x16x32_bf16 v[96:99], v[148:151], v[20:23], v[96:99]
s_waitcnt vmcnt(37) lgkmcnt(4)
s_barrier
v_mfma_f32_16x16x32_bf16 v[100:103], v[156:159], v[20:23], v[100:103]
ds_read_b128 v[148:151], v144 offset:49152
v_mfma_f32_16x16x32_bf16 v[100:103], v[160:163], v[28:31], v[100:103]
buffer_load_dwordx4 v253, s[8:11], s69 offen offset:1024 sc1 lds
v_mfma_f32_16x16x32_bf16 v[84:87], v[160:163], v[24:27], v[84:87]
ds_read_b128 v[152:155], v144 offset:57344
s_add_u32 s7, s7, s64
v_mfma_f32_16x16x32_bf16 v[84:87], v[156:159], v[16:19], v[84:87]
s_waitcnt lgkmcnt(4)
v_mfma_f32_16x16x32_bf16 v[88:91], v[164:167], v[16:19], v[88:91]
ds_read_b128 v[156:159], v144 offset:50176
s_sub_u32 s42, s42, 1
v_mfma_f32_16x16x32_bf16 v[88:91], v[168:171], v[24:27], v[88:91]
buffer_load_dwordx4 v253, s[8:11], s69 offen offset:2048 sc1 lds
v_mfma_f32_16x16x32_bf16 v[104:107], v[168:171], v[28:31], v[104:107]
ds_read_b128 v[160:163], v144 offset:58368
v_mfma_f32_16x16x32_bf16 v[104:107], v[164:167], v[20:23], v[104:107]
s_waitcnt lgkmcnt(4)
v_mfma_f32_16x16x32_bf16 v[108:111], v[172:175], v[20:23], v[108:111]
ds_read_b128 v[164:167], v144 offset:51200
v_mfma_f32_16x16x32_bf16 v[108:111], v[176:179], v[28:31], v[108:111]
buffer_load_dwordx4 v253, s[8:11], s69 offen offset:3072 sc1 lds
v_mfma_f32_16x16x32_bf16 v[92:95], v[176:179], v[24:27], v[92:95]
ds_read_b128 v[168:171], v144 offset:59392
s_cmp_eq_u32 s42, 0
v_mfma_f32_16x16x32_bf16 v[92:95], v[172:175], v[16:19], v[92:95]
s_cbranch_scc1 L_main_kernel_p3x0
L_main_kernel_p30:
s_waitcnt lgkmcnt(4)
v_mfma_f32_16x16x32_bf16 v[112:115], v[148:151], v[32:35], v[112:115]
ds_read_b128 v[172:175], v144 offset:52224
s_xor_b32 s68, s6, s46
v_mfma_f32_16x16x32_bf16 v[112:115], v[152:155], v[40:43], v[112:115]
buffer_load_dwordx4 a[176:179], v2, s[92:95], s68 offen sc1
v_mfma_f32_16x16x32_bf16 v[128:131], v[152:155], v[44:47], v[128:131]
ds_read_b128 v[176:179], v144 offset:60416
v_mfma_f32_16x16x32_bf16 v[128:131], v[148:151], v[36:39], v[128:131]
s_waitcnt lgkmcnt(4)
v_mfma_f32_16x16x32_bf16 v[132:135], v[156:159], v[36:39], v[132:135]
ds_read_b128 v[148:151], v144 offset:53248
v_mfma_f32_16x16x32_bf16 v[132:135], v[160:163], v[44:47], v[132:135]
buffer_load_dwordx4 a[180:183], v3, s[92:95], s68 offen sc1
v_mfma_f32_16x16x32_bf16 v[116:119], v[160:163], v[40:43], v[116:119]
ds_read_b128 v[152:155], v144 offset:61440
v_mfma_f32_16x16x32_bf16 v[116:119], v[156:159], v[32:35], v[116:119]
s_waitcnt lgkmcnt(4)
v_mfma_f32_16x16x32_bf16 v[120:123], v[164:167], v[32:35], v[120:123]
ds_read_b128 v[156:159], v144 offset:54272
v_mfma_f32_16x16x32_bf16 v[120:123], v[168:171], v[40:43], v[120:123]
buffer_load_dwordx4 a[184:187], v4, s[92:95], s68 offen sc1
v_mfma_f32_16x16x32_bf16 v[136:139], v[168:171], v[44:47], v[136:139]
ds_read_b128 v[160:163], v144 offset:62464
v_mfma_f32_16x16x32_bf16 v[136:139], v[164:167], v[36:39], v[136:139]
s_waitcnt lgkmcnt(4)
v_mfma_f32_16x16x32_bf16 v[140:143], v[172:175], v[36:39], v[140:143]
ds_read_b128 v[164:167], v144 offset:55296
s_xor_b32 s69, s7, s46
v_mfma_f32_16x16x32_bf16 v[140:143], v[176:179], v[44:47], v[140:143]
buffer_load_dwordx4 a[188:191], v13, s[92:95], s68 offen sc1
v_mfma_f32_16x16x32_bf16 v[124:127], v[176:179], v[40:43], v[124:127]
ds_read_b128 v[168:171], v144 offset:63488
s_add_u32 m0, s57, 16384
v_mfma_f32_16x16x32_bf16 v[124:127], v[172:175], v[32:35], v[124:127]
s_waitcnt lgkmcnt(4)
v_mfma_f32_16x16x32_bf16 v[80:83], v[148:151], v[32:35], v[80:83]
ds_read_b128 v[172:175], v144 offset:56320
s_add_u32 s6, s6, s64
v_mfma_f32_16x16x32_bf16 v[80:83], v[152:155], v[40:43], v[80:83]
buffer_load_dwordx4 v253, s[8:11], s69 offen offset:0 sc1 lds
v_mfma_f32_16x16x32_bf16 v[96:99], v[152:155], v[44:47], v[96:99]
ds_read_b128 v[176:179], v144 offset:64512
v_mfma_f32_16x16x32_bf16 v[96:99], v[148:151], v[36:39], v[96:99]
s_waitcnt vmcnt(37) lgkmcnt(4)
s_barrier
v_mfma_f32_16x16x32_bf16 v[100:103], v[156:159], v[36:39], v[100:103]
ds_read_b128 v[148:151], v248 offset:0
v_mfma_f32_16x16x32_bf16 v[100:103], v[160:163], v[44:47], v[100:103]
buffer_load_dwordx4 v253, s[8:11], s69 offen offset:1024 sc1 lds
v_mfma_f32_16x16x32_bf16 v[84:87], v[160:163], v[40:43], v[84:87]
ds_read_b128 v[152:155], v248 offset:8192
s_add_u32 s7, s7, s64
v_mfma_f32_16x16x32_bf16 v[84:87], v[156:159], v[32:35], v[84:87]
s_waitcnt lgkmcnt(4)
v_mfma_f32_16x16x32_bf16 v[88:91], v[164:167], v[32:35], v[88:91]
ds_read_b128 v[156:159], v248 offset:1024
s_sub_u32 s42, s42, 1
v_mfma_f32_16x16x32_bf16 v[88:91], v[168:171], v[40:43], v[88:91]
buffer_load_dwordx4 v253, s[8:11], s69 offen offset:2048 sc1 lds
v_mfma_f32_16x16x32_bf16 v[104:107], v[168:171], v[44:47], v[104:107]
ds_read_b128 v[160:163], v248 offset:9216
v_mfma_f32_16x16x32_bf16 v[104:107], v[164:167], v[36:39], v[104:107]
s_waitcnt lgkmcnt(4)
v_mfma_f32_16x16x32_bf16 v[108:111], v[172:175], v[36:39], v[108:111]
ds_read_b128 v[164:167], v248 offset:2048
v_mfma_f32_16x16x32_bf16 v[108:111], v[176:179], v[44:47], v[108:111]
buffer_load_dwordx4 v253, s[8:11], s69 offen offset:3072 sc1 lds
v_mfma_f32_16x16x32_bf16 v[92:95], v[176:179], v[40:43], v[92:95]
ds_read_b128 v[168:171], v248 offset:10240
s_cmp_eq_u32 s42, 0
v_mfma_f32_16x16x32_bf16 v[92:95], v[172:175], v[32:35], v[92:95]
s_cbranch_scc1 L_main_kernel_p3x1
L_main_kernel_p31:
s_waitcnt lgkmcnt(4)
v_mfma_f32_16x16x32_bf16 v[112:115], v[148:151], a[192:195], v[112:115]
ds_read_b128 v[172:175], v248 offset:3072
s_xor_b32 s68, s6, s46
v_mfma_f32_16x16x32_bf16 v[112:115], v[152:155], a[200:203], v[112:115]
buffer_load_dwordx4 v[16:19], v2, s[92:95], s68 offen sc1
v_mfma_f32_16x16x32_bf16 v[128:131], v[152:155], a[204:207], v[128:131]
ds_read_b128 v[176:179], v248 offset:11264
v_mfma_f32_16x16x32_bf16 v[128:131], v[148:151], a[196:199], v[128:131]
s_waitcnt lgkmcnt(4)
v_mfma_f32_16x16x32_bf16 v[132:135], v[156:159], a[196:199], v[132:135]
ds_read_b128 v[148:151], v248 offset:4096
v_mfma_f32_16x16x32_bf16 v[132:135], v[160:163], a[204:207], v[132:135]
buffer_load_dwordx4 v[20:23], v3, s[92:95], s68 offen sc1
v_mfma_f32_16x16x32_bf16 v[116:119], v[160:163], a[200:203], v[116:119]
ds_read_b128 v[152:155], v248 offset:12288
v_mfma_f32_16x16x32_bf16 v[116:119], v[156:159], a[192:195], v[116:119]
s_waitcnt lgkmcnt(4)
v_mfma_f32_16x16x32_bf16 v[120:123], v[164:167], a[192:195], v[120:123]
ds_read_b128 v[156:159], v248 offset:5120
v_mfma_f32_16x16x32_bf16 v[120:123], v[168:171], a[200:203], v[120:123]
buffer_load_dwordx4 v[24:27], v4, s[92:95], s68 offen sc1
v_mfma_f32_16x16x32_bf16 v[136:139], v[168:171], a[204:207], v[136:139]
ds_read_b128 v[160:163], v248 offset:13312
v_mfma_f32_16x16x32_bf16 v[136:139], v[164:167], a[196:199], v[136:139]
s_waitcnt lgkmcnt(4)
v_mfma_f32_16x16x32_bf16 v[140:143], v[172:175], a[196:199], v[140:143]
ds_read_b128 v[164:167], v248 offset:6144
s_xor_b32 s69, s7, s46
v_mfma_f32_16x16x32_bf16 v[140:143], v[176:179], a[204:207], v[140:143]
buffer_load_dwordx4 v[28:31], v13, s[92:95], s68 offen sc1
v_mfma_f32_16x16x32_bf16 v[124:127], v[176:179], a[200:203], v[124:127]
ds_read_b128 v[168:171], v248 offset:14336
s_add_u32 m0, s57, 32768
v_mfma_f32_16x16x32_bf16 v[124:127], v[172:175], a[192:195], v[124:127]
s_waitcnt lgkmcnt(4)
v_mfma_f32_16x16x32_bf16 v[80:83], v[148:151], a[192:195], v[80:83]
ds_read_b128 v[172:175], v248 offset:7168
s_add_u32 s6, s6, s64
v_mfma_f32_16x16x32_bf16 v[80:83], v[152:155], a[200:203], v[80:83]
buffer_load_dwordx4 v253, s[8:11], s69 offen offset:0 sc1 lds
v_mfma_f32_16x16x32_bf16 v[96:99], v[152:155], a[204:207], v[96:99]
ds_read_b128 v[176:179], v248 offset:15360
v_mfma_f32_16x16x32_bf16 v[96:99], v[148:151], a[196:199], v[96:99]
s_waitcnt vmcnt(37) lgkmcnt(4)
s_barrier
v_mfma_f32_16x16x32_bf16 v[100:103], v[156:159], a[196:199], v[100:103]
ds_read_b128 v[148:151], v248 offset:16384
v_mfma_f32_16x16x32_bf16 v[100:103], v[160:163], a[204:207], v[100:103]
buffer_load_dwordx4 v253, s[8:11], s69 offen offset:1024 sc1 lds
v_mfma_f32_16x16x32_bf16 v[84:87], v[160:163], a[200:203], v[84:87]
ds_read_b128 v[152:155], v248 offset:24576
s_add_u32 s7, s7, s64
v_mfma_f32_16x16x32_bf16 v[84:87], v[156:159], a[192:195], v[84:87]
s_waitcnt lgkmcnt(4)
v_mfma_f32_16x16x32_bf16 v[88:91], v[164:167], a[192:195], v[88:91]
ds_read_b128 v[156:159], v248 offset:17408
s_sub_u32 s42, s42, 1
v_mfma_f32_16x16x32_bf16 v[88:91], v[168:171], a[200:203], v[88:91]
buffer_load_dwordx4 v253, s[8:11], s69 offen offset:2048 sc1 lds
v_mfma_f32_16x16x32_bf16 v[104:107], v[168:171], a[204:207], v[104:107]
ds_read_b128 v[160:163], v248 offset:25600
v_mfma_f32_16x16x32_bf16 v[104:107], v[164:167], a[196:199], v[104:107]
s_waitcnt lgkmcnt(4)
v_mfma_f32_16x16x32_bf16 v[108:111], v[172:175], a[196:199], v[108:111]
ds_read_b128 v[164:167], v248 offset:18432
v_mfma_f32_16x16x32_bf16 v[108:111], v[176:179], a[204:207], v[108:111]
buffer_load_dwordx4 v253, s[8:11], s69 offen offset:3072 sc1 lds
v_mfma_f32_16x16x32_bf16 v[92:95], v[176:179], a[200:203], v[92:95]
ds_read_b128 v[168:171], v248 offset:26624
s_cmp_eq_u32 s42, 0
v_mfma_f32_16x16x32_bf16 v[92:95], v[172:175], a[192:195], v[92:95]
s_cbranch_scc1 L_main_kernel_p3x2
L_main_kernel_p32:
s_waitcnt lgkmcnt(4)
v_mfma_f32_16x16x32_bf16 v[112:115], v[148:151], a[208:211], v[112:115]
ds_read_b128 v[172:175], v248 offset:19456
s_xor_b32 s68, s6, s46
v_mfma_f32_16x16x32_bf16 v[112:115], v[152:155], a[216:219], v[112:115]
buffer_load_dwordx4 v[32:35], v2, s[92:95], s68 offen sc1
v_mfma_f32_16x16x32_bf16 v[128:131], v[152:155], a[220:223], v[128:131]
ds_read_b128 v[176:179], v248 offset:27648
v_mfma_f32_16x16x32_bf16 v[128:131], v[148:151], a[212:215], v[128:131]
s_waitcnt lgkmcnt(4)
v_mfma_f32_16x16x32_bf16 v[132:135], v[156:159], a[212:215], v[132:135]
ds_read_b128 v[148:151], v248 offset:20480
v_mfma_f32_16x16x32_bf16 v[132:135], v[160:163], a[220:223], v[132:135]
buffer_load_dwordx4 v[36:39], v3, s[92:95], s68 offen sc1
v_mfma_f32_16x16x32_bf16 v[116:119], v[160:163], a[216:219], v[116:119]
ds_read_b128 v[152:155], v248 offset:28672
v_mfma_f32_16x16x32_bf16 v[116:119], v[156:159], a[208:211], v[116:119]
s_waitcnt lgkmcnt(4)
v_mfma_f32_16x16x32_bf16 v[120:123], v[164:167], a[208:211], v[120:123]
ds_read_b128 v[156:159], v248 offset:21504
v_mfma_f32_16x16x32_bf16 v[120:123], v[168:171], a[216:219], v[120:123]
buffer_load_dwordx4 v[40:43], v4, s[92:95], s68 offen sc1
v_mfma_f32_16x16x32_bf16 v[136:139], v[168:171], a[220:223], v[136:139]
ds_read_b128 v[160:163], v248 offset:29696
v_mfma_f32_16x16x32_bf16 v[136:139], v[164:167], a[212:215], v[136:139]
s_waitcnt lgkmcnt(4)
v_mfma_f32_16x16x32_bf16 v[140:143], v[172:175], a[212:215], v[140:143]
ds_read_b128 v[164:167], v248 offset:22528
s_xor_b32 s69, s7, s46
v_mfma_f32_16x16x32_bf16 v[140:143], v[176:179], a[220:223], v[140:143]
buffer_load_dwordx4 v[44:47], v13, s[92:95], s68 offen sc1
v_mfma_f32_16x16x32_bf16 v[124:127], v[176:179], a[216:219], v[124:127]
ds_read_b128 v[168:171], v248 offset:30720
s_add_u32 m0, s57, 49152
v_mfma_f32_16x16x32_bf16 v[124:127], v[172:175], a[208:211], v[124:127]
s_waitcnt lgkmcnt(4)
v_mfma_f32_16x16x32_bf16 v[80:83], v[148:151], a[208:211], v[80:83]
ds_read_b128 v[172:175], v248 offset:23552
s_add_u32 s6, s6, s64
v_mfma_f32_16x16x32_bf16 v[80:83], v[152:155], a[216:219], v[80:83]
buffer_load_dwordx4 v253, s[8:11], s69 offen offset:0 sc1 lds
v_mfma_f32_16x16x32_bf16 v[96:99], v[152:155], a[220:223], v[96:99]
ds_read_b128 v[176:179], v248 offset:31744
v_mfma_f32_16x16x32_bf16 v[96:99], v[148:151], a[212:215], v[96:99]
s_waitcnt vmcnt(37) lgkmcnt(4)
s_barrier
v_mfma_f32_16x16x32_bf16 v[100:103], v[156:159], a[212:215], v[100:103]
ds_read_b128 v[148:151], v248 offset:32768
v_mfma_f32_16x16x32_bf16 v[100:103], v[160:163], a[220:223], v[100:103]
buffer_load_dwordx4 v253, s[8:11], s69 offen offset:1024 sc1 lds
v_mfma_f32_16x16x32_bf16 v[84:87], v[160:163], a[216:219], v[84:87]
ds_read_b128 v[152:155], v248 offset:40960
s_add_u32 s7, s7, s64
v_mfma_f32_16x16x32_bf16 v[84:87], v[156:159], a[208:211], v[84:87]
s_waitcnt lgkmcnt(4)
v_mfma_f32_16x16x32_bf16 v[88:91], v[164:167], a[208:211], v[88:91]
ds_read_b128 v[156:159], v248 offset:33792
s_sub_u32 s42, s42, 1
v_mfma_f32_16x16x32_bf16 v[88:91], v[168:171], a[216:219], v[88:91]
buffer_load_dwordx4 v253, s[8:11], s69 offen offset:2048 sc1 lds
v_mfma_f32_16x16x32_bf16 v[104:107], v[168:171], a[220:223], v[104:107]
ds_read_b128 v[160:163], v248 offset:41984
v_mfma_f32_16x16x32_bf16 v[104:107], v[164:167], a[212:215], v[104:107]
s_waitcnt lgkmcnt(4)
v_mfma_f32_16x16x32_bf16 v[108:111], v[172:175], a[212:215], v[108:111]
ds_read_b128 v[164:167], v248 offset:34816
v_mfma_f32_16x16x32_bf16 v[108:111], v[176:179], a[220:223], v[108:111]
buffer_load_dwordx4 v253, s[8:11], s69 offen offset:3072 sc1 lds
v_mfma_f32_16x16x32_bf16 v[92:95], v[176:179], a[216:219], v[92:95]
ds_read_b128 v[168:171], v248 offset:43008
s_cmp_eq_u32 s42, 0
v_mfma_f32_16x16x32_bf16 v[92:95], v[172:175], a[208:211], v[92:95]
s_cbranch_scc1 L_main_kernel_p3x3
L_main_kernel_p33:
s_waitcnt lgkmcnt(4)
v_mfma_f32_16x16x32_bf16 v[112:115], v[148:151], a[128:131], v[112:115]
ds_read_b128 v[172:175], v248 offset:35840
s_xor_b32 s68, s6, s46
v_mfma_f32_16x16x32_bf16 v[112:115], v[152:155], a[136:139], v[112:115]
buffer_load_dwordx4 a[192:195], v2, s[92:95], s68 offen sc1
v_mfma_f32_16x16x32_bf16 v[128:131], v[152:155], a[140:143], v[128:131]
ds_read_b128 v[176:179], v248 offset:44032
v_mfma_f32_16x16x32_bf16 v[128:131], v[148:151], a[132:135], v[128:131]
s_waitcnt lgkmcnt(4)
v_mfma_f32_16x16x32_bf16 v[132:135], v[156:159], a[132:135], v[132:135]
ds_read_b128 v[148:151], v248 offset:36864
v_mfma_f32_16x16x32_bf16 v[132:135], v[160:163], a[140:143], v[132:135]
buffer_load_dwordx4 a[196:199], v3, s[92:95], s68 offen sc1
v_mfma_f32_16x16x32_bf16 v[116:119], v[160:163], a[136:139], v[116:119]
ds_read_b128 v[152:155], v248 offset:45056
v_mfma_f32_16x16x32_bf16 v[116:119], v[156:159], a[128:131], v[116:119]
s_waitcnt lgkmcnt(4)
v_mfma_f32_16x16x32_bf16 v[120:123], v[164:167], a[128:131], v[120:123]
ds_read_b128 v[156:159], v248 offset:37888
v_mfma_f32_16x16x32_bf16 v[120:123], v[168:171], a[136:139], v[120:123]
buffer_load_dwordx4 a[200:203], v4, s[92:95], s68 offen sc1
v_mfma_f32_16x16x32_bf16 v[136:139], v[168:171], a[140:143], v[136:139]
ds_read_b128 v[160:163], v248 offset:46080
v_mfma_f32_16x16x32_bf16 v[136:139], v[164:167], a[132:135], v[136:139]
s_waitcnt lgkmcnt(4)
v_mfma_f32_16x16x32_bf16 v[140:143], v[172:175], a[132:135], v[140:143]
ds_read_b128 v[164:167], v248 offset:38912
s_xor_b32 s69, s7, s46
v_mfma_f32_16x16x32_bf16 v[140:143], v[176:179], a[140:143], v[140:143]
buffer_load_dwordx4 a[204:207], v13, s[92:95], s68 offen sc1
v_mfma_f32_16x16x32_bf16 v[124:127], v[176:179], a[136:139], v[124:127]
ds_read_b128 v[168:171], v248 offset:47104
s_add_u32 m0, s57, 98304
v_mfma_f32_16x16x32_bf16 v[124:127], v[172:175], a[128:131], v[124:127]
s_waitcnt lgkmcnt(4)
v_mfma_f32_16x16x32_bf16 v[80:83], v[148:151], a[128:131], v[80:83]
ds_read_b128 v[172:175], v248 offset:39936
s_add_u32 s6, s6, s64
v_mfma_f32_16x16x32_bf16 v[80:83], v[152:155], a[136:139], v[80:83]
buffer_load_dwordx4 v253, s[8:11], s69 offen offset:0 sc1 lds
v_mfma_f32_16x16x32_bf16 v[96:99], v[152:155], a[140:143], v[96:99]
ds_read_b128 v[176:179], v248 offset:48128
v_mfma_f32_16x16x32_bf16 v[96:99], v[148:151], a[132:135], v[96:99]
s_waitcnt vmcnt(37) lgkmcnt(4)
s_barrier
v_mfma_f32_16x16x32_bf16 v[100:103], v[156:159], a[132:135], v[100:103]
ds_read_b128 v[148:151], v144 offset:0
v_mfma_f32_16x16x32_bf16 v[100:103], v[160:163], a[140:143], v[100:103]
buffer_load_dwordx4 v253, s[8:11], s69 offen offset:1024 sc1 lds
v_mfma_f32_16x16x32_bf16 v[84:87], v[160:163], a[136:139], v[84:87]
ds_read_b128 v[152:155], v144 offset:8192
s_add_u32 s7, s7, s64
v_mfma_f32_16x16x32_bf16 v[84:87], v[156:159], a[128:131], v[84:87]
s_waitcnt lgkmcnt(4)
v_mfma_f32_16x16x32_bf16 v[88:91], v[164:167], a[128:131], v[88:91]
ds_read_b128 v[156:159], v144 offset:1024
s_sub_u32 s42, s42, 1
v_mfma_f32_16x16x32_bf16 v[88:91], v[168:171], a[136:139], v[88:91]
buffer_load_dwordx4 v253, s[8:11], s69 offen offset:2048 sc1 lds
v_mfma_f32_16x16x32_bf16 v[104:107], v[168:171], a[140:143], v[104:107]
ds_read_b128 v[160:163], v144 offset:9216
v_mfma_f32_16x16x32_bf16 v[104:107], v[164:167], a[132:135], v[104:107]
s_waitcnt lgkmcnt(4)
v_mfma_f32_16x16x32_bf16 v[108:111], v[172:175], a[132:135], v[108:111]
ds_read_b128 v[164:167], v144 offset:2048
v_mfma_f32_16x16x32_bf16 v[108:111], v[176:179], a[140:143], v[108:111]
buffer_load_dwordx4 v253, s[8:11], s69 offen offset:3072 sc1 lds
v_mfma_f32_16x16x32_bf16 v[92:95], v[176:179], a[136:139], v[92:95]
ds_read_b128 v[168:171], v144 offset:10240
s_cmp_eq_u32 s42, 0
v_mfma_f32_16x16x32_bf16 v[92:95], v[172:175], a[128:131], v[92:95]
s_cbranch_scc1 L_main_kernel_p3x4
L_main_kernel_p34:
s_waitcnt lgkmcnt(4)
v_mfma_f32_16x16x32_bf16 v[112:115], v[148:151], a[144:147], v[112:115]
ds_read_b128 v[172:175], v144 offset:3072
s_xor_b32 s68, s6, s46
v_mfma_f32_16x16x32_bf16 v[112:115], v[152:155], a[152:155], v[112:115]
buffer_load_dwordx4 a[208:211], v2, s[92:95], s68 offen sc1
v_mfma_f32_16x16x32_bf16 v[128:131], v[152:155], a[156:159], v[128:131]
ds_read_b128 v[176:179], v144 offset:11264
v_mfma_f32_16x16x32_bf16 v[128:131], v[148:151], a[148:151], v[128:131]
s_waitcnt lgkmcnt(4)
v_mfma_f32_16x16x32_bf16 v[132:135], v[156:159], a[148:151], v[132:135]
ds_read_b128 v[148:151], v144 offset:4096
v_mfma_f32_16x16x32_bf16 v[132:135], v[160:163], a[156:159], v[132:135]
buffer_load_dwordx4 a[212:215], v3, s[92:95], s68 offen sc1
v_mfma_f32_16x16x32_bf16 v[116:119], v[160:163], a[152:155], v[116:119]
ds_read_b128 v[152:155], v144 offset:12288
v_mfma_f32_16x16x32_bf16 v[116:119], v[156:159], a[144:147], v[116:119]
s_waitcnt lgkmcnt(4)
v_mfma_f32_16x16x32_bf16 v[120:123], v[164:167], a[144:147], v[120:123]
ds_read_b128 v[156:159], v144 offset:5120
v_mfma_f32_16x16x32_bf16 v[120:123], v[168:171], a[152:155], v[120:123]
buffer_load_dwordx4 a[216:219], v4, s[92:95], s68 offen sc1
v_mfma_f32_16x16x32_bf16 v[136:139], v[168:171], a[156:159], v[136:139]
ds_read_b128 v[160:163], v144 offset:13312
v_mfma_f32_16x16x32_bf16 v[136:139], v[164:167], a[148:151], v[136:139]
s_waitcnt lgkmcnt(4)
v_mfma_f32_16x16x32_bf16 v[140:143], v[172:175], a[148:151], v[140:143]
ds_read_b128 v[164:167], v144 offset:6144
s_xor_b32 s69, s7, s46
v_mfma_f32_16x16x32_bf16 v[140:143], v[176:179], a[156:159], v[140:143]
buffer_load_dwordx4 a[220:223], v13, s[92:95], s68 offen sc1
v_mfma_f32_16x16x32_bf16 v[124:127], v[176:179], a[152:155], v[124:127]
ds_read_b128 v[168:171], v144 offset:14336
s_add_u32 m0, s57, 114688
v_mfma_f32_16x16x32_bf16 v[124:127], v[172:175], a[144:147], v[124:127]
s_waitcnt lgkmcnt(4)
v_mfma_f32_16x16x32_bf16 v[80:83], v[148:151], a[144:147], v[80:83]
ds_read_b128 v[172:175], v144 offset:7168
s_add_u32 s6, s6, s64
v_mfma_f32_16x16x32_bf16 v[80:83], v[152:155], a[152:155], v[80:83]
buffer_load_dwordx4 v253, s[8:11], s69 offen offset:0 sc1 lds
v_mfma_f32_16x16x32_bf16 v[96:99], v[152:155], a[156:159], v[96:99]
ds_read_b128 v[176:179], v144 offset:15360
v_mfma_f32_16x16x32_bf16 v[96:99], v[148:151], a[148:151], v[96:99]
s_waitcnt vmcnt(37) lgkmcnt(4)
s_barrier
v_mfma_f32_16x16x32_bf16 v[100:103], v[156:159], a[148:151], v[100:103]
ds_read_b128 v[148:151], v248 offset:49152
v_mfma_f32_16x16x32_bf16 v[100:103], v[160:163], a[156:159], v[100:103]
buffer_load_dwordx4 v253, s[8:11], s69 offen offset:1024 sc1 lds
v_mfma_f32_16x16x32_bf16 v[84:87], v[160:163], a[152:155], v[84:87]
ds_read_b128 v[152:155], v248 offset:57344
s_add_u32 s7, s7, s64
v_mfma_f32_16x16x32_bf16 v[84:87], v[156:159], a[144:147], v[84:87]
s_waitcnt lgkmcnt(4)
v_mfma_f32_16x16x32_bf16 v[88:91], v[164:167], a[144:147], v[88:91]
ds_read_b128 v[156:159], v248 offset:50176
s_sub_u32 s42, s42, 1
v_mfma_f32_16x16x32_bf16 v[88:91], v[168:171], a[152:155], v[88:91]
buffer_load_dwordx4 v253, s[8:11], s69 offen offset:2048 sc1 lds
v_mfma_f32_16x16x32_bf16 v[104:107], v[168:171], a[156:159], v[104:107]
ds_read_b128 v[160:163], v248 offset:58368
v_mfma_f32_16x16x32_bf16 v[104:107], v[164:167], a[148:151], v[104:107]
s_waitcnt lgkmcnt(4)
v_mfma_f32_16x16x32_bf16 v[108:111], v[172:175], a[148:151], v[108:111]
ds_read_b128 v[164:167], v248 offset:51200
v_mfma_f32_16x16x32_bf16 v[108:111], v[176:179], a[156:159], v[108:111]
buffer_load_dwordx4 v253, s[8:11], s69 offen offset:3072 sc1 lds
v_mfma_f32_16x16x32_bf16 v[92:95], v[176:179], a[152:155], v[92:95]
ds_read_b128 v[168:171], v248 offset:59392
s_cmp_eq_u32 s42, 0
v_mfma_f32_16x16x32_bf16 v[92:95], v[172:175], a[144:147], v[92:95]
s_cbranch_scc1 L_main_kernel_p3x5
L_main_kernel_p35:
s_waitcnt lgkmcnt(4)
v_mfma_f32_16x16x32_bf16 v[112:115], v[148:151], a[160:163], v[112:115]
ds_read_b128 v[172:175], v248 offset:52224
s_xor_b32 s68, s6, s46
v_mfma_f32_16x16x32_bf16 v[112:115], v[152:155], a[168:171], v[112:115]
buffer_load_dwordx4 a[128:131], v2, s[92:95], s68 offen sc1
v_mfma_f32_16x16x32_bf16 v[128:131], v[152:155], a[172:175], v[128:131]
ds_read_b128 v[176:179], v248 offset:60416
v_mfma_f32_16x16x32_bf16 v[128:131], v[148:151], a[164:167], v[128:131]
s_waitcnt lgkmcnt(4)
v_mfma_f32_16x16x32_bf16 v[132:135], v[156:159], a[164:167], v[132:135]
ds_read_b128 v[148:151], v248 offset:53248
v_mfma_f32_16x16x32_bf16 v[132:135], v[160:163], a[172:175], v[132:135]
buffer_load_dwordx4 a[132:135], v3, s[92:95], s68 offen sc1
v_mfma_f32_16x16x32_bf16 v[116:119], v[160:163], a[168:171], v[116:119]
ds_read_b128 v[152:155], v248 offset:61440
v_mfma_f32_16x16x32_bf16 v[116:119], v[156:159], a[160:163], v[116:119]
s_waitcnt lgkmcnt(4)
v_mfma_f32_16x16x32_bf16 v[120:123], v[164:167], a[160:163], v[120:123]
ds_read_b128 v[156:159], v248 offset:54272
v_mfma_f32_16x16x32_bf16 v[120:123], v[168:171], a[168:171], v[120:123]
buffer_load_dwordx4 a[136:139], v4, s[92:95], s68 offen sc1
v_mfma_f32_16x16x32_bf16 v[136:139], v[168:171], a[172:175], v[136:139]
ds_read_b128 v[160:163], v248 offset:62464
v_mfma_f32_16x16x32_bf16 v[136:139], v[164:167], a[164:167], v[136:139]
s_waitcnt lgkmcnt(4)
v_mfma_f32_16x16x32_bf16 v[140:143], v[172:175], a[164:167], v[140:143]
ds_read_b128 v[164:167], v248 offset:55296
s_xor_b32 s69, s7, s46
v_mfma_f32_16x16x32_bf16 v[140:143], v[176:179], a[172:175], v[140:143]
buffer_load_dwordx4 a[140:143], v13, s[92:95], s68 offen sc1
v_mfma_f32_16x16x32_bf16 v[124:127], v[176:179], a[168:171], v[124:127]
ds_read_b128 v[168:171], v248 offset:63488
s_add_u32 m0, s57, 131072
v_mfma_f32_16x16x32_bf16 v[124:127], v[172:175], a[160:163], v[124:127]
s_waitcnt lgkmcnt(4)
v_mfma_f32_16x16x32_bf16 v[80:83], v[148:151], a[160:163], v[80:83]
ds_read_b128 v[172:175], v248 offset:56320
s_add_u32 s6, s6, s64
v_mfma_f32_16x16x32_bf16 v[80:83], v[152:155], a[168:171], v[80:83]
buffer_load_dwordx4 v253, s[8:11], s69 offen offset:0 sc1 lds
v_mfma_f32_16x16x32_bf16 v[96:99], v[152:155], a[172:175], v[96:99]
ds_read_b128 v[176:179], v248 offset:64512
v_mfma_f32_16x16x32_bf16 v[96:99], v[148:151], a[164:167], v[96:99]
s_waitcnt vmcnt(37) lgkmcnt(4)
s_barrier
v_mfma_f32_16x16x32_bf16 v[100:103], v[156:159], a[164:167], v[100:103]
ds_read_b128 v[148:151], v144 offset:16384
v_mfma_f32_16x16x32_bf16 v[100:103], v[160:163], a[172:175], v[100:103]
buffer_load_dwordx4 v253, s[8:11], s69 offen offset:1024 sc1 lds
v_mfma_f32_16x16x32_bf16 v[84:87], v[160:163], a[168:171], v[84:87]
ds_read_b128 v[152:155], v144 offset:24576
s_add_u32 s7, s7, s64
v_mfma_f32_16x16x32_bf16 v[84:87], v[156:159], a[160:163], v[84:87]
s_waitcnt lgkmcnt(4)
v_mfma_f32_16x16x32_bf16 v[88:91], v[164:167], a[160:163], v[88:91]
ds_read_b128 v[156:159], v144 offset:17408
s_sub_u32 s42, s42, 1
v_mfma_f32_16x16x32_bf16 v[88:91], v[168:171], a[168:171], v[88:91]
buffer_load_dwordx4 v253, s[8:11], s69 offen offset:2048 sc1 lds
v_mfma_f32_16x16x32_bf16 v[104:107], v[168:171], a[172:175], v[104:107]
ds_read_b128 v[160:163], v144 offset:25600
v_mfma_f32_16x16x32_bf16 v[104:107], v[164:167], a[164:167], v[104:107]
s_waitcnt lgkmcnt(4)
v_mfma_f32_16x16x32_bf16 v[108:111], v[172:175], a[164:167], v[108:111]
ds_read_b128 v[164:167], v144 offset:18432
v_mfma_f32_16x16x32_bf16 v[108:111], v[176:179], a[172:175], v[108:111]
buffer_load_dwordx4 v253, s[8:11], s69 offen offset:3072 sc1 lds
v_mfma_f32_16x16x32_bf16 v[92:95], v[176:179], a[168:171], v[92:95]
ds_read_b128 v[168:171], v144 offset:26624
s_cmp_eq_u32 s42, 0
v_mfma_f32_16x16x32_bf16 v[92:95], v[172:175], a[160:163], v[92:95]
s_cbranch_scc1 L_main_kernel_p3x6
L_main_kernel_p36:
s_waitcnt lgkmcnt(4)
v_mfma_f32_16x16x32_bf16 v[112:115], v[148:151], a[176:179], v[112:115]
ds_read_b128 v[172:175], v144 offset:19456
s_xor_b32 s68, s6, s46
v_mfma_f32_16x16x32_bf16 v[112:115], v[152:155], a[184:187], v[112:115]
buffer_load_dwordx4 a[144:147], v2, s[92:95], s68 offen sc1
v_mfma_f32_16x16x32_bf16 v[128:131], v[152:155], a[188:191], v[128:131]
ds_read_b128 v[176:179], v144 offset:27648
v_mfma_f32_16x16x32_bf16 v[128:131], v[148:151], a[180:183], v[128:131]
s_waitcnt lgkmcnt(4)
v_mfma_f32_16x16x32_bf16 v[132:135], v[156:159], a[180:183], v[132:135]
ds_read_b128 v[148:151], v144 offset:20480
v_mfma_f32_16x16x32_bf16 v[132:135], v[160:163], a[188:191], v[132:135]
buffer_load_dwordx4 a[148:151], v3, s[92:95], s68 offen sc1
v_mfma_f32_16x16x32_bf16 v[116:119], v[160:163], a[184:187], v[116:119]
ds_read_b128 v[152:155], v144 offset:28672
v_mfma_f32_16x16x32_bf16 v[116:119], v[156:159], a[176:179], v[116:119]
s_waitcnt lgkmcnt(4)
v_mfma_f32_16x16x32_bf16 v[120:123], v[164:167], a[176:179], v[120:123]
ds_read_b128 v[156:159], v144 offset:21504
v_mfma_f32_16x16x32_bf16 v[120:123], v[168:171], a[184:187], v[120:123]
buffer_load_dwordx4 a[152:155], v4, s[92:95], s68 offen sc1
v_mfma_f32_16x16x32_bf16 v[136:139], v[168:171], a[188:191], v[136:139]
ds_read_b128 v[160:163], v144 offset:29696
v_mfma_f32_16x16x32_bf16 v[136:139], v[164:167], a[180:183], v[136:139]
s_waitcnt lgkmcnt(4)
v_mfma_f32_16x16x32_bf16 v[140:143], v[172:175], a[180:183], v[140:143]
ds_read_b128 v[164:167], v144 offset:22528
s_xor_b32 s69, s7, s46
v_mfma_f32_16x16x32_bf16 v[140:143], v[176:179], a[188:191], v[140:143]
buffer_load_dwordx4 a[156:159], v13, s[92:95], s68 offen sc1
v_mfma_f32_16x16x32_bf16 v[124:127], v[176:179], a[184:187], v[124:127]
ds_read_b128 v[168:171], v144 offset:30720
s_add_u32 m0, s57, 0
v_mfma_f32_16x16x32_bf16 v[124:127], v[172:175], a[176:179], v[124:127]
s_waitcnt lgkmcnt(4)
v_mfma_f32_16x16x32_bf16 v[80:83], v[148:151], a[176:179], v[80:83]
ds_read_b128 v[172:175], v144 offset:23552
s_add_u32 s6, s6, s64
v_mfma_f32_16x16x32_bf16 v[80:83], v[152:155], a[184:187], v[80:83]
buffer_load_dwordx4 v253, s[8:11], s69 offen offset:0 sc1 lds
v_mfma_f32_16x16x32_bf16 v[96:99], v[152:155], a[188:191], v[96:99]
ds_read_b128 v[176:179], v144 offset:31744
v_mfma_f32_16x16x32_bf16 v[96:99], v[148:151], a[180:183], v[96:99]
s_waitcnt vmcnt(37) lgkmcnt(4)
s_barrier
v_mfma_f32_16x16x32_bf16 v[100:103], v[156:159], a[180:183], v[100:103]
ds_read_b128 v[148:151], v144 offset:32768
v_mfma_f32_16x16x32_bf16 v[100:103], v[160:163], a[188:191], v[100:103]
buffer_load_dwordx4 v253, s[8:11], s69 offen offset:1024 sc1 lds
v_mfma_f32_16x16x32_bf16 v[84:87], v[160:163], a[184:187], v[84:87]
ds_read_b128 v[152:155], v144 offset:40960
s_add_u32 s7, s7, s64
v_mfma_f32_16x16x32_bf16 v[84:87], v[156:159], a[176:179], v[84:87]
s_waitcnt lgkmcnt(4)
v_mfma_f32_16x16x32_bf16 v[88:91], v[164:167], a[176:179], v[88:91]
ds_read_b128 v[156:159], v144 offset:33792
s_sub_u32 s42, s42, 1
v_mfma_f32_16x16x32_bf16 v[88:91], v[168:171], a[184:187], v[88:91]
buffer_load_dwordx4 v253, s[8:11], s69 offen offset:2048 sc1 lds
v_mfma_f32_16x16x32_bf16 v[104:107], v[168:171], a[188:191], v[104:107]
ds_read_b128 v[160:163], v144 offset:41984
v_mfma_f32_16x16x32_bf16 v[104:107], v[164:167], a[180:183], v[104:107]
s_waitcnt lgkmcnt(4)
v_mfma_f32_16x16x32_bf16 v[108:111], v[172:175], a[180:183], v[108:111]
ds_read_b128 v[164:167], v144 offset:34816
v_mfma_f32_16x16x32_bf16 v[108:111], v[176:179], a[188:191], v[108:111]
buffer_load_dwordx4 v253, s[8:11], s69 offen offset:3072 sc1 lds
v_mfma_f32_16x16x32_bf16 v[92:95], v[176:179], a[184:187], v[92:95]
ds_read_b128 v[168:171], v144 offset:43008
s_cmp_eq_u32 s42, 0
v_mfma_f32_16x16x32_bf16 v[92:95], v[172:175], a[176:179], v[92:95]
s_cbranch_scc0 L_main_kernel_p3b
L_main_kernel_p3s:
s_swappc_b64 s[52:53], s[62:63]
s_branch L_main_kernel_p3b
s_branch L_main_kernel_e6
L_main_kernel_p3x0:
s_swappc_b64 s[52:53], s[62:63]
s_branch L_main_kernel_p30
s_branch L_main_kernel_e7
L_main_kernel_p3x1:
s_swappc_b64 s[52:53], s[62:63]
s_branch L_main_kernel_p31
s_branch L_main_kernel_e0
L_main_kernel_p3x2:
s_swappc_b64 s[52:53], s[62:63]
s_branch L_main_kernel_p32
s_branch L_main_kernel_e1
L_main_kernel_p3x3:
s_swappc_b64 s[52:53], s[62:63]
s_branch L_main_kernel_p33
s_branch L_main_kernel_e2
L_main_kernel_p3x4:
s_swappc_b64 s[52:53], s[62:63]
s_branch L_main_kernel_p34
s_branch L_main_kernel_e3
L_main_kernel_p3x5:
s_swappc_b64 s[52:53], s[62:63]
s_branch L_main_kernel_p35
s_branch L_main_kernel_e4
L_main_kernel_p3x6:
s_swappc_b64 s[52:53], s[62:63]
s_branch L_main_kernel_p36
s_branch L_main_kernel_e5
.p2align 6
L_main_kernel_eb:
L_main_kernel_e6:
s_waitcnt lgkmcnt(4)
v_mfma_f32_16x16x32_bf16 v[112:115], v[148:151], v[16:19], v[112:115]
ds_read_b128 v[172:175], v144 offset:35840
v_mfma_f32_16x16x32_bf16 v[112:115], v[152:155], v[24:27], v[112:115]
v_mfma_f32_16x16x32_bf16 v[128:131], v[152:155], v[28:31], v[128:131]
ds_read_b128 v[176:179], v144 offset:44032
v_mfma_f32_16x16x32_bf16 v[128:131], v[148:151], v[20:23], v[128:131]
s_waitcnt vmcnt(8)
s_barrier
s_waitcnt lgkmcnt(4)
v_mfma_f32_16x16x32_bf16 v[132:135], v[156:159], v[20:23], v[132:135]
ds_read_b128 v[148:151], v144 offset:49152
s_mov_b32 s37, 0xffff0000
v_mfma_f32_16x16x32_bf16 v[132:135], v[160:163], v[28:31], v[132:135]
s_mov_b32 s38, 0xbfb8aa3b
s_mov_b32 s39, 0xbfb8aa3b
v_mfma_f32_16x16x32_bf16 v[116:119], v[160:163], v[24:27], v[116:119]
ds_read_b128 v[152:155], v144 offset:57344
v_mov_b32 v14, 1
v_mfma_f32_16x16x32_bf16 v[116:119], v[156:159], v[16:19], v[116:119]
v_permlane16_swap_b32 v52, v54
s_waitcnt lgkmcnt(4)
v_mfma_f32_16x16x32_bf16 v[120:123], v[164:167], v[16:19], v[120:123]
ds_read_b128 v[156:159], v144 offset:50176
v_permlane16_swap_b32 v53, v55
v_mfma_f32_16x16x32_bf16 v[120:123], v[168:171], v[24:27], v[120:123]
v_permlane16_swap_b32 v60, v62
v_permlane16_swap_b32 v61, v63
v_mfma_f32_16x16x32_bf16 v[136:139], v[168:171], v[28:31], v[136:139]
ds_read_b128 v[160:163], v144 offset:58368
v_permlane16_swap_b32 v68, v70
v_mfma_f32_16x16x32_bf16 v[136:139], v[164:167], v[20:23], v[136:139]
v_permlane16_swap_b32 v69, v71
s_waitcnt lgkmcnt(4)
v_mfma_f32_16x16x32_bf16 v[140:143], v[172:175], v[20:23], v[140:143]
ds_read_b128 v[164:167], v144 offset:51200
v_permlane16_swap_b32 v76, v78
v_mfma_f32_16x16x32_bf16 v[140:143], v[176:179], v[28:31], v[140:143]
v_permlane16_swap_b32 v77, v79
v_lshlrev_b32 v48, 16, v52
v_mfma_f32_16x16x32_bf16 v[124:127], v[176:179], v[24:27], v[124:127]
ds_read_b128 v[168:171], v144 offset:59392
v_and_b32 v49, s37, v52
v_mfma_f32_16x16x32_bf16 v[124:127], v[172:175], v[16:19], v[124:127]
v_lshlrev_b32 v50, 16, v53
s_waitcnt lgkmcnt(4)
v_mfma_f32_16x16x32_bf16 v[112:115], v[148:151], v[32:35], v[112:115]
ds_read_b128 v[172:175], v144 offset:52224
v_and_b32 v51, s37, v53
v_mfma_f32_16x16x32_bf16 v[112:115], v[152:155], v[40:43], v[112:115]
v_lshlrev_b32 v52, 16, v54
v_and_b32 v53, s37, v54
v_mfma_f32_16x16x32_bf16 v[128:131], v[152:155], v[44:47], v[128:131]
ds_read_b128 v[176:179], v144 offset:60416
v_lshlrev_b32 v54, 16, v55
v_mfma_f32_16x16x32_bf16 v[128:131], v[148:151], v[36:39], v[128:131]
v_and_b32 v55, s37, v55
s_waitcnt lgkmcnt(4)
v_mfma_f32_16x16x32_bf16 v[132:135], v[156:159], v[36:39], v[132:135]
ds_read_b128 v[148:151], v248 offset:0
v_lshlrev_b32 v56, 16, v60
v_mfma_f32_16x16x32_bf16 v[132:135], v[160:163], v[44:47], v[132:135]
v_and_b32 v57, s37, v60
v_lshlrev_b32 v58, 16, v61
v_mfma_f32_16x16x32_bf16 v[116:119], v[160:163], v[40:43], v[116:119]
ds_read_b128 v[152:155], v248 offset:8192
v_and_b32 v59, s37, v61
v_mfma_f32_16x16x32_bf16 v[116:119], v[156:159], v[32:35], v[116:119]
v_lshlrev_b32 v60, 16, v62
s_waitcnt lgkmcnt(4)
v_mfma_f32_16x16x32_bf16 v[120:123], v[164:167], v[32:35], v[120:123]
ds_read_b128 v[156:159], v248 offset:16384
v_and_b32 v61, s37, v62
v_mfma_f32_16x16x32_bf16 v[120:123], v[168:171], v[40:43], v[120:123]
v_lshlrev_b32 v62, 16, v63
v_and_b32 v63, s37, v63
v_mfma_f32_16x16x32_bf16 v[136:139], v[168:171], v[44:47], v[136:139]
ds_read_b128 v[160:163], v248 offset:24576
v_lshlrev_b32 v64, 16, v68
v_mfma_f32_16x16x32_bf16 v[136:139], v[164:167], v[36:39], v[136:139]
v_and_b32 v65, s37, v68
s_waitcnt lgkmcnt(4)
v_mfma_f32_16x16x32_bf16 v[140:143], v[172:175], v[36:39], v[140:143]
ds_read_b128 v[164:167], v248 offset:32768
v_lshlrev_b32 v66, 16, v69
v_mfma_f32_16x16x32_bf16 v[140:143], v[176:179], v[44:47], v[140:143]
v_and_b32 v67, s37, v69
v_lshlrev_b32 v68, 16, v70
v_mfma_f32_16x16x32_bf16 v[124:127], v[176:179], v[40:43], v[124:127]
ds_read_b128 v[168:171], v248 offset:40960
v_and_b32 v69, s37, v70
v_mfma_f32_16x16x32_bf16 v[124:127], v[172:175], v[32:35], v[124:127]
v_lshlrev_b32 v70, 16, v71
s_waitcnt vmcnt(0)
s_barrier
s_waitcnt lgkmcnt(4)
v_mfma_f32_16x16x32_bf16 v[112:115], v[148:151], a[192:195], v[112:115]
ds_read_b128 v[172:175], v144 offset:0
v_and_b32 v71, s37, v71
v_mfma_f32_16x16x32_bf16 v[112:115], v[152:155], a[200:203], v[112:115]
v_lshlrev_b32 v72, 16, v76
v_and_b32 v73, s37, v76
v_mfma_f32_16x16x32_bf16 v[128:131], v[152:155], a[204:207], v[128:131]
ds_read_b128 v[176:179], v144 offset:8192
v_lshlrev_b32 v74, 16, v77
v_mfma_f32_16x16x32_bf16 v[128:131], v[148:151], a[196:199], v[128:131]
v_and_b32 v75, s37, v77
s_waitcnt lgkmcnt(4)
v_mfma_f32_16x16x32_bf16 v[128:131], v[156:159], a[212:215], v[128:131]
ds_read_b128 v[148:151], v248 offset:1024
v_lshlrev_b32 v76, 16, v78
v_mfma_f32_16x16x32_bf16 v[128:131], v[160:163], a[220:223], v[128:131]
v_and_b32 v77, s37, v78
v_lshlrev_b32 v78, 16, v79
v_mfma_f32_16x16x32_bf16 v[112:115], v[160:163], a[216:219], v[112:115]
ds_read_b128 v[152:155], v248 offset:9216
v_and_b32 v79, s37, v79
v_mfma_f32_16x16x32_bf16 v[112:115], v[156:159], a[208:211], v[112:115]
v_add_f32 v180, v180, v212
s_waitcnt lgkmcnt(4)
v_mfma_f32_16x16x32_bf16 v[112:115], v[164:167], a[128:131], v[112:115]
ds_read_b128 v[156:159], v248 offset:17408
v_add_f32 v181, v181, v213
v_mfma_f32_16x16x32_bf16 v[112:115], v[168:171], a[136:139], v[112:115]
v_add_f32 v182, v182, v214
v_add_f32 v183, v183, v215
v_mfma_f32_16x16x32_bf16 v[128:131], v[168:171], a[140:143], v[128:131]
ds_read_b128 v[160:163], v248 offset:25600
v_add_f32 v184, v184, v216
v_mfma_f32_16x16x32_bf16 v[128:131], v[164:167], a[132:135], v[128:131]
v_add_f32 v185, v185, v217
s_waitcnt lgkmcnt(4)
v_mfma_f32_16x16x32_bf16 v[128:131], v[172:175], a[148:151], v[128:131]
ds_read_b128 v[164:167], v248 offset:33792
v_add_f32 v186, v186, v218
v_mfma_f32_16x16x32_bf16 v[128:131], v[176:179], a[156:159], v[128:131]
v_add_f32 v187, v187, v219
v_add_f32 v188, v188, v220
v_mfma_f32_16x16x32_bf16 v[112:115], v[176:179], a[152:155], v[112:115]
ds_read_b128 v[168:171], v248 offset:41984
v_add_f32 v189, v189, v221
v_mfma_f32_16x16x32_bf16 v[112:115], v[172:175], a[144:147], v[112:115]
v_add_f32 v190, v190, v222
s_waitcnt lgkmcnt(4)
v_mfma_f32_16x16x32_bf16 v[116:119], v[148:151], a[192:195], v[116:119]
ds_read_b128 v[172:175], v144 offset:1024
v_add_f32 v191, v191, v223
v_mfma_f32_16x16x32_bf16 v[116:119], v[152:155], a[200:203], v[116:119]
v_add_f32 v192, v192, v224
v_add_f32 v193, v193, v225
v_mfma_f32_16x16x32_bf16 v[132:135], v[152:155], a[204:207], v[132:135]
ds_read_b128 v[176:179], v144 offset:9216
v_add_f32 v194, v194, v226
v_mfma_f32_16x16x32_bf16 v[132:135], v[148:151], a[196:199], v[132:135]
buffer_store_dwordx4 v[128:131], v252, s[84:87], s75 offen offset:0 sc0 sc1
s_waitcnt lgkmcnt(4)
v_mfma_f32_16x16x32_bf16 v[132:135], v[156:159], a[212:215], v[132:135]
ds_read_b128 v[148:151], v248 offset:2048
v_add_f32 v195, v195, v227
v_mfma_f32_16x16x32_bf16 v[132:135], v[160:163], a[220:223], v[132:135]
v_add_f32 v196, v196, v228
v_add_f32 v197, v197, v229
v_mfma_f32_16x16x32_bf16 v[116:119], v[160:163], a[216:219], v[116:119]
ds_read_b128 v[152:155], v248 offset:10240
v_add_f32 v198, v198, v230
v_mfma_f32_16x16x32_bf16 v[116:119], v[156:159], a[208:211], v[116:119]
buffer_store_dwordx4 v[112:115], v252, s[84:87], s74 offen offset:0 sc0 sc1
s_waitcnt lgkmcnt(4)
v_mfma_f32_16x16x32_bf16 v[116:119], v[164:167], a[128:131], v[116:119]
ds_read_b128 v[156:159], v248 offset:18432
v_add_f32 v199, v199, v231
v_mfma_f32_16x16x32_bf16 v[116:119], v[168:171], a[136:139], v[116:119]
v_add_f32 v200, v200, v232
v_add_f32 v201, v201, v233
v_mfma_f32_16x16x32_bf16 v[132:135], v[168:171], a[140:143], v[132:135]
ds_read_b128 v[160:163], v248 offset:26624
v_add_f32 v202, v202, v234
v_mfma_f32_16x16x32_bf16 v[132:135], v[164:167], a[132:135], v[132:135]
v_add_f32 v203, v203, v235
s_waitcnt lgkmcnt(4)
v_mfma_f32_16x16x32_bf16 v[132:135], v[172:175], a[148:151], v[132:135]
ds_read_b128 v[164:167], v248 offset:34816
v_add_f32 v204, v204, v236
v_mfma_f32_16x16x32_bf16 v[132:135], v[176:179], a[156:159], v[132:135]
v_add_f32 v205, v205, v237
v_add_f32 v206, v206, v238
v_mfma_f32_16x16x32_bf16 v[116:119], v[176:179], a[152:155], v[116:119]
ds_read_b128 v[168:171], v248 offset:43008
v_add_f32 v207, v207, v239
v_mfma_f32_16x16x32_bf16 v[116:119], v[172:175], a[144:147], v[116:119]
v_add_f32 v208, v208, v240
s_waitcnt lgkmcnt(4)
v_mfma_f32_16x16x32_bf16 v[120:123], v[148:151], a[192:195], v[120:123]
ds_read_b128 v[172:175], v144 offset:2048
v_add_f32 v209, v209, v241
v_mfma_f32_16x16x32_bf16 v[120:123], v[152:155], a[200:203], v[120:123]
v_add_f32 v210, v210, v242
v_add_f32 v211, v211, v243
v_mfma_f32_16x16x32_bf16 v[136:139], v[152:155], a[204:207], v[136:139]
ds_read_b128 v[176:179], v144 offset:10240
v_cvt_pk_bf16_f32 v180, 0, v180
v_mfma_f32_16x16x32_bf16 v[136:139], v[148:151], a[196:199], v[136:139]
buffer_store_dwordx4 v[132:135], v252, s[84:87], s75 offen offset:1024 sc0 sc1
s_waitcnt lgkmcnt(4)
v_mfma_f32_16x16x32_bf16 v[136:139], v[156:159], a[212:215], v[136:139]
ds_read_b128 v[148:151], v248 offset:3072
v_cvt_pk_bf16_f32 v181, 0, v181
v_mfma_f32_16x16x32_bf16 v[136:139], v[160:163], a[220:223], v[136:139]
v_cvt_pk_bf16_f32 v182, 0, v182
v_cvt_pk_bf16_f32 v183, 0, v183
v_mfma_f32_16x16x32_bf16 v[120:123], v[160:163], a[216:219], v[120:123]
ds_read_b128 v[152:155], v248 offset:11264
v_cvt_pk_bf16_f32 v184, 0, v184
v_mfma_f32_16x16x32_bf16 v[120:123], v[156:159], a[208:211], v[120:123]
buffer_store_dwordx4 v[116:119], v252, s[84:87], s74 offen offset:1024 sc0 sc1
s_waitcnt lgkmcnt(4)
v_mfma_f32_16x16x32_bf16 v[120:123], v[164:167], a[128:131], v[120:123]
ds_read_b128 v[156:159], v248 offset:19456
v_cvt_pk_bf16_f32 v185, 0, v185
v_mfma_f32_16x16x32_bf16 v[120:123], v[168:171], a[136:139], v[120:123]
v_cvt_pk_bf16_f32 v186, 0, v186
v_cvt_pk_bf16_f32 v187, 0, v187
v_mfma_f32_16x16x32_bf16 v[136:139], v[168:171], a[140:143], v[136:139]
ds_read_b128 v[160:163], v248 offset:27648
v_cvt_pk_bf16_f32 v188, 0, v188
v_mfma_f32_16x16x32_bf16 v[136:139], v[164:167], a[132:135], v[136:139]
v_cvt_pk_bf16_f32 v189, 0, v189
s_waitcnt lgkmcnt(4)
v_mfma_f32_16x16x32_bf16 v[136:139], v[172:175], a[148:151], v[136:139]
ds_read_b128 v[164:167], v248 offset:35840
v_cvt_pk_bf16_f32 v190, 0, v190
v_mfma_f32_16x16x32_bf16 v[136:139], v[176:179], a[156:159], v[136:139]
v_cvt_pk_bf16_f32 v191, 0, v191
v_cvt_pk_bf16_f32 v192, 0, v192
v_mfma_f32_16x16x32_bf16 v[120:123], v[176:179], a[152:155], v[120:123]
ds_read_b128 v[168:171], v248 offset:44032
v_cvt_pk_bf16_f32 v193, 0, v193
v_mfma_f32_16x16x32_bf16 v[120:123], v[172:175], a[144:147], v[120:123]
v_cvt_pk_bf16_f32 v194, 0, v194
s_waitcnt lgkmcnt(4)
v_mfma_f32_16x16x32_bf16 v[124:127], v[148:151], a[192:195], v[124:127]
ds_read_b128 v[172:175], v144 offset:3072
v_cvt_pk_bf16_f32 v195, 0, v195
v_mfma_f32_16x16x32_bf16 v[124:127], v[152:155], a[200:203], v[124:127]
v_cvt_pk_bf16_f32 v196, 0, v196
v_cvt_pk_bf16_f32 v197, 0, v197
v_mfma_f32_16x16x32_bf16 v[140:143], v[152:155], a[204:207], v[140:143]
ds_read_b128 v[176:179], v144 offset:11264
v_cvt_pk_bf16_f32 v198, 0, v198
v_mfma_f32_16x16x32_bf16 v[140:143], v[148:151], a[196:199], v[140:143]
buffer_store_dwordx4 v[136:139], v252, s[84:87], s75 offen offset:2048 sc0 sc1
s_waitcnt lgkmcnt(4)
v_mfma_f32_16x16x32_bf16 v[140:143], v[156:159], a[212:215], v[140:143]
ds_read_b128 v[148:151], v144 offset:36864
v_cvt_pk_bf16_f32 v199, 0, v199
v_mfma_f32_16x16x32_bf16 v[140:143], v[160:163], a[220:223], v[140:143]
v_cvt_pk_bf16_f32 v200, 0, v200
v_cvt_pk_bf16_f32 v201, 0, v201
v_mfma_f32_16x16x32_bf16 v[124:127], v[160:163], a[216:219], v[124:127]
ds_read_b128 v[152:155], v144 offset:45056
v_cvt_pk_bf16_f32 v202, 0, v202
v_mfma_f32_16x16x32_bf16 v[124:127], v[156:159], a[208:211], v[124:127]
buffer_store_dwordx4 v[120:123], v252, s[84:87], s74 offen offset:2048 sc0 sc1
s_waitcnt lgkmcnt(4)
v_mfma_f32_16x16x32_bf16 v[124:127], v[164:167], a[128:131], v[124:127]
ds_read_b128 v[156:159], v144 offset:37888
v_cvt_pk_bf16_f32 v203, 0, v203
v_mfma_f32_16x16x32_bf16 v[124:127], v[168:171], a[136:139], v[124:127]
v_cvt_pk_bf16_f32 v204, 0, v204
v_cvt_pk_bf16_f32 v205, 0, v205
v_mfma_f32_16x16x32_bf16 v[140:143], v[168:171], a[140:143], v[140:143]
ds_read_b128 v[160:163], v144 offset:46080
v_cvt_pk_bf16_f32 v206, 0, v206
v_mfma_f32_16x16x32_bf16 v[140:143], v[164:167], a[132:135], v[140:143]
v_cvt_pk_bf16_f32 v207, 0, v207
s_waitcnt lgkmcnt(4)
v_mfma_f32_16x16x32_bf16 v[140:143], v[172:175], a[148:151], v[140:143]
ds_read_b128 v[164:167], v144 offset:38912
v_cvt_pk_bf16_f32 v208, 0, v208
v_mfma_f32_16x16x32_bf16 v[140:143], v[176:179], a[156:159], v[140:143]
v_cvt_pk_bf16_f32 v209, 0, v209
v_cvt_pk_bf16_f32 v210, 0, v210
v_mfma_f32_16x16x32_bf16 v[124:127], v[176:179], a[152:155], v[124:127]
ds_read_b128 v[168:171], v144 offset:47104
v_cvt_pk_bf16_f32 v211, 0, v211
v_mfma_f32_16x16x32_bf16 v[124:127], v[172:175], a[144:147], v[124:127]
v_mul_f32 v212, s38, v180
s_waitcnt lgkmcnt(4)
v_mfma_f32_16x16x32_bf16 v[80:83], v[148:151], v[16:19], v[80:83]
ds_read_b128 v[172:175], v144 offset:39936
v_mul_f32 v213, s38, v181
v_mfma_f32_16x16x32_bf16 v[80:83], v[152:155], v[24:27], v[80:83]
v_mul_f32 v214, s38, v182
v_mul_f32 v215, s38, v183
v_mfma_f32_16x16x32_bf16 v[96:99], v[152:155], v[28:31], v[96:99]
ds_read_b128 v[176:179], v144 offset:48128
v_mul_f32 v216, s38, v184
v_mfma_f32_16x16x32_bf16 v[96:99], v[148:151], v[20:23], v[96:99]
buffer_store_dwordx4 v[140:143], v252, s[84:87], s75 offen offset:3072 sc0 sc1
s_waitcnt lgkmcnt(4)
v_mfma_f32_16x16x32_bf16 v[100:103], v[156:159], v[20:23], v[100:103]
ds_read_b128 v[148:151], v144 offset:53248
v_mul_f32 v217, s38, v185
v_mfma_f32_16x16x32_bf16 v[100:103], v[160:163], v[28:31], v[100:103]
v_mul_f32 v218, s38, v186
v_mul_f32 v219, s38, v187
v_mfma_f32_16x16x32_bf16 v[84:87], v[160:163], v[24:27], v[84:87]
ds_read_b128 v[152:155], v144 offset:61440
v_mul_f32 v220, s38, v188
v_mfma_f32_16x16x32_bf16 v[84:87], v[156:159], v[16:19], v[84:87]
buffer_store_dwordx4 v[124:127], v252, s[84:87], s74 offen offset:3072 sc0 sc1
s_waitcnt lgkmcnt(4)
v_mfma_f32_16x16x32_bf16 v[88:91], v[164:167], v[16:19], v[88:91]
ds_read_b128 v[156:159], v144 offset:54272
v_mul_f32 v221, s38, v189
v_mfma_f32_16x16x32_bf16 v[88:91], v[168:171], v[24:27], v[88:91]
v_mul_f32 v222, s38, v190
v_mul_f32 v223, s38, v191
v_mfma_f32_16x16x32_bf16 v[104:107], v[168:171], v[28:31], v[104:107]
ds_read_b128 v[160:163], v144 offset:62464
v_mul_f32 v224, s38, v192
v_mfma_f32_16x16x32_bf16 v[104:107], v[164:167], v[20:23], v[104:107]
v_mul_f32 v225, s38, v193
s_waitcnt lgkmcnt(4)
v_mfma_f32_16x16x32_bf16 v[108:111], v[172:175], v[20:23], v[108:111]
ds_read_b128 v[164:167], v144 offset:55296
v_mul_f32 v226, s38, v194
v_mfma_f32_16x16x32_bf16 v[108:111], v[176:179], v[28:31], v[108:111]
v_mul_f32 v227, s38, v195
v_mul_f32 v228, s38, v196
v_mfma_f32_16x16x32_bf16 v[92:95], v[176:179], v[24:27], v[92:95]
ds_read_b128 v[168:171], v144 offset:63488
v_mul_f32 v229, s38, v197
v_mfma_f32_16x16x32_bf16 v[92:95], v[172:175], v[16:19], v[92:95]
v_mul_f32 v230, s38, v198
s_waitcnt lgkmcnt(4)
v_mfma_f32_16x16x32_bf16 v[80:83], v[148:151], v[32:35], v[80:83]
ds_read_b128 v[172:175], v144 offset:56320
v_mul_f32 v231, s38, v199
v_mfma_f32_16x16x32_bf16 v[80:83], v[152:155], v[40:43], v[80:83]
v_mul_f32 v232, s38, v200
v_mul_f32 v233, s38, v201
v_mfma_f32_16x16x32_bf16 v[96:99], v[152:155], v[44:47], v[96:99]
ds_read_b128 v[176:179], v144 offset:64512
v_mul_f32 v234, s38, v202
v_mfma_f32_16x16x32_bf16 v[96:99], v[148:151], v[36:39], v[96:99]
v_mul_f32 v235, s38, v203
s_waitcnt lgkmcnt(4)
v_mfma_f32_16x16x32_bf16 v[100:103], v[156:159], v[36:39], v[100:103]
ds_read_b128 v[148:151], v248 offset:4096
v_mul_f32 v236, s38, v204
v_mfma_f32_16x16x32_bf16 v[100:103], v[160:163], v[44:47], v[100:103]
v_mul_f32 v237, s38, v205
v_mul_f32 v238, s38, v206
v_mfma_f32_16x16x32_bf16 v[84:87], v[160:163], v[40:43], v[84:87]
ds_read_b128 v[152:155], v248 offset:12288
v_mul_f32 v239, s38, v207
v_mfma_f32_16x16x32_bf16 v[84:87], v[156:159], v[32:35], v[84:87]
v_mul_f32 v240, s38, v208
s_waitcnt lgkmcnt(4)
v_mfma_f32_16x16x32_bf16 v[88:91], v[164:167], v[32:35], v[88:91]
ds_read_b128 v[156:159], v248 offset:5120
v_mul_f32 v241, s38, v209
v_mfma_f32_16x16x32_bf16 v[88:91], v[168:171], v[40:43], v[88:91]
v_mul_f32 v242, s38, v210
v_mul_f32 v243, s38, v211
v_mfma_f32_16x16x32_bf16 v[104:107], v[168:171], v[44:47], v[104:107]
ds_read_b128 v[160:163], v248 offset:13312
v_mfma_f32_16x16x32_bf16 v[104:107], v[164:167], v[36:39], v[104:107]
s_waitcnt lgkmcnt(4)
v_mfma_f32_16x16x32_bf16 v[108:111], v[172:175], v[36:39], v[108:111]
ds_read_b128 v[164:167], v248 offset:6144
v_mfma_f32_16x16x32_bf16 v[108:111], v[176:179], v[44:47], v[108:111]
v_mfma_f32_16x16x32_bf16 v[92:95], v[176:179], v[40:43], v[92:95]
ds_read_b128 v[168:171], v248 offset:14336
v_mfma_f32_16x16x32_bf16 v[92:95], v[172:175], v[32:35], v[92:95]
s_waitcnt lgkmcnt(4)
v_mfma_f32_16x16x32_bf16 v[80:83], v[148:151], a[192:195], v[80:83]
ds_read_b128 v[172:175], v248 offset:7168
v_mfma_f32_16x16x32_bf16 v[80:83], v[152:155], a[200:203], v[80:83]
v_mfma_f32_16x16x32_bf16 v[96:99], v[152:155], a[204:207], v[96:99]
ds_read_b128 v[176:179], v248 offset:15360
v_mfma_f32_16x16x32_bf16 v[96:99], v[148:151], a[196:199], v[96:99]
s_waitcnt lgkmcnt(4)
v_mfma_f32_16x16x32_bf16 v[100:103], v[156:159], a[196:199], v[100:103]
ds_read_b128 v[148:151], v248 offset:20480
v_mfma_f32_16x16x32_bf16 v[100:103], v[160:163], a[204:207], v[100:103]
v_mfma_f32_16x16x32_bf16 v[84:87], v[160:163], a[200:203], v[84:87]
ds_read_b128 v[152:155], v248 offset:28672
v_mfma_f32_16x16x32_bf16 v[84:87], v[156:159], a[192:195], v[84:87]
s_waitcnt lgkmcnt(4)
v_mfma_f32_16x16x32_bf16 v[88:91], v[164:167], a[192:195], v[88:91]
ds_read_b128 v[156:159], v248 offset:21504
v_mfma_f32_16x16x32_bf16 v[88:91], v[168:171], a[200:203], v[88:91]
v_mfma_f32_16x16x32_bf16 v[104:107], v[168:171], a[204:207], v[104:107]
ds_read_b128 v[160:163], v248 offset:29696
v_mfma_f32_16x16x32_bf16 v[104:107], v[164:167], a[196:199], v[104:107]
s_waitcnt lgkmcnt(4)
v_mfma_f32_16x16x32_bf16 v[108:111], v[172:175], a[196:199], v[108:111]
ds_read_b128 v[164:167], v248 offset:22528
v_mfma_f32_16x16x32_bf16 v[108:111], v[176:179], a[204:207], v[108:111]
v_mfma_f32_16x16x32_bf16 v[92:95], v[176:179], a[200:203], v[92:95]
ds_read_b128 v[168:171], v248 offset:30720
v_mfma_f32_16x16x32_bf16 v[92:95], v[172:175], a[192:195], v[92:95]
s_waitcnt lgkmcnt(4)
v_mfma_f32_16x16x32_bf16 v[80:83], v[148:151], a[208:211], v[80:83]
ds_read_b128 v[172:175], v248 offset:23552
v_mfma_f32_16x16x32_bf16 v[80:83], v[152:155], a[216:219], v[80:83]
v_mfma_f32_16x16x32_bf16 v[96:99], v[152:155], a[220:223], v[96:99]
ds_read_b128 v[176:179], v248 offset:31744
v_mfma_f32_16x16x32_bf16 v[96:99], v[148:151], a[212:215], v[96:99]
s_waitcnt lgkmcnt(4)
v_mfma_f32_16x16x32_bf16 v[100:103], v[156:159], a[212:215], v[100:103]
ds_read_b128 v[148:151], v248 offset:36864
v_mfma_f32_16x16x32_bf16 v[100:103], v[160:163], a[220:223], v[100:103]
v_mfma_f32_16x16x32_bf16 v[84:87], v[160:163], a[216:219], v[84:87]
ds_read_b128 v[152:155], v248 offset:45056
v_mfma_f32_16x16x32_bf16 v[84:87], v[156:159], a[208:211], v[84:87]
s_waitcnt lgkmcnt(4)
v_mfma_f32_16x16x32_bf16 v[88:91], v[164:167], a[208:211], v[88:91]
ds_read_b128 v[156:159], v248 offset:37888
v_mfma_f32_16x16x32_bf16 v[88:91], v[168:171], a[216:219], v[88:91]
v_mfma_f32_16x16x32_bf16 v[104:107], v[168:171], a[220:223], v[104:107]
ds_read_b128 v[160:163], v248 offset:46080
v_mfma_f32_16x16x32_bf16 v[104:107], v[164:167], a[212:215], v[104:107]
s_waitcnt lgkmcnt(4)
v_mfma_f32_16x16x32_bf16 v[108:111], v[172:175], a[212:215], v[108:111]
ds_read_b128 v[164:167], v248 offset:38912
v_mfma_f32_16x16x32_bf16 v[108:111], v[176:179], a[220:223], v[108:111]
v_mfma_f32_16x16x32_bf16 v[92:95], v[176:179], a[216:219], v[92:95]
ds_read_b128 v[168:171], v248 offset:47104
v_mfma_f32_16x16x32_bf16 v[92:95], v[172:175], a[208:211], v[92:95]
s_waitcnt lgkmcnt(4)
v_mfma_f32_16x16x32_bf16 v[80:83], v[148:151], a[128:131], v[80:83]
ds_read_b128 v[172:175], v248 offset:39936
v_mfma_f32_16x16x32_bf16 v[80:83], v[152:155], a[136:139], v[80:83]
v_mfma_f32_16x16x32_bf16 v[96:99], v[152:155], a[140:143], v[96:99]
ds_read_b128 v[176:179], v248 offset:48128
v_mfma_f32_16x16x32_bf16 v[96:99], v[148:151], a[132:135], v[96:99]
s_waitcnt vmcnt(0)
buffer_store_dword v14, off, s[32:35], s82 offset:64 sc0 sc1
s_waitcnt lgkmcnt(4)
v_mfma_f32_16x16x32_bf16 v[100:103], v[156:159], a[132:135], v[100:103]
ds_read_b128 v[148:151], v144 offset:4096
v_mfma_f32_16x16x32_bf16 v[100:103], v[160:163], a[140:143], v[100:103]
v_mfma_f32_16x16x32_bf16 v[84:87], v[160:163], a[136:139], v[84:87]
ds_read_b128 v[152:155], v144 offset:12288
v_mfma_f32_16x16x32_bf16 v[84:87], v[156:159], a[128:131], v[84:87]
s_waitcnt lgkmcnt(4)
v_mfma_f32_16x16x32_bf16 v[88:91], v[164:167], a[128:131], v[88:91]
ds_read_b128 v[156:159], v144 offset:5120
v_mfma_f32_16x16x32_bf16 v[88:91], v[168:171], a[136:139], v[88:91]
v_mfma_f32_16x16x32_bf16 v[104:107], v[168:171], a[140:143], v[104:107]
ds_read_b128 v[160:163], v144 offset:13312
v_mfma_f32_16x16x32_bf16 v[104:107], v[164:167], a[132:135], v[104:107]
s_waitcnt lgkmcnt(4)
v_mfma_f32_16x16x32_bf16 v[108:111], v[172:175], a[132:135], v[108:111]
ds_read_b128 v[164:167], v144 offset:6144
v_mfma_f32_16x16x32_bf16 v[108:111], v[176:179], a[140:143], v[108:111]
v_mfma_f32_16x16x32_bf16 v[92:95], v[176:179], a[136:139], v[92:95]
ds_read_b128 v[168:171], v144 offset:14336
v_mfma_f32_16x16x32_bf16 v[92:95], v[172:175], a[128:131], v[92:95]
s_waitcnt lgkmcnt(4)
v_mfma_f32_16x16x32_bf16 v[80:83], v[148:151], a[144:147], v[80:83]
ds_read_b128 v[172:175], v144 offset:7168
v_mfma_f32_16x16x32_bf16 v[80:83], v[152:155], a[152:155], v[80:83]
v_mfma_f32_16x16x32_bf16 v[96:99], v[152:155], a[156:159], v[96:99]
ds_read_b128 v[176:179], v144 offset:15360
v_mfma_f32_16x16x32_bf16 v[96:99], v[148:151], a[148:151], v[96:99]
s_waitcnt lgkmcnt(4)
v_mfma_f32_16x16x32_bf16 v[100:103], v[156:159], a[148:151], v[100:103]
v_mfma_f32_16x16x32_bf16 v[100:103], v[160:163], a[156:159], v[100:103]
v_mfma_f32_16x16x32_bf16 v[84:87], v[160:163], a[152:155], v[84:87]
v_mfma_f32_16x16x32_bf16 v[84:87], v[156:159], a[144:147], v[84:87]
s_waitcnt lgkmcnt(2)
v_mfma_f32_16x16x32_bf16 v[88:91], v[164:167], a[144:147], v[88:91]
v_mfma_f32_16x16x32_bf16 v[88:91], v[168:171], a[152:155], v[88:91]
v_mfma_f32_16x16x32_bf16 v[104:107], v[168:171], a[156:159], v[104:107]
v_mfma_f32_16x16x32_bf16 v[104:107], v[164:167], a[148:151], v[104:107]
s_waitcnt lgkmcnt(0)
v_mfma_f32_16x16x32_bf16 v[108:111], v[172:175], a[148:151], v[108:111]
v_mfma_f32_16x16x32_bf16 v[108:111], v[176:179], a[156:159], v[108:111]
v_mfma_f32_16x16x32_bf16 v[92:95], v[176:179], a[152:155], v[92:95]
v_mfma_f32_16x16x32_bf16 v[92:95], v[172:175], a[144:147], v[92:95]
s_branch L_main_kernel_tl
.org L_main_kernel_eb + 3456
L_main_kernel_e7:
s_waitcnt lgkmcnt(4)
v_mfma_f32_16x16x32_bf16 v[112:115], v[148:151], v[32:35], v[112:115]
ds_read_b128 v[172:175], v144 offset:52224
v_mfma_f32_16x16x32_bf16 v[112:115], v[152:155], v[40:43], v[112:115]
v_mfma_f32_16x16x32_bf16 v[128:131], v[152:155], v[44:47], v[128:131]
ds_read_b128 v[176:179], v144 offset:60416
v_mfma_f32_16x16x32_bf16 v[128:131], v[148:151], v[36:39], v[128:131]
s_waitcnt vmcnt(8)
s_barrier
s_waitcnt lgkmcnt(4)
v_mfma_f32_16x16x32_bf16 v[132:135], v[156:159], v[36:39], v[132:135]
ds_read_b128 v[148:151], v248 offset:0
s_mov_b32 s37, 0xffff0000
v_mfma_f32_16x16x32_bf16 v[132:135], v[160:163], v[44:47], v[132:135]
s_mov_b32 s38, 0xbfb8aa3b
s_mov_b32 s39, 0xbfb8aa3b
v_mfma_f32_16x16x32_bf16 v[116:119], v[160:163], v[40:43], v[116:119]
ds_read_b128 v[152:155], v248 offset:8192
v_mov_b32 v14, 1
v_mfma_f32_16x16x32_bf16 v[116:119], v[156:159], v[32:35], v[116:119]
v_permlane16_swap_b32 v52, v54
s_waitcnt lgkmcnt(4)
v_mfma_f32_16x16x32_bf16 v[120:123], v[164:167], v[32:35], v[120:123]
ds_read_b128 v[156:159], v248 offset:1024
v_permlane16_swap_b32 v53, v55
v_mfma_f32_16x16x32_bf16 v[120:123], v[168:171], v[40:43], v[120:123]
v_permlane16_swap_b32 v60, v62
v_permlane16_swap_b32 v61, v63
v_mfma_f32_16x16x32_bf16 v[136:139], v[168:171], v[44:47], v[136:139]
ds_read_b128 v[160:163], v248 offset:9216
v_permlane16_swap_b32 v68, v70
v_mfma_f32_16x16x32_bf16 v[136:139], v[164:167], v[36:39], v[136:139]
v_permlane16_swap_b32 v69, v71
s_waitcnt lgkmcnt(4)
v_mfma_f32_16x16x32_bf16 v[140:143], v[172:175], v[36:39], v[140:143]
ds_read_b128 v[164:167], v248 offset:2048
v_permlane16_swap_b32 v76, v78
v_mfma_f32_16x16x32_bf16 v[140:143], v[176:179], v[44:47], v[140:143]
v_permlane16_swap_b32 v77, v79
v_lshlrev_b32 v48, 16, v52
v_mfma_f32_16x16x32_bf16 v[124:127], v[176:179], v[40:43], v[124:127]
ds_read_b128 v[168:171], v248 offset:10240
v_and_b32 v49, s37, v52
v_mfma_f32_16x16x32_bf16 v[124:127], v[172:175], v[32:35], v[124:127]
v_lshlrev_b32 v50, 16, v53
s_waitcnt lgkmcnt(4)
v_mfma_f32_16x16x32_bf16 v[112:115], v[148:151], a[192:195], v[112:115]
ds_read_b128 v[172:175], v248 offset:3072
v_and_b32 v51, s37, v53
v_mfma_f32_16x16x32_bf16 v[112:115], v[152:155], a[200:203], v[112:115]
v_lshlrev_b32 v52, 16, v54
v_and_b32 v53, s37, v54
v_mfma_f32_16x16x32_bf16 v[128:131], v[152:155], a[204:207], v[128:131]
ds_read_b128 v[176:179], v248 offset:11264
v_lshlrev_b32 v54, 16, v55
v_mfma_f32_16x16x32_bf16 v[128:131], v[148:151], a[196:199], v[128:131]
v_and_b32 v55, s37, v55
s_waitcnt lgkmcnt(4)
v_mfma_f32_16x16x32_bf16 v[132:135], v[156:159], a[196:199], v[132:135]
ds_read_b128 v[148:151], v248 offset:16384
v_lshlrev_b32 v56, 16, v60
v_mfma_f32_16x16x32_bf16 v[132:135], v[160:163], a[204:207], v[132:135]
v_and_b32 v57, s37, v60
v_lshlrev_b32 v58, 16, v61
v_mfma_f32_16x16x32_bf16 v[116:119], v[160:163], a[200:203], v[116:119]
ds_read_b128 v[152:155], v248 offset:24576
v_and_b32 v59, s37, v61
v_mfma_f32_16x16x32_bf16 v[116:119], v[156:159], a[192:195], v[116:119]
v_lshlrev_b32 v60, 16, v62
s_waitcnt lgkmcnt(4)
v_mfma_f32_16x16x32_bf16 v[120:123], v[164:167], a[192:195], v[120:123]
ds_read_b128 v[156:159], v248 offset:32768
v_and_b32 v61, s37, v62
v_mfma_f32_16x16x32_bf16 v[120:123], v[168:171], a[200:203], v[120:123]
v_lshlrev_b32 v62, 16, v63
v_and_b32 v63, s37, v63
v_mfma_f32_16x16x32_bf16 v[136:139], v[168:171], a[204:207], v[136:139]
ds_read_b128 v[160:163], v248 offset:40960
v_lshlrev_b32 v64, 16, v68
v_mfma_f32_16x16x32_bf16 v[136:139], v[164:167], a[196:199], v[136:139]
v_and_b32 v65, s37, v68
s_waitcnt lgkmcnt(4)
v_mfma_f32_16x16x32_bf16 v[140:143], v[172:175], a[196:199], v[140:143]
ds_read_b128 v[164:167], v144 offset:0
v_lshlrev_b32 v66, 16, v69
v_mfma_f32_16x16x32_bf16 v[140:143], v[176:179], a[204:207], v[140:143]
v_and_b32 v67, s37, v69
v_lshlrev_b32 v68, 16, v70
v_mfma_f32_16x16x32_bf16 v[124:127], v[176:179], a[200:203], v[124:127]
ds_read_b128 v[168:171], v144 offset:8192
v_and_b32 v69, s37, v70
v_mfma_f32_16x16x32_bf16 v[124:127], v[172:175], a[192:195], v[124:127]
v_lshlrev_b32 v70, 16, v71
s_waitcnt vmcnt(0)
s_barrier
s_waitcnt lgkmcnt(4)
v_mfma_f32_16x16x32_bf16 v[112:115], v[148:151], a[208:211], v[112:115]
ds_read_b128 v[172:175], v248 offset:49152
v_and_b32 v71, s37, v71
v_mfma_f32_16x16x32_bf16 v[112:115], v[152:155], a[216:219], v[112:115]
v_lshlrev_b32 v72, 16, v76
v_and_b32 v73, s37, v76
v_mfma_f32_16x16x32_bf16 v[128:131], v[152:155], a[220:223], v[128:131]
ds_read_b128 v[176:179], v248 offset:57344
v_lshlrev_b32 v74, 16, v77
v_mfma_f32_16x16x32_bf16 v[128:131], v[148:151], a[212:215], v[128:131]
v_and_b32 v75, s37, v77
s_waitcnt lgkmcnt(4)
v_mfma_f32_16x16x32_bf16 v[128:131], v[156:159], a[132:135], v[128:131]
ds_read_b128 v[148:151], v248 offset:17408
v_lshlrev_b32 v76, 16, v78
v_mfma_f32_16x16x32_bf16 v[128:131], v[160:163], a[140:143], v[128:131]
v_and_b32 v77, s37, v78
v_lshlrev_b32 v78, 16, v79
v_mfma_f32_16x16x32_bf16 v[112:115], v[160:163], a[136:139], v[112:115]
ds_read_b128 v[152:155], v248 offset:25600
v_and_b32 v79, s37, v79
v_mfma_f32_16x16x32_bf16 v[112:115], v[156:159], a[128:131], v[112:115]
v_add_f32 v180, v180, v212
s_waitcnt lgkmcnt(4)
v_mfma_f32_16x16x32_bf16 v[112:115], v[164:167], a[144:147], v[112:115]
ds_read_b128 v[156:159], v248 offset:33792
v_add_f32 v181, v181, v213
v_mfma_f32_16x16x32_bf16 v[112:115], v[168:171], a[152:155], v[112:115]
v_add_f32 v182, v182, v214
v_add_f32 v183, v183, v215
v_mfma_f32_16x16x32_bf16 v[128:131], v[168:171], a[156:159], v[128:131]
ds_read_b128 v[160:163], v248 offset:41984
v_add_f32 v184, v184, v216
v_mfma_f32_16x16x32_bf16 v[128:131], v[164:167], a[148:151], v[128:131]
v_add_f32 v185, v185, v217
s_waitcnt lgkmcnt(4)
v_mfma_f32_16x16x32_bf16 v[128:131], v[172:175], a[164:167], v[128:131]
ds_read_b128 v[164:167], v144 offset:1024
v_add_f32 v186, v186, v218
v_mfma_f32_16x16x32_bf16 v[128:131], v[176:179], a[172:175], v[128:131]
v_add_f32 v187, v187, v219
v_add_f32 v188, v188, v220
v_mfma_f32_16x16x32_bf16 v[112:115], v[176:179], a[168:171], v[112:115]
ds_read_b128 v[168:171], v144 offset:9216
v_add_f32 v189, v189, v221
v_mfma_f32_16x16x32_bf16 v[112:115], v[172:175], a[160:163], v[112:115]
v_add_f32 v190, v190, v222
s_waitcnt lgkmcnt(4)
v_mfma_f32_16x16x32_bf16 v[116:119], v[148:151], a[208:211], v[116:119]
ds_read_b128 v[172:175], v248 offset:50176
v_add_f32 v191, v191, v223
v_mfma_f32_16x16x32_bf16 v[116:119], v[152:155], a[216:219], v[116:119]
v_add_f32 v192, v192, v224
v_add_f32 v193, v193, v225
v_mfma_f32_16x16x32_bf16 v[132:135], v[152:155], a[220:223], v[132:135]
ds_read_b128 v[176:179], v248 offset:58368
v_add_f32 v194, v194, v226
v_mfma_f32_16x16x32_bf16 v[132:135], v[148:151], a[212:215], v[132:135]
buffer_store_dwordx4 v[128:131], v252, s[84:87], s75 offen offset:0 sc0 sc1
s_waitcnt lgkmcnt(4)
v_mfma_f32_16x16x32_bf16 v[132:135], v[156:159], a[132:135], v[132:135]
ds_read_b128 v[148:151], v248 offset:18432
v_add_f32 v195, v195, v227
v_mfma_f32_16x16x32_bf16 v[132:135], v[160:163], a[140:143], v[132:135]
v_add_f32 v196, v196, v228
v_add_f32 v197, v197, v229
v_mfma_f32_16x16x32_bf16 v[116:119], v[160:163], a[136:139], v[116:119]
ds_read_b128 v[152:155], v248 offset:26624
v_add_f32 v198, v198, v230
v_mfma_f32_16x16x32_bf16 v[116:119], v[156:159], a[128:131], v[116:119]
buffer_store_dwordx4 v[112:115], v252, s[84:87], s74 offen offset:0 sc0 sc1
s_waitcnt lgkmcnt(4)
v_mfma_f32_16x16x32_bf16 v[116:119], v[164:167], a[144:147], v[116:119]
ds_read_b128 v[156:159], v248 offset:34816
v_add_f32 v199, v199, v231
v_mfma_f32_16x16x32_bf16 v[116:119], v[168:171], a[152:155], v[116:119]
v_add_f32 v200, v200, v232
v_add_f32 v201, v201, v233
v_mfma_f32_16x16x32_bf16 v[132:135], v[168:171], a[156:159], v[132:135]
ds_read_b128 v[160:163], v248 offset:43008
v_add_f32 v202, v202, v234
v_mfma_f32_16x16x32_bf16 v[132:135], v[164:167], a[148:151], v[132:135]
v_add_f32 v203, v203, v235
s_waitcnt lgkmcnt(4)
v_mfma_f32_16x16x32_bf16 v[132:135], v[172:175], a[164:167], v[132:135]
ds_read_b128 v[164:167], v144 offset:2048
v_add_f32 v204, v204, v236
v_mfma_f32_16x16x32_bf16 v[132:135], v[176:179], a[172:175], v[132:135]
v_add_f32 v205, v205, v237
v_add_f32 v206, v206, v238
v_mfma_f32_16x16x32_bf16 v[116:119], v[176:179], a[168:171], v[116:119]
ds_read_b128 v[168:171], v144 offset:10240
v_add_f32 v207, v207, v239
v_mfma_f32_16x16x32_bf16 v[116:119], v[172:175], a[160:163], v[116:119]
v_add_f32 v208, v208, v240
s_waitcnt lgkmcnt(4)
v_mfma_f32_16x16x32_bf16 v[120:123], v[148:151], a[208:211], v[120:123]
ds_read_b128 v[172:175], v248 offset:51200
v_add_f32 v209, v209, v241
v_mfma_f32_16x16x32_bf16 v[120:123], v[152:155], a[216:219], v[120:123]
v_add_f32 v210, v210, v242
v_add_f32 v211, v211, v243
v_mfma_f32_16x16x32_bf16 v[136:139], v[152:155], a[220:223], v[136:139]
ds_read_b128 v[176:179], v248 offset:59392
v_cvt_pk_bf16_f32 v180, 0, v180
v_mfma_f32_16x16x32_bf16 v[136:139], v[148:151], a[212:215], v[136:139]
buffer_store_dwordx4 v[132:135], v252, s[84:87], s75 offen offset:1024 sc0 sc1
s_waitcnt lgkmcnt(4)
v_mfma_f32_16x16x32_bf16 v[136:139], v[156:159], a[132:135], v[136:139]
ds_read_b128 v[148:151], v248 offset:19456
v_cvt_pk_bf16_f32 v181, 0, v181
v_mfma_f32_16x16x32_bf16 v[136:139], v[160:163], a[140:143], v[136:139]
v_cvt_pk_bf16_f32 v182, 0, v182
v_cvt_pk_bf16_f32 v183, 0, v183
v_mfma_f32_16x16x32_bf16 v[120:123], v[160:163], a[136:139], v[120:123]
ds_read_b128 v[152:155], v248 offset:27648
v_cvt_pk_bf16_f32 v184, 0, v184
v_mfma_f32_16x16x32_bf16 v[120:123], v[156:159], a[128:131], v[120:123]
buffer_store_dwordx4 v[116:119], v252, s[84:87], s74 offen offset:1024 sc0 sc1
s_waitcnt lgkmcnt(4)
v_mfma_f32_16x16x32_bf16 v[120:123], v[164:167], a[144:147], v[120:123]
ds_read_b128 v[156:159], v248 offset:35840
v_cvt_pk_bf16_f32 v185, 0, v185
v_mfma_f32_16x16x32_bf16 v[120:123], v[168:171], a[152:155], v[120:123]
v_cvt_pk_bf16_f32 v186, 0, v186
v_cvt_pk_bf16_f32 v187, 0, v187
v_mfma_f32_16x16x32_bf16 v[136:139], v[168:171], a[156:159], v[136:139]
ds_read_b128 v[160:163], v248 offset:44032
v_cvt_pk_bf16_f32 v188, 0, v188
v_mfma_f32_16x16x32_bf16 v[136:139], v[164:167], a[148:151], v[136:139]
v_cvt_pk_bf16_f32 v189, 0, v189
s_waitcnt lgkmcnt(4)
v_mfma_f32_16x16x32_bf16 v[136:139], v[172:175], a[164:167], v[136:139]
ds_read_b128 v[164:167], v144 offset:3072
v_cvt_pk_bf16_f32 v190, 0, v190
v_mfma_f32_16x16x32_bf16 v[136:139], v[176:179], a[172:175], v[136:139]
v_cvt_pk_bf16_f32 v191, 0, v191
v_cvt_pk_bf16_f32 v192, 0, v192
v_mfma_f32_16x16x32_bf16 v[120:123], v[176:179], a[168:171], v[120:123]
ds_read_b128 v[168:171], v144 offset:11264
v_cvt_pk_bf16_f32 v193, 0, v193
v_mfma_f32_16x16x32_bf16 v[120:123], v[172:175], a[160:163], v[120:123]
v_cvt_pk_bf16_f32 v194, 0, v194
s_waitcnt lgkmcnt(4)
v_mfma_f32_16x16x32_bf16 v[124:127], v[148:151], a[208:211], v[124:127]
ds_read_b128 v[172:175], v248 offset:52224
v_cvt_pk_bf16_f32 v195, 0, v195
v_mfma_f32_16x16x32_bf16 v[124:127], v[152:155], a[216:219], v[124:127]
v_cvt_pk_bf16_f32 v196, 0, v196
v_cvt_pk_bf16_f32 v197, 0, v197
v_mfma_f32_16x16x32_bf16 v[140:143], v[152:155], a[220:223], v[140:143]
ds_read_b128 v[176:179], v248 offset:60416
v_cvt_pk_bf16_f32 v198, 0, v198
v_mfma_f32_16x16x32_bf16 v[140:143], v[148:151], a[212:215], v[140:143]
buffer_store_dwordx4 v[136:139], v252, s[84:87], s75 offen offset:2048 sc0 sc1
s_waitcnt lgkmcnt(4)
v_mfma_f32_16x16x32_bf16 v[140:143], v[156:159], a[132:135], v[140:143]
ds_read_b128 v[148:151], v144 offset:53248
v_cvt_pk_bf16_f32 v199, 0, v199
v_mfma_f32_16x16x32_bf16 v[140:143], v[160:163], a[140:143], v[140:143]
v_cvt_pk_bf16_f32 v200, 0, v200
v_cvt_pk_bf16_f32 v201, 0, v201
v_mfma_f32_16x16x32_bf16 v[124:127], v[160:163], a[136:139], v[124:127]
ds_read_b128 v[152:155], v144 offset:61440
v_cvt_pk_bf16_f32 v202, 0, v202
v_mfma_f32_16x16x32_bf16 v[124:127], v[156:159], a[128:131], v[124:127]
buffer_store_dwordx4 v[120:123], v252, s[84:87], s74 offen offset:2048 sc0 sc1
s_waitcnt lgkmcnt(4)
v_mfma_f32_16x16x32_bf16 v[124:127], v[164:167], a[144:147], v[124:127]
ds_read_b128 v[156:159], v144 offset:54272
v_cvt_pk_bf16_f32 v203, 0, v203
v_mfma_f32_16x16x32_bf16 v[124:127], v[168:171], a[152:155], v[124:127]
v_cvt_pk_bf16_f32 v204, 0, v204
v_cvt_pk_bf16_f32 v205, 0, v205
v_mfma_f32_16x16x32_bf16 v[140:143], v[168:171], a[156:159], v[140:143]
ds_read_b128 v[160:163], v144 offset:62464
v_cvt_pk_bf16_f32 v206, 0, v206
v_mfma_f32_16x16x32_bf16 v[140:143], v[164:167], a[148:151], v[140:143]
v_cvt_pk_bf16_f32 v207, 0, v207
s_waitcnt lgkmcnt(4)
v_mfma_f32_16x16x32_bf16 v[140:143], v[172:175], a[164:167], v[140:143]
ds_read_b128 v[164:167], v144 offset:55296
v_cvt_pk_bf16_f32 v208, 0, v208
v_mfma_f32_16x16x32_bf16 v[140:143], v[176:179], a[172:175], v[140:143]
v_cvt_pk_bf16_f32 v209, 0, v209
v_cvt_pk_bf16_f32 v210, 0, v210
v_mfma_f32_16x16x32_bf16 v[124:127], v[176:179], a[168:171], v[124:127]
ds_read_b128 v[168:171], v144 offset:63488
v_cvt_pk_bf16_f32 v211, 0, v211
v_mfma_f32_16x16x32_bf16 v[124:127], v[172:175], a[160:163], v[124:127]
v_mul_f32 v212, s38, v180
s_waitcnt lgkmcnt(4)
v_mfma_f32_16x16x32_bf16 v[80:83], v[148:151], v[32:35], v[80:83]
ds_read_b128 v[172:175], v144 offset:56320
v_mul_f32 v213, s38, v181
v_mfma_f32_16x16x32_bf16 v[80:83], v[152:155], v[40:43], v[80:83]
v_mul_f32 v214, s38, v182
v_mul_f32 v215, s38, v183
v_mfma_f32_16x16x32_bf16 v[96:99], v[152:155], v[44:47], v[96:99]
ds_read_b128 v[176:179], v144 offset:64512
v_mul_f32 v216, s38, v184
v_mfma_f32_16x16x32_bf16 v[96:99], v[148:151], v[36:39], v[96:99]
buffer_store_dwordx4 v[140:143], v252, s[84:87], s75 offen offset:3072 sc0 sc1
s_waitcnt lgkmcnt(4)
v_mfma_f32_16x16x32_bf16 v[100:103], v[156:159], v[36:39], v[100:103]
ds_read_b128 v[148:151], v248 offset:4096
v_mul_f32 v217, s38, v185
v_mfma_f32_16x16x32_bf16 v[100:103], v[160:163], v[44:47], v[100:103]
v_mul_f32 v218, s38, v186
v_mul_f32 v219, s38, v187
v_mfma_f32_16x16x32_bf16 v[84:87], v[160:163], v[40:43], v[84:87]
ds_read_b128 v[152:155], v248 offset:12288
v_mul_f32 v220, s38, v188
v_mfma_f32_16x16x32_bf16 v[84:87], v[156:159], v[32:35], v[84:87]
buffer_store_dwordx4 v[124:127], v252, s[84:87], s74 offen offset:3072 sc0 sc1
s_waitcnt lgkmcnt(4)
v_mfma_f32_16x16x32_bf16 v[88:91], v[164:167], v[32:35], v[88:91]
ds_read_b128 v[156:159], v248 offset:5120
v_mul_f32 v221, s38, v189
v_mfma_f32_16x16x32_bf16 v[88:91], v[168:171], v[40:43], v[88:91]
v_mul_f32 v222, s38, v190
v_mul_f32 v223, s38, v191
v_mfma_f32_16x16x32_bf16 v[104:107], v[168:171], v[44:47], v[104:107]
ds_read_b128 v[160:163], v248 offset:13312
v_mul_f32 v224, s38, v192
v_mfma_f32_16x16x32_bf16 v[104:107], v[164:167], v[36:39], v[104:107]
v_mul_f32 v225, s38, v193
s_waitcnt lgkmcnt(4)
v_mfma_f32_16x16x32_bf16 v[108:111], v[172:175], v[36:39], v[108:111]
ds_read_b128 v[164:167], v248 offset:6144
v_mul_f32 v226, s38, v194
v_mfma_f32_16x16x32_bf16 v[108:111], v[176:179], v[44:47], v[108:111]
v_mul_f32 v227, s38, v195
v_mul_f32 v228, s38, v196
v_mfma_f32_16x16x32_bf16 v[92:95], v[176:179], v[40:43], v[92:95]
ds_read_b128 v[168:171], v248 offset:14336
v_mul_f32 v229, s38, v197
v_mfma_f32_16x16x32_bf16 v[92:95], v[172:175], v[32:35], v[92:95]
v_mul_f32 v230, s38, v198
s_waitcnt lgkmcnt(4)
v_mfma_f32_16x16x32_bf16 v[80:83], v[148:151], a[192:195], v[80:83]
ds_read_b128 v[172:175], v248 offset:7168
v_mul_f32 v231, s38, v199
v_mfma_f32_16x16x32_bf16 v[80:83], v[152:155], a[200:203], v[80:83]
v_mul_f32 v232, s38, v200
v_mul_f32 v233, s38, v201
v_mfma_f32_16x16x32_bf16 v[96:99], v[152:155], a[204:207], v[96:99]
ds_read_b128 v[176:179], v248 offset:15360
v_mul_f32 v234, s38, v202
v_mfma_f32_16x16x32_bf16 v[96:99], v[148:151], a[196:199], v[96:99]
v_mul_f32 v235, s38, v203
s_waitcnt lgkmcnt(4)
v_mfma_f32_16x16x32_bf16 v[100:103], v[156:159], a[196:199], v[100:103]
ds_read_b128 v[148:151], v248 offset:20480
v_mul_f32 v236, s38, v204
v_mfma_f32_16x16x32_bf16 v[100:103], v[160:163], a[204:207], v[100:103]
v_mul_f32 v237, s38, v205
v_mul_f32 v238, s38, v206
v_mfma_f32_16x16x32_bf16 v[84:87], v[160:163], a[200:203], v[84:87]
ds_read_b128 v[152:155], v248 offset:28672
v_mul_f32 v239, s38, v207
v_mfma_f32_16x16x32_bf16 v[84:87], v[156:159], a[192:195], v[84:87]
v_mul_f32 v240, s38, v208
s_waitcnt lgkmcnt(4)
v_mfma_f32_16x16x32_bf16 v[88:91], v[164:167], a[192:195], v[88:91]
ds_read_b128 v[156:159], v248 offset:21504
v_mul_f32 v241, s38, v209
v_mfma_f32_16x16x32_bf16 v[88:91], v[168:171], a[200:203], v[88:91]
v_mul_f32 v242, s38, v210
v_mul_f32 v243, s38, v211
v_mfma_f32_16x16x32_bf16 v[104:107], v[168:171], a[204:207], v[104:107]
ds_read_b128 v[160:163], v248 offset:29696
v_mfma_f32_16x16x32_bf16 v[104:107], v[164:167], a[196:199], v[104:107]
s_waitcnt lgkmcnt(4)
v_mfma_f32_16x16x32_bf16 v[108:111], v[172:175], a[196:199], v[108:111]
ds_read_b128 v[164:167], v248 offset:22528
v_mfma_f32_16x16x32_bf16 v[108:111], v[176:179], a[204:207], v[108:111]
v_mfma_f32_16x16x32_bf16 v[92:95], v[176:179], a[200:203], v[92:95]
ds_read_b128 v[168:171], v248 offset:30720
v_mfma_f32_16x16x32_bf16 v[92:95], v[172:175], a[192:195], v[92:95]
s_waitcnt lgkmcnt(4)
v_mfma_f32_16x16x32_bf16 v[80:83], v[148:151], a[208:211], v[80:83]
ds_read_b128 v[172:175], v248 offset:23552
v_mfma_f32_16x16x32_bf16 v[80:83], v[152:155], a[216:219], v[80:83]
v_mfma_f32_16x16x32_bf16 v[96:99], v[152:155], a[220:223], v[96:99]
ds_read_b128 v[176:179], v248 offset:31744
v_mfma_f32_16x16x32_bf16 v[96:99], v[148:151], a[212:215], v[96:99]
s_waitcnt lgkmcnt(4)
v_mfma_f32_16x16x32_bf16 v[100:103], v[156:159], a[212:215], v[100:103]
ds_read_b128 v[148:151], v248 offset:36864
v_mfma_f32_16x16x32_bf16 v[100:103], v[160:163], a[220:223], v[100:103]
v_mfma_f32_16x16x32_bf16 v[84:87], v[160:163], a[216:219], v[84:87]
ds_read_b128 v[152:155], v248 offset:45056
v_mfma_f32_16x16x32_bf16 v[84:87], v[156:159], a[208:211], v[84:87]
s_waitcnt lgkmcnt(4)
v_mfma_f32_16x16x32_bf16 v[88:91], v[164:167], a[208:211], v[88:91]
ds_read_b128 v[156:159], v248 offset:37888
v_mfma_f32_16x16x32_bf16 v[88:91], v[168:171], a[216:219], v[88:91]
v_mfma_f32_16x16x32_bf16 v[104:107], v[168:171], a[220:223], v[104:107]
ds_read_b128 v[160:163], v248 offset:46080
v_mfma_f32_16x16x32_bf16 v[104:107], v[164:167], a[212:215], v[104:107]
s_waitcnt lgkmcnt(4)
v_mfma_f32_16x16x32_bf16 v[108:111], v[172:175], a[212:215], v[108:111]
ds_read_b128 v[164:167], v248 offset:38912
v_mfma_f32_16x16x32_bf16 v[108:111], v[176:179], a[220:223], v[108:111]
v_mfma_f32_16x16x32_bf16 v[92:95], v[176:179], a[216:219], v[92:95]
ds_read_b128 v[168:171], v248 offset:47104
v_mfma_f32_16x16x32_bf16 v[92:95], v[172:175], a[208:211], v[92:95]
s_waitcnt lgkmcnt(4)
v_mfma_f32_16x16x32_bf16 v[80:83], v[148:151], a[128:131], v[80:83]
ds_read_b128 v[172:175], v248 offset:39936
v_mfma_f32_16x16x32_bf16 v[80:83], v[152:155], a[136:139], v[80:83]
v_mfma_f32_16x16x32_bf16 v[96:99], v[152:155], a[140:143], v[96:99]
ds_read_b128 v[176:179], v248 offset:48128
v_mfma_f32_16x16x32_bf16 v[96:99], v[148:151], a[132:135], v[96:99]
s_waitcnt lgkmcnt(4)
v_mfma_f32_16x16x32_bf16 v[100:103], v[156:159], a[132:135], v[100:103]
ds_read_b128 v[148:151], v144 offset:4096
v_mfma_f32_16x16x32_bf16 v[100:103], v[160:163], a[140:143], v[100:103]
v_mfma_f32_16x16x32_bf16 v[84:87], v[160:163], a[136:139], v[84:87]
ds_read_b128 v[152:155], v144 offset:12288
v_mfma_f32_16x16x32_bf16 v[84:87], v[156:159], a[128:131], v[84:87]
s_waitcnt lgkmcnt(4)
v_mfma_f32_16x16x32_bf16 v[88:91], v[164:167], a[128:131], v[88:91]
ds_read_b128 v[156:159], v144 offset:5120
v_mfma_f32_16x16x32_bf16 v[88:91], v[168:171], a[136:139], v[88:91]
v_mfma_f32_16x16x32_bf16 v[104:107], v[168:171], a[140:143], v[104:107]
ds_read_b128 v[160:163], v144 offset:13312
v_mfma_f32_16x16x32_bf16 v[104:107], v[164:167], a[132:135], v[104:107]
s_waitcnt lgkmcnt(4)
v_mfma_f32_16x16x32_bf16 v[108:111], v[172:175], a[132:135], v[108:111]
ds_read_b128 v[164:167], v144 offset:6144
v_mfma_f32_16x16x32_bf16 v[108:111], v[176:179], a[140:143], v[108:111]
v_mfma_f32_16x16x32_bf16 v[92:95], v[176:179], a[136:139], v[92:95]
ds_read_b128 v[168:171], v144 offset:14336
v_mfma_f32_16x16x32_bf16 v[92:95], v[172:175], a[128:131], v[92:95]
s_waitcnt lgkmcnt(4)
v_mfma_f32_16x16x32_bf16 v[80:83], v[148:151], a[144:147], v[80:83]
ds_read_b128 v[172:175], v144 offset:7168
v_mfma_f32_16x16x32_bf16 v[80:83], v[152:155], a[152:155], v[80:83]
v_mfma_f32_16x16x32_bf16 v[96:99], v[152:155], a[156:159], v[96:99]
ds_read_b128 v[176:179], v144 offset:15360
v_mfma_f32_16x16x32_bf16 v[96:99], v[148:151], a[148:151], v[96:99]
s_waitcnt vmcnt(0)
buffer_store_dword v14, off, s[32:35], s82 offset:64 sc0 sc1
s_waitcnt lgkmcnt(4)
v_mfma_f32_16x16x32_bf16 v[100:103], v[156:159], a[148:151], v[100:103]
ds_read_b128 v[148:151], v248 offset:53248
v_mfma_f32_16x16x32_bf16 v[100:103], v[160:163], a[156:159], v[100:103]
v_mfma_f32_16x16x32_bf16 v[84:87], v[160:163], a[152:155], v[84:87]
ds_read_b128 v[152:155], v248 offset:61440
v_mfma_f32_16x16x32_bf16 v[84:87], v[156:159], a[144:147], v[84:87]
s_waitcnt lgkmcnt(4)
v_mfma_f32_16x16x32_bf16 v[88:91], v[164:167], a[144:147], v[88:91]
ds_read_b128 v[156:159], v248 offset:54272
v_mfma_f32_16x16x32_bf16 v[88:91], v[168:171], a[152:155], v[88:91]
v_mfma_f32_16x16x32_bf16 v[104:107], v[168:171], a[156:159], v[104:107]
ds_read_b128 v[160:163], v248 offset:62464
v_mfma_f32_16x16x32_bf16 v[104:107], v[164:167], a[148:151], v[104:107]
s_waitcnt lgkmcnt(4)
v_mfma_f32_16x16x32_bf16 v[108:111], v[172:175], a[148:151], v[108:111]
ds_read_b128 v[164:167], v248 offset:55296
v_mfma_f32_16x16x32_bf16 v[108:111], v[176:179], a[156:159], v[108:111]
v_mfma_f32_16x16x32_bf16 v[92:95], v[176:179], a[152:155], v[92:95]
ds_read_b128 v[168:171], v248 offset:63488
v_mfma_f32_16x16x32_bf16 v[92:95], v[172:175], a[144:147], v[92:95]
s_waitcnt lgkmcnt(4)
v_mfma_f32_16x16x32_bf16 v[80:83], v[148:151], a[160:163], v[80:83]
ds_read_b128 v[172:175], v248 offset:56320
v_mfma_f32_16x16x32_bf16 v[80:83], v[152:155], a[168:171], v[80:83]
v_mfma_f32_16x16x32_bf16 v[96:99], v[152:155], a[172:175], v[96:99]
ds_read_b128 v[176:179], v248 offset:64512
v_mfma_f32_16x16x32_bf16 v[96:99], v[148:151], a[164:167], v[96:99]
s_waitcnt lgkmcnt(4)
v_mfma_f32_16x16x32_bf16 v[100:103], v[156:159], a[164:167], v[100:103]
v_mfma_f32_16x16x32_bf16 v[100:103], v[160:163], a[172:175], v[100:103]
v_mfma_f32_16x16x32_bf16 v[84:87], v[160:163], a[168:171], v[84:87]
v_mfma_f32_16x16x32_bf16 v[84:87], v[156:159], a[160:163], v[84:87]
s_waitcnt lgkmcnt(2)
v_mfma_f32_16x16x32_bf16 v[88:91], v[164:167], a[160:163], v[88:91]
v_mfma_f32_16x16x32_bf16 v[88:91], v[168:171], a[168:171], v[88:91]
v_mfma_f32_16x16x32_bf16 v[104:107], v[168:171], a[172:175], v[104:107]
v_mfma_f32_16x16x32_bf16 v[104:107], v[164:167], a[164:167], v[104:107]
s_waitcnt lgkmcnt(0)
v_mfma_f32_16x16x32_bf16 v[108:111], v[172:175], a[164:167], v[108:111]
v_mfma_f32_16x16x32_bf16 v[108:111], v[176:179], a[172:175], v[108:111]
v_mfma_f32_16x16x32_bf16 v[92:95], v[176:179], a[168:171], v[92:95]
v_mfma_f32_16x16x32_bf16 v[92:95], v[172:175], a[160:163], v[92:95]
s_branch L_main_kernel_tl
.org L_main_kernel_eb + 6912
L_main_kernel_e0:
s_waitcnt lgkmcnt(4)
v_mfma_f32_16x16x32_bf16 v[112:115], v[148:151], a[192:195], v[112:115]
ds_read_b128 v[172:175], v248 offset:3072
v_mfma_f32_16x16x32_bf16 v[112:115], v[152:155], a[200:203], v[112:115]
v_mfma_f32_16x16x32_bf16 v[128:131], v[152:155], a[204:207], v[128:131]
ds_read_b128 v[176:179], v248 offset:11264
v_mfma_f32_16x16x32_bf16 v[128:131], v[148:151], a[196:199], v[128:131]
s_waitcnt vmcnt(8)
s_barrier
s_waitcnt lgkmcnt(4)
v_mfma_f32_16x16x32_bf16 v[132:135], v[156:159], a[196:199], v[132:135]
ds_read_b128 v[148:151], v248 offset:16384
s_mov_b32 s37, 0xffff0000
v_mfma_f32_16x16x32_bf16 v[132:135], v[160:163], a[204:207], v[132:135]
s_mov_b32 s38, 0xbfb8aa3b
s_mov_b32 s39, 0xbfb8aa3b
v_mfma_f32_16x16x32_bf16 v[116:119], v[160:163], a[200:203], v[116:119]
ds_read_b128 v[152:155], v248 offset:24576
v_mov_b32 v14, 1
v_mfma_f32_16x16x32_bf16 v[116:119], v[156:159], a[192:195], v[116:119]
v_permlane16_swap_b32 v52, v54
s_waitcnt lgkmcnt(4)
v_mfma_f32_16x16x32_bf16 v[120:123], v[164:167], a[192:195], v[120:123]
ds_read_b128 v[156:159], v248 offset:17408
v_permlane16_swap_b32 v53, v55
v_mfma_f32_16x16x32_bf16 v[120:123], v[168:171], a[200:203], v[120:123]
v_permlane16_swap_b32 v60, v62
v_permlane16_swap_b32 v61, v63
v_mfma_f32_16x16x32_bf16 v[136:139], v[168:171], a[204:207], v[136:139]
ds_read_b128 v[160:163], v248 offset:25600
v_permlane16_swap_b32 v68, v70
v_mfma_f32_16x16x32_bf16 v[136:139], v[164:167], a[196:199], v[136:139]
v_permlane16_swap_b32 v69, v71
s_waitcnt lgkmcnt(4)
v_mfma_f32_16x16x32_bf16 v[140:143], v[172:175], a[196:199], v[140:143]
ds_read_b128 v[164:167], v248 offset:18432
v_permlane16_swap_b32 v76, v78
v_mfma_f32_16x16x32_bf16 v[140:143], v[176:179], a[204:207], v[140:143]
v_permlane16_swap_b32 v77, v79
v_lshlrev_b32 v48, 16, v52
v_mfma_f32_16x16x32_bf16 v[124:127], v[176:179], a[200:203], v[124:127]
ds_read_b128 v[168:171], v248 offset:26624
v_and_b32 v49, s37, v52
v_mfma_f32_16x16x32_bf16 v[124:127], v[172:175], a[192:195], v[124:127]
v_lshlrev_b32 v50, 16, v53
s_waitcnt lgkmcnt(4)
v_mfma_f32_16x16x32_bf16 v[112:115], v[148:151], a[208:211], v[112:115]
ds_read_b128 v[172:175], v248 offset:19456
v_and_b32 v51, s37, v53
v_mfma_f32_16x16x32_bf16 v[112:115], v[152:155], a[216:219], v[112:115]
v_lshlrev_b32 v52, 16, v54
v_and_b32 v53, s37, v54
v_mfma_f32_16x16x32_bf16 v[128:131], v[152:155], a[220:223], v[128:131]
ds_read_b128 v[176:179], v248 offset:27648
v_lshlrev_b32 v54, 16, v55
v_mfma_f32_16x16x32_bf16 v[128:131], v[148:151], a[212:215], v[128:131]
v_and_b32 v55, s37, v55
s_waitcnt lgkmcnt(4)
v_mfma_f32_16x16x32_bf16 v[132:135], v[156:159], a[212:215], v[132:135]
ds_read_b128 v[148:151], v248 offset:32768
v_lshlrev_b32 v56, 16, v60
v_mfma_f32_16x16x32_bf16 v[132:135], v[160:163], a[220:223], v[132:135]
v_and_b32 v57, s37, v60
v_lshlrev_b32 v58, 16, v61
v_mfma_f32_16x16x32_bf16 v[116:119], v[160:163], a[216:219], v[116:119]
ds_read_b128 v[152:155], v248 offset:40960
v_and_b32 v59, s37, v61
v_mfma_f32_16x16x32_bf16 v[116:119], v[156:159], a[208:211], v[116:119]
v_lshlrev_b32 v60, 16, v62
s_waitcnt lgkmcnt(4)
v_mfma_f32_16x16x32_bf16 v[120:123], v[164:167], a[208:211], v[120:123]
ds_read_b128 v[156:159], v144 offset:0
v_and_b32 v61, s37, v62
v_mfma_f32_16x16x32_bf16 v[120:123], v[168:171], a[216:219], v[120:123]
v_lshlrev_b32 v62, 16, v63
v_and_b32 v63, s37, v63
v_mfma_f32_16x16x32_bf16 v[136:139], v[168:171], a[220:223], v[136:139]
ds_read_b128 v[160:163], v144 offset:8192
v_lshlrev_b32 v64, 16, v68
v_mfma_f32_16x16x32_bf16 v[136:139], v[164:167], a[212:215], v[136:139]
v_and_b32 v65, s37, v68
s_waitcnt lgkmcnt(4)
v_mfma_f32_16x16x32_bf16 v[140:143], v[172:175], a[212:215], v[140:143]
ds_read_b128 v[164:167], v248 offset:49152
v_lshlrev_b32 v66, 16, v69
v_mfma_f32_16x16x32_bf16 v[140:143], v[176:179], a[220:223], v[140:143]
v_and_b32 v67, s37, v69
v_lshlrev_b32 v68, 16, v70
v_mfma_f32_16x16x32_bf16 v[124:127], v[176:179], a[216:219], v[124:127]
ds_read_b128 v[168:171], v248 offset:57344
v_and_b32 v69, s37, v70
v_mfma_f32_16x16x32_bf16 v[124:127], v[172:175], a[208:211], v[124:127]
v_lshlrev_b32 v70, 16, v71
s_waitcnt vmcnt(0)
s_barrier
s_waitcnt lgkmcnt(4)
v_mfma_f32_16x16x32_bf16 v[112:115], v[148:151], a[128:131], v[112:115]
ds_read_b128 v[172:175], v144 offset:16384
v_and_b32 v71, s37, v71
v_mfma_f32_16x16x32_bf16 v[112:115], v[152:155], a[136:139], v[112:115]
v_lshlrev_b32 v72, 16, v76
v_and_b32 v73, s37, v76
v_mfma_f32_16x16x32_bf16 v[128:131], v[152:155], a[140:143], v[128:131]
ds_read_b128 v[176:179], v144 offset:24576
v_lshlrev_b32 v74, 16, v77
v_mfma_f32_16x16x32_bf16 v[128:131], v[148:151], a[132:135], v[128:131]
v_and_b32 v75, s37, v77
s_waitcnt lgkmcnt(4)
v_mfma_f32_16x16x32_bf16 v[128:131], v[156:159], a[148:151], v[128:131]
ds_read_b128 v[148:151], v248 offset:33792
v_lshlrev_b32 v76, 16, v78
v_mfma_f32_16x16x32_bf16 v[128:131], v[160:163], a[156:159], v[128:131]
v_and_b32 v77, s37, v78
v_lshlrev_b32 v78, 16, v79
v_mfma_f32_16x16x32_bf16 v[112:115], v[160:163], a[152:155], v[112:115]
ds_read_b128 v[152:155], v248 offset:41984
v_and_b32 v79, s37, v79
v_mfma_f32_16x16x32_bf16 v[112:115], v[156:159], a[144:147], v[112:115]
v_add_f32 v180, v180, v212
s_waitcnt lgkmcnt(4)
v_mfma_f32_16x16x32_bf16 v[112:115], v[164:167], a[160:163], v[112:115]
ds_read_b128 v[156:159], v144 offset:1024
v_add_f32 v181, v181, v213
v_mfma_f32_16x16x32_bf16 v[112:115], v[168:171], a[168:171], v[112:115]
v_add_f32 v182, v182, v214
v_add_f32 v183, v183, v215
v_mfma_f32_16x16x32_bf16 v[128:131], v[168:171], a[172:175], v[128:131]
ds_read_b128 v[160:163], v144 offset:9216
v_add_f32 v184, v184, v216
v_mfma_f32_16x16x32_bf16 v[128:131], v[164:167], a[164:167], v[128:131]
v_add_f32 v185, v185, v217
s_waitcnt lgkmcnt(4)
v_mfma_f32_16x16x32_bf16 v[128:131], v[172:175], a[180:183], v[128:131]
ds_read_b128 v[164:167], v248 offset:50176
v_add_f32 v186, v186, v218
v_mfma_f32_16x16x32_bf16 v[128:131], v[176:179], a[188:191], v[128:131]
v_add_f32 v187, v187, v219
v_add_f32 v188, v188, v220
v_mfma_f32_16x16x32_bf16 v[112:115], v[176:179], a[184:187], v[112:115]
ds_read_b128 v[168:171], v248 offset:58368
v_add_f32 v189, v189, v221
v_mfma_f32_16x16x32_bf16 v[112:115], v[172:175], a[176:179], v[112:115]
v_add_f32 v190, v190, v222
s_waitcnt lgkmcnt(4)
v_mfma_f32_16x16x32_bf16 v[116:119], v[148:151], a[128:131], v[116:119]
ds_read_b128 v[172:175], v144 offset:17408
v_add_f32 v191, v191, v223
v_mfma_f32_16x16x32_bf16 v[116:119], v[152:155], a[136:139], v[116:119]
v_add_f32 v192, v192, v224
v_add_f32 v193, v193, v225
v_mfma_f32_16x16x32_bf16 v[132:135], v[152:155], a[140:143], v[132:135]
ds_read_b128 v[176:179], v144 offset:25600
v_add_f32 v194, v194, v226
v_mfma_f32_16x16x32_bf16 v[132:135], v[148:151], a[132:135], v[132:135]
buffer_store_dwordx4 v[128:131], v252, s[84:87], s75 offen offset:0 sc0 sc1
s_waitcnt lgkmcnt(4)
v_mfma_f32_16x16x32_bf16 v[132:135], v[156:159], a[148:151], v[132:135]
ds_read_b128 v[148:151], v248 offset:34816
v_add_f32 v195, v195, v227
v_mfma_f32_16x16x32_bf16 v[132:135], v[160:163], a[156:159], v[132:135]
v_add_f32 v196, v196, v228
v_add_f32 v197, v197, v229
v_mfma_f32_16x16x32_bf16 v[116:119], v[160:163], a[152:155], v[116:119]
ds_read_b128 v[152:155], v248 offset:43008
v_add_f32 v198, v198, v230
v_mfma_f32_16x16x32_bf16 v[116:119], v[156:159], a[144:147], v[116:119]
buffer_store_dwordx4 v[112:115], v252, s[84:87], s74 offen offset:0 sc0 sc1
s_waitcnt lgkmcnt(4)
v_mfma_f32_16x16x32_bf16 v[116:119], v[164:167], a[160:163], v[116:119]
ds_read_b128 v[156:159], v144 offset:2048
v_add_f32 v199, v199, v231
v_mfma_f32_16x16x32_bf16 v[116:119], v[168:171], a[168:171], v[116:119]
v_add_f32 v200, v200, v232
v_add_f32 v201, v201, v233
v_mfma_f32_16x16x32_bf16 v[132:135], v[168:171], a[172:175], v[132:135]
ds_read_b128 v[160:163], v144 offset:10240
v_add_f32 v202, v202, v234
v_mfma_f32_16x16x32_bf16 v[132:135], v[164:167], a[164:167], v[132:135]
v_add_f32 v203, v203, v235
s_waitcnt lgkmcnt(4)
v_mfma_f32_16x16x32_bf16 v[132:135], v[172:175], a[180:183], v[132:135]
ds_read_b128 v[164:167], v248 offset:51200
v_add_f32 v204, v204, v236
v_mfma_f32_16x16x32_bf16 v[132:135], v[176:179], a[188:191], v[132:135]
v_add_f32 v205, v205, v237
v_add_f32 v206, v206, v238
v_mfma_f32_16x16x32_bf16 v[116:119], v[176:179], a[184:187], v[116:119]
ds_read_b128 v[168:171], v248 offset:59392
v_add_f32 v207, v207, v239
v_mfma_f32_16x16x32_bf16 v[116:119], v[172:175], a[176:179], v[116:119]
v_add_f32 v208, v208, v240
s_waitcnt lgkmcnt(4)
v_mfma_f32_16x16x32_bf16 v[120:123], v[148:151], a[128:131], v[120:123]
ds_read_b128 v[172:175], v144 offset:18432
v_add_f32 v209, v209, v241
v_mfma_f32_16x16x32_bf16 v[120:123], v[152:155], a[136:139], v[120:123]
v_add_f32 v210, v210, v242
v_add_f32 v211, v211, v243
v_mfma_f32_16x16x32_bf16 v[136:139], v[152:155], a[140:143], v[136:139]
ds_read_b128 v[176:179], v144 offset:26624
v_cvt_pk_bf16_f32 v180, 0, v180
v_mfma_f32_16x16x32_bf16 v[136:139], v[148:151], a[132:135], v[136:139]
buffer_store_dwordx4 v[132:135], v252, s[84:87], s75 offen offset:1024 sc0 sc1
s_waitcnt lgkmcnt(4)
v_mfma_f32_16x16x32_bf16 v[136:139], v[156:159], a[148:151], v[136:139]
ds_read_b128 v[148:151], v248 offset:35840
v_cvt_pk_bf16_f32 v181, 0, v181
v_mfma_f32_16x16x32_bf16 v[136:139], v[160:163], a[156:159], v[136:139]
v_cvt_pk_bf16_f32 v182, 0, v182
v_cvt_pk_bf16_f32 v183, 0, v183
v_mfma_f32_16x16x32_bf16 v[120:123], v[160:163], a[152:155], v[120:123]
ds_read_b128 v[152:155], v248 offset:44032
v_cvt_pk_bf16_f32 v184, 0, v184
v_mfma_f32_16x16x32_bf16 v[120:123], v[156:159], a[144:147], v[120:123]
buffer_store_dwordx4 v[116:119], v252, s[84:87], s74 offen offset:1024 sc0 sc1
s_waitcnt lgkmcnt(4)
v_mfma_f32_16x16x32_bf16 v[120:123], v[164:167], a[160:163], v[120:123]
ds_read_b128 v[156:159], v144 offset:3072
v_cvt_pk_bf16_f32 v185, 0, v185
v_mfma_f32_16x16x32_bf16 v[120:123], v[168:171], a[168:171], v[120:123]
v_cvt_pk_bf16_f32 v186, 0, v186
v_cvt_pk_bf16_f32 v187, 0, v187
v_mfma_f32_16x16x32_bf16 v[136:139], v[168:171], a[172:175], v[136:139]
ds_read_b128 v[160:163], v144 offset:11264
v_cvt_pk_bf16_f32 v188, 0, v188
v_mfma_f32_16x16x32_bf16 v[136:139], v[164:167], a[164:167], v[136:139]
v_cvt_pk_bf16_f32 v189, 0, v189
s_waitcnt lgkmcnt(4)
v_mfma_f32_16x16x32_bf16 v[136:139], v[172:175], a[180:183], v[136:139]
ds_read_b128 v[164:167], v248 offset:52224
v_cvt_pk_bf16_f32 v190, 0, v190
v_mfma_f32_16x16x32_bf16 v[136:139], v[176:179], a[188:191], v[136:139]
v_cvt_pk_bf16_f32 v191, 0, v191
v_cvt_pk_bf16_f32 v192, 0, v192
v_mfma_f32_16x16x32_bf16 v[120:123], v[176:179], a[184:187], v[120:123]
ds_read_b128 v[168:171], v248 offset:60416
v_cvt_pk_bf16_f32 v193, 0, v193
v_mfma_f32_16x16x32_bf16 v[120:123], v[172:175], a[176:179], v[120:123]
v_cvt_pk_bf16_f32 v194, 0, v194
s_waitcnt lgkmcnt(4)
v_mfma_f32_16x16x32_bf16 v[124:127], v[148:151], a[128:131], v[124:127]
ds_read_b128 v[172:175], v144 offset:19456
v_cvt_pk_bf16_f32 v195, 0, v195
v_mfma_f32_16x16x32_bf16 v[124:127], v[152:155], a[136:139], v[124:127]
v_cvt_pk_bf16_f32 v196, 0, v196
v_cvt_pk_bf16_f32 v197, 0, v197
v_mfma_f32_16x16x32_bf16 v[140:143], v[152:155], a[140:143], v[140:143]
ds_read_b128 v[176:179], v144 offset:27648
v_cvt_pk_bf16_f32 v198, 0, v198
v_mfma_f32_16x16x32_bf16 v[140:143], v[148:151], a[132:135], v[140:143]
buffer_store_dwordx4 v[136:139], v252, s[84:87], s75 offen offset:2048 sc0 sc1
s_waitcnt lgkmcnt(4)
v_mfma_f32_16x16x32_bf16 v[140:143], v[156:159], a[148:151], v[140:143]
ds_read_b128 v[148:151], v248 offset:4096
v_cvt_pk_bf16_f32 v199, 0, v199
v_mfma_f32_16x16x32_bf16 v[140:143], v[160:163], a[156:159], v[140:143]
v_cvt_pk_bf16_f32 v200, 0, v200
v_cvt_pk_bf16_f32 v201, 0, v201
v_mfma_f32_16x16x32_bf16 v[124:127], v[160:163], a[152:155], v[124:127]
ds_read_b128 v[152:155], v248 offset:12288
v_cvt_pk_bf16_f32 v202, 0, v202
v_mfma_f32_16x16x32_bf16 v[124:127], v[156:159], a[144:147], v[124:127]
buffer_store_dwordx4 v[120:123], v252, s[84:87], s74 offen offset:2048 sc0 sc1
s_waitcnt lgkmcnt(4)
v_mfma_f32_16x16x32_bf16 v[124:127], v[164:167], a[160:163], v[124:127]
ds_read_b128 v[156:159], v248 offset:5120
v_cvt_pk_bf16_f32 v203, 0, v203
v_mfma_f32_16x16x32_bf16 v[124:127], v[168:171], a[168:171], v[124:127]
v_cvt_pk_bf16_f32 v204, 0, v204
v_cvt_pk_bf16_f32 v205, 0, v205
v_mfma_f32_16x16x32_bf16 v[140:143], v[168:171], a[172:175], v[140:143]
ds_read_b128 v[160:163], v248 offset:13312
v_cvt_pk_bf16_f32 v206, 0, v206
v_mfma_f32_16x16x32_bf16 v[140:143], v[164:167], a[164:167], v[140:143]
v_cvt_pk_bf16_f32 v207, 0, v207
s_waitcnt lgkmcnt(4)
v_mfma_f32_16x16x32_bf16 v[140:143], v[172:175], a[180:183], v[140:143]
ds_read_b128 v[164:167], v248 offset:6144
v_cvt_pk_bf16_f32 v208, 0, v208
v_mfma_f32_16x16x32_bf16 v[140:143], v[176:179], a[188:191], v[140:143]
v_cvt_pk_bf16_f32 v209, 0, v209
v_cvt_pk_bf16_f32 v210, 0, v210
v_mfma_f32_16x16x32_bf16 v[124:127], v[176:179], a[184:187], v[124:127]
ds_read_b128 v[168:171], v248 offset:14336
v_cvt_pk_bf16_f32 v211, 0, v211
v_mfma_f32_16x16x32_bf16 v[124:127], v[172:175], a[176:179], v[124:127]
v_mul_f32 v212, s38, v180
s_waitcnt lgkmcnt(4)
v_mfma_f32_16x16x32_bf16 v[80:83], v[148:151], a[192:195], v[80:83]
ds_read_b128 v[172:175], v248 offset:7168
v_mul_f32 v213, s38, v181
v_mfma_f32_16x16x32_bf16 v[80:83], v[152:155], a[200:203], v[80:83]
v_mul_f32 v214, s38, v182
v_mul_f32 v215, s38, v183
v_mfma_f32_16x16x32_bf16 v[96:99], v[152:155], a[204:207], v[96:99]
ds_read_b128 v[176:179], v248 offset:15360
v_mul_f32 v216, s38, v184
v_mfma_f32_16x16x32_bf16 v[96:99], v[148:151], a[196:199], v[96:99]
buffer_store_dwordx4 v[140:143], v252, s[84:87], s75 offen offset:3072 sc0 sc1
s_waitcnt lgkmcnt(4)
v_mfma_f32_16x16x32_bf16 v[100:103], v[156:159], a[196:199], v[100:103]
ds_read_b128 v[148:151], v248 offset:20480
v_mul_f32 v217, s38, v185
v_mfma_f32_16x16x32_bf16 v[100:103], v[160:163], a[204:207], v[100:103]
v_mul_f32 v218, s38, v186
v_mul_f32 v219, s38, v187
v_mfma_f32_16x16x32_bf16 v[84:87], v[160:163], a[200:203], v[84:87]
ds_read_b128 v[152:155], v248 offset:28672
v_mul_f32 v220, s38, v188
v_mfma_f32_16x16x32_bf16 v[84:87], v[156:159], a[192:195], v[84:87]
buffer_store_dwordx4 v[124:127], v252, s[84:87], s74 offen offset:3072 sc0 sc1
s_waitcnt lgkmcnt(4)
v_mfma_f32_16x16x32_bf16 v[88:91], v[164:167], a[192:195], v[88:91]
ds_read_b128 v[156:159], v248 offset:21504
v_mul_f32 v221, s38, v189
v_mfma_f32_16x16x32_bf16 v[88:91], v[168:171], a[200:203], v[88:91]
v_mul_f32 v222, s38, v190
v_mul_f32 v223, s38, v191
v_mfma_f32_16x16x32_bf16 v[104:107], v[168:171], a[204:207], v[104:107]
ds_read_b128 v[160:163], v248 offset:29696
v_mul_f32 v224, s38, v192
v_mfma_f32_16x16x32_bf16 v[104:107], v[164:167], a[196:199], v[104:107]
v_mul_f32 v225, s38, v193
s_waitcnt lgkmcnt(4)
v_mfma_f32_16x16x32_bf16 v[108:111], v[172:175], a[196:199], v[108:111]
ds_read_b128 v[164:167], v248 offset:22528
v_mul_f32 v226, s38, v194
v_mfma_f32_16x16x32_bf16 v[108:111], v[176:179], a[204:207], v[108:111]
v_mul_f32 v227, s38, v195
v_mul_f32 v228, s38, v196
v_mfma_f32_16x16x32_bf16 v[92:95], v[176:179], a[200:203], v[92:95]
ds_read_b128 v[168:171], v248 offset:30720
v_mul_f32 v229, s38, v197
v_mfma_f32_16x16x32_bf16 v[92:95], v[172:175], a[192:195], v[92:95]
v_mul_f32 v230, s38, v198
s_waitcnt lgkmcnt(4)
v_mfma_f32_16x16x32_bf16 v[80:83], v[148:151], a[208:211], v[80:83]
ds_read_b128 v[172:175], v248 offset:23552
v_mul_f32 v231, s38, v199
v_mfma_f32_16x16x32_bf16 v[80:83], v[152:155], a[216:219], v[80:83]
v_mul_f32 v232, s38, v200
v_mul_f32 v233, s38, v201
v_mfma_f32_16x16x32_bf16 v[96:99], v[152:155], a[220:223], v[96:99]
ds_read_b128 v[176:179], v248 offset:31744
v_mul_f32 v234, s38, v202
v_mfma_f32_16x16x32_bf16 v[96:99], v[148:151], a[212:215], v[96:99]
v_mul_f32 v235, s38, v203
s_waitcnt lgkmcnt(4)
v_mfma_f32_16x16x32_bf16 v[100:103], v[156:159], a[212:215], v[100:103]
ds_read_b128 v[148:151], v248 offset:36864
v_mul_f32 v236, s38, v204
v_mfma_f32_16x16x32_bf16 v[100:103], v[160:163], a[220:223], v[100:103]
v_mul_f32 v237, s38, v205
v_mul_f32 v238, s38, v206
v_mfma_f32_16x16x32_bf16 v[84:87], v[160:163], a[216:219], v[84:87]
ds_read_b128 v[152:155], v248 offset:45056
v_mul_f32 v239, s38, v207
v_mfma_f32_16x16x32_bf16 v[84:87], v[156:159], a[208:211], v[84:87]
v_mul_f32 v240, s38, v208
s_waitcnt lgkmcnt(4)
v_mfma_f32_16x16x32_bf16 v[88:91], v[164:167], a[208:211], v[88:91]
ds_read_b128 v[156:159], v248 offset:37888
v_mul_f32 v241, s38, v209
v_mfma_f32_16x16x32_bf16 v[88:91], v[168:171], a[216:219], v[88:91]
v_mul_f32 v242, s38, v210
v_mul_f32 v243, s38, v211
v_mfma_f32_16x16x32_bf16 v[104:107], v[168:171], a[220:223], v[104:107]
ds_read_b128 v[160:163], v248 offset:46080
v_mfma_f32_16x16x32_bf16 v[104:107], v[164:167], a[212:215], v[104:107]
s_waitcnt lgkmcnt(4)
v_mfma_f32_16x16x32_bf16 v[108:111], v[172:175], a[212:215], v[108:111]
ds_read_b128 v[164:167], v248 offset:38912
v_mfma_f32_16x16x32_bf16 v[108:111], v[176:179], a[220:223], v[108:111]
v_mfma_f32_16x16x32_bf16 v[92:95], v[176:179], a[216:219], v[92:95]
ds_read_b128 v[168:171], v248 offset:47104
v_mfma_f32_16x16x32_bf16 v[92:95], v[172:175], a[208:211], v[92:95]
s_waitcnt lgkmcnt(4)
v_mfma_f32_16x16x32_bf16 v[80:83], v[148:151], a[128:131], v[80:83]
ds_read_b128 v[172:175], v248 offset:39936
v_mfma_f32_16x16x32_bf16 v[80:83], v[152:155], a[136:139], v[80:83]
v_mfma_f32_16x16x32_bf16 v[96:99], v[152:155], a[140:143], v[96:99]
ds_read_b128 v[176:179], v248 offset:48128
v_mfma_f32_16x16x32_bf16 v[96:99], v[148:151], a[132:135], v[96:99]
s_waitcnt lgkmcnt(4)
v_mfma_f32_16x16x32_bf16 v[100:103], v[156:159], a[132:135], v[100:103]
ds_read_b128 v[148:151], v144 offset:4096
v_mfma_f32_16x16x32_bf16 v[100:103], v[160:163], a[140:143], v[100:103]
v_mfma_f32_16x16x32_bf16 v[84:87], v[160:163], a[136:139], v[84:87]
ds_read_b128 v[152:155], v144 offset:12288
v_mfma_f32_16x16x32_bf16 v[84:87], v[156:159], a[128:131], v[84:87]
s_waitcnt lgkmcnt(4)
v_mfma_f32_16x16x32_bf16 v[88:91], v[164:167], a[128:131], v[88:91]
ds_read_b128 v[156:159], v144 offset:5120
v_mfma_f32_16x16x32_bf16 v[88:91], v[168:171], a[136:139], v[88:91]
v_mfma_f32_16x16x32_bf16 v[104:107], v[168:171], a[140:143], v[104:107]
ds_read_b128 v[160:163], v144 offset:13312
v_mfma_f32_16x16x32_bf16 v[104:107], v[164:167], a[132:135], v[104:107]
s_waitcnt lgkmcnt(4)
v_mfma_f32_16x16x32_bf16 v[108:111], v[172:175], a[132:135], v[108:111]
ds_read_b128 v[164:167], v144 offset:6144
v_mfma_f32_16x16x32_bf16 v[108:111], v[176:179], a[140:143], v[108:111]
v_mfma_f32_16x16x32_bf16 v[92:95], v[176:179], a[136:139], v[92:95]
ds_read_b128 v[168:171], v144 offset:14336
v_mfma_f32_16x16x32_bf16 v[92:95], v[172:175], a[128:131], v[92:95]
s_waitcnt lgkmcnt(4)
v_mfma_f32_16x16x32_bf16 v[80:83], v[148:151], a[144:147], v[80:83]
ds_read_b128 v[172:175], v144 offset:7168
v_mfma_f32_16x16x32_bf16 v[80:83], v[152:155], a[152:155], v[80:83]
v_mfma_f32_16x16x32_bf16 v[96:99], v[152:155], a[156:159], v[96:99]
ds_read_b128 v[176:179], v144 offset:15360
v_mfma_f32_16x16x32_bf16 v[96:99], v[148:151], a[148:151], v[96:99]
s_waitcnt lgkmcnt(4)
v_mfma_f32_16x16x32_bf16 v[100:103], v[156:159], a[148:151], v[100:103]
ds_read_b128 v[148:151], v248 offset:53248
v_mfma_f32_16x16x32_bf16 v[100:103], v[160:163], a[156:159], v[100:103]
v_mfma_f32_16x16x32_bf16 v[84:87], v[160:163], a[152:155], v[84:87]
ds_read_b128 v[152:155], v248 offset:61440
v_mfma_f32_16x16x32_bf16 v[84:87], v[156:159], a[144:147], v[84:87]
s_waitcnt lgkmcnt(4)
v_mfma_f32_16x16x32_bf16 v[88:91], v[164:167], a[144:147], v[88:91]
ds_read_b128 v[156:159], v248 offset:54272
v_mfma_f32_16x16x32_bf16 v[88:91], v[168:171], a[152:155], v[88:91]
v_mfma_f32_16x16x32_bf16 v[104:107], v[168:171], a[156:159], v[104:107]
ds_read_b128 v[160:163], v248 offset:62464
v_mfma_f32_16x16x32_bf16 v[104:107], v[164:167], a[148:151], v[104:107]
s_waitcnt lgkmcnt(4)
v_mfma_f32_16x16x32_bf16 v[108:111], v[172:175], a[148:151], v[108:111]
ds_read_b128 v[164:167], v248 offset:55296
v_mfma_f32_16x16x32_bf16 v[108:111], v[176:179], a[156:159], v[108:111]
v_mfma_f32_16x16x32_bf16 v[92:95], v[176:179], a[152:155], v[92:95]
ds_read_b128 v[168:171], v248 offset:63488
v_mfma_f32_16x16x32_bf16 v[92:95], v[172:175], a[144:147], v[92:95]
s_waitcnt lgkmcnt(4)
v_mfma_f32_16x16x32_bf16 v[80:83], v[148:151], a[160:163], v[80:83]
ds_read_b128 v[172:175], v248 offset:56320
v_mfma_f32_16x16x32_bf16 v[80:83], v[152:155], a[168:171], v[80:83]
v_mfma_f32_16x16x32_bf16 v[96:99], v[152:155], a[172:175], v[96:99]
ds_read_b128 v[176:179], v248 offset:64512
v_mfma_f32_16x16x32_bf16 v[96:99], v[148:151], a[164:167], v[96:99]
s_waitcnt vmcnt(0)
buffer_store_dword v14, off, s[32:35], s82 offset:64 sc0 sc1
s_waitcnt lgkmcnt(4)
v_mfma_f32_16x16x32_bf16 v[100:103], v[156:159], a[164:167], v[100:103]
ds_read_b128 v[148:151], v144 offset:20480
v_mfma_f32_16x16x32_bf16 v[100:103], v[160:163], a[172:175], v[100:103]
v_mfma_f32_16x16x32_bf16 v[84:87], v[160:163], a[168:171], v[84:87]
ds_read_b128 v[152:155], v144 offset:28672
v_mfma_f32_16x16x32_bf16 v[84:87], v[156:159], a[160:163], v[84:87]
s_waitcnt lgkmcnt(4)
v_mfma_f32_16x16x32_bf16 v[88:91], v[164:167], a[160:163], v[88:91]
ds_read_b128 v[156:159], v144 offset:21504
v_mfma_f32_16x16x32_bf16 v[88:91], v[168:171], a[168:171], v[88:91]
v_mfma_f32_16x16x32_bf16 v[104:107], v[168:171], a[172:175], v[104:107]
ds_read_b128 v[160:163], v144 offset:29696
v_mfma_f32_16x16x32_bf16 v[104:107], v[164:167], a[164:167], v[104:107]
s_waitcnt lgkmcnt(4)
v_mfma_f32_16x16x32_bf16 v[108:111], v[172:175], a[164:167], v[108:111]
ds_read_b128 v[164:167], v144 offset:22528
v_mfma_f32_16x16x32_bf16 v[108:111], v[176:179], a[172:175], v[108:111]
v_mfma_f32_16x16x32_bf16 v[92:95], v[176:179], a[168:171], v[92:95]
ds_read_b128 v[168:171], v144 offset:30720
v_mfma_f32_16x16x32_bf16 v[92:95], v[172:175], a[160:163], v[92:95]
s_waitcnt lgkmcnt(4)
v_mfma_f32_16x16x32_bf16 v[80:83], v[148:151], a[176:179], v[80:83]
ds_read_b128 v[172:175], v144 offset:23552
v_mfma_f32_16x16x32_bf16 v[80:83], v[152:155], a[184:187], v[80:83]
v_mfma_f32_16x16x32_bf16 v[96:99], v[152:155], a[188:191], v[96:99]
ds_read_b128 v[176:179], v144 offset:31744
v_mfma_f32_16x16x32_bf16 v[96:99], v[148:151], a[180:183], v[96:99]
s_waitcnt lgkmcnt(4)
v_mfma_f32_16x16x32_bf16 v[100:103], v[156:159], a[180:183], v[100:103]
v_mfma_f32_16x16x32_bf16 v[100:103], v[160:163], a[188:191], v[100:103]
v_mfma_f32_16x16x32_bf16 v[84:87], v[160:163], a[184:187], v[84:87]
v_mfma_f32_16x16x32_bf16 v[84:87], v[156:159], a[176:179], v[84:87]
s_waitcnt lgkmcnt(2)
v_mfma_f32_16x16x32_bf16 v[88:91], v[164:167], a[176:179], v[88:91]
v_mfma_f32_16x16x32_bf16 v[88:91], v[168:171], a[184:187], v[88:91]
v_mfma_f32_16x16x32_bf16 v[104:107], v[168:171], a[188:191], v[104:107]
v_mfma_f32_16x16x32_bf16 v[104:107], v[164:167], a[180:183], v[104:107]
s_waitcnt lgkmcnt(0)
v_mfma_f32_16x16x32_bf16 v[108:111], v[172:175], a[180:183], v[108:111]
v_mfma_f32_16x16x32_bf16 v[108:111], v[176:179], a[188:191], v[108:111]
v_mfma_f32_16x16x32_bf16 v[92:95], v[176:179], a[184:187], v[92:95]
v_mfma_f32_16x16x32_bf16 v[92:95], v[172:175], a[176:179], v[92:95]
s_branch L_main_kernel_tl
.org L_main_kernel_eb + 10368
L_main_kernel_e1:
s_waitcnt lgkmcnt(4)
v_mfma_f32_16x16x32_bf16 v[112:115], v[148:151], a[208:211], v[112:115]
ds_read_b128 v[172:175], v248 offset:19456
v_mfma_f32_16x16x32_bf16 v[112:115], v[152:155], a[216:219], v[112:115]
v_mfma_f32_16x16x32_bf16 v[128:131], v[152:155], a[220:223], v[128:131]
ds_read_b128 v[176:179], v248 offset:27648
v_mfma_f32_16x16x32_bf16 v[128:131], v[148:151], a[212:215], v[128:131]
s_waitcnt vmcnt(8)
s_barrier
s_waitcnt lgkmcnt(4)
v_mfma_f32_16x16x32_bf16 v[132:135], v[156:159], a[212:215], v[132:135]
ds_read_b128 v[148:151], v248 offset:32768
s_mov_b32 s37, 0xffff0000
v_mfma_f32_16x16x32_bf16 v[132:135], v[160:163], a[220:223], v[132:135]
s_mov_b32 s38, 0xbfb8aa3b
s_mov_b32 s39, 0xbfb8aa3b
v_mfma_f32_16x16x32_bf16 v[116:119], v[160:163], a[216:219], v[116:119]
ds_read_b128 v[152:155], v248 offset:40960
v_mov_b32 v14, 1
v_mfma_f32_16x16x32_bf16 v[116:119], v[156:159], a[208:211], v[116:119]
v_permlane16_swap_b32 v52, v54
s_waitcnt lgkmcnt(4)
v_mfma_f32_16x16x32_bf16 v[120:123], v[164:167], a[208:211], v[120:123]
ds_read_b128 v[156:159], v248 offset:33792
v_permlane16_swap_b32 v53, v55
v_mfma_f32_16x16x32_bf16 v[120:123], v[168:171], a[216:219], v[120:123]
v_permlane16_swap_b32 v60, v62
v_permlane16_swap_b32 v61, v63
v_mfma_f32_16x16x32_bf16 v[136:139], v[168:171], a[220:223], v[136:139]
ds_read_b128 v[160:163], v248 offset:41984
v_permlane16_swap_b32 v68, v70
v_mfma_f32_16x16x32_bf16 v[136:139], v[164:167], a[212:215], v[136:139]
v_permlane16_swap_b32 v69, v71
s_waitcnt lgkmcnt(4)
v_mfma_f32_16x16x32_bf16 v[140:143], v[172:175], a[212:215], v[140:143]
ds_read_b128 v[164:167], v248 offset:34816
v_permlane16_swap_b32 v76, v78
v_mfma_f32_16x16x32_bf16 v[140:143], v[176:179], a[220:223], v[140:143]
v_permlane16_swap_b32 v77, v79
v_lshlrev_b32 v48, 16, v52
v_mfma_f32_16x16x32_bf16 v[124:127], v[176:179], a[216:219], v[124:127]
ds_read_b128 v[168:171], v248 offset:43008
v_and_b32 v49, s37, v52
v_mfma_f32_16x16x32_bf16 v[124:127], v[172:175], a[208:211], v[124:127]
v_lshlrev_b32 v50, 16, v53
s_waitcnt lgkmcnt(4)
v_mfma_f32_16x16x32_bf16 v[112:115], v[148:151], a[128:131], v[112:115]
ds_read_b128 v[172:175], v248 offset:35840
v_and_b32 v51, s37, v53
v_mfma_f32_16x16x32_bf16 v[112:115], v[152:155], a[136:139], v[112:115]
v_lshlrev_b32 v52, 16, v54
v_and_b32 v53, s37, v54
v_mfma_f32_16x16x32_bf16 v[128:131], v[152:155], a[140:143], v[128:131]
ds_read_b128 v[176:179], v248 offset:44032
v_lshlrev_b32 v54, 16, v55
v_mfma_f32_16x16x32_bf16 v[128:131], v[148:151], a[132:135], v[128:131]
v_and_b32 v55, s37, v55
s_waitcnt lgkmcnt(4)
v_mfma_f32_16x16x32_bf16 v[132:135], v[156:159], a[132:135], v[132:135]
ds_read_b128 v[148:151], v144 offset:0
v_lshlrev_b32 v56, 16, v60
v_mfma_f32_16x16x32_bf16 v[132:135], v[160:163], a[140:143], v[132:135]
v_and_b32 v57, s37, v60
v_lshlrev_b32 v58, 16, v61
v_mfma_f32_16x16x32_bf16 v[116:119], v[160:163], a[136:139], v[116:119]
ds_read_b128 v[152:155], v144 offset:8192
v_and_b32 v59, s37, v61
v_mfma_f32_16x16x32_bf16 v[116:119], v[156:159], a[128:131], v[116:119]
v_lshlrev_b32 v60, 16, v62
s_waitcnt lgkmcnt(4)
v_mfma_f32_16x16x32_bf16 v[120:123], v[164:167], a[128:131], v[120:123]
ds_read_b128 v[156:159], v248 offset:49152
v_and_b32 v61, s37, v62
v_mfma_f32_16x16x32_bf16 v[120:123], v[168:171], a[136:139], v[120:123]
v_lshlrev_b32 v62, 16, v63
v_and_b32 v63, s37, v63
v_mfma_f32_16x16x32_bf16 v[136:139], v[168:171], a[140:143], v[136:139]
ds_read_b128 v[160:163], v248 offset:57344
v_lshlrev_b32 v64, 16, v68
v_mfma_f32_16x16x32_bf16 v[136:139], v[164:167], a[132:135], v[136:139]
v_and_b32 v65, s37, v68
s_waitcnt lgkmcnt(4)
v_mfma_f32_16x16x32_bf16 v[140:143], v[172:175], a[132:135], v[140:143]
ds_read_b128 v[164:167], v144 offset:16384
v_lshlrev_b32 v66, 16, v69
v_mfma_f32_16x16x32_bf16 v[140:143], v[176:179], a[140:143], v[140:143]
v_and_b32 v67, s37, v69
v_lshlrev_b32 v68, 16, v70
v_mfma_f32_16x16x32_bf16 v[124:127], v[176:179], a[136:139], v[124:127]
ds_read_b128 v[168:171], v144 offset:24576
v_and_b32 v69, s37, v70
v_mfma_f32_16x16x32_bf16 v[124:127], v[172:175], a[128:131], v[124:127]
v_lshlrev_b32 v70, 16, v71
s_waitcnt vmcnt(0)
s_barrier
s_waitcnt lgkmcnt(4)
v_mfma_f32_16x16x32_bf16 v[112:115], v[148:151], a[144:147], v[112:115]
ds_read_b128 v[172:175], v144 offset:32768
v_and_b32 v71, s37, v71
v_mfma_f32_16x16x32_bf16 v[112:115], v[152:155], a[152:155], v[112:115]
v_lshlrev_b32 v72, 16, v76
v_and_b32 v73, s37, v76
v_mfma_f32_16x16x32_bf16 v[128:131], v[152:155], a[156:159], v[128:131]
ds_read_b128 v[176:179], v144 offset:40960
v_lshlrev_b32 v74, 16, v77
v_mfma_f32_16x16x32_bf16 v[128:131], v[148:151], a[148:151], v[128:131]
v_and_b32 v75, s37, v77
s_waitcnt lgkmcnt(4)
v_mfma_f32_16x16x32_bf16 v[128:131], v[156:159], a[164:167], v[128:131]
ds_read_b128 v[148:151], v144 offset:1024
v_lshlrev_b32 v76, 16, v78
v_mfma_f32_16x16x32_bf16 v[128:131], v[160:163], a[172:175], v[128:131]
v_and_b32 v77, s37, v78
v_lshlrev_b32 v78, 16, v79
v_mfma_f32_16x16x32_bf16 v[112:115], v[160:163], a[168:171], v[112:115]
ds_read_b128 v[152:155], v144 offset:9216
v_and_b32 v79, s37, v79
v_mfma_f32_16x16x32_bf16 v[112:115], v[156:159], a[160:163], v[112:115]
v_add_f32 v180, v180, v212
s_waitcnt lgkmcnt(4)
v_mfma_f32_16x16x32_bf16 v[112:115], v[164:167], a[176:179], v[112:115]
ds_read_b128 v[156:159], v248 offset:50176
v_add_f32 v181, v181, v213
v_mfma_f32_16x16x32_bf16 v[112:115], v[168:171], a[184:187], v[112:115]
v_add_f32 v182, v182, v214
v_add_f32 v183, v183, v215
v_mfma_f32_16x16x32_bf16 v[128:131], v[168:171], a[188:191], v[128:131]
ds_read_b128 v[160:163], v248 offset:58368
v_add_f32 v184, v184, v216
v_mfma_f32_16x16x32_bf16 v[128:131], v[164:167], a[180:183], v[128:131]
v_add_f32 v185, v185, v217
s_waitcnt lgkmcnt(4)
v_mfma_f32_16x16x32_bf16 v[128:131], v[172:175], v[20:23], v[128:131]
ds_read_b128 v[164:167], v144 offset:17408
v_add_f32 v186, v186, v218
v_mfma_f32_16x16x32_bf16 v[128:131], v[176:179], v[28:31], v[128:131]
v_add_f32 v187, v187, v219
v_add_f32 v188, v188, v220
v_mfma_f32_16x16x32_bf16 v[112:115], v[176:179], v[24:27], v[112:115]
ds_read_b128 v[168:171], v144 offset:25600
v_add_f32 v189, v189, v221
v_mfma_f32_16x16x32_bf16 v[112:115], v[172:175], v[16:19], v[112:115]
v_add_f32 v190, v190, v222
s_waitcnt lgkmcnt(4)
v_mfma_f32_16x16x32_bf16 v[116:119], v[148:151], a[144:147], v[116:119]
ds_read_b128 v[172:175], v144 offset:33792
v_add_f32 v191, v191, v223
v_mfma_f32_16x16x32_bf16 v[116:119], v[152:155], a[152:155], v[116:119]
v_add_f32 v192, v192, v224
v_add_f32 v193, v193, v225
v_mfma_f32_16x16x32_bf16 v[132:135], v[152:155], a[156:159], v[132:135]
ds_read_b128 v[176:179], v144 offset:41984
v_add_f32 v194, v194, v226
v_mfma_f32_16x16x32_bf16 v[132:135], v[148:151], a[148:151], v[132:135]
buffer_store_dwordx4 v[128:131], v252, s[84:87], s75 offen offset:0 sc0 sc1
s_waitcnt lgkmcnt(4)
v_mfma_f32_16x16x32_bf16 v[132:135], v[156:159], a[164:167], v[132:135]
ds_read_b128 v[148:151], v144 offset:2048
v_add_f32 v195, v195, v227
v_mfma_f32_16x16x32_bf16 v[132:135], v[160:163], a[172:175], v[132:135]
v_add_f32 v196, v196, v228
v_add_f32 v197, v197, v229
v_mfma_f32_16x16x32_bf16 v[116:119], v[160:163], a[168:171], v[116:119]
ds_read_b128 v[152:155], v144 offset:10240
v_add_f32 v198, v198, v230
v_mfma_f32_16x16x32_bf16 v[116:119], v[156:159], a[160:163], v[116:119]
buffer_store_dwordx4 v[112:115], v252, s[84:87], s74 offen offset:0 sc0 sc1
s_waitcnt lgkmcnt(4)
v_mfma_f32_16x16x32_bf16 v[116:119], v[164:167], a[176:179], v[116:119]
ds_read_b128 v[156:159], v248 offset:51200
v_add_f32 v199, v199, v231
v_mfma_f32_16x16x32_bf16 v[116:119], v[168:171], a[184:187], v[116:119]
v_add_f32 v200, v200, v232
v_add_f32 v201, v201, v233
v_mfma_f32_16x16x32_bf16 v[132:135], v[168:171], a[188:191], v[132:135]
ds_read_b128 v[160:163], v248 offset:59392
v_add_f32 v202, v202, v234
v_mfma_f32_16x16x32_bf16 v[132:135], v[164:167], a[180:183], v[132:135]
v_add_f32 v203, v203, v235
s_waitcnt lgkmcnt(4)
v_mfma_f32_16x16x32_bf16 v[132:135], v[172:175], v[20:23], v[132:135]
ds_read_b128 v[164:167], v144 offset:18432
v_add_f32 v204, v204, v236
v_mfma_f32_16x16x32_bf16 v[132:135], v[176:179], v[28:31], v[132:135]
v_add_f32 v205, v205, v237
v_add_f32 v206, v206, v238
v_mfma_f32_16x16x32_bf16 v[116:119], v[176:179], v[24:27], v[116:119]
ds_read_b128 v[168:171], v144 offset:26624
v_add_f32 v207, v207, v239
v_mfma_f32_16x16x32_bf16 v[116:119], v[172:175], v[16:19], v[116:119]
v_add_f32 v208, v208, v240
s_waitcnt lgkmcnt(4)
v_mfma_f32_16x16x32_bf16 v[120:123], v[148:151], a[144:147], v[120:123]
ds_read_b128 v[172:175], v144 offset:34816
v_add_f32 v209, v209, v241
v_mfma_f32_16x16x32_bf16 v[120:123], v[152:155], a[152:155], v[120:123]
v_add_f32 v210, v210, v242
v_add_f32 v211, v211, v243
v_mfma_f32_16x16x32_bf16 v[136:139], v[152:155], a[156:159], v[136:139]
ds_read_b128 v[176:179], v144 offset:43008
v_cvt_pk_bf16_f32 v180, 0, v180
v_mfma_f32_16x16x32_bf16 v[136:139], v[148:151], a[148:151], v[136:139]
buffer_store_dwordx4 v[132:135], v252, s[84:87], s75 offen offset:1024 sc0 sc1
s_waitcnt lgkmcnt(4)
v_mfma_f32_16x16x32_bf16 v[136:139], v[156:159], a[164:167], v[136:139]
ds_read_b128 v[148:151], v144 offset:3072
v_cvt_pk_bf16_f32 v181, 0, v181
v_mfma_f32_16x16x32_bf16 v[136:139], v[160:163], a[172:175], v[136:139]
v_cvt_pk_bf16_f32 v182, 0, v182
v_cvt_pk_bf16_f32 v183, 0, v183
v_mfma_f32_16x16x32_bf16 v[120:123], v[160:163], a[168:171], v[120:123]
ds_read_b128 v[152:155], v144 offset:11264
v_cvt_pk_bf16_f32 v184, 0, v184
v_mfma_f32_16x16x32_bf16 v[120:123], v[156:159], a[160:163], v[120:123]
buffer_store_dwordx4 v[116:119], v252, s[84:87], s74 offen offset:1024 sc0 sc1
s_waitcnt lgkmcnt(4)
v_mfma_f32_16x16x32_bf16 v[120:123], v[164:167], a[176:179], v[120:123]
ds_read_b128 v[156:159], v248 offset:52224
v_cvt_pk_bf16_f32 v185, 0, v185
v_mfma_f32_16x16x32_bf16 v[120:123], v[168:171], a[184:187], v[120:123]
v_cvt_pk_bf16_f32 v186, 0, v186
v_cvt_pk_bf16_f32 v187, 0, v187
v_mfma_f32_16x16x32_bf16 v[136:139], v[168:171], a[188:191], v[136:139]
ds_read_b128 v[160:163], v248 offset:60416
v_cvt_pk_bf16_f32 v188, 0, v188
v_mfma_f32_16x16x32_bf16 v[136:139], v[164:167], a[180:183], v[136:139]
v_cvt_pk_bf16_f32 v189, 0, v189
s_waitcnt lgkmcnt(4)
v_mfma_f32_16x16x32_bf16 v[136:139], v[172:175], v[20:23], v[136:139]
ds_read_b128 v[164:167], v144 offset:19456
v_cvt_pk_bf16_f32 v190, 0, v190
v_mfma_f32_16x16x32_bf16 v[136:139], v[176:179], v[28:31], v[136:139]
v_cvt_pk_bf16_f32 v191, 0, v191
v_cvt_pk_bf16_f32 v192, 0, v192
v_mfma_f32_16x16x32_bf16 v[120:123], v[176:179], v[24:27], v[120:123]
ds_read_b128 v[168:171], v144 offset:27648
v_cvt_pk_bf16_f32 v193, 0, v193
v_mfma_f32_16x16x32_bf16 v[120:123], v[172:175], v[16:19], v[120:123]
v_cvt_pk_bf16_f32 v194, 0, v194
s_waitcnt lgkmcnt(4)
v_mfma_f32_16x16x32_bf16 v[124:127], v[148:151], a[144:147], v[124:127]
ds_read_b128 v[172:175], v144 offset:35840
v_cvt_pk_bf16_f32 v195, 0, v195
v_mfma_f32_16x16x32_bf16 v[124:127], v[152:155], a[152:155], v[124:127]
v_cvt_pk_bf16_f32 v196, 0, v196
v_cvt_pk_bf16_f32 v197, 0, v197
v_mfma_f32_16x16x32_bf16 v[140:143], v[152:155], a[156:159], v[140:143]
ds_read_b128 v[176:179], v144 offset:44032
v_cvt_pk_bf16_f32 v198, 0, v198
v_mfma_f32_16x16x32_bf16 v[140:143], v[148:151], a[148:151], v[140:143]
buffer_store_dwordx4 v[136:139], v252, s[84:87], s75 offen offset:2048 sc0 sc1
s_waitcnt lgkmcnt(4)
v_mfma_f32_16x16x32_bf16 v[140:143], v[156:159], a[164:167], v[140:143]
ds_read_b128 v[148:151], v248 offset:20480
v_cvt_pk_bf16_f32 v199, 0, v199
v_mfma_f32_16x16x32_bf16 v[140:143], v[160:163], a[172:175], v[140:143]
v_cvt_pk_bf16_f32 v200, 0, v200
v_cvt_pk_bf16_f32 v201, 0, v201
v_mfma_f32_16x16x32_bf16 v[124:127], v[160:163], a[168:171], v[124:127]
ds_read_b128 v[152:155], v248 offset:28672
v_cvt_pk_bf16_f32 v202, 0, v202
v_mfma_f32_16x16x32_bf16 v[124:127], v[156:159], a[160:163], v[124:127]
buffer_store_dwordx4 v[120:123], v252, s[84:87], s74 offen offset:2048 sc0 sc1
s_waitcnt lgkmcnt(4)
v_mfma_f32_16x16x32_bf16 v[124:127], v[164:167], a[176:179], v[124:127]
ds_read_b128 v[156:159], v248 offset:21504
v_cvt_pk_bf16_f32 v203, 0, v203
v_mfma_f32_16x16x32_bf16 v[124:127], v[168:171], a[184:187], v[124:127]
v_cvt_pk_bf16_f32 v204, 0, v204
v_cvt_pk_bf16_f32 v205, 0, v205
v_mfma_f32_16x16x32_bf16 v[140:143], v[168:171], a[188:191], v[140:143]
ds_read_b128 v[160:163], v248 offset:29696
v_cvt_pk_bf16_f32 v206, 0, v206
v_mfma_f32_16x16x32_bf16 v[140:143], v[164:167], a[180:183], v[140:143]
v_cvt_pk_bf16_f32 v207, 0, v207
s_waitcnt lgkmcnt(4)
v_mfma_f32_16x16x32_bf16 v[140:143], v[172:175], v[20:23], v[140:143]
ds_read_b128 v[164:167], v248 offset:22528
v_cvt_pk_bf16_f32 v208, 0, v208
v_mfma_f32_16x16x32_bf16 v[140:143], v[176:179], v[28:31], v[140:143]
v_cvt_pk_bf16_f32 v209, 0, v209
v_cvt_pk_bf16_f32 v210, 0, v210
v_mfma_f32_16x16x32_bf16 v[124:127], v[176:179], v[24:27], v[124:127]
ds_read_b128 v[168:171], v248 offset:30720
v_cvt_pk_bf16_f32 v211, 0, v211
v_mfma_f32_16x16x32_bf16 v[124:127], v[172:175], v[16:19], v[124:127]
v_mul_f32 v212, s38, v180
s_waitcnt lgkmcnt(4)
v_mfma_f32_16x16x32_bf16 v[80:83], v[148:151], a[208:211], v[80:83]
ds_read_b128 v[172:175], v248 offset:23552
v_mul_f32 v213, s38, v181
v_mfma_f32_16x16x32_bf16 v[80:83], v[152:155], a[216:219], v[80:83]
v_mul_f32 v214, s38, v182
v_mul_f32 v215, s38, v183
v_mfma_f32_16x16x32_bf16 v[96:99], v[152:155], a[220:223], v[96:99]
ds_read_b128 v[176:179], v248 offset:31744
v_mul_f32 v216, s38, v184
v_mfma_f32_16x16x32_bf16 v[96:99], v[148:151], a[212:215], v[96:99]
buffer_store_dwordx4 v[140:143], v252, s[84:87], s75 offen offset:3072 sc0 sc1
s_waitcnt lgkmcnt(4)
v_mfma_f32_16x16x32_bf16 v[100:103], v[156:159], a[212:215], v[100:103]
ds_read_b128 v[148:151], v248 offset:36864
v_mul_f32 v217, s38, v185
v_mfma_f32_16x16x32_bf16 v[100:103], v[160:163], a[220:223], v[100:103]
v_mul_f32 v218, s38, v186
v_mul_f32 v219, s38, v187
v_mfma_f32_16x16x32_bf16 v[84:87], v[160:163], a[216:219], v[84:87]
ds_read_b128 v[152:155], v248 offset:45056
v_mul_f32 v220, s38, v188
v_mfma_f32_16x16x32_bf16 v[84:87], v[156:159], a[208:211], v[84:87]
buffer_store_dwordx4 v[124:127], v252, s[84:87], s74 offen offset:3072 sc0 sc1
s_waitcnt lgkmcnt(4)
v_mfma_f32_16x16x32_bf16 v[88:91], v[164:167], a[208:211], v[88:91]
ds_read_b128 v[156:159], v248 offset:37888
v_mul_f32 v221, s38, v189
v_mfma_f32_16x16x32_bf16 v[88:91], v[168:171], a[216:219], v[88:91]
v_mul_f32 v222, s38, v190
v_mul_f32 v223, s38, v191
v_mfma_f32_16x16x32_bf16 v[104:107], v[168:171], a[220:223], v[104:107]
ds_read_b128 v[160:163], v248 offset:46080
v_mul_f32 v224, s38, v192
v_mfma_f32_16x16x32_bf16 v[104:107], v[164:167], a[212:215], v[104:107]
v_mul_f32 v225, s38, v193
s_waitcnt lgkmcnt(4)
v_mfma_f32_16x16x32_bf16 v[108:111], v[172:175], a[212:215], v[108:111]
ds_read_b128 v[164:167], v248 offset:38912
v_mul_f32 v226, s38, v194
v_mfma_f32_16x16x32_bf16 v[108:111], v[176:179], a[220:223], v[108:111]
v_mul_f32 v227, s38, v195
v_mul_f32 v228, s38, v196
v_mfma_f32_16x16x32_bf16 v[92:95], v[176:179], a[216:219], v[92:95]
ds_read_b128 v[168:171], v248 offset:47104
v_mul_f32 v229, s38, v197
v_mfma_f32_16x16x32_bf16 v[92:95], v[172:175], a[208:211], v[92:95]
v_mul_f32 v230, s38, v198
s_waitcnt lgkmcnt(4)
v_mfma_f32_16x16x32_bf16 v[80:83], v[148:151], a[128:131], v[80:83]
ds_read_b128 v[172:175], v248 offset:39936
v_mul_f32 v231, s38, v199
v_mfma_f32_16x16x32_bf16 v[80:83], v[152:155], a[136:139], v[80:83]
v_mul_f32 v232, s38, v200
v_mul_f32 v233, s38, v201
v_mfma_f32_16x16x32_bf16 v[96:99], v[152:155], a[140:143], v[96:99]
ds_read_b128 v[176:179], v248 offset:48128
v_mul_f32 v234, s38, v202
v_mfma_f32_16x16x32_bf16 v[96:99], v[148:151], a[132:135], v[96:99]
v_mul_f32 v235, s38, v203
s_waitcnt lgkmcnt(4)
v_mfma_f32_16x16x32_bf16 v[100:103], v[156:159], a[132:135], v[100:103]
ds_read_b128 v[148:151], v144 offset:4096
v_mul_f32 v236, s38, v204
v_mfma_f32_16x16x32_bf16 v[100:103], v[160:163], a[140:143], v[100:103]
v_mul_f32 v237, s38, v205
v_mul_f32 v238, s38, v206
v_mfma_f32_16x16x32_bf16 v[84:87], v[160:163], a[136:139], v[84:87]
ds_read_b128 v[152:155], v144 offset:12288
v_mul_f32 v239, s38, v207
v_mfma_f32_16x16x32_bf16 v[84:87], v[156:159], a[128:131], v[84:87]
v_mul_f32 v240, s38, v208
s_waitcnt lgkmcnt(4)
v_mfma_f32_16x16x32_bf16 v[88:91], v[164:167], a[128:131], v[88:91]
ds_read_b128 v[156:159], v144 offset:5120
v_mul_f32 v241, s38, v209
v_mfma_f32_16x16x32_bf16 v[88:91], v[168:171], a[136:139], v[88:91]
v_mul_f32 v242, s38, v210
v_mul_f32 v243, s38, v211
v_mfma_f32_16x16x32_bf16 v[104:107], v[168:171], a[140:143], v[104:107]
ds_read_b128 v[160:163], v144 offset:13312
v_mfma_f32_16x16x32_bf16 v[104:107], v[164:167], a[132:135], v[104:107]
s_waitcnt lgkmcnt(4)
v_mfma_f32_16x16x32_bf16 v[108:111], v[172:175], a[132:135], v[108:111]
ds_read_b128 v[164:167], v144 offset:6144
v_mfma_f32_16x16x32_bf16 v[108:111], v[176:179], a[140:143], v[108:111]
v_mfma_f32_16x16x32_bf16 v[92:95], v[176:179], a[136:139], v[92:95]
ds_read_b128 v[168:171], v144 offset:14336
v_mfma_f32_16x16x32_bf16 v[92:95], v[172:175], a[128:131], v[92:95]
s_waitcnt lgkmcnt(4)
v_mfma_f32_16x16x32_bf16 v[80:83], v[148:151], a[144:147], v[80:83]
ds_read_b128 v[172:175], v144 offset:7168
v_mfma_f32_16x16x32_bf16 v[80:83], v[152:155], a[152:155], v[80:83]
v_mfma_f32_16x16x32_bf16 v[96:99], v[152:155], a[156:159], v[96:99]
ds_read_b128 v[176:179], v144 offset:15360
v_mfma_f32_16x16x32_bf16 v[96:99], v[148:151], a[148:151], v[96:99]
s_waitcnt lgkmcnt(4)
v_mfma_f32_16x16x32_bf16 v[100:103], v[156:159], a[148:151], v[100:103]
ds_read_b128 v[148:151], v248 offset:53248
v_mfma_f32_16x16x32_bf16 v[100:103], v[160:163], a[156:159], v[100:103]
v_mfma_f32_16x16x32_bf16 v[84:87], v[160:163], a[152:155], v[84:87]
ds_read_b128 v[152:155], v248 offset:61440
v_mfma_f32_16x16x32_bf16 v[84:87], v[156:159], a[144:147], v[84:87]
s_waitcnt lgkmcnt(4)
v_mfma_f32_16x16x32_bf16 v[88:91], v[164:167], a[144:147], v[88:91]
ds_read_b128 v[156:159], v248 offset:54272
v_mfma_f32_16x16x32_bf16 v[88:91], v[168:171], a[152:155], v[88:91]
v_mfma_f32_16x16x32_bf16 v[104:107], v[168:171], a[156:159], v[104:107]
ds_read_b128 v[160:163], v248 offset:62464
v_mfma_f32_16x16x32_bf16 v[104:107], v[164:167], a[148:151], v[104:107]
s_waitcnt lgkmcnt(4)
v_mfma_f32_16x16x32_bf16 v[108:111], v[172:175], a[148:151], v[108:111]
ds_read_b128 v[164:167], v248 offset:55296
v_mfma_f32_16x16x32_bf16 v[108:111], v[176:179], a[156:159], v[108:111]
v_mfma_f32_16x16x32_bf16 v[92:95], v[176:179], a[152:155], v[92:95]
ds_read_b128 v[168:171], v248 offset:63488
v_mfma_f32_16x16x32_bf16 v[92:95], v[172:175], a[144:147], v[92:95]
s_waitcnt lgkmcnt(4)
v_mfma_f32_16x16x32_bf16 v[80:83], v[148:151], a[160:163], v[80:83]
ds_read_b128 v[172:175], v248 offset:56320
v_mfma_f32_16x16x32_bf16 v[80:83], v[152:155], a[168:171], v[80:83]
v_mfma_f32_16x16x32_bf16 v[96:99], v[152:155], a[172:175], v[96:99]
ds_read_b128 v[176:179], v248 offset:64512
v_mfma_f32_16x16x32_bf16 v[96:99], v[148:151], a[164:167], v[96:99]
s_waitcnt lgkmcnt(4)
v_mfma_f32_16x16x32_bf16 v[100:103], v[156:159], a[164:167], v[100:103]
ds_read_b128 v[148:151], v144 offset:20480
v_mfma_f32_16x16x32_bf16 v[100:103], v[160:163], a[172:175], v[100:103]
v_mfma_f32_16x16x32_bf16 v[84:87], v[160:163], a[168:171], v[84:87]
ds_read_b128 v[152:155], v144 offset:28672
v_mfma_f32_16x16x32_bf16 v[84:87], v[156:159], a[160:163], v[84:87]
s_waitcnt lgkmcnt(4)
v_mfma_f32_16x16x32_bf16 v[88:91], v[164:167], a[160:163], v[88:91]
ds_read_b128 v[156:159], v144 offset:21504
v_mfma_f32_16x16x32_bf16 v[88:91], v[168:171], a[168:171], v[88:91]
v_mfma_f32_16x16x32_bf16 v[104:107], v[168:171], a[172:175], v[104:107]
ds_read_b128 v[160:163], v144 offset:29696
v_mfma_f32_16x16x32_bf16 v[104:107], v[164:167], a[164:167], v[104:107]
s_waitcnt lgkmcnt(4)
v_mfma_f32_16x16x32_bf16 v[108:111], v[172:175], a[164:167], v[108:111]
ds_read_b128 v[164:167], v144 offset:22528
v_mfma_f32_16x16x32_bf16 v[108:111], v[176:179], a[172:175], v[108:111]
v_mfma_f32_16x16x32_bf16 v[92:95], v[176:179], a[168:171], v[92:95]
ds_read_b128 v[168:171], v144 offset:30720
v_mfma_f32_16x16x32_bf16 v[92:95], v[172:175], a[160:163], v[92:95]
s_waitcnt lgkmcnt(4)
v_mfma_f32_16x16x32_bf16 v[80:83], v[148:151], a[176:179], v[80:83]
ds_read_b128 v[172:175], v144 offset:23552
v_mfma_f32_16x16x32_bf16 v[80:83], v[152:155], a[184:187], v[80:83]
v_mfma_f32_16x16x32_bf16 v[96:99], v[152:155], a[188:191], v[96:99]
ds_read_b128 v[176:179], v144 offset:31744
v_mfma_f32_16x16x32_bf16 v[96:99], v[148:151], a[180:183], v[96:99]
s_waitcnt vmcnt(0)
buffer_store_dword v14, off, s[32:35], s82 offset:64 sc0 sc1
s_waitcnt lgkmcnt(4)
v_mfma_f32_16x16x32_bf16 v[100:103], v[156:159], a[180:183], v[100:103]
ds_read_b128 v[148:151], v144 offset:36864
v_mfma_f32_16x16x32_bf16 v[100:103], v[160:163], a[188:191], v[100:103]
v_mfma_f32_16x16x32_bf16 v[84:87], v[160:163], a[184:187], v[84:87]
ds_read_b128 v[152:155], v144 offset:45056
v_mfma_f32_16x16x32_bf16 v[84:87], v[156:159], a[176:179], v[84:87]
s_waitcnt lgkmcnt(4)
v_mfma_f32_16x16x32_bf16 v[88:91], v[164:167], a[176:179], v[88:91]
ds_read_b128 v[156:159], v144 offset:37888
v_mfma_f32_16x16x32_bf16 v[88:91], v[168:171], a[184:187], v[88:91]
v_mfma_f32_16x16x32_bf16 v[104:107], v[168:171], a[188:191], v[104:107]
ds_read_b128 v[160:163], v144 offset:46080
v_mfma_f32_16x16x32_bf16 v[104:107], v[164:167], a[180:183], v[104:107]
s_waitcnt lgkmcnt(4)
v_mfma_f32_16x16x32_bf16 v[108:111], v[172:175], a[180:183], v[108:111]
ds_read_b128 v[164:167], v144 offset:38912
v_mfma_f32_16x16x32_bf16 v[108:111], v[176:179], a[188:191], v[108:111]
v_mfma_f32_16x16x32_bf16 v[92:95], v[176:179], a[184:187], v[92:95]
ds_read_b128 v[168:171], v144 offset:47104
v_mfma_f32_16x16x32_bf16 v[92:95], v[172:175], a[176:179], v[92:95]
s_waitcnt lgkmcnt(4)
v_mfma_f32_16x16x32_bf16 v[80:83], v[148:151], v[16:19], v[80:83]
ds_read_b128 v[172:175], v144 offset:39936
v_mfma_f32_16x16x32_bf16 v[80:83], v[152:155], v[24:27], v[80:83]
v_mfma_f32_16x16x32_bf16 v[96:99], v[152:155], v[28:31], v[96:99]
ds_read_b128 v[176:179], v144 offset:48128
v_mfma_f32_16x16x32_bf16 v[96:99], v[148:151], v[20:23], v[96:99]
s_waitcnt lgkmcnt(4)
v_mfma_f32_16x16x32_bf16 v[100:103], v[156:159], v[20:23], v[100:103]
v_mfma_f32_16x16x32_bf16 v[100:103], v[160:163], v[28:31], v[100:103]
v_mfma_f32_16x16x32_bf16 v[84:87], v[160:163], v[24:27], v[84:87]
v_mfma_f32_16x16x32_bf16 v[84:87], v[156:159], v[16:19], v[84:87]
s_waitcnt lgkmcnt(2)
v_mfma_f32_16x16x32_bf16 v[88:91], v[164:167], v[16:19], v[88:91]
v_mfma_f32_16x16x32_bf16 v[88:91], v[168:171], v[24:27], v[88:91]
v_mfma_f32_16x16x32_bf16 v[104:107], v[168:171], v[28:31], v[104:107]
v_mfma_f32_16x16x32_bf16 v[104:107], v[164:167], v[20:23], v[104:107]
s_waitcnt lgkmcnt(0)
v_mfma_f32_16x16x32_bf16 v[108:111], v[172:175], v[20:23], v[108:111]
v_mfma_f32_16x16x32_bf16 v[108:111], v[176:179], v[28:31], v[108:111]
v_mfma_f32_16x16x32_bf16 v[92:95], v[176:179], v[24:27], v[92:95]
v_mfma_f32_16x16x32_bf16 v[92:95], v[172:175], v[16:19], v[92:95]
s_branch L_main_kernel_tl
.org L_main_kernel_eb + 13824
L_main_kernel_e2:
s_waitcnt lgkmcnt(4)
v_mfma_f32_16x16x32_bf16 v[112:115], v[148:151], a[128:131], v[112:115]
ds_read_b128 v[172:175], v248 offset:35840
v_mfma_f32_16x16x32_bf16 v[112:115], v[152:155], a[136:139], v[112:115]
v_mfma_f32_16x16x32_bf16 v[128:131], v[152:155], a[140:143], v[128:131]
ds_read_b128 v[176:179], v248 offset:44032
v_mfma_f32_16x16x32_bf16 v[128:131], v[148:151], a[132:135], v[128:131]
s_waitcnt vmcnt(8)
s_barrier
s_waitcnt lgkmcnt(4)
v_mfma_f32_16x16x32_bf16 v[132:135], v[156:159], a[132:135], v[132:135]
ds_read_b128 v[148:151], v144 offset:0
s_mov_b32 s37, 0xffff0000
v_mfma_f32_16x16x32_bf16 v[132:135], v[160:163], a[140:143], v[132:135]
s_mov_b32 s38, 0xbfb8aa3b
s_mov_b32 s39, 0xbfb8aa3b
v_mfma_f32_16x16x32_bf16 v[116:119], v[160:163], a[136:139], v[116:119]
ds_read_b128 v[152:155], v144 offset:8192
v_mov_b32 v14, 1
v_mfma_f32_16x16x32_bf16 v[116:119], v[156:159], a[128:131], v[116:119]
v_permlane16_swap_b32 v52, v54
s_waitcnt lgkmcnt(4)
v_mfma_f32_16x16x32_bf16 v[120:123], v[164:167], a[128:131], v[120:123]
ds_read_b128 v[156:159], v144 offset:1024
v_permlane16_swap_b32 v53, v55
v_mfma_f32_16x16x32_bf16 v[120:123], v[168:171], a[136:139], v[120:123]
v_permlane16_swap_b32 v60, v62
v_permlane16_swap_b32 v61, v63
v_mfma_f32_16x16x32_bf16 v[136:139], v[168:171], a[140:143], v[136:139]
ds_read_b128 v[160:163], v144 offset:9216
v_permlane16_swap_b32 v68, v70
v_mfma_f32_16x16x32_bf16 v[136:139], v[164:167], a[132:135], v[136:139]
v_permlane16_swap_b32 v69, v71
s_waitcnt lgkmcnt(4)
v_mfma_f32_16x16x32_bf16 v[140:143], v[172:175], a[132:135], v[140:143]
ds_read_b128 v[164:167], v144 offset:2048
v_permlane16_swap_b32 v76, v78
v_mfma_f32_16x16x32_bf16 v[140:143], v[176:179], a[140:143], v[140:143]
v_permlane16_swap_b32 v77, v79
v_lshlrev_b32 v48, 16, v52
v_mfma_f32_16x16x32_bf16 v[124:127], v[176:179], a[136:139], v[124:127]
ds_read_b128 v[168:171], v144 offset:10240
v_and_b32 v49, s37, v52
v_mfma_f32_16x16x32_bf16 v[124:127], v[172:175], a[128:131], v[124:127]
v_lshlrev_b32 v50, 16, v53
s_waitcnt lgkmcnt(4)
v_mfma_f32_16x16x32_bf16 v[112:115], v[148:151], a[144:147], v[112:115]
ds_read_b128 v[172:175], v144 offset:3072
v_and_b32 v51, s37, v53
v_mfma_f32_16x16x32_bf16 v[112:115], v[152:155], a[152:155], v[112:115]
v_lshlrev_b32 v52, 16, v54
v_and_b32 v53, s37, v54
v_mfma_f32_16x16x32_bf16 v[128:131], v[152:155], a[156:159], v[128:131]
ds_read_b128 v[176:179], v144 offset:11264
v_lshlrev_b32 v54, 16, v55
v_mfma_f32_16x16x32_bf16 v[128:131], v[148:151], a[148:151], v[128:131]
v_and_b32 v55, s37, v55
s_waitcnt lgkmcnt(4)
v_mfma_f32_16x16x32_bf16 v[132:135], v[156:159], a[148:151], v[132:135]
ds_read_b128 v[148:151], v248 offset:49152
v_lshlrev_b32 v56, 16, v60
v_mfma_f32_16x16x32_bf16 v[132:135], v[160:163], a[156:159], v[132:135]
v_and_b32 v57, s37, v60
v_lshlrev_b32 v58, 16, v61
v_mfma_f32_16x16x32_bf16 v[116:119], v[160:163], a[152:155], v[116:119]
ds_read_b128 v[152:155], v248 offset:57344
v_and_b32 v59, s37, v61
v_mfma_f32_16x16x32_bf16 v[116:119], v[156:159], a[144:147], v[116:119]
v_lshlrev_b32 v60, 16, v62
s_waitcnt lgkmcnt(4)
v_mfma_f32_16x16x32_bf16 v[120:123], v[164:167], a[144:147], v[120:123]
ds_read_b128 v[156:159], v144 offset:16384
v_and_b32 v61, s37, v62
v_mfma_f32_16x16x32_bf16 v[120:123], v[168:171], a[152:155], v[120:123]
v_lshlrev_b32 v62, 16, v63
v_and_b32 v63, s37, v63
v_mfma_f32_16x16x32_bf16 v[136:139], v[168:171], a[156:159], v[136:139]
ds_read_b128 v[160:163], v144 offset:24576
v_lshlrev_b32 v64, 16, v68
v_mfma_f32_16x16x32_bf16 v[136:139], v[164:167], a[148:151], v[136:139]
v_and_b32 v65, s37, v68
s_waitcnt lgkmcnt(4)
v_mfma_f32_16x16x32_bf16 v[140:143], v[172:175], a[148:151], v[140:143]
ds_read_b128 v[164:167], v144 offset:32768
v_lshlrev_b32 v66, 16, v69
v_mfma_f32_16x16x32_bf16 v[140:143], v[176:179], a[156:159], v[140:143]
v_and_b32 v67, s37, v69
v_lshlrev_b32 v68, 16, v70
v_mfma_f32_16x16x32_bf16 v[124:127], v[176:179], a[152:155], v[124:127]
ds_read_b128 v[168:171], v144 offset:40960
v_and_b32 v69, s37, v70
v_mfma_f32_16x16x32_bf16 v[124:127], v[172:175], a[144:147], v[124:127]
v_lshlrev_b32 v70, 16, v71
s_waitcnt vmcnt(0)
s_barrier
s_waitcnt lgkmcnt(4)
v_mfma_f32_16x16x32_bf16 v[112:115], v[148:151], a[160:163], v[112:115]
ds_read_b128 v[172:175], v144 offset:49152
v_and_b32 v71, s37, v71
v_mfma_f32_16x16x32_bf16 v[112:115], v[152:155], a[168:171], v[112:115]
v_lshlrev_b32 v72, 16, v76
v_and_b32 v73, s37, v76
v_mfma_f32_16x16x32_bf16 v[128:131], v[152:155], a[172:175], v[128:131]
ds_read_b128 v[176:179], v144 offset:57344
v_lshlrev_b32 v74, 16, v77
v_mfma_f32_16x16x32_bf16 v[128:131], v[148:151], a[164:167], v[128:131]
v_and_b32 v75, s37, v77
s_waitcnt lgkmcnt(4)
v_mfma_f32_16x16x32_bf16 v[128:131], v[156:159], a[180:183], v[128:131]
ds_read_b128 v[148:151], v248 offset:50176
v_lshlrev_b32 v76, 16, v78
v_mfma_f32_16x16x32_bf16 v[128:131], v[160:163], a[188:191], v[128:131]
v_and_b32 v77, s37, v78
v_lshlrev_b32 v78, 16, v79
v_mfma_f32_16x16x32_bf16 v[112:115], v[160:163], a[184:187], v[112:115]
ds_read_b128 v[152:155], v248 offset:58368
v_and_b32 v79, s37, v79
v_mfma_f32_16x16x32_bf16 v[112:115], v[156:159], a[176:179], v[112:115]
v_add_f32 v180, v180, v212
s_waitcnt lgkmcnt(4)
v_mfma_f32_16x16x32_bf16 v[112:115], v[164:167], v[16:19], v[112:115]
ds_read_b128 v[156:159], v144 offset:17408
v_add_f32 v181, v181, v213
v_mfma_f32_16x16x32_bf16 v[112:115], v[168:171], v[24:27], v[112:115]
v_add_f32 v182, v182, v214
v_add_f32 v183, v183, v215
v_mfma_f32_16x16x32_bf16 v[128:131], v[168:171], v[28:31], v[128:131]
ds_read_b128 v[160:163], v144 offset:25600
v_add_f32 v184, v184, v216
v_mfma_f32_16x16x32_bf16 v[128:131], v[164:167], v[20:23], v[128:131]
v_add_f32 v185, v185, v217
s_waitcnt lgkmcnt(4)
v_mfma_f32_16x16x32_bf16 v[128:131], v[172:175], v[36:39], v[128:131]
ds_read_b128 v[164:167], v144 offset:33792
v_add_f32 v186, v186, v218
v_mfma_f32_16x16x32_bf16 v[128:131], v[176:179], v[44:47], v[128:131]
v_add_f32 v187, v187, v219
v_add_f32 v188, v188, v220
v_mfma_f32_16x16x32_bf16 v[112:115], v[176:179], v[40:43], v[112:115]
ds_read_b128 v[168:171], v144 offset:41984
v_add_f32 v189, v189, v221
v_mfma_f32_16x16x32_bf16 v[112:115], v[172:175], v[32:35], v[112:115]
v_add_f32 v190, v190, v222
s_waitcnt lgkmcnt(4)
v_mfma_f32_16x16x32_bf16 v[116:119], v[148:151], a[160:163], v[116:119]
ds_read_b128 v[172:175], v144 offset:50176
v_add_f32 v191, v191, v223
v_mfma_f32_16x16x32_bf16 v[116:119], v[152:155], a[168:171], v[116:119]
v_add_f32 v192, v192, v224
v_add_f32 v193, v193, v225
v_mfma_f32_16x16x32_bf16 v[132:135], v[152:155], a[172:175], v[132:135]
ds_read_b128 v[176:179], v144 offset:58368
v_add_f32 v194, v194, v226
v_mfma_f32_16x16x32_bf16 v[132:135], v[148:151], a[164:167], v[132:135]
buffer_store_dwordx4 v[128:131], v252, s[84:87], s75 offen offset:0 sc0 sc1
s_waitcnt lgkmcnt(4)
v_mfma_f32_16x16x32_bf16 v[132:135], v[156:159], a[180:183], v[132:135]
ds_read_b128 v[148:151], v248 offset:51200
v_add_f32 v195, v195, v227
v_mfma_f32_16x16x32_bf16 v[132:135], v[160:163], a[188:191], v[132:135]
v_add_f32 v196, v196, v228
v_add_f32 v197, v197, v229
v_mfma_f32_16x16x32_bf16 v[116:119], v[160:163], a[184:187], v[116:119]
ds_read_b128 v[152:155], v248 offset:59392
v_add_f32 v198, v198, v230
v_mfma_f32_16x16x32_bf16 v[116:119], v[156:159], a[176:179], v[116:119]
buffer_store_dwordx4 v[112:115], v252, s[84:87], s74 offen offset:0 sc0 sc1
s_waitcnt lgkmcnt(4)
v_mfma_f32_16x16x32_bf16 v[116:119], v[164:167], v[16:19], v[116:119]
ds_read_b128 v[156:159], v144 offset:18432
v_add_f32 v199, v199, v231
v_mfma_f32_16x16x32_bf16 v[116:119], v[168:171], v[24:27], v[116:119]
v_add_f32 v200, v200, v232
v_add_f32 v201, v201, v233
v_mfma_f32_16x16x32_bf16 v[132:135], v[168:171], v[28:31], v[132:135]
ds_read_b128 v[160:163], v144 offset:26624
v_add_f32 v202, v202, v234
v_mfma_f32_16x16x32_bf16 v[132:135], v[164:167], v[20:23], v[132:135]
v_add_f32 v203, v203, v235
s_waitcnt lgkmcnt(4)
v_mfma_f32_16x16x32_bf16 v[132:135], v[172:175], v[36:39], v[132:135]
ds_read_b128 v[164:167], v144 offset:34816
v_add_f32 v204, v204, v236
v_mfma_f32_16x16x32_bf16 v[132:135], v[176:179], v[44:47], v[132:135]
v_add_f32 v205, v205, v237
v_add_f32 v206, v206, v238
v_mfma_f32_16x16x32_bf16 v[116:119], v[176:179], v[40:43], v[116:119]
ds_read_b128 v[168:171], v144 offset:43008
v_add_f32 v207, v207, v239
v_mfma_f32_16x16x32_bf16 v[116:119], v[172:175], v[32:35], v[116:119]
v_add_f32 v208, v208, v240
s_waitcnt lgkmcnt(4)
v_mfma_f32_16x16x32_bf16 v[120:123], v[148:151], a[160:163], v[120:123]
ds_read_b128 v[172:175], v144 offset:51200
v_add_f32 v209, v209, v241
v_mfma_f32_16x16x32_bf16 v[120:123], v[152:155], a[168:171], v[120:123]
v_add_f32 v210, v210, v242
v_add_f32 v211, v211, v243
v_mfma_f32_16x16x32_bf16 v[136:139], v[152:155], a[172:175], v[136:139]
ds_read_b128 v[176:179], v144 offset:59392
v_cvt_pk_bf16_f32 v180, 0, v180
v_mfma_f32_16x16x32_bf16 v[136:139], v[148:151], a[164:167], v[136:139]
buffer_store_dwordx4 v[132:135], v252, s[84:87], s75 offen offset:1024 sc0 sc1
s_waitcnt lgkmcnt(4)
v_mfma_f32_16x16x32_bf16 v[136:139], v[156:159], a[180:183], v[136:139]
ds_read_b128 v[148:151], v248 offset:52224
v_cvt_pk_bf16_f32 v181, 0, v181
v_mfma_f32_16x16x32_bf16 v[136:139], v[160:163], a[188:191], v[136:139]
v_cvt_pk_bf16_f32 v182, 0, v182
v_cvt_pk_bf16_f32 v183, 0, v183
v_mfma_f32_16x16x32_bf16 v[120:123], v[160:163], a[184:187], v[120:123]
ds_read_b128 v[152:155], v248 offset:60416
v_cvt_pk_bf16_f32 v184, 0, v184
v_mfma_f32_16x16x32_bf16 v[120:123], v[156:159], a[176:179], v[120:123]
buffer_store_dwordx4 v[116:119], v252, s[84:87], s74 offen offset:1024 sc0 sc1
s_waitcnt lgkmcnt(4)
v_mfma_f32_16x16x32_bf16 v[120:123], v[164:167], v[16:19], v[120:123]
ds_read_b128 v[156:159], v144 offset:19456
v_cvt_pk_bf16_f32 v185, 0, v185
v_mfma_f32_16x16x32_bf16 v[120:123], v[168:171], v[24:27], v[120:123]
v_cvt_pk_bf16_f32 v186, 0, v186
v_cvt_pk_bf16_f32 v187, 0, v187
v_mfma_f32_16x16x32_bf16 v[136:139], v[168:171], v[28:31], v[136:139]
ds_read_b128 v[160:163], v144 offset:27648
v_cvt_pk_bf16_f32 v188, 0, v188
v_mfma_f32_16x16x32_bf16 v[136:139], v[164:167], v[20:23], v[136:139]
v_cvt_pk_bf16_f32 v189, 0, v189
s_waitcnt lgkmcnt(4)
v_mfma_f32_16x16x32_bf16 v[136:139], v[172:175], v[36:39], v[136:139]
ds_read_b128 v[164:167], v144 offset:35840
v_cvt_pk_bf16_f32 v190, 0, v190
v_mfma_f32_16x16x32_bf16 v[136:139], v[176:179], v[44:47], v[136:139]
v_cvt_pk_bf16_f32 v191, 0, v191
v_cvt_pk_bf16_f32 v192, 0, v192
v_mfma_f32_16x16x32_bf16 v[120:123], v[176:179], v[40:43], v[120:123]
ds_read_b128 v[168:171], v144 offset:44032
v_cvt_pk_bf16_f32 v193, 0, v193
v_mfma_f32_16x16x32_bf16 v[120:123], v[172:175], v[32:35], v[120:123]
v_cvt_pk_bf16_f32 v194, 0, v194
s_waitcnt lgkmcnt(4)
v_mfma_f32_16x16x32_bf16 v[124:127], v[148:151], a[160:163], v[124:127]
ds_read_b128 v[172:175], v144 offset:52224
v_cvt_pk_bf16_f32 v195, 0, v195
v_mfma_f32_16x16x32_bf16 v[124:127], v[152:155], a[168:171], v[124:127]
v_cvt_pk_bf16_f32 v196, 0, v196
v_cvt_pk_bf16_f32 v197, 0, v197
v_mfma_f32_16x16x32_bf16 v[140:143], v[152:155], a[172:175], v[140:143]
ds_read_b128 v[176:179], v144 offset:60416
v_cvt_pk_bf16_f32 v198, 0, v198
v_mfma_f32_16x16x32_bf16 v[140:143], v[148:151], a[164:167], v[140:143]
buffer_store_dwordx4 v[136:139], v252, s[84:87], s75 offen offset:2048 sc0 sc1
s_waitcnt lgkmcnt(4)
v_mfma_f32_16x16x32_bf16 v[140:143], v[156:159], a[180:183], v[140:143]
ds_read_b128 v[148:151], v248 offset:36864
v_cvt_pk_bf16_f32 v199, 0, v199
v_mfma_f32_16x16x32_bf16 v[140:143], v[160:163], a[188:191], v[140:143]
v_cvt_pk_bf16_f32 v200, 0, v200
v_cvt_pk_bf16_f32 v201, 0, v201
v_mfma_f32_16x16x32_bf16 v[124:127], v[160:163], a[184:187], v[124:127]
ds_read_b128 v[152:155], v248 offset:45056
v_cvt_pk_bf16_f32 v202, 0, v202
v_mfma_f32_16x16x32_bf16 v[124:127], v[156:159], a[176:179], v[124:127]
buffer_store_dwordx4 v[120:123], v252, s[84:87], s74 offen offset:2048 sc0 sc1
s_waitcnt lgkmcnt(4)
v_mfma_f32_16x16x32_bf16 v[124:127], v[164:167], v[16:19], v[124:127]
ds_read_b128 v[156:159], v248 offset:37888
v_cvt_pk_bf16_f32 v203, 0, v203
v_mfma_f32_16x16x32_bf16 v[124:127], v[168:171], v[24:27], v[124:127]
v_cvt_pk_bf16_f32 v204, 0, v204
v_cvt_pk_bf16_f32 v205, 0, v205
v_mfma_f32_16x16x32_bf16 v[140:143], v[168:171], v[28:31], v[140:143]
ds_read_b128 v[160:163], v248 offset:46080
v_cvt_pk_bf16_f32 v206, 0, v206
v_mfma_f32_16x16x32_bf16 v[140:143], v[164:167], v[20:23], v[140:143]
v_cvt_pk_bf16_f32 v207, 0, v207
s_waitcnt lgkmcnt(4)
v_mfma_f32_16x16x32_bf16 v[140:143], v[172:175], v[36:39], v[140:143]
ds_read_b128 v[164:167], v248 offset:38912
v_cvt_pk_bf16_f32 v208, 0, v208
v_mfma_f32_16x16x32_bf16 v[140:143], v[176:179], v[44:47], v[140:143]
v_cvt_pk_bf16_f32 v209, 0, v209
v_cvt_pk_bf16_f32 v210, 0, v210
v_mfma_f32_16x16x32_bf16 v[124:127], v[176:179], v[40:43], v[124:127]
ds_read_b128 v[168:171], v248 offset:47104
v_cvt_pk_bf16_f32 v211, 0, v211
v_mfma_f32_16x16x32_bf16 v[124:127], v[172:175], v[32:35], v[124:127]
v_mul_f32 v212, s38, v180
s_waitcnt lgkmcnt(4)
v_mfma_f32_16x16x32_bf16 v[80:83], v[148:151], a[128:131], v[80:83]
ds_read_b128 v[172:175], v248 offset:39936
v_mul_f32 v213, s38, v181
v_mfma_f32_16x16x32_bf16 v[80:83], v[152:155], a[136:139], v[80:83]
v_mul_f32 v214, s38, v182
v_mul_f32 v215, s38, v183
v_mfma_f32_16x16x32_bf16 v[96:99], v[152:155], a[140:143], v[96:99]
ds_read_b128 v[176:179], v248 offset:48128
v_mul_f32 v216, s38, v184
v_mfma_f32_16x16x32_bf16 v[96:99], v[148:151], a[132:135], v[96:99]
buffer_store_dwordx4 v[140:143], v252, s[84:87], s75 offen offset:3072 sc0 sc1
s_waitcnt lgkmcnt(4)
v_mfma_f32_16x16x32_bf16 v[100:103], v[156:159], a[132:135], v[100:103]
ds_read_b128 v[148:151], v144 offset:4096
v_mul_f32 v217, s38, v185
v_mfma_f32_16x16x32_bf16 v[100:103], v[160:163], a[140:143], v[100:103]
v_mul_f32 v218, s38, v186
v_mul_f32 v219, s38, v187
v_mfma_f32_16x16x32_bf16 v[84:87], v[160:163], a[136:139], v[84:87]
ds_read_b128 v[152:155], v144 offset:12288
v_mul_f32 v220, s38, v188
v_mfma_f32_16x16x32_bf16 v[84:87], v[156:159], a[128:131], v[84:87]
buffer_store_dwordx4 v[124:127], v252, s[84:87], s74 offen offset:3072 sc0 sc1
s_waitcnt lgkmcnt(4)
v_mfma_f32_16x16x32_bf16 v[88:91], v[164:167], a[128:131], v[88:91]
ds_read_b128 v[156:159], v144 offset:5120
v_mul_f32 v221, s38, v189
v_mfma_f32_16x16x32_bf16 v[88:91], v[168:171], a[136:139], v[88:91]
v_mul_f32 v222, s38, v190
v_mul_f32 v223, s38, v191
v_mfma_f32_16x16x32_bf16 v[104:107], v[168:171], a[140:143], v[104:107]
ds_read_b128 v[160:163], v144 offset:13312
v_mul_f32 v224, s38, v192
v_mfma_f32_16x16x32_bf16 v[104:107], v[164:167], a[132:135], v[104:107]
v_mul_f32 v225, s38, v193
s_waitcnt lgkmcnt(4)
v_mfma_f32_16x16x32_bf16 v[108:111], v[172:175], a[132:135], v[108:111]
ds_read_b128 v[164:167], v144 offset:6144
v_mul_f32 v226, s38, v194
v_mfma_f32_16x16x32_bf16 v[108:111], v[176:179], a[140:143], v[108:111]
v_mul_f32 v227, s38, v195
v_mul_f32 v228, s38, v196
v_mfma_f32_16x16x32_bf16 v[92:95], v[176:179], a[136:139], v[92:95]
ds_read_b128 v[168:171], v144 offset:14336
v_mul_f32 v229, s38, v197
v_mfma_f32_16x16x32_bf16 v[92:95], v[172:175], a[128:131], v[92:95]
v_mul_f32 v230, s38, v198
s_waitcnt lgkmcnt(4)
v_mfma_f32_16x16x32_bf16 v[80:83], v[148:151], a[144:147], v[80:83]
ds_read_b128 v[172:175], v144 offset:7168
v_mul_f32 v231, s38, v199
v_mfma_f32_16x16x32_bf16 v[80:83], v[152:155], a[152:155], v[80:83]
v_mul_f32 v232, s38, v200
v_mul_f32 v233, s38, v201
v_mfma_f32_16x16x32_bf16 v[96:99], v[152:155], a[156:159], v[96:99]
ds_read_b128 v[176:179], v144 offset:15360
v_mul_f32 v234, s38, v202
v_mfma_f32_16x16x32_bf16 v[96:99], v[148:151], a[148:151], v[96:99]
v_mul_f32 v235, s38, v203
s_waitcnt lgkmcnt(4)
v_mfma_f32_16x16x32_bf16 v[100:103], v[156:159], a[148:151], v[100:103]
ds_read_b128 v[148:151], v248 offset:53248
v_mul_f32 v236, s38, v204
v_mfma_f32_16x16x32_bf16 v[100:103], v[160:163], a[156:159], v[100:103]
v_mul_f32 v237, s38, v205
v_mul_f32 v238, s38, v206
v_mfma_f32_16x16x32_bf16 v[84:87], v[160:163], a[152:155], v[84:87]
ds_read_b128 v[152:155], v248 offset:61440
v_mul_f32 v239, s38, v207
v_mfma_f32_16x16x32_bf16 v[84:87], v[156:159], a[144:147], v[84:87]
v_mul_f32 v240, s38, v208
s_waitcnt lgkmcnt(4)
v_mfma_f32_16x16x32_bf16 v[88:91], v[164:167], a[144:147], v[88:91]
ds_read_b128 v[156:159], v248 offset:54272
v_mul_f32 v241, s38, v209
v_mfma_f32_16x16x32_bf16 v[88:91], v[168:171], a[152:155], v[88:91]
v_mul_f32 v242, s38, v210
v_mul_f32 v243, s38, v211
v_mfma_f32_16x16x32_bf16 v[104:107], v[168:171], a[156:159], v[104:107]
ds_read_b128 v[160:163], v248 offset:62464
v_mfma_f32_16x16x32_bf16 v[104:107], v[164:167], a[148:151], v[104:107]
s_waitcnt lgkmcnt(4)
v_mfma_f32_16x16x32_bf16 v[108:111], v[172:175], a[148:151], v[108:111]
ds_read_b128 v[164:167], v248 offset:55296
v_mfma_f32_16x16x32_bf16 v[108:111], v[176:179], a[156:159], v[108:111]
v_mfma_f32_16x16x32_bf16 v[92:95], v[176:179], a[152:155], v[92:95]
ds_read_b128 v[168:171], v248 offset:63488
v_mfma_f32_16x16x32_bf16 v[92:95], v[172:175], a[144:147], v[92:95]
s_waitcnt lgkmcnt(4)
v_mfma_f32_16x16x32_bf16 v[80:83], v[148:151], a[160:163], v[80:83]
ds_read_b128 v[172:175], v248 offset:56320
v_mfma_f32_16x16x32_bf16 v[80:83], v[152:155], a[168:171], v[80:83]
v_mfma_f32_16x16x32_bf16 v[96:99], v[152:155], a[172:175], v[96:99]
ds_read_b128 v[176:179], v248 offset:64512
v_mfma_f32_16x16x32_bf16 v[96:99], v[148:151], a[164:167], v[96:99]
s_waitcnt lgkmcnt(4)
v_mfma_f32_16x16x32_bf16 v[100:103], v[156:159], a[164:167], v[100:103]
ds_read_b128 v[148:151], v144 offset:20480
v_mfma_f32_16x16x32_bf16 v[100:103], v[160:163], a[172:175], v[100:103]
v_mfma_f32_16x16x32_bf16 v[84:87], v[160:163], a[168:171], v[84:87]
ds_read_b128 v[152:155], v144 offset:28672
v_mfma_f32_16x16x32_bf16 v[84:87], v[156:159], a[160:163], v[84:87]
s_waitcnt lgkmcnt(4)
v_mfma_f32_16x16x32_bf16 v[88:91], v[164:167], a[160:163], v[88:91]
ds_read_b128 v[156:159], v144 offset:21504
v_mfma_f32_16x16x32_bf16 v[88:91], v[168:171], a[168:171], v[88:91]
v_mfma_f32_16x16x32_bf16 v[104:107], v[168:171], a[172:175], v[104:107]
ds_read_b128 v[160:163], v144 offset:29696
v_mfma_f32_16x16x32_bf16 v[104:107], v[164:167], a[164:167], v[104:107]
s_waitcnt lgkmcnt(4)
v_mfma_f32_16x16x32_bf16 v[108:111], v[172:175], a[164:167], v[108:111]
ds_read_b128 v[164:167], v144 offset:22528
v_mfma_f32_16x16x32_bf16 v[108:111], v[176:179], a[172:175], v[108:111]
v_mfma_f32_16x16x32_bf16 v[92:95], v[176:179], a[168:171], v[92:95]
ds_read_b128 v[168:171], v144 offset:30720
v_mfma_f32_16x16x32_bf16 v[92:95], v[172:175], a[160:163], v[92:95]
s_waitcnt lgkmcnt(4)
v_mfma_f32_16x16x32_bf16 v[80:83], v[148:151], a[176:179], v[80:83]
ds_read_b128 v[172:175], v144 offset:23552
v_mfma_f32_16x16x32_bf16 v[80:83], v[152:155], a[184:187], v[80:83]
v_mfma_f32_16x16x32_bf16 v[96:99], v[152:155], a[188:191], v[96:99]
ds_read_b128 v[176:179], v144 offset:31744
v_mfma_f32_16x16x32_bf16 v[96:99], v[148:151], a[180:183], v[96:99]
s_waitcnt lgkmcnt(4)
v_mfma_f32_16x16x32_bf16 v[100:103], v[156:159], a[180:183], v[100:103]
ds_read_b128 v[148:151], v144 offset:36864
v_mfma_f32_16x16x32_bf16 v[100:103], v[160:163], a[188:191], v[100:103]
v_mfma_f32_16x16x32_bf16 v[84:87], v[160:163], a[184:187], v[84:87]
ds_read_b128 v[152:155], v144 offset:45056
v_mfma_f32_16x16x32_bf16 v[84:87], v[156:159], a[176:179], v[84:87]
s_waitcnt lgkmcnt(4)
v_mfma_f32_16x16x32_bf16 v[88:91], v[164:167], a[176:179], v[88:91]
ds_read_b128 v[156:159], v144 offset:37888
v_mfma_f32_16x16x32_bf16 v[88:91], v[168:171], a[184:187], v[88:91]
v_mfma_f32_16x16x32_bf16 v[104:107], v[168:171], a[188:191], v[104:107]
ds_read_b128 v[160:163], v144 offset:46080
v_mfma_f32_16x16x32_bf16 v[104:107], v[164:167], a[180:183], v[104:107]
s_waitcnt lgkmcnt(4)
v_mfma_f32_16x16x32_bf16 v[108:111], v[172:175], a[180:183], v[108:111]
ds_read_b128 v[164:167], v144 offset:38912
v_mfma_f32_16x16x32_bf16 v[108:111], v[176:179], a[188:191], v[108:111]
v_mfma_f32_16x16x32_bf16 v[92:95], v[176:179], a[184:187], v[92:95]
ds_read_b128 v[168:171], v144 offset:47104
v_mfma_f32_16x16x32_bf16 v[92:95], v[172:175], a[176:179], v[92:95]
s_waitcnt lgkmcnt(4)
v_mfma_f32_16x16x32_bf16 v[80:83], v[148:151], v[16:19], v[80:83]
ds_read_b128 v[172:175], v144 offset:39936
v_mfma_f32_16x16x32_bf16 v[80:83], v[152:155], v[24:27], v[80:83]
v_mfma_f32_16x16x32_bf16 v[96:99], v[152:155], v[28:31], v[96:99]
ds_read_b128 v[176:179], v144 offset:48128
v_mfma_f32_16x16x32_bf16 v[96:99], v[148:151], v[20:23], v[96:99]
s_waitcnt vmcnt(0)
buffer_store_dword v14, off, s[32:35], s82 offset:64 sc0 sc1
s_waitcnt lgkmcnt(4)
v_mfma_f32_16x16x32_bf16 v[100:103], v[156:159], v[20:23], v[100:103]
ds_read_b128 v[148:151], v144 offset:53248
v_mfma_f32_16x16x32_bf16 v[100:103], v[160:163], v[28:31], v[100:103]
v_mfma_f32_16x16x32_bf16 v[84:87], v[160:163], v[24:27], v[84:87]
ds_read_b128 v[152:155], v144 offset:61440
v_mfma_f32_16x16x32_bf16 v[84:87], v[156:159], v[16:19], v[84:87]
s_waitcnt lgkmcnt(4)
v_mfma_f32_16x16x32_bf16 v[88:91], v[164:167], v[16:19], v[88:91]
ds_read_b128 v[156:159], v144 offset:54272
v_mfma_f32_16x16x32_bf16 v[88:91], v[168:171], v[24:27], v[88:91]
v_mfma_f32_16x16x32_bf16 v[104:107], v[168:171], v[28:31], v[104:107]
ds_read_b128 v[160:163], v144 offset:62464
v_mfma_f32_16x16x32_bf16 v[104:107], v[164:167], v[20:23], v[104:107]
s_waitcnt lgkmcnt(4)
v_mfma_f32_16x16x32_bf16 v[108:111], v[172:175], v[20:23], v[108:111]
ds_read_b128 v[164:167], v144 offset:55296
v_mfma_f32_16x16x32_bf16 v[108:111], v[176:179], v[28:31], v[108:111]
v_mfma_f32_16x16x32_bf16 v[92:95], v[176:179], v[24:27], v[92:95]
ds_read_b128 v[168:171], v144 offset:63488
v_mfma_f32_16x16x32_bf16 v[92:95], v[172:175], v[16:19], v[92:95]
s_waitcnt lgkmcnt(4)
v_mfma_f32_16x16x32_bf16 v[80:83], v[148:151], v[32:35], v[80:83]
ds_read_b128 v[172:175], v144 offset:56320
v_mfma_f32_16x16x32_bf16 v[80:83], v[152:155], v[40:43], v[80:83]
v_mfma_f32_16x16x32_bf16 v[96:99], v[152:155], v[44:47], v[96:99]
ds_read_b128 v[176:179], v144 offset:64512
v_mfma_f32_16x16x32_bf16 v[96:99], v[148:151], v[36:39], v[96:99]
s_waitcnt lgkmcnt(4)
v_mfma_f32_16x16x32_bf16 v[100:103], v[156:159], v[36:39], v[100:103]
v_mfma_f32_16x16x32_bf16 v[100:103], v[160:163], v[44:47], v[100:103]
v_mfma_f32_16x16x32_bf16 v[84:87], v[160:163], v[40:43], v[84:87]
v_mfma_f32_16x16x32_bf16 v[84:87], v[156:159], v[32:35], v[84:87]
s_waitcnt lgkmcnt(2)
v_mfma_f32_16x16x32_bf16 v[88:91], v[164:167], v[32:35], v[88:91]
v_mfma_f32_16x16x32_bf16 v[88:91], v[168:171], v[40:43], v[88:91]
v_mfma_f32_16x16x32_bf16 v[104:107], v[168:171], v[44:47], v[104:107]
v_mfma_f32_16x16x32_bf16 v[104:107], v[164:167], v[36:39], v[104:107]
s_waitcnt lgkmcnt(0)
v_mfma_f32_16x16x32_bf16 v[108:111], v[172:175], v[36:39], v[108:111]
v_mfma_f32_16x16x32_bf16 v[108:111], v[176:179], v[44:47], v[108:111]
v_mfma_f32_16x16x32_bf16 v[92:95], v[176:179], v[40:43], v[92:95]
v_mfma_f32_16x16x32_bf16 v[92:95], v[172:175], v[32:35], v[92:95]
s_branch L_main_kernel_tl
.org L_main_kernel_eb + 17280
L_main_kernel_e3:
s_waitcnt lgkmcnt(4)
v_mfma_f32_16x16x32_bf16 v[112:115], v[148:151], a[144:147], v[112:115]
ds_read_b128 v[172:175], v144 offset:3072
v_mfma_f32_16x16x32_bf16 v[112:115], v[152:155], a[152:155], v[112:115]
v_mfma_f32_16x16x32_bf16 v[128:131], v[152:155], a[156:159], v[128:131]
ds_read_b128 v[176:179], v144 offset:11264
v_mfma_f32_16x16x32_bf16 v[128:131], v[148:151], a[148:151], v[128:131]
s_waitcnt vmcnt(8)
s_barrier
s_waitcnt lgkmcnt(4)
v_mfma_f32_16x16x32_bf16 v[132:135], v[156:159], a[148:151], v[132:135]
ds_read_b128 v[148:151], v248 offset:49152
s_mov_b32 s37, 0xffff0000
v_mfma_f32_16x16x32_bf16 v[132:135], v[160:163], a[156:159], v[132:135]
s_mov_b32 s38, 0xbfb8aa3b
s_mov_b32 s39, 0xbfb8aa3b
v_mfma_f32_16x16x32_bf16 v[116:119], v[160:163], a[152:155], v[116:119]
ds_read_b128 v[152:155], v248 offset:57344
v_mov_b32 v14, 1
v_mfma_f32_16x16x32_bf16 v[116:119], v[156:159], a[144:147], v[116:119]
v_permlane16_swap_b32 v52, v54
s_waitcnt lgkmcnt(4)
v_mfma_f32_16x16x32_bf16 v[120:123], v[164:167], a[144:147], v[120:123]
ds_read_b128 v[156:159], v248 offset:50176
v_permlane16_swap_b32 v53, v55
v_mfma_f32_16x16x32_bf16 v[120:123], v[168:171], a[152:155], v[120:123]
v_permlane16_swap_b32 v60, v62
v_permlane16_swap_b32 v61, v63
v_mfma_f32_16x16x32_bf16 v[136:139], v[168:171], a[156:159], v[136:139]
ds_read_b128 v[160:163], v248 offset:58368
v_permlane16_swap_b32 v68, v70
v_mfma_f32_16x16x32_bf16 v[136:139], v[164:167], a[148:151], v[136:139]
v_permlane16_swap_b32 v69, v71
s_waitcnt lgkmcnt(4)
v_mfma_f32_16x16x32_bf16 v[140:143], v[172:175], a[148:151], v[140:143]
ds_read_b128 v[164:167], v248 offset:51200
v_permlane16_swap_b32 v76, v78
v_mfma_f32_16x16x32_bf16 v[140:143], v[176:179], a[156:159], v[140:143]
v_permlane16_swap_b32 v77, v79
v_lshlrev_b32 v48, 16, v52
v_mfma_f32_16x16x32_bf16 v[124:127], v[176:179], a[152:155], v[124:127]
ds_read_b128 v[168:171], v248 offset:59392
v_and_b32 v49, s37, v52
v_mfma_f32_16x16x32_bf16 v[124:127], v[172:175], a[144:147], v[124:127]
v_lshlrev_b32 v50, 16, v53
s_waitcnt lgkmcnt(4)
v_mfma_f32_16x16x32_bf16 v[112:115], v[148:151], a[160:163], v[112:115]
ds_read_b128 v[172:175], v248 offset:52224
v_and_b32 v51, s37, v53
v_mfma_f32_16x16x32_bf16 v[112:115], v[152:155], a[168:171], v[112:115]
v_lshlrev_b32 v52, 16, v54
v_and_b32 v53, s37, v54
v_mfma_f32_16x16x32_bf16 v[128:131], v[152:155], a[172:175], v[128:131]
ds_read_b128 v[176:179], v248 offset:60416
v_lshlrev_b32 v54, 16, v55
v_mfma_f32_16x16x32_bf16 v[128:131], v[148:151], a[164:167], v[128:131]
v_and_b32 v55, s37, v55
s_waitcnt lgkmcnt(4)
v_mfma_f32_16x16x32_bf16 v[132:135], v[156:159], a[164:167], v[132:135]
ds_read_b128 v[148:151], v144 offset:16384
v_lshlrev_b32 v56, 16, v60
v_mfma_f32_16x16x32_bf16 v[132:135], v[160:163], a[172:175], v[132:135]
v_and_b32 v57, s37, v60
v_lshlrev_b32 v58, 16, v61
v_mfma_f32_16x16x32_bf16 v[116:119], v[160:163], a[168:171], v[116:119]
ds_read_b128 v[152:155], v144 offset:24576
v_and_b32 v59, s37, v61
v_mfma_f32_16x16x32_bf16 v[116:119], v[156:159], a[160:163], v[116:119]
v_lshlrev_b32 v60, 16, v62
s_waitcnt lgkmcnt(4)
v_mfma_f32_16x16x32_bf16 v[120:123], v[164:167], a[160:163], v[120:123]
ds_read_b128 v[156:159], v144 offset:32768
v_and_b32 v61, s37, v62
v_mfma_f32_16x16x32_bf16 v[120:123], v[168:171], a[168:171], v[120:123]
v_lshlrev_b32 v62, 16, v63
v_and_b32 v63, s37, v63
v_mfma_f32_16x16x32_bf16 v[136:139], v[168:171], a[172:175], v[136:139]
ds_read_b128 v[160:163], v144 offset:40960
v_lshlrev_b32 v64, 16, v68
v_mfma_f32_16x16x32_bf16 v[136:139], v[164:167], a[164:167], v[136:139]
v_and_b32 v65, s37, v68
s_waitcnt lgkmcnt(4)
v_mfma_f32_16x16x32_bf16 v[140:143], v[172:175], a[164:167], v[140:143]
ds_read_b128 v[164:167], v144 offset:49152
v_lshlrev_b32 v66, 16, v69
v_mfma_f32_16x16x32_bf16 v[140:143], v[176:179], a[172:175], v[140:143]
v_and_b32 v67, s37, v69
v_lshlrev_b32 v68, 16, v70
v_mfma_f32_16x16x32_bf16 v[124:127], v[176:179], a[168:171], v[124:127]
ds_read_b128 v[168:171], v144 offset:57344
v_and_b32 v69, s37, v70
v_mfma_f32_16x16x32_bf16 v[124:127], v[172:175], a[160:163], v[124:127]
v_lshlrev_b32 v70, 16, v71
s_waitcnt vmcnt(0)
s_barrier
s_waitcnt lgkmcnt(4)
v_mfma_f32_16x16x32_bf16 v[112:115], v[148:151], a[176:179], v[112:115]
ds_read_b128 v[172:175], v248 offset:0
v_and_b32 v71, s37, v71
v_mfma_f32_16x16x32_bf16 v[112:115], v[152:155], a[184:187], v[112:115]
v_lshlrev_b32 v72, 16, v76
v_and_b32 v73, s37, v76
v_mfma_f32_16x16x32_bf16 v[128:131], v[152:155], a[188:191], v[128:131]
ds_read_b128 v[176:179], v248 offset:8192
v_lshlrev_b32 v74, 16, v77
v_mfma_f32_16x16x32_bf16 v[128:131], v[148:151], a[180:183], v[128:131]
v_and_b32 v75, s37, v77
s_waitcnt lgkmcnt(4)
v_mfma_f32_16x16x32_bf16 v[128:131], v[156:159], v[20:23], v[128:131]
ds_read_b128 v[148:151], v144 offset:17408
v_lshlrev_b32 v76, 16, v78
v_mfma_f32_16x16x32_bf16 v[128:131], v[160:163], v[28:31], v[128:131]
v_and_b32 v77, s37, v78
v_lshlrev_b32 v78, 16, v79
v_mfma_f32_16x16x32_bf16 v[112:115], v[160:163], v[24:27], v[112:115]
ds_read_b128 v[152:155], v144 offset:25600
v_and_b32 v79, s37, v79
v_mfma_f32_16x16x32_bf16 v[112:115], v[156:159], v[16:19], v[112:115]
v_add_f32 v180, v180, v212
s_waitcnt lgkmcnt(4)
v_mfma_f32_16x16x32_bf16 v[112:115], v[164:167], v[32:35], v[112:115]
ds_read_b128 v[156:159], v144 offset:33792
v_add_f32 v181, v181, v213
v_mfma_f32_16x16x32_bf16 v[112:115], v[168:171], v[40:43], v[112:115]
v_add_f32 v182, v182, v214
v_add_f32 v183, v183, v215
v_mfma_f32_16x16x32_bf16 v[128:131], v[168:171], v[44:47], v[128:131]
ds_read_b128 v[160:163], v144 offset:41984
v_add_f32 v184, v184, v216
v_mfma_f32_16x16x32_bf16 v[128:131], v[164:167], v[36:39], v[128:131]
v_add_f32 v185, v185, v217
s_waitcnt lgkmcnt(4)
v_mfma_f32_16x16x32_bf16 v[128:131], v[172:175], a[196:199], v[128:131]
ds_read_b128 v[164:167], v144 offset:50176
v_add_f32 v186, v186, v218
v_mfma_f32_16x16x32_bf16 v[128:131], v[176:179], a[204:207], v[128:131]
v_add_f32 v187, v187, v219
v_add_f32 v188, v188, v220
v_mfma_f32_16x16x32_bf16 v[112:115], v[176:179], a[200:203], v[112:115]
ds_read_b128 v[168:171], v144 offset:58368
v_add_f32 v189, v189, v221
v_mfma_f32_16x16x32_bf16 v[112:115], v[172:175], a[192:195], v[112:115]
v_add_f32 v190, v190, v222
s_waitcnt lgkmcnt(4)
v_mfma_f32_16x16x32_bf16 v[116:119], v[148:151], a[176:179], v[116:119]
ds_read_b128 v[172:175], v248 offset:1024
v_add_f32 v191, v191, v223
v_mfma_f32_16x16x32_bf16 v[116:119], v[152:155], a[184:187], v[116:119]
v_add_f32 v192, v192, v224
v_add_f32 v193, v193, v225
v_mfma_f32_16x16x32_bf16 v[132:135], v[152:155], a[188:191], v[132:135]
ds_read_b128 v[176:179], v248 offset:9216
v_add_f32 v194, v194, v226
v_mfma_f32_16x16x32_bf16 v[132:135], v[148:151], a[180:183], v[132:135]
buffer_store_dwordx4 v[128:131], v252, s[84:87], s75 offen offset:0 sc0 sc1
s_waitcnt lgkmcnt(4)
v_mfma_f32_16x16x32_bf16 v[132:135], v[156:159], v[20:23], v[132:135]
ds_read_b128 v[148:151], v144 offset:18432
v_add_f32 v195, v195, v227
v_mfma_f32_16x16x32_bf16 v[132:135], v[160:163], v[28:31], v[132:135]
v_add_f32 v196, v196, v228
v_add_f32 v197, v197, v229
v_mfma_f32_16x16x32_bf16 v[116:119], v[160:163], v[24:27], v[116:119]
ds_read_b128 v[152:155], v144 offset:26624
v_add_f32 v198, v198, v230
v_mfma_f32_16x16x32_bf16 v[116:119], v[156:159], v[16:19], v[116:119]
buffer_store_dwordx4 v[112:115], v252, s[84:87], s74 offen offset:0 sc0 sc1
s_waitcnt lgkmcnt(4)
v_mfma_f32_16x16x32_bf16 v[116:119], v[164:167], v[32:35], v[116:119]
ds_read_b128 v[156:159], v144 offset:34816
v_add_f32 v199, v199, v231
v_mfma_f32_16x16x32_bf16 v[116:119], v[168:171], v[40:43], v[116:119]
v_add_f32 v200, v200, v232
v_add_f32 v201, v201, v233
v_mfma_f32_16x16x32_bf16 v[132:135], v[168:171], v[44:47], v[132:135]
ds_read_b128 v[160:163], v144 offset:43008
v_add_f32 v202, v202, v234
v_mfma_f32_16x16x32_bf16 v[132:135], v[164:167], v[36:39], v[132:135]
v_add_f32 v203, v203, v235
s_waitcnt lgkmcnt(4)
v_mfma_f32_16x16x32_bf16 v[132:135], v[172:175], a[196:199], v[132:135]
ds_read_b128 v[164:167], v144 offset:51200
v_add_f32 v204, v204, v236
v_mfma_f32_16x16x32_bf16 v[132:135], v[176:179], a[204:207], v[132:135]
v_add_f32 v205, v205, v237
v_add_f32 v206, v206, v238
v_mfma_f32_16x16x32_bf16 v[116:119], v[176:179], a[200:203], v[116:119]
ds_read_b128 v[168:171], v144 offset:59392
v_add_f32 v207, v207, v239
v_mfma_f32_16x16x32_bf16 v[116:119], v[172:175], a[192:195], v[116:119]
v_add_f32 v208, v208, v240
s_waitcnt lgkmcnt(4)
v_mfma_f32_16x16x32_bf16 v[120:123], v[148:151], a[176:179], v[120:123]
ds_read_b128 v[172:175], v248 offset:2048
v_add_f32 v209, v209, v241
v_mfma_f32_16x16x32_bf16 v[120:123], v[152:155], a[184:187], v[120:123]
v_add_f32 v210, v210, v242
v_add_f32 v211, v211, v243
v_mfma_f32_16x16x32_bf16 v[136:139], v[152:155], a[188:191], v[136:139]
ds_read_b128 v[176:179], v248 offset:10240
v_cvt_pk_bf16_f32 v180, 0, v180
v_mfma_f32_16x16x32_bf16 v[136:139], v[148:151], a[180:183], v[136:139]
buffer_store_dwordx4 v[132:135], v252, s[84:87], s75 offen offset:1024 sc0 sc1
s_waitcnt lgkmcnt(4)
v_mfma_f32_16x16x32_bf16 v[136:139], v[156:159], v[20:23], v[136:139]
ds_read_b128 v[148:151], v144 offset:19456
v_cvt_pk_bf16_f32 v181, 0, v181
v_mfma_f32_16x16x32_bf16 v[136:139], v[160:163], v[28:31], v[136:139]
v_cvt_pk_bf16_f32 v182, 0, v182
v_cvt_pk_bf16_f32 v183, 0, v183
v_mfma_f32_16x16x32_bf16 v[120:123], v[160:163], v[24:27], v[120:123]
ds_read_b128 v[152:155], v144 offset:27648
v_cvt_pk_bf16_f32 v184, 0, v184
v_mfma_f32_16x16x32_bf16 v[120:123], v[156:159], v[16:19], v[120:123]
buffer_store_dwordx4 v[116:119], v252, s[84:87], s74 offen offset:1024 sc0 sc1
s_waitcnt lgkmcnt(4)
v_mfma_f32_16x16x32_bf16 v[120:123], v[164:167], v[32:35], v[120:123]
ds_read_b128 v[156:159], v144 offset:35840
v_cvt_pk_bf16_f32 v185, 0, v185
v_mfma_f32_16x16x32_bf16 v[120:123], v[168:171], v[40:43], v[120:123]
v_cvt_pk_bf16_f32 v186, 0, v186
v_cvt_pk_bf16_f32 v187, 0, v187
v_mfma_f32_16x16x32_bf16 v[136:139], v[168:171], v[44:47], v[136:139]
ds_read_b128 v[160:163], v144 offset:44032
v_cvt_pk_bf16_f32 v188, 0, v188
v_mfma_f32_16x16x32_bf16 v[136:139], v[164:167], v[36:39], v[136:139]
v_cvt_pk_bf16_f32 v189, 0, v189
s_waitcnt lgkmcnt(4)
v_mfma_f32_16x16x32_bf16 v[136:139], v[172:175], a[196:199], v[136:139]
ds_read_b128 v[164:167], v144 offset:52224
v_cvt_pk_bf16_f32 v190, 0, v190
v_mfma_f32_16x16x32_bf16 v[136:139], v[176:179], a[204:207], v[136:139]
v_cvt_pk_bf16_f32 v191, 0, v191
v_cvt_pk_bf16_f32 v192, 0, v192
v_mfma_f32_16x16x32_bf16 v[120:123], v[176:179], a[200:203], v[120:123]
ds_read_b128 v[168:171], v144 offset:60416
v_cvt_pk_bf16_f32 v193, 0, v193
v_mfma_f32_16x16x32_bf16 v[120:123], v[172:175], a[192:195], v[120:123]
v_cvt_pk_bf16_f32 v194, 0, v194
s_waitcnt lgkmcnt(4)
v_mfma_f32_16x16x32_bf16 v[124:127], v[148:151], a[176:179], v[124:127]
ds_read_b128 v[172:175], v248 offset:3072
v_cvt_pk_bf16_f32 v195, 0, v195
v_mfma_f32_16x16x32_bf16 v[124:127], v[152:155], a[184:187], v[124:127]
v_cvt_pk_bf16_f32 v196, 0, v196
v_cvt_pk_bf16_f32 v197, 0, v197
v_mfma_f32_16x16x32_bf16 v[140:143], v[152:155], a[188:191], v[140:143]
ds_read_b128 v[176:179], v248 offset:11264
v_cvt_pk_bf16_f32 v198, 0, v198
v_mfma_f32_16x16x32_bf16 v[140:143], v[148:151], a[180:183], v[140:143]
buffer_store_dwordx4 v[136:139], v252, s[84:87], s75 offen offset:2048 sc0 sc1
s_waitcnt lgkmcnt(4)
v_mfma_f32_16x16x32_bf16 v[140:143], v[156:159], v[20:23], v[140:143]
ds_read_b128 v[148:151], v144 offset:4096
v_cvt_pk_bf16_f32 v199, 0, v199
v_mfma_f32_16x16x32_bf16 v[140:143], v[160:163], v[28:31], v[140:143]
v_cvt_pk_bf16_f32 v200, 0, v200
v_cvt_pk_bf16_f32 v201, 0, v201
v_mfma_f32_16x16x32_bf16 v[124:127], v[160:163], v[24:27], v[124:127]
ds_read_b128 v[152:155], v144 offset:12288
v_cvt_pk_bf16_f32 v202, 0, v202
v_mfma_f32_16x16x32_bf16 v[124:127], v[156:159], v[16:19], v[124:127]
buffer_store_dwordx4 v[120:123], v252, s[84:87], s74 offen offset:2048 sc0 sc1
s_waitcnt lgkmcnt(4)
v_mfma_f32_16x16x32_bf16 v[124:127], v[164:167], v[32:35], v[124:127]
ds_read_b128 v[156:159], v144 offset:5120
v_cvt_pk_bf16_f32 v203, 0, v203
v_mfma_f32_16x16x32_bf16 v[124:127], v[168:171], v[40:43], v[124:127]
v_cvt_pk_bf16_f32 v204, 0, v204
v_cvt_pk_bf16_f32 v205, 0, v205
v_mfma_f32_16x16x32_bf16 v[140:143], v[168:171], v[44:47], v[140:143]
ds_read_b128 v[160:163], v144 offset:13312
v_cvt_pk_bf16_f32 v206, 0, v206
v_mfma_f32_16x16x32_bf16 v[140:143], v[164:167], v[36:39], v[140:143]
v_cvt_pk_bf16_f32 v207, 0, v207
s_waitcnt lgkmcnt(4)
v_mfma_f32_16x16x32_bf16 v[140:143], v[172:175], a[196:199], v[140:143]
ds_read_b128 v[164:167], v144 offset:6144
v_cvt_pk_bf16_f32 v208, 0, v208
v_mfma_f32_16x16x32_bf16 v[140:143], v[176:179], a[204:207], v[140:143]
v_cvt_pk_bf16_f32 v209, 0, v209
v_cvt_pk_bf16_f32 v210, 0, v210
v_mfma_f32_16x16x32_bf16 v[124:127], v[176:179], a[200:203], v[124:127]
ds_read_b128 v[168:171], v144 offset:14336
v_cvt_pk_bf16_f32 v211, 0, v211
v_mfma_f32_16x16x32_bf16 v[124:127], v[172:175], a[192:195], v[124:127]
v_mul_f32 v212, s38, v180
s_waitcnt lgkmcnt(4)
v_mfma_f32_16x16x32_bf16 v[80:83], v[148:151], a[144:147], v[80:83]
ds_read_b128 v[172:175], v144 offset:7168
v_mul_f32 v213, s38, v181
v_mfma_f32_16x16x32_bf16 v[80:83], v[152:155], a[152:155], v[80:83]
v_mul_f32 v214, s38, v182
v_mul_f32 v215, s38, v183
v_mfma_f32_16x16x32_bf16 v[96:99], v[152:155], a[156:159], v[96:99]
ds_read_b128 v[176:179], v144 offset:15360
v_mul_f32 v216, s38, v184
v_mfma_f32_16x16x32_bf16 v[96:99], v[148:151], a[148:151], v[96:99]
buffer_store_dwordx4 v[140:143], v252, s[84:87], s75 offen offset:3072 sc0 sc1
s_waitcnt lgkmcnt(4)
v_mfma_f32_16x16x32_bf16 v[100:103], v[156:159], a[148:151], v[100:103]
ds_read_b128 v[148:151], v248 offset:53248
v_mul_f32 v217, s38, v185
v_mfma_f32_16x16x32_bf16 v[100:103], v[160:163], a[156:159], v[100:103]
v_mul_f32 v218, s38, v186
v_mul_f32 v219, s38, v187
v_mfma_f32_16x16x32_bf16 v[84:87], v[160:163], a[152:155], v[84:87]
ds_read_b128 v[152:155], v248 offset:61440
v_mul_f32 v220, s38, v188
v_mfma_f32_16x16x32_bf16 v[84:87], v[156:159], a[144:147], v[84:87]
buffer_store_dwordx4 v[124:127], v252, s[84:87], s74 offen offset:3072 sc0 sc1
s_waitcnt lgkmcnt(4)
v_mfma_f32_16x16x32_bf16 v[88:91], v[164:167], a[144:147], v[88:91]
ds_read_b128 v[156:159], v248 offset:54272
v_mul_f32 v221, s38, v189
v_mfma_f32_16x16x32_bf16 v[88:91], v[168:171], a[152:155], v[88:91]
v_mul_f32 v222, s38, v190
v_mul_f32 v223, s38, v191
v_mfma_f32_16x16x32_bf16 v[104:107], v[168:171], a[156:159], v[104:107]
ds_read_b128 v[160:163], v248 offset:62464
v_mul_f32 v224, s38, v192
v_mfma_f32_16x16x32_bf16 v[104:107], v[164:167], a[148:151], v[104:107]
v_mul_f32 v225, s38, v193
s_waitcnt lgkmcnt(4)
v_mfma_f32_16x16x32_bf16 v[108:111], v[172:175], a[148:151], v[108:111]
ds_read_b128 v[164:167], v248 offset:55296
v_mul_f32 v226, s38, v194
v_mfma_f32_16x16x32_bf16 v[108:111], v[176:179], a[156:159], v[108:111]
v_mul_f32 v227, s38, v195
v_mul_f32 v228, s38, v196
v_mfma_f32_16x16x32_bf16 v[92:95], v[176:179], a[152:155], v[92:95]
ds_read_b128 v[168:171], v248 offset:63488
v_mul_f32 v229, s38, v197
v_mfma_f32_16x16x32_bf16 v[92:95], v[172:175], a[144:147], v[92:95]
v_mul_f32 v230, s38, v198
s_waitcnt lgkmcnt(4)
v_mfma_f32_16x16x32_bf16 v[80:83], v[148:151], a[160:163], v[80:83]
ds_read_b128 v[172:175], v248 offset:56320
v_mul_f32 v231, s38, v199
v_mfma_f32_16x16x32_bf16 v[80:83], v[152:155], a[168:171], v[80:83]
v_mul_f32 v232, s38, v200
v_mul_f32 v233, s38, v201
v_mfma_f32_16x16x32_bf16 v[96:99], v[152:155], a[172:175], v[96:99]
ds_read_b128 v[176:179], v248 offset:64512
v_mul_f32 v234, s38, v202
v_mfma_f32_16x16x32_bf16 v[96:99], v[148:151], a[164:167], v[96:99]
v_mul_f32 v235, s38, v203
s_waitcnt lgkmcnt(4)
v_mfma_f32_16x16x32_bf16 v[100:103], v[156:159], a[164:167], v[100:103]
ds_read_b128 v[148:151], v144 offset:20480
v_mul_f32 v236, s38, v204
v_mfma_f32_16x16x32_bf16 v[100:103], v[160:163], a[172:175], v[100:103]
v_mul_f32 v237, s38, v205
v_mul_f32 v238, s38, v206
v_mfma_f32_16x16x32_bf16 v[84:87], v[160:163], a[168:171], v[84:87]
ds_read_b128 v[152:155], v144 offset:28672
v_mul_f32 v239, s38, v207
v_mfma_f32_16x16x32_bf16 v[84:87], v[156:159], a[160:163], v[84:87]
v_mul_f32 v240, s38, v208
s_waitcnt lgkmcnt(4)
v_mfma_f32_16x16x32_bf16 v[88:91], v[164:167], a[160:163], v[88:91]
ds_read_b128 v[156:159], v144 offset:21504
v_mul_f32 v241, s38, v209
v_mfma_f32_16x16x32_bf16 v[88:91], v[168:171], a[168:171], v[88:91]
v_mul_f32 v242, s38, v210
v_mul_f32 v243, s38, v211
v_mfma_f32_16x16x32_bf16 v[104:107], v[168:171], a[172:175], v[104:107]
ds_read_b128 v[160:163], v144 offset:29696
v_mfma_f32_16x16x32_bf16 v[104:107], v[164:167], a[164:167], v[104:107]
s_waitcnt lgkmcnt(4)
v_mfma_f32_16x16x32_bf16 v[108:111], v[172:175], a[164:167], v[108:111]
ds_read_b128 v[164:167], v144 offset:22528
v_mfma_f32_16x16x32_bf16 v[108:111], v[176:179], a[172:175], v[108:111]
v_mfma_f32_16x16x32_bf16 v[92:95], v[176:179], a[168:171], v[92:95]
ds_read_b128 v[168:171], v144 offset:30720
v_mfma_f32_16x16x32_bf16 v[92:95], v[172:175], a[160:163], v[92:95]
s_waitcnt lgkmcnt(4)
v_mfma_f32_16x16x32_bf16 v[80:83], v[148:151], a[176:179], v[80:83]
ds_read_b128 v[172:175], v144 offset:23552
v_mfma_f32_16x16x32_bf16 v[80:83], v[152:155], a[184:187], v[80:83]
v_mfma_f32_16x16x32_bf16 v[96:99], v[152:155], a[188:191], v[96:99]
ds_read_b128 v[176:179], v144 offset:31744
v_mfma_f32_16x16x32_bf16 v[96:99], v[148:151], a[180:183], v[96:99]
s_waitcnt lgkmcnt(4)
v_mfma_f32_16x16x32_bf16 v[100:103], v[156:159], a[180:183], v[100:103]
ds_read_b128 v[148:151], v144 offset:36864
v_mfma_f32_16x16x32_bf16 v[100:103], v[160:163], a[188:191], v[100:103]
v_mfma_f32_16x16x32_bf16 v[84:87], v[160:163], a[184:187], v[84:87]
ds_read_b128 v[152:155], v144 offset:45056
v_mfma_f32_16x16x32_bf16 v[84:87], v[156:159], a[176:179], v[84:87]
s_waitcnt lgkmcnt(4)
v_mfma_f32_16x16x32_bf16 v[88:91], v[164:167], a[176:179], v[88:91]
ds_read_b128 v[156:159], v144 offset:37888
v_mfma_f32_16x16x32_bf16 v[88:91], v[168:171], a[184:187], v[88:91]
v_mfma_f32_16x16x32_bf16 v[104:107], v[168:171], a[188:191], v[104:107]
ds_read_b128 v[160:163], v144 offset:46080
v_mfma_f32_16x16x32_bf16 v[104:107], v[164:167], a[180:183], v[104:107]
s_waitcnt lgkmcnt(4)
v_mfma_f32_16x16x32_bf16 v[108:111], v[172:175], a[180:183], v[108:111]
ds_read_b128 v[164:167], v144 offset:38912
v_mfma_f32_16x16x32_bf16 v[108:111], v[176:179], a[188:191], v[108:111]
v_mfma_f32_16x16x32_bf16 v[92:95], v[176:179], a[184:187], v[92:95]
ds_read_b128 v[168:171], v144 offset:47104
v_mfma_f32_16x16x32_bf16 v[92:95], v[172:175], a[176:179], v[92:95]
s_waitcnt lgkmcnt(4)
v_mfma_f32_16x16x32_bf16 v[80:83], v[148:151], v[16:19], v[80:83]
ds_read_b128 v[172:175], v144 offset:39936
v_mfma_f32_16x16x32_bf16 v[80:83], v[152:155], v[24:27], v[80:83]
v_mfma_f32_16x16x32_bf16 v[96:99], v[152:155], v[28:31], v[96:99]
ds_read_b128 v[176:179], v144 offset:48128
v_mfma_f32_16x16x32_bf16 v[96:99], v[148:151], v[20:23], v[96:99]
s_waitcnt lgkmcnt(4)
v_mfma_f32_16x16x32_bf16 v[100:103], v[156:159], v[20:23], v[100:103]
ds_read_b128 v[148:151], v144 offset:53248
v_mfma_f32_16x16x32_bf16 v[100:103], v[160:163], v[28:31], v[100:103]
v_mfma_f32_16x16x32_bf16 v[84:87], v[160:163], v[24:27], v[84:87]
ds_read_b128 v[152:155], v144 offset:61440
v_mfma_f32_16x16x32_bf16 v[84:87], v[156:159], v[16:19], v[84:87]
s_waitcnt lgkmcnt(4)
v_mfma_f32_16x16x32_bf16 v[88:91], v[164:167], v[16:19], v[88:91]
ds_read_b128 v[156:159], v144 offset:54272
v_mfma_f32_16x16x32_bf16 v[88:91], v[168:171], v[24:27], v[88:91]
v_mfma_f32_16x16x32_bf16 v[104:107], v[168:171], v[28:31], v[104:107]
ds_read_b128 v[160:163], v144 offset:62464
v_mfma_f32_16x16x32_bf16 v[104:107], v[164:167], v[20:23], v[104:107]
s_waitcnt lgkmcnt(4)
v_mfma_f32_16x16x32_bf16 v[108:111], v[172:175], v[20:23], v[108:111]
ds_read_b128 v[164:167], v144 offset:55296
v_mfma_f32_16x16x32_bf16 v[108:111], v[176:179], v[28:31], v[108:111]
v_mfma_f32_16x16x32_bf16 v[92:95], v[176:179], v[24:27], v[92:95]
ds_read_b128 v[168:171], v144 offset:63488
v_mfma_f32_16x16x32_bf16 v[92:95], v[172:175], v[16:19], v[92:95]
s_waitcnt lgkmcnt(4)
v_mfma_f32_16x16x32_bf16 v[80:83], v[148:151], v[32:35], v[80:83]
ds_read_b128 v[172:175], v144 offset:56320
v_mfma_f32_16x16x32_bf16 v[80:83], v[152:155], v[40:43], v[80:83]
v_mfma_f32_16x16x32_bf16 v[96:99], v[152:155], v[44:47], v[96:99]
ds_read_b128 v[176:179], v144 offset:64512
v_mfma_f32_16x16x32_bf16 v[96:99], v[148:151], v[36:39], v[96:99]
s_waitcnt vmcnt(0)
buffer_store_dword v14, off, s[32:35], s82 offset:64 sc0 sc1
s_waitcnt lgkmcnt(4)
v_mfma_f32_16x16x32_bf16 v[100:103], v[156:159], v[36:39], v[100:103]
ds_read_b128 v[148:151], v248 offset:4096
v_mfma_f32_16x16x32_bf16 v[100:103], v[160:163], v[44:47], v[100:103]
v_mfma_f32_16x16x32_bf16 v[84:87], v[160:163], v[40:43], v[84:87]
ds_read_b128 v[152:155], v248 offset:12288
v_mfma_f32_16x16x32_bf16 v[84:87], v[156:159], v[32:35], v[84:87]
s_waitcnt lgkmcnt(4)
v_mfma_f32_16x16x32_bf16 v[88:91], v[164:167], v[32:35], v[88:91]
ds_read_b128 v[156:159], v248 offset:5120
v_mfma_f32_16x16x32_bf16 v[88:91], v[168:171], v[40:43], v[88:91]
v_mfma_f32_16x16x32_bf16 v[104:107], v[168:171], v[44:47], v[104:107]
ds_read_b128 v[160:163], v248 offset:13312
v_mfma_f32_16x16x32_bf16 v[104:107], v[164:167], v[36:39], v[104:107]
s_waitcnt lgkmcnt(4)
v_mfma_f32_16x16x32_bf16 v[108:111], v[172:175], v[36:39], v[108:111]
ds_read_b128 v[164:167], v248 offset:6144
v_mfma_f32_16x16x32_bf16 v[108:111], v[176:179], v[44:47], v[108:111]
v_mfma_f32_16x16x32_bf16 v[92:95], v[176:179], v[40:43], v[92:95]
ds_read_b128 v[168:171], v248 offset:14336
v_mfma_f32_16x16x32_bf16 v[92:95], v[172:175], v[32:35], v[92:95]
s_waitcnt lgkmcnt(4)
v_mfma_f32_16x16x32_bf16 v[80:83], v[148:151], a[192:195], v[80:83]
ds_read_b128 v[172:175], v248 offset:7168
v_mfma_f32_16x16x32_bf16 v[80:83], v[152:155], a[200:203], v[80:83]
v_mfma_f32_16x16x32_bf16 v[96:99], v[152:155], a[204:207], v[96:99]
ds_read_b128 v[176:179], v248 offset:15360
v_mfma_f32_16x16x32_bf16 v[96:99], v[148:151], a[196:199], v[96:99]
s_waitcnt lgkmcnt(4)
v_mfma_f32_16x16x32_bf16 v[100:103], v[156:159], a[196:199], v[100:103]
v_mfma_f32_16x16x32_bf16 v[100:103], v[160:163], a[204:207], v[100:103]
v_mfma_f32_16x16x32_bf16 v[84:87], v[160:163], a[200:203], v[84:87]
v_mfma_f32_16x16x32_bf16 v[84:87], v[156:159], a[192:195], v[84:87]
s_waitcnt lgkmcnt(2)
v_mfma_f32_16x16x32_bf16 v[88:91], v[164:167], a[192:195], v[88:91]
v_mfma_f32_16x16x32_bf16 v[88:91], v[168:171], a[200:203], v[88:91]
v_mfma_f32_16x16x32_bf16 v[104:107], v[168:171], a[204:207], v[104:107]
v_mfma_f32_16x16x32_bf16 v[104:107], v[164:167], a[196:199], v[104:107]
s_waitcnt lgkmcnt(0)
v_mfma_f32_16x16x32_bf16 v[108:111], v[172:175], a[196:199], v[108:111]
v_mfma_f32_16x16x32_bf16 v[108:111], v[176:179], a[204:207], v[108:111]
v_mfma_f32_16x16x32_bf16 v[92:95], v[176:179], a[200:203], v[92:95]
v_mfma_f32_16x16x32_bf16 v[92:95], v[172:175], a[192:195], v[92:95]
s_branch L_main_kernel_tl
.org L_main_kernel_eb + 20736
L_main_kernel_e4:
s_waitcnt lgkmcnt(4)
v_mfma_f32_16x16x32_bf16 v[112:115], v[148:151], a[160:163], v[112:115]
ds_read_b128 v[172:175], v248 offset:52224
v_mfma_f32_16x16x32_bf16 v[112:115], v[152:155], a[168:171], v[112:115]
v_mfma_f32_16x16x32_bf16 v[128:131], v[152:155], a[172:175], v[128:131]
ds_read_b128 v[176:179], v248 offset:60416
v_mfma_f32_16x16x32_bf16 v[128:131], v[148:151], a[164:167], v[128:131]
s_waitcnt vmcnt(8)
s_barrier
s_waitcnt lgkmcnt(4)
v_mfma_f32_16x16x32_bf16 v[132:135], v[156:159], a[164:167], v[132:135]
ds_read_b128 v[148:151], v144 offset:16384
s_mov_b32 s37, 0xffff0000
v_mfma_f32_16x16x32_bf16 v[132:135], v[160:163], a[172:175], v[132:135]
s_mov_b32 s38, 0xbfb8aa3b
s_mov_b32 s39, 0xbfb8aa3b
v_mfma_f32_16x16x32_bf16 v[116:119], v[160:163], a[168:171], v[116:119]
ds_read_b128 v[152:155], v144 offset:24576
v_mov_b32 v14, 1
v_mfma_f32_16x16x32_bf16 v[116:119], v[156:159], a[160:163], v[116:119]
v_permlane16_swap_b32 v52, v54
s_waitcnt lgkmcnt(4)
v_mfma_f32_16x16x32_bf16 v[120:123], v[164:167], a[160:163], v[120:123]
ds_read_b128 v[156:159], v144 offset:17408
v_permlane16_swap_b32 v53, v55
v_mfma_f32_16x16x32_bf16 v[120:123], v[168:171], a[168:171], v[120:123]
v_permlane16_swap_b32 v60, v62
v_permlane16_swap_b32 v61, v63
v_mfma_f32_16x16x32_bf16 v[136:139], v[168:171], a[172:175], v[136:139]
ds_read_b128 v[160:163], v144 offset:25600
v_permlane16_swap_b32 v68, v70
v_mfma_f32_16x16x32_bf16 v[136:139], v[164:167], a[164:167], v[136:139]
v_permlane16_swap_b32 v69, v71
s_waitcnt lgkmcnt(4)
v_mfma_f32_16x16x32_bf16 v[140:143], v[172:175], a[164:167], v[140:143]
ds_read_b128 v[164:167], v144 offset:18432
v_permlane16_swap_b32 v76, v78
v_mfma_f32_16x16x32_bf16 v[140:143], v[176:179], a[172:175], v[140:143]
v_permlane16_swap_b32 v77, v79
v_lshlrev_b32 v48, 16, v52
v_mfma_f32_16x16x32_bf16 v[124:127], v[176:179], a[168:171], v[124:127]
ds_read_b128 v[168:171], v144 offset:26624
v_and_b32 v49, s37, v52
v_mfma_f32_16x16x32_bf16 v[124:127], v[172:175], a[160:163], v[124:127]
v_lshlrev_b32 v50, 16, v53
s_waitcnt lgkmcnt(4)
v_mfma_f32_16x16x32_bf16 v[112:115], v[148:151], a[176:179], v[112:115]
ds_read_b128 v[172:175], v144 offset:19456
v_and_b32 v51, s37, v53
v_mfma_f32_16x16x32_bf16 v[112:115], v[152:155], a[184:187], v[112:115]
v_lshlrev_b32 v52, 16, v54
v_and_b32 v53, s37, v54
v_mfma_f32_16x16x32_bf16 v[128:131], v[152:155], a[188:191], v[128:131]
ds_read_b128 v[176:179], v144 offset:27648
v_lshlrev_b32 v54, 16, v55
v_mfma_f32_16x16x32_bf16 v[128:131], v[148:151], a[180:183], v[128:131]
v_and_b32 v55, s37, v55
s_waitcnt lgkmcnt(4)
v_mfma_f32_16x16x32_bf16 v[132:135], v[156:159], a[180:183], v[132:135]
ds_read_b128 v[148:151], v144 offset:32768
v_lshlrev_b32 v56, 16, v60
v_mfma_f32_16x16x32_bf16 v[132:135], v[160:163], a[188:191], v[132:135]
v_and_b32 v57, s37, v60
v_lshlrev_b32 v58, 16, v61
v_mfma_f32_16x16x32_bf16 v[116:119], v[160:163], a[184:187], v[116:119]
ds_read_b128 v[152:155], v144 offset:40960
v_and_b32 v59, s37, v61
v_mfma_f32_16x16x32_bf16 v[116:119], v[156:159], a[176:179], v[116:119]
v_lshlrev_b32 v60, 16, v62
s_waitcnt lgkmcnt(4)
v_mfma_f32_16x16x32_bf16 v[120:123], v[164:167], a[176:179], v[120:123]
ds_read_b128 v[156:159], v144 offset:49152
v_and_b32 v61, s37, v62
v_mfma_f32_16x16x32_bf16 v[120:123], v[168:171], a[184:187], v[120:123]
v_lshlrev_b32 v62, 16, v63
v_and_b32 v63, s37, v63
v_mfma_f32_16x16x32_bf16 v[136:139], v[168:171], a[188:191], v[136:139]
ds_read_b128 v[160:163], v144 offset:57344
v_lshlrev_b32 v64, 16, v68
v_mfma_f32_16x16x32_bf16 v[136:139], v[164:167], a[180:183], v[136:139]
v_and_b32 v65, s37, v68
s_waitcnt lgkmcnt(4)
v_mfma_f32_16x16x32_bf16 v[140:143], v[172:175], a[180:183], v[140:143]
ds_read_b128 v[164:167], v248 offset:0
v_lshlrev_b32 v66, 16, v69
v_mfma_f32_16x16x32_bf16 v[140:143], v[176:179], a[188:191], v[140:143]
v_and_b32 v67, s37, v69
v_lshlrev_b32 v68, 16, v70
v_mfma_f32_16x16x32_bf16 v[124:127], v[176:179], a[184:187], v[124:127]
ds_read_b128 v[168:171], v248 offset:8192
v_and_b32 v69, s37, v70
v_mfma_f32_16x16x32_bf16 v[124:127], v[172:175], a[176:179], v[124:127]
v_lshlrev_b32 v70, 16, v71
s_waitcnt vmcnt(0)
s_barrier
s_waitcnt lgkmcnt(4)
v_mfma_f32_16x16x32_bf16 v[112:115], v[148:151], v[16:19], v[112:115]
ds_read_b128 v[172:175], v248 offset:16384
v_and_b32 v71, s37, v71
v_mfma_f32_16x16x32_bf16 v[112:115], v[152:155], v[24:27], v[112:115]
v_lshlrev_b32 v72, 16, v76
v_and_b32 v73, s37, v76
v_mfma_f32_16x16x32_bf16 v[128:131], v[152:155], v[28:31], v[128:131]
ds_read_b128 v[176:179], v248 offset:24576
v_lshlrev_b32 v74, 16, v77
v_mfma_f32_16x16x32_bf16 v[128:131], v[148:151], v[20:23], v[128:131]
v_and_b32 v75, s37, v77
s_waitcnt lgkmcnt(4)
v_mfma_f32_16x16x32_bf16 v[128:131], v[156:159], v[36:39], v[128:131]
ds_read_b128 v[148:151], v144 offset:33792
v_lshlrev_b32 v76, 16, v78
v_mfma_f32_16x16x32_bf16 v[128:131], v[160:163], v[44:47], v[128:131]
v_and_b32 v77, s37, v78
v_lshlrev_b32 v78, 16, v79
v_mfma_f32_16x16x32_bf16 v[112:115], v[160:163], v[40:43], v[112:115]
ds_read_b128 v[152:155], v144 offset:41984
v_and_b32 v79, s37, v79
v_mfma_f32_16x16x32_bf16 v[112:115], v[156:159], v[32:35], v[112:115]
v_add_f32 v180, v180, v212
s_waitcnt lgkmcnt(4)
v_mfma_f32_16x16x32_bf16 v[112:115], v[164:167], a[192:195], v[112:115]
ds_read_b128 v[156:159], v144 offset:50176
v_add_f32 v181, v181, v213
v_mfma_f32_16x16x32_bf16 v[112:115], v[168:171], a[200:203], v[112:115]
v_add_f32 v182, v182, v214
v_add_f32 v183, v183, v215
v_mfma_f32_16x16x32_bf16 v[128:131], v[168:171], a[204:207], v[128:131]
ds_read_b128 v[160:163], v144 offset:58368
v_add_f32 v184, v184, v216
v_mfma_f32_16x16x32_bf16 v[128:131], v[164:167], a[196:199], v[128:131]
v_add_f32 v185, v185, v217
s_waitcnt lgkmcnt(4)
v_mfma_f32_16x16x32_bf16 v[128:131], v[172:175], a[212:215], v[128:131]
ds_read_b128 v[164:167], v248 offset:1024
v_add_f32 v186, v186, v218
v_mfma_f32_16x16x32_bf16 v[128:131], v[176:179], a[220:223], v[128:131]
v_add_f32 v187, v187, v219
v_add_f32 v188, v188, v220
v_mfma_f32_16x16x32_bf16 v[112:115], v[176:179], a[216:219], v[112:115]
ds_read_b128 v[168:171], v248 offset:9216
v_add_f32 v189, v189, v221
v_mfma_f32_16x16x32_bf16 v[112:115], v[172:175], a[208:211], v[112:115]
v_add_f32 v190, v190, v222
s_waitcnt lgkmcnt(4)
v_mfma_f32_16x16x32_bf16 v[116:119], v[148:151], v[16:19], v[116:119]
ds_read_b128 v[172:175], v248 offset:17408
v_add_f32 v191, v191, v223
v_mfma_f32_16x16x32_bf16 v[116:119], v[152:155], v[24:27], v[116:119]
v_add_f32 v192, v192, v224
v_add_f32 v193, v193, v225
v_mfma_f32_16x16x32_bf16 v[132:135], v[152:155], v[28:31], v[132:135]
ds_read_b128 v[176:179], v248 offset:25600
v_add_f32 v194, v194, v226
v_mfma_f32_16x16x32_bf16 v[132:135], v[148:151], v[20:23], v[132:135]
buffer_store_dwordx4 v[128:131], v252, s[84:87], s75 offen offset:0 sc0 sc1
s_waitcnt lgkmcnt(4)
v_mfma_f32_16x16x32_bf16 v[132:135], v[156:159], v[36:39], v[132:135]
ds_read_b128 v[148:151], v144 offset:34816
v_add_f32 v195, v195, v227
v_mfma_f32_16x16x32_bf16 v[132:135], v[160:163], v[44:47], v[132:135]
v_add_f32 v196, v196, v228
v_add_f32 v197, v197, v229
v_mfma_f32_16x16x32_bf16 v[116:119], v[160:163], v[40:43], v[116:119]
ds_read_b128 v[152:155], v144 offset:43008
v_add_f32 v198, v198, v230
v_mfma_f32_16x16x32_bf16 v[116:119], v[156:159], v[32:35], v[116:119]
buffer_store_dwordx4 v[112:115], v252, s[84:87], s74 offen offset:0 sc0 sc1
s_waitcnt lgkmcnt(4)
v_mfma_f32_16x16x32_bf16 v[116:119], v[164:167], a[192:195], v[116:119]
ds_read_b128 v[156:159], v144 offset:51200
v_add_f32 v199, v199, v231
v_mfma_f32_16x16x32_bf16 v[116:119], v[168:171], a[200:203], v[116:119]
v_add_f32 v200, v200, v232
v_add_f32 v201, v201, v233
v_mfma_f32_16x16x32_bf16 v[132:135], v[168:171], a[204:207], v[132:135]
ds_read_b128 v[160:163], v144 offset:59392
v_add_f32 v202, v202, v234
v_mfma_f32_16x16x32_bf16 v[132:135], v[164:167], a[196:199], v[132:135]
v_add_f32 v203, v203, v235
s_waitcnt lgkmcnt(4)
v_mfma_f32_16x16x32_bf16 v[132:135], v[172:175], a[212:215], v[132:135]
ds_read_b128 v[164:167], v248 offset:2048
v_add_f32 v204, v204, v236
v_mfma_f32_16x16x32_bf16 v[132:135], v[176:179], a[220:223], v[132:135]
v_add_f32 v205, v205, v237
v_add_f32 v206, v206, v238
v_mfma_f32_16x16x32_bf16 v[116:119], v[176:179], a[216:219], v[116:119]
ds_read_b128 v[168:171], v248 offset:10240
v_add_f32 v207, v207, v239
v_mfma_f32_16x16x32_bf16 v[116:119], v[172:175], a[208:211], v[116:119]
v_add_f32 v208, v208, v240
s_waitcnt lgkmcnt(4)
v_mfma_f32_16x16x32_bf16 v[120:123], v[148:151], v[16:19], v[120:123]
ds_read_b128 v[172:175], v248 offset:18432
v_add_f32 v209, v209, v241
v_mfma_f32_16x16x32_bf16 v[120:123], v[152:155], v[24:27], v[120:123]
v_add_f32 v210, v210, v242
v_add_f32 v211, v211, v243
v_mfma_f32_16x16x32_bf16 v[136:139], v[152:155], v[28:31], v[136:139]
ds_read_b128 v[176:179], v248 offset:26624
v_cvt_pk_bf16_f32 v180, 0, v180
v_mfma_f32_16x16x32_bf16 v[136:139], v[148:151], v[20:23], v[136:139]
buffer_store_dwordx4 v[132:135], v252, s[84:87], s75 offen offset:1024 sc0 sc1
s_waitcnt lgkmcnt(4)
v_mfma_f32_16x16x32_bf16 v[136:139], v[156:159], v[36:39], v[136:139]
ds_read_b128 v[148:151], v144 offset:35840
v_cvt_pk_bf16_f32 v181, 0, v181
v_mfma_f32_16x16x32_bf16 v[136:139], v[160:163], v[44:47], v[136:139]
v_cvt_pk_bf16_f32 v182, 0, v182
v_cvt_pk_bf16_f32 v183, 0, v183
v_mfma_f32_16x16x32_bf16 v[120:123], v[160:163], v[40:43], v[120:123]
ds_read_b128 v[152:155], v144 offset:44032
v_cvt_pk_bf16_f32 v184, 0, v184
v_mfma_f32_16x16x32_bf16 v[120:123], v[156:159], v[32:35], v[120:123]
buffer_store_dwordx4 v[116:119], v252, s[84:87], s74 offen offset:1024 sc0 sc1
s_waitcnt lgkmcnt(4)
v_mfma_f32_16x16x32_bf16 v[120:123], v[164:167], a[192:195], v[120:123]
ds_read_b128 v[156:159], v144 offset:52224
v_cvt_pk_bf16_f32 v185, 0, v185
v_mfma_f32_16x16x32_bf16 v[120:123], v[168:171], a[200:203], v[120:123]
v_cvt_pk_bf16_f32 v186, 0, v186
v_cvt_pk_bf16_f32 v187, 0, v187
v_mfma_f32_16x16x32_bf16 v[136:139], v[168:171], a[204:207], v[136:139]
ds_read_b128 v[160:163], v144 offset:60416
v_cvt_pk_bf16_f32 v188, 0, v188
v_mfma_f32_16x16x32_bf16 v[136:139], v[164:167], a[196:199], v[136:139]
v_cvt_pk_bf16_f32 v189, 0, v189
s_waitcnt lgkmcnt(4)
v_mfma_f32_16x16x32_bf16 v[136:139], v[172:175], a[212:215], v[136:139]
ds_read_b128 v[164:167], v248 offset:3072
v_cvt_pk_bf16_f32 v190, 0, v190
v_mfma_f32_16x16x32_bf16 v[136:139], v[176:179], a[220:223], v[136:139]
v_cvt_pk_bf16_f32 v191, 0, v191
v_cvt_pk_bf16_f32 v192, 0, v192
v_mfma_f32_16x16x32_bf16 v[120:123], v[176:179], a[216:219], v[120:123]
ds_read_b128 v[168:171], v248 offset:11264
v_cvt_pk_bf16_f32 v193, 0, v193
v_mfma_f32_16x16x32_bf16 v[120:123], v[172:175], a[208:211], v[120:123]
v_cvt_pk_bf16_f32 v194, 0, v194
s_waitcnt lgkmcnt(4)
v_mfma_f32_16x16x32_bf16 v[124:127], v[148:151], v[16:19], v[124:127]
ds_read_b128 v[172:175], v248 offset:19456
v_cvt_pk_bf16_f32 v195, 0, v195
v_mfma_f32_16x16x32_bf16 v[124:127], v[152:155], v[24:27], v[124:127]
v_cvt_pk_bf16_f32 v196, 0, v196
v_cvt_pk_bf16_f32 v197, 0, v197
v_mfma_f32_16x16x32_bf16 v[140:143], v[152:155], v[28:31], v[140:143]
ds_read_b128 v[176:179], v248 offset:27648
v_cvt_pk_bf16_f32 v198, 0, v198
v_mfma_f32_16x16x32_bf16 v[140:143], v[148:151], v[20:23], v[140:143]
buffer_store_dwordx4 v[136:139], v252, s[84:87], s75 offen offset:2048 sc0 sc1
s_waitcnt lgkmcnt(4)
v_mfma_f32_16x16x32_bf16 v[140:143], v[156:159], v[36:39], v[140:143]
ds_read_b128 v[148:151], v248 offset:53248
v_cvt_pk_bf16_f32 v199, 0, v199
v_mfma_f32_16x16x32_bf16 v[140:143], v[160:163], v[44:47], v[140:143]
v_cvt_pk_bf16_f32 v200, 0, v200
v_cvt_pk_bf16_f32 v201, 0, v201
v_mfma_f32_16x16x32_bf16 v[124:127], v[160:163], v[40:43], v[124:127]
ds_read_b128 v[152:155], v248 offset:61440
v_cvt_pk_bf16_f32 v202, 0, v202
v_mfma_f32_16x16x32_bf16 v[124:127], v[156:159], v[32:35], v[124:127]
buffer_store_dwordx4 v[120:123], v252, s[84:87], s74 offen offset:2048 sc0 sc1
s_waitcnt lgkmcnt(4)
v_mfma_f32_16x16x32_bf16 v[124:127], v[164:167], a[192:195], v[124:127]
ds_read_b128 v[156:159], v248 offset:54272
v_cvt_pk_bf16_f32 v203, 0, v203
v_mfma_f32_16x16x32_bf16 v[124:127], v[168:171], a[200:203], v[124:127]
v_cvt_pk_bf16_f32 v204, 0, v204
v_cvt_pk_bf16_f32 v205, 0, v205
v_mfma_f32_16x16x32_bf16 v[140:143], v[168:171], a[204:207], v[140:143]
ds_read_b128 v[160:163], v248 offset:62464
v_cvt_pk_bf16_f32 v206, 0, v206
v_mfma_f32_16x16x32_bf16 v[140:143], v[164:167], a[196:199], v[140:143]
v_cvt_pk_bf16_f32 v207, 0, v207
s_waitcnt lgkmcnt(4)
v_mfma_f32_16x16x32_bf16 v[140:143], v[172:175], a[212:215], v[140:143]
ds_read_b128 v[164:167], v248 offset:55296
v_cvt_pk_bf16_f32 v208, 0, v208
v_mfma_f32_16x16x32_bf16 v[140:143], v[176:179], a[220:223], v[140:143]
v_cvt_pk_bf16_f32 v209, 0, v209
v_cvt_pk_bf16_f32 v210, 0, v210
v_mfma_f32_16x16x32_bf16 v[124:127], v[176:179], a[216:219], v[124:127]
ds_read_b128 v[168:171], v248 offset:63488
v_cvt_pk_bf16_f32 v211, 0, v211
v_mfma_f32_16x16x32_bf16 v[124:127], v[172:175], a[208:211], v[124:127]
v_mul_f32 v212, s38, v180
s_waitcnt lgkmcnt(4)
v_mfma_f32_16x16x32_bf16 v[80:83], v[148:151], a[160:163], v[80:83]
ds_read_b128 v[172:175], v248 offset:56320
v_mul_f32 v213, s38, v181
v_mfma_f32_16x16x32_bf16 v[80:83], v[152:155], a[168:171], v[80:83]
v_mul_f32 v214, s38, v182
v_mul_f32 v215, s38, v183
v_mfma_f32_16x16x32_bf16 v[96:99], v[152:155], a[172:175], v[96:99]
ds_read_b128 v[176:179], v248 offset:64512
v_mul_f32 v216, s38, v184
v_mfma_f32_16x16x32_bf16 v[96:99], v[148:151], a[164:167], v[96:99]
buffer_store_dwordx4 v[140:143], v252, s[84:87], s75 offen offset:3072 sc0 sc1
s_waitcnt lgkmcnt(4)
v_mfma_f32_16x16x32_bf16 v[100:103], v[156:159], a[164:167], v[100:103]
ds_read_b128 v[148:151], v144 offset:20480
v_mul_f32 v217, s38, v185
v_mfma_f32_16x16x32_bf16 v[100:103], v[160:163], a[172:175], v[100:103]
v_mul_f32 v218, s38, v186
v_mul_f32 v219, s38, v187
v_mfma_f32_16x16x32_bf16 v[84:87], v[160:163], a[168:171], v[84:87]
ds_read_b128 v[152:155], v144 offset:28672
v_mul_f32 v220, s38, v188
v_mfma_f32_16x16x32_bf16 v[84:87], v[156:159], a[160:163], v[84:87]
buffer_store_dwordx4 v[124:127], v252, s[84:87], s74 offen offset:3072 sc0 sc1
s_waitcnt lgkmcnt(4)
v_mfma_f32_16x16x32_bf16 v[88:91], v[164:167], a[160:163], v[88:91]
ds_read_b128 v[156:159], v144 offset:21504
v_mul_f32 v221, s38, v189
v_mfma_f32_16x16x32_bf16 v[88:91], v[168:171], a[168:171], v[88:91]
v_mul_f32 v222, s38, v190
v_mul_f32 v223, s38, v191
v_mfma_f32_16x16x32_bf16 v[104:107], v[168:171], a[172:175], v[104:107]
ds_read_b128 v[160:163], v144 offset:29696
v_mul_f32 v224, s38, v192
v_mfma_f32_16x16x32_bf16 v[104:107], v[164:167], a[164:167], v[104:107]
v_mul_f32 v225, s38, v193
s_waitcnt lgkmcnt(4)
v_mfma_f32_16x16x32_bf16 v[108:111], v[172:175], a[164:167], v[108:111]
ds_read_b128 v[164:167], v144 offset:22528
v_mul_f32 v226, s38, v194
v_mfma_f32_16x16x32_bf16 v[108:111], v[176:179], a[172:175], v[108:111]
v_mul_f32 v227, s38, v195
v_mul_f32 v228, s38, v196
v_mfma_f32_16x16x32_bf16 v[92:95], v[176:179], a[168:171], v[92:95]
ds_read_b128 v[168:171], v144 offset:30720
v_mul_f32 v229, s38, v197
v_mfma_f32_16x16x32_bf16 v[92:95], v[172:175], a[160:163], v[92:95]
v_mul_f32 v230, s38, v198
s_waitcnt lgkmcnt(4)
v_mfma_f32_16x16x32_bf16 v[80:83], v[148:151], a[176:179], v[80:83]
ds_read_b128 v[172:175], v144 offset:23552
v_mul_f32 v231, s38, v199
v_mfma_f32_16x16x32_bf16 v[80:83], v[152:155], a[184:187], v[80:83]
v_mul_f32 v232, s38, v200
v_mul_f32 v233, s38, v201
v_mfma_f32_16x16x32_bf16 v[96:99], v[152:155], a[188:191], v[96:99]
ds_read_b128 v[176:179], v144 offset:31744
v_mul_f32 v234, s38, v202
v_mfma_f32_16x16x32_bf16 v[96:99], v[148:151], a[180:183], v[96:99]
v_mul_f32 v235, s38, v203
s_waitcnt lgkmcnt(4)
v_mfma_f32_16x16x32_bf16 v[100:103], v[156:159], a[180:183], v[100:103]
ds_read_b128 v[148:151], v144 offset:36864
v_mul_f32 v236, s38, v204
v_mfma_f32_16x16x32_bf16 v[100:103], v[160:163], a[188:191], v[100:103]
v_mul_f32 v237, s38, v205
v_mul_f32 v238, s38, v206
v_mfma_f32_16x16x32_bf16 v[84:87], v[160:163], a[184:187], v[84:87]
ds_read_b128 v[152:155], v144 offset:45056
v_mul_f32 v239, s38, v207
v_mfma_f32_16x16x32_bf16 v[84:87], v[156:159], a[176:179], v[84:87]
v_mul_f32 v240, s38, v208
s_waitcnt lgkmcnt(4)
v_mfma_f32_16x16x32_bf16 v[88:91], v[164:167], a[176:179], v[88:91]
ds_read_b128 v[156:159], v144 offset:37888
v_mul_f32 v241, s38, v209
v_mfma_f32_16x16x32_bf16 v[88:91], v[168:171], a[184:187], v[88:91]
v_mul_f32 v242, s38, v210
v_mul_f32 v243, s38, v211
v_mfma_f32_16x16x32_bf16 v[104:107], v[168:171], a[188:191], v[104:107]
ds_read_b128 v[160:163], v144 offset:46080
v_mfma_f32_16x16x32_bf16 v[104:107], v[164:167], a[180:183], v[104:107]
s_waitcnt lgkmcnt(4)
v_mfma_f32_16x16x32_bf16 v[108:111], v[172:175], a[180:183], v[108:111]
ds_read_b128 v[164:167], v144 offset:38912
v_mfma_f32_16x16x32_bf16 v[108:111], v[176:179], a[188:191], v[108:111]
v_mfma_f32_16x16x32_bf16 v[92:95], v[176:179], a[184:187], v[92:95]
ds_read_b128 v[168:171], v144 offset:47104
v_mfma_f32_16x16x32_bf16 v[92:95], v[172:175], a[176:179], v[92:95]
s_waitcnt lgkmcnt(4)
v_mfma_f32_16x16x32_bf16 v[80:83], v[148:151], v[16:19], v[80:83]
ds_read_b128 v[172:175], v144 offset:39936
v_mfma_f32_16x16x32_bf16 v[80:83], v[152:155], v[24:27], v[80:83]
v_mfma_f32_16x16x32_bf16 v[96:99], v[152:155], v[28:31], v[96:99]
ds_read_b128 v[176:179], v144 offset:48128
v_mfma_f32_16x16x32_bf16 v[96:99], v[148:151], v[20:23], v[96:99]
s_waitcnt lgkmcnt(4)
v_mfma_f32_16x16x32_bf16 v[100:103], v[156:159], v[20:23], v[100:103]
ds_read_b128 v[148:151], v144 offset:53248
v_mfma_f32_16x16x32_bf16 v[100:103], v[160:163], v[28:31], v[100:103]
v_mfma_f32_16x16x32_bf16 v[84:87], v[160:163], v[24:27], v[84:87]
ds_read_b128 v[152:155], v144 offset:61440
v_mfma_f32_16x16x32_bf16 v[84:87], v[156:159], v[16:19], v[84:87]
s_waitcnt lgkmcnt(4)
v_mfma_f32_16x16x32_bf16 v[88:91], v[164:167], v[16:19], v[88:91]
ds_read_b128 v[156:159], v144 offset:54272
v_mfma_f32_16x16x32_bf16 v[88:91], v[168:171], v[24:27], v[88:91]
v_mfma_f32_16x16x32_bf16 v[104:107], v[168:171], v[28:31], v[104:107]
ds_read_b128 v[160:163], v144 offset:62464
v_mfma_f32_16x16x32_bf16 v[104:107], v[164:167], v[20:23], v[104:107]
s_waitcnt lgkmcnt(4)
v_mfma_f32_16x16x32_bf16 v[108:111], v[172:175], v[20:23], v[108:111]
ds_read_b128 v[164:167], v144 offset:55296
v_mfma_f32_16x16x32_bf16 v[108:111], v[176:179], v[28:31], v[108:111]
v_mfma_f32_16x16x32_bf16 v[92:95], v[176:179], v[24:27], v[92:95]
ds_read_b128 v[168:171], v144 offset:63488
v_mfma_f32_16x16x32_bf16 v[92:95], v[172:175], v[16:19], v[92:95]
s_waitcnt lgkmcnt(4)
v_mfma_f32_16x16x32_bf16 v[80:83], v[148:151], v[32:35], v[80:83]
ds_read_b128 v[172:175], v144 offset:56320
v_mfma_f32_16x16x32_bf16 v[80:83], v[152:155], v[40:43], v[80:83]
v_mfma_f32_16x16x32_bf16 v[96:99], v[152:155], v[44:47], v[96:99]
ds_read_b128 v[176:179], v144 offset:64512
v_mfma_f32_16x16x32_bf16 v[96:99], v[148:151], v[36:39], v[96:99]
s_waitcnt lgkmcnt(4)
v_mfma_f32_16x16x32_bf16 v[100:103], v[156:159], v[36:39], v[100:103]
ds_read_b128 v[148:151], v248 offset:4096
v_mfma_f32_16x16x32_bf16 v[100:103], v[160:163], v[44:47], v[100:103]
v_mfma_f32_16x16x32_bf16 v[84:87], v[160:163], v[40:43], v[84:87]
ds_read_b128 v[152:155], v248 offset:12288
v_mfma_f32_16x16x32_bf16 v[84:87], v[156:159], v[32:35], v[84:87]
s_waitcnt lgkmcnt(4)
v_mfma_f32_16x16x32_bf16 v[88:91], v[164:167], v[32:35], v[88:91]
ds_read_b128 v[156:159], v248 offset:5120
v_mfma_f32_16x16x32_bf16 v[88:91], v[168:171], v[40:43], v[88:91]
v_mfma_f32_16x16x32_bf16 v[104:107], v[168:171], v[44:47], v[104:107]
ds_read_b128 v[160:163], v248 offset:13312
v_mfma_f32_16x16x32_bf16 v[104:107], v[164:167], v[36:39], v[104:107]
s_waitcnt lgkmcnt(4)
v_mfma_f32_16x16x32_bf16 v[108:111], v[172:175], v[36:39], v[108:111]
ds_read_b128 v[164:167], v248 offset:6144
v_mfma_f32_16x16x32_bf16 v[108:111], v[176:179], v[44:47], v[108:111]
v_mfma_f32_16x16x32_bf16 v[92:95], v[176:179], v[40:43], v[92:95]
ds_read_b128 v[168:171], v248 offset:14336
v_mfma_f32_16x16x32_bf16 v[92:95], v[172:175], v[32:35], v[92:95]
s_waitcnt lgkmcnt(4)
v_mfma_f32_16x16x32_bf16 v[80:83], v[148:151], a[192:195], v[80:83]
ds_read_b128 v[172:175], v248 offset:7168
v_mfma_f32_16x16x32_bf16 v[80:83], v[152:155], a[200:203], v[80:83]
v_mfma_f32_16x16x32_bf16 v[96:99], v[152:155], a[204:207], v[96:99]
ds_read_b128 v[176:179], v248 offset:15360
v_mfma_f32_16x16x32_bf16 v[96:99], v[148:151], a[196:199], v[96:99]
s_waitcnt vmcnt(0)
buffer_store_dword v14, off, s[32:35], s82 offset:64 sc0 sc1
s_waitcnt lgkmcnt(4)
v_mfma_f32_16x16x32_bf16 v[100:103], v[156:159], a[196:199], v[100:103]
ds_read_b128 v[148:151], v248 offset:20480
v_mfma_f32_16x16x32_bf16 v[100:103], v[160:163], a[204:207], v[100:103]
v_mfma_f32_16x16x32_bf16 v[84:87], v[160:163], a[200:203], v[84:87]
ds_read_b128 v[152:155], v248 offset:28672
v_mfma_f32_16x16x32_bf16 v[84:87], v[156:159], a[192:195], v[84:87]
s_waitcnt lgkmcnt(4)
v_mfma_f32_16x16x32_bf16 v[88:91], v[164:167], a[192:195], v[88:91]
ds_read_b128 v[156:159], v248 offset:21504
v_mfma_f32_16x16x32_bf16 v[88:91], v[168:171], a[200:203], v[88:91]
v_mfma_f32_16x16x32_bf16 v[104:107], v[168:171], a[204:207], v[104:107]
ds_read_b128 v[160:163], v248 offset:29696
v_mfma_f32_16x16x32_bf16 v[104:107], v[164:167], a[196:199], v[104:107]
s_waitcnt lgkmcnt(4)
v_mfma_f32_16x16x32_bf16 v[108:111], v[172:175], a[196:199], v[108:111]
ds_read_b128 v[164:167], v248 offset:22528
v_mfma_f32_16x16x32_bf16 v[108:111], v[176:179], a[204:207], v[108:111]
v_mfma_f32_16x16x32_bf16 v[92:95], v[176:179], a[200:203], v[92:95]
ds_read_b128 v[168:171], v248 offset:30720
v_mfma_f32_16x16x32_bf16 v[92:95], v[172:175], a[192:195], v[92:95]
s_waitcnt lgkmcnt(4)
v_mfma_f32_16x16x32_bf16 v[80:83], v[148:151], a[208:211], v[80:83]
ds_read_b128 v[172:175], v248 offset:23552
v_mfma_f32_16x16x32_bf16 v[80:83], v[152:155], a[216:219], v[80:83]
v_mfma_f32_16x16x32_bf16 v[96:99], v[152:155], a[220:223], v[96:99]
ds_read_b128 v[176:179], v248 offset:31744
v_mfma_f32_16x16x32_bf16 v[96:99], v[148:151], a[212:215], v[96:99]
s_waitcnt lgkmcnt(4)
v_mfma_f32_16x16x32_bf16 v[100:103], v[156:159], a[212:215], v[100:103]
v_mfma_f32_16x16x32_bf16 v[100:103], v[160:163], a[220:223], v[100:103]
v_mfma_f32_16x16x32_bf16 v[84:87], v[160:163], a[216:219], v[84:87]
v_mfma_f32_16x16x32_bf16 v[84:87], v[156:159], a[208:211], v[84:87]
s_waitcnt lgkmcnt(2)
v_mfma_f32_16x16x32_bf16 v[88:91], v[164:167], a[208:211], v[88:91]
v_mfma_f32_16x16x32_bf16 v[88:91], v[168:171], a[216:219], v[88:91]
v_mfma_f32_16x16x32_bf16 v[104:107], v[168:171], a[220:223], v[104:107]
v_mfma_f32_16x16x32_bf16 v[104:107], v[164:167], a[212:215], v[104:107]
s_waitcnt lgkmcnt(0)
v_mfma_f32_16x16x32_bf16 v[108:111], v[172:175], a[212:215], v[108:111]
v_mfma_f32_16x16x32_bf16 v[108:111], v[176:179], a[220:223], v[108:111]
v_mfma_f32_16x16x32_bf16 v[92:95], v[176:179], a[216:219], v[92:95]
v_mfma_f32_16x16x32_bf16 v[92:95], v[172:175], a[208:211], v[92:95]
s_branch L_main_kernel_tl
.org L_main_kernel_eb + 24192
L_main_kernel_e5:
s_waitcnt lgkmcnt(4)
v_mfma_f32_16x16x32_bf16 v[112:115], v[148:151], a[176:179], v[112:115]
ds_read_b128 v[172:175], v144 offset:19456
v_mfma_f32_16x16x32_bf16 v[112:115], v[152:155], a[184:187], v[112:115]
v_mfma_f32_16x16x32_bf16 v[128:131], v[152:155], a[188:191], v[128:131]
ds_read_b128 v[176:179], v144 offset:27648
v_mfma_f32_16x16x32_bf16 v[128:131], v[148:151], a[180:183], v[128:131]
s_waitcnt vmcnt(8)
s_barrier
s_waitcnt lgkmcnt(4)
v_mfma_f32_16x16x32_bf16 v[132:135], v[156:159], a[180:183], v[132:135]
ds_read_b128 v[148:151], v144 offset:32768
s_mov_b32 s37, 0xffff0000
v_mfma_f32_16x16x32_bf16 v[132:135], v[160:163], a[188:191], v[132:135]
s_mov_b32 s38, 0xbfb8aa3b
s_mov_b32 s39, 0xbfb8aa3b
v_mfma_f32_16x16x32_bf16 v[116:119], v[160:163], a[184:187], v[116:119]
ds_read_b128 v[152:155], v144 offset:40960
v_mov_b32 v14, 1
v_mfma_f32_16x16x32_bf16 v[116:119], v[156:159], a[176:179], v[116:119]
v_permlane16_swap_b32 v52, v54
s_waitcnt lgkmcnt(4)
v_mfma_f32_16x16x32_bf16 v[120:123], v[164:167], a[176:179], v[120:123]
ds_read_b128 v[156:159], v144 offset:33792
v_permlane16_swap_b32 v53, v55
v_mfma_f32_16x16x32_bf16 v[120:123], v[168:171], a[184:187], v[120:123]
v_permlane16_swap_b32 v60, v62
v_permlane16_swap_b32 v61, v63
v_mfma_f32_16x16x32_bf16 v[136:139], v[168:171], a[188:191], v[136:139]
ds_read_b128 v[160:163], v144 offset:41984
v_permlane16_swap_b32 v68, v70
v_mfma_f32_16x16x32_bf16 v[136:139], v[164:167], a[180:183], v[136:139]
v_permlane16_swap_b32 v69, v71
s_waitcnt lgkmcnt(4)
v_mfma_f32_16x16x32_bf16 v[140:143], v[172:175], a[180:183], v[140:143]
ds_read_b128 v[164:167], v144 offset:34816
v_permlane16_swap_b32 v76, v78
v_mfma_f32_16x16x32_bf16 v[140:143], v[176:179], a[188:191], v[140:143]
v_permlane16_swap_b32 v77, v79
v_lshlrev_b32 v48, 16, v52
v_mfma_f32_16x16x32_bf16 v[124:127], v[176:179], a[184:187], v[124:127]
ds_read_b128 v[168:171], v144 offset:43008
v_and_b32 v49, s37, v52
v_mfma_f32_16x16x32_bf16 v[124:127], v[172:175], a[176:179], v[124:127]
v_lshlrev_b32 v50, 16, v53
s_waitcnt lgkmcnt(4)
v_mfma_f32_16x16x32_bf16 v[112:115], v[148:151], v[16:19], v[112:115]
ds_read_b128 v[172:175], v144 offset:35840
v_and_b32 v51, s37, v53
v_mfma_f32_16x16x32_bf16 v[112:115], v[152:155], v[24:27], v[112:115]
v_lshlrev_b32 v52, 16, v54
v_and_b32 v53, s37, v54
v_mfma_f32_16x16x32_bf16 v[128:131], v[152:155], v[28:31], v[128:131]
ds_read_b128 v[176:179], v144 offset:44032
v_lshlrev_b32 v54, 16, v55
v_mfma_f32_16x16x32_bf16 v[128:131], v[148:151], v[20:23], v[128:131]
v_and_b32 v55, s37, v55
s_waitcnt lgkmcnt(4)
v_mfma_f32_16x16x32_bf16 v[132:135], v[156:159], v[20:23], v[132:135]
ds_read_b128 v[148:151], v144 offset:49152
v_lshlrev_b32 v56, 16, v60
v_mfma_f32_16x16x32_bf16 v[132:135], v[160:163], v[28:31], v[132:135]
v_and_b32 v57, s37, v60
v_lshlrev_b32 v58, 16, v61
v_mfma_f32_16x16x32_bf16 v[116:119], v[160:163], v[24:27], v[116:119]
ds_read_b128 v[152:155], v144 offset:57344
v_and_b32 v59, s37, v61
v_mfma_f32_16x16x32_bf16 v[116:119], v[156:159], v[16:19], v[116:119]
v_lshlrev_b32 v60, 16, v62
s_waitcnt lgkmcnt(4)
v_mfma_f32_16x16x32_bf16 v[120:123], v[164:167], v[16:19], v[120:123]
ds_read_b128 v[156:159], v248 offset:0
v_and_b32 v61, s37, v62
v_mfma_f32_16x16x32_bf16 v[120:123], v[168:171], v[24:27], v[120:123]
v_lshlrev_b32 v62, 16, v63
v_and_b32 v63, s37, v63
v_mfma_f32_16x16x32_bf16 v[136:139], v[168:171], v[28:31], v[136:139]
ds_read_b128 v[160:163], v248 offset:8192
v_lshlrev_b32 v64, 16, v68
v_mfma_f32_16x16x32_bf16 v[136:139], v[164:167], v[20:23], v[136:139]
v_and_b32 v65, s37, v68
s_waitcnt lgkmcnt(4)
v_mfma_f32_16x16x32_bf16 v[140:143], v[172:175], v[20:23], v[140:143]
ds_read_b128 v[164:167], v248 offset:16384
v_lshlrev_b32 v66, 16, v69
v_mfma_f32_16x16x32_bf16 v[140:143], v[176:179], v[28:31], v[140:143]
v_and_b32 v67, s37, v69
v_lshlrev_b32 v68, 16, v70
v_mfma_f32_16x16x32_bf16 v[124:127], v[176:179], v[24:27], v[124:127]
ds_read_b128 v[168:171], v248 offset:24576
v_and_b32 v69, s37, v70
v_mfma_f32_16x16x32_bf16 v[124:127], v[172:175], v[16:19], v[124:127]
v_lshlrev_b32 v70, 16, v71
s_waitcnt vmcnt(0)
s_barrier
s_waitcnt lgkmcnt(4)
v_mfma_f32_16x16x32_bf16 v[112:115], v[148:151], v[32:35], v[112:115]
ds_read_b128 v[172:175], v248 offset:32768
v_and_b32 v71, s37, v71
v_mfma_f32_16x16x32_bf16 v[112:115], v[152:155], v[40:43], v[112:115]
v_lshlrev_b32 v72, 16, v76
v_and_b32 v73, s37, v76
v_mfma_f32_16x16x32_bf16 v[128:131], v[152:155], v[44:47], v[128:131]
ds_read_b128 v[176:179], v248 offset:40960
v_lshlrev_b32 v74, 16, v77
v_mfma_f32_16x16x32_bf16 v[128:131], v[148:151], v[36:39], v[128:131]
v_and_b32 v75, s37, v77
s_waitcnt lgkmcnt(4)
v_mfma_f32_16x16x32_bf16 v[128:131], v[156:159], a[196:199], v[128:131]
ds_read_b128 v[148:151], v144 offset:50176
v_lshlrev_b32 v76, 16, v78
v_mfma_f32_16x16x32_bf16 v[128:131], v[160:163], a[204:207], v[128:131]
v_and_b32 v77, s37, v78
v_lshlrev_b32 v78, 16, v79
v_mfma_f32_16x16x32_bf16 v[112:115], v[160:163], a[200:203], v[112:115]
ds_read_b128 v[152:155], v144 offset:58368
v_and_b32 v79, s37, v79
v_mfma_f32_16x16x32_bf16 v[112:115], v[156:159], a[192:195], v[112:115]
v_add_f32 v180, v180, v212
s_waitcnt lgkmcnt(4)
v_mfma_f32_16x16x32_bf16 v[112:115], v[164:167], a[208:211], v[112:115]
ds_read_b128 v[156:159], v248 offset:1024
v_add_f32 v181, v181, v213
v_mfma_f32_16x16x32_bf16 v[112:115], v[168:171], a[216:219], v[112:115]
v_add_f32 v182, v182, v214
v_add_f32 v183, v183, v215
v_mfma_f32_16x16x32_bf16 v[128:131], v[168:171], a[220:223], v[128:131]
ds_read_b128 v[160:163], v248 offset:9216
v_add_f32 v184, v184, v216
v_mfma_f32_16x16x32_bf16 v[128:131], v[164:167], a[212:215], v[128:131]
v_add_f32 v185, v185, v217
s_waitcnt lgkmcnt(4)
v_mfma_f32_16x16x32_bf16 v[128:131], v[172:175], a[132:135], v[128:131]
ds_read_b128 v[164:167], v248 offset:17408
v_add_f32 v186, v186, v218
v_mfma_f32_16x16x32_bf16 v[128:131], v[176:179], a[140:143], v[128:131]
v_add_f32 v187, v187, v219
v_add_f32 v188, v188, v220
v_mfma_f32_16x16x32_bf16 v[112:115], v[176:179], a[136:139], v[112:115]
ds_read_b128 v[168:171], v248 offset:25600
v_add_f32 v189, v189, v221
v_mfma_f32_16x16x32_bf16 v[112:115], v[172:175], a[128:131], v[112:115]
v_add_f32 v190, v190, v222
s_waitcnt lgkmcnt(4)
v_mfma_f32_16x16x32_bf16 v[116:119], v[148:151], v[32:35], v[116:119]
ds_read_b128 v[172:175], v248 offset:33792
v_add_f32 v191, v191, v223
v_mfma_f32_16x16x32_bf16 v[116:119], v[152:155], v[40:43], v[116:119]
v_add_f32 v192, v192, v224
v_add_f32 v193, v193, v225
v_mfma_f32_16x16x32_bf16 v[132:135], v[152:155], v[44:47], v[132:135]
ds_read_b128 v[176:179], v248 offset:41984
v_add_f32 v194, v194, v226
v_mfma_f32_16x16x32_bf16 v[132:135], v[148:151], v[36:39], v[132:135]
buffer_store_dwordx4 v[128:131], v252, s[84:87], s75 offen offset:0 sc0 sc1
s_waitcnt lgkmcnt(4)
v_mfma_f32_16x16x32_bf16 v[132:135], v[156:159], a[196:199], v[132:135]
ds_read_b128 v[148:151], v144 offset:51200
v_add_f32 v195, v195, v227
v_mfma_f32_16x16x32_bf16 v[132:135], v[160:163], a[204:207], v[132:135]
v_add_f32 v196, v196, v228
v_add_f32 v197, v197, v229
v_mfma_f32_16x16x32_bf16 v[116:119], v[160:163], a[200:203], v[116:119]
ds_read_b128 v[152:155], v144 offset:59392
v_add_f32 v198, v198, v230
v_mfma_f32_16x16x32_bf16 v[116:119], v[156:159], a[192:195], v[116:119]
buffer_store_dwordx4 v[112:115], v252, s[84:87], s74 offen offset:0 sc0 sc1
s_waitcnt lgkmcnt(4)
v_mfma_f32_16x16x32_bf16 v[116:119], v[164:167], a[208:211], v[116:119]
ds_read_b128 v[156:159], v248 offset:2048
v_add_f32 v199, v199, v231
v_mfma_f32_16x16x32_bf16 v[116:119], v[168:171], a[216:219], v[116:119]
v_add_f32 v200, v200, v232
v_add_f32 v201, v201, v233
v_mfma_f32_16x16x32_bf16 v[132:135], v[168:171], a[220:223], v[132:135]
ds_read_b128 v[160:163], v248 offset:10240
v_add_f32 v202, v202, v234
v_mfma_f32_16x16x32_bf16 v[132:135], v[164:167], a[212:215], v[132:135]
v_add_f32 v203, v203, v235
s_waitcnt lgkmcnt(4)
v_mfma_f32_16x16x32_bf16 v[132:135], v[172:175], a[132:135], v[132:135]
ds_read_b128 v[164:167], v248 offset:18432
v_add_f32 v204, v204, v236
v_mfma_f32_16x16x32_bf16 v[132:135], v[176:179], a[140:143], v[132:135]
v_add_f32 v205, v205, v237
v_add_f32 v206, v206, v238
v_mfma_f32_16x16x32_bf16 v[116:119], v[176:179], a[136:139], v[116:119]
ds_read_b128 v[168:171], v248 offset:26624
v_add_f32 v207, v207, v239
v_mfma_f32_16x16x32_bf16 v[116:119], v[172:175], a[128:131], v[116:119]
v_add_f32 v208, v208, v240
s_waitcnt lgkmcnt(4)
v_mfma_f32_16x16x32_bf16 v[120:123], v[148:151], v[32:35], v[120:123]
ds_read_b128 v[172:175], v248 offset:34816
v_add_f32 v209, v209, v241
v_mfma_f32_16x16x32_bf16 v[120:123], v[152:155], v[40:43], v[120:123]
v_add_f32 v210, v210, v242
v_add_f32 v211, v211, v243
v_mfma_f32_16x16x32_bf16 v[136:139], v[152:155], v[44:47], v[136:139]
ds_read_b128 v[176:179], v248 offset:43008
v_cvt_pk_bf16_f32 v180, 0, v180
v_mfma_f32_16x16x32_bf16 v[136:139], v[148:151], v[36:39], v[136:139]
buffer_store_dwordx4 v[132:135], v252, s[84:87], s75 offen offset:1024 sc0 sc1
s_waitcnt lgkmcnt(4)
v_mfma_f32_16x16x32_bf16 v[136:139], v[156:159], a[196:199], v[136:139]
ds_read_b128 v[148:151], v144 offset:52224
v_cvt_pk_bf16_f32 v181, 0, v181
v_mfma_f32_16x16x32_bf16 v[136:139], v[160:163], a[204:207], v[136:139]
v_cvt_pk_bf16_f32 v182, 0, v182
v_cvt_pk_bf16_f32 v183, 0, v183
v_mfma_f32_16x16x32_bf16 v[120:123], v[160:163], a[200:203], v[120:123]
ds_read_b128 v[152:155], v144 offset:60416
v_cvt_pk_bf16_f32 v184, 0, v184
v_mfma_f32_16x16x32_bf16 v[120:123], v[156:159], a[192:195], v[120:123]
buffer_store_dwordx4 v[116:119], v252, s[84:87], s74 offen offset:1024 sc0 sc1
s_waitcnt lgkmcnt(4)
v_mfma_f32_16x16x32_bf16 v[120:123], v[164:167], a[208:211], v[120:123]
ds_read_b128 v[156:159], v248 offset:3072
v_cvt_pk_bf16_f32 v185, 0, v185
v_mfma_f32_16x16x32_bf16 v[120:123], v[168:171], a[216:219], v[120:123]
v_cvt_pk_bf16_f32 v186, 0, v186
v_cvt_pk_bf16_f32 v187, 0, v187
v_mfma_f32_16x16x32_bf16 v[136:139], v[168:171], a[220:223], v[136:139]
ds_read_b128 v[160:163], v248 offset:11264
v_cvt_pk_bf16_f32 v188, 0, v188
v_mfma_f32_16x16x32_bf16 v[136:139], v[164:167], a[212:215], v[136:139]
v_cvt_pk_bf16_f32 v189, 0, v189
s_waitcnt lgkmcnt(4)
v_mfma_f32_16x16x32_bf16 v[136:139], v[172:175], a[132:135], v[136:139]
ds_read_b128 v[164:167], v248 offset:19456
v_cvt_pk_bf16_f32 v190, 0, v190
v_mfma_f32_16x16x32_bf16 v[136:139], v[176:179], a[140:143], v[136:139]
v_cvt_pk_bf16_f32 v191, 0, v191
v_cvt_pk_bf16_f32 v192, 0, v192
v_mfma_f32_16x16x32_bf16 v[120:123], v[176:179], a[136:139], v[120:123]
ds_read_b128 v[168:171], v248 offset:27648
v_cvt_pk_bf16_f32 v193, 0, v193
v_mfma_f32_16x16x32_bf16 v[120:123], v[172:175], a[128:131], v[120:123]
v_cvt_pk_bf16_f32 v194, 0, v194
s_waitcnt lgkmcnt(4)
v_mfma_f32_16x16x32_bf16 v[124:127], v[148:151], v[32:35], v[124:127]
ds_read_b128 v[172:175], v248 offset:35840
v_cvt_pk_bf16_f32 v195, 0, v195
v_mfma_f32_16x16x32_bf16 v[124:127], v[152:155], v[40:43], v[124:127]
v_cvt_pk_bf16_f32 v196, 0, v196
v_cvt_pk_bf16_f32 v197, 0, v197
v_mfma_f32_16x16x32_bf16 v[140:143], v[152:155], v[44:47], v[140:143]
ds_read_b128 v[176:179], v248 offset:44032
v_cvt_pk_bf16_f32 v198, 0, v198
v_mfma_f32_16x16x32_bf16 v[140:143], v[148:151], v[36:39], v[140:143]
buffer_store_dwordx4 v[136:139], v252, s[84:87], s75 offen offset:2048 sc0 sc1
s_waitcnt lgkmcnt(4)
v_mfma_f32_16x16x32_bf16 v[140:143], v[156:159], a[196:199], v[140:143]
ds_read_b128 v[148:151], v144 offset:20480
v_cvt_pk_bf16_f32 v199, 0, v199
v_mfma_f32_16x16x32_bf16 v[140:143], v[160:163], a[204:207], v[140:143]
v_cvt_pk_bf16_f32 v200, 0, v200
v_cvt_pk_bf16_f32 v201, 0, v201
v_mfma_f32_16x16x32_bf16 v[124:127], v[160:163], a[200:203], v[124:127]
ds_read_b128 v[152:155], v144 offset:28672
v_cvt_pk_bf16_f32 v202, 0, v202
v_mfma_f32_16x16x32_bf16 v[124:127], v[156:159], a[192:195], v[124:127]
buffer_store_dwordx4 v[120:123], v252, s[84:87], s74 offen offset:2048 sc0 sc1
s_waitcnt lgkmcnt(4)
v_mfma_f32_16x16x32_bf16 v[124:127], v[164:167], a[208:211], v[124:127]
ds_read_b128 v[156:159], v144 offset:21504
v_cvt_pk_bf16_f32 v203, 0, v203
v_mfma_f32_16x16x32_bf16 v[124:127], v[168:171], a[216:219], v[124:127]
v_cvt_pk_bf16_f32 v204, 0, v204
v_cvt_pk_bf16_f32 v205, 0, v205
v_mfma_f32_16x16x32_bf16 v[140:143], v[168:171], a[220:223], v[140:143]
ds_read_b128 v[160:163], v144 offset:29696
v_cvt_pk_bf16_f32 v206, 0, v206
v_mfma_f32_16x16x32_bf16 v[140:143], v[164:167], a[212:215], v[140:143]
v_cvt_pk_bf16_f32 v207, 0, v207
s_waitcnt lgkmcnt(4)
v_mfma_f32_16x16x32_bf16 v[140:143], v[172:175], a[132:135], v[140:143]
ds_read_b128 v[164:167], v144 offset:22528
v_cvt_pk_bf16_f32 v208, 0, v208
v_mfma_f32_16x16x32_bf16 v[140:143], v[176:179], a[140:143], v[140:143]
v_cvt_pk_bf16_f32 v209, 0, v209
v_cvt_pk_bf16_f32 v210, 0, v210
v_mfma_f32_16x16x32_bf16 v[124:127], v[176:179], a[136:139], v[124:127]
ds_read_b128 v[168:171], v144 offset:30720
v_cvt_pk_bf16_f32 v211, 0, v211
v_mfma_f32_16x16x32_bf16 v[124:127], v[172:175], a[128:131], v[124:127]
v_mul_f32 v212, s38, v180
s_waitcnt lgkmcnt(4)
v_mfma_f32_16x16x32_bf16 v[80:83], v[148:151], a[176:179], v[80:83]
ds_read_b128 v[172:175], v144 offset:23552
v_mul_f32 v213, s38, v181
v_mfma_f32_16x16x32_bf16 v[80:83], v[152:155], a[184:187], v[80:83]
v_mul_f32 v214, s38, v182
v_mul_f32 v215, s38, v183
v_mfma_f32_16x16x32_bf16 v[96:99], v[152:155], a[188:191], v[96:99]
ds_read_b128 v[176:179], v144 offset:31744
v_mul_f32 v216, s38, v184
v_mfma_f32_16x16x32_bf16 v[96:99], v[148:151], a[180:183], v[96:99]
buffer_store_dwordx4 v[140:143], v252, s[84:87], s75 offen offset:3072 sc0 sc1
s_waitcnt lgkmcnt(4)
v_mfma_f32_16x16x32_bf16 v[100:103], v[156:159], a[180:183], v[100:103]
ds_read_b128 v[148:151], v144 offset:36864
v_mul_f32 v217, s38, v185
v_mfma_f32_16x16x32_bf16 v[100:103], v[160:163], a[188:191], v[100:103]
v_mul_f32 v218, s38, v186
v_mul_f32 v219, s38, v187
v_mfma_f32_16x16x32_bf16 v[84:87], v[160:163], a[184:187], v[84:87]
ds_read_b128 v[152:155], v144 offset:45056
v_mul_f32 v220, s38, v188
v_mfma_f32_16x16x32_bf16 v[84:87], v[156:159], a[176:179], v[84:87]
buffer_store_dwordx4 v[124:127], v252, s[84:87], s74 offen offset:3072 sc0 sc1
s_waitcnt lgkmcnt(4)
v_mfma_f32_16x16x32_bf16 v[88:91], v[164:167], a[176:179], v[88:91]
ds_read_b128 v[156:159], v144 offset:37888
v_mul_f32 v221, s38, v189
v_mfma_f32_16x16x32_bf16 v[88:91], v[168:171], a[184:187], v[88:91]
v_mul_f32 v222, s38, v190
v_mul_f32 v223, s38, v191
v_mfma_f32_16x16x32_bf16 v[104:107], v[168:171], a[188:191], v[104:107]
ds_read_b128 v[160:163], v144 offset:46080
v_mul_f32 v224, s38, v192
v_mfma_f32_16x16x32_bf16 v[104:107], v[164:167], a[180:183], v[104:107]
v_mul_f32 v225, s38, v193
s_waitcnt lgkmcnt(4)
v_mfma_f32_16x16x32_bf16 v[108:111], v[172:175], a[180:183], v[108:111]
ds_read_b128 v[164:167], v144 offset:38912
v_mul_f32 v226, s38, v194
v_mfma_f32_16x16x32_bf16 v[108:111], v[176:179], a[188:191], v[108:111]
v_mul_f32 v227, s38, v195
v_mul_f32 v228, s38, v196
v_mfma_f32_16x16x32_bf16 v[92:95], v[176:179], a[184:187], v[92:95]
ds_read_b128 v[168:171], v144 offset:47104
v_mul_f32 v229, s38, v197
v_mfma_f32_16x16x32_bf16 v[92:95], v[172:175], a[176:179], v[92:95]
v_mul_f32 v230, s38, v198
s_waitcnt lgkmcnt(4)
v_mfma_f32_16x16x32_bf16 v[80:83], v[148:151], v[16:19], v[80:83]
ds_read_b128 v[172:175], v144 offset:39936
v_mul_f32 v231, s38, v199
v_mfma_f32_16x16x32_bf16 v[80:83], v[152:155], v[24:27], v[80:83]
v_mul_f32 v232, s38, v200
v_mul_f32 v233, s38, v201
v_mfma_f32_16x16x32_bf16 v[96:99], v[152:155], v[28:31], v[96:99]
ds_read_b128 v[176:179], v144 offset:48128
v_mul_f32 v234, s38, v202
v_mfma_f32_16x16x32_bf16 v[96:99], v[148:151], v[20:23], v[96:99]
v_mul_f32 v235, s38, v203
s_waitcnt lgkmcnt(4)
v_mfma_f32_16x16x32_bf16 v[100:103], v[156:159], v[20:23], v[100:103]
ds_read_b128 v[148:151], v144 offset:53248
v_mul_f32 v236, s38, v204
v_mfma_f32_16x16x32_bf16 v[100:103], v[160:163], v[28:31], v[100:103]
v_mul_f32 v237, s38, v205
v_mul_f32 v238, s38, v206
v_mfma_f32_16x16x32_bf16 v[84:87], v[160:163], v[24:27], v[84:87]
ds_read_b128 v[152:155], v144 offset:61440
v_mul_f32 v239, s38, v207
v_mfma_f32_16x16x32_bf16 v[84:87], v[156:159], v[16:19], v[84:87]
v_mul_f32 v240, s38, v208
s_waitcnt lgkmcnt(4)
v_mfma_f32_16x16x32_bf16 v[88:91], v[164:167], v[16:19], v[88:91]
ds_read_b128 v[156:159], v144 offset:54272
v_mul_f32 v241, s38, v209
v_mfma_f32_16x16x32_bf16 v[88:91], v[168:171], v[24:27], v[88:91]
v_mul_f32 v242, s38, v210
v_mul_f32 v243, s38, v211
v_mfma_f32_16x16x32_bf16 v[104:107], v[168:171], v[28:31], v[104:107]
ds_read_b128 v[160:163], v144 offset:62464
v_mfma_f32_16x16x32_bf16 v[104:107], v[164:167], v[20:23], v[104:107]
s_waitcnt lgkmcnt(4)
v_mfma_f32_16x16x32_bf16 v[108:111], v[172:175], v[20:23], v[108:111]
ds_read_b128 v[164:167], v144 offset:55296
v_mfma_f32_16x16x32_bf16 v[108:111], v[176:179], v[28:31], v[108:111]
v_mfma_f32_16x16x32_bf16 v[92:95], v[176:179], v[24:27], v[92:95]
ds_read_b128 v[168:171], v144 offset:63488
v_mfma_f32_16x16x32_bf16 v[92:95], v[172:175], v[16:19], v[92:95]
s_waitcnt lgkmcnt(4)
v_mfma_f32_16x16x32_bf16 v[80:83], v[148:151], v[32:35], v[80:83]
ds_read_b128 v[172:175], v144 offset:56320
v_mfma_f32_16x16x32_bf16 v[80:83], v[152:155], v[40:43], v[80:83]
v_mfma_f32_16x16x32_bf16 v[96:99], v[152:155], v[44:47], v[96:99]
ds_read_b128 v[176:179], v144 offset:64512
v_mfma_f32_16x16x32_bf16 v[96:99], v[148:151], v[36:39], v[96:99]
s_waitcnt lgkmcnt(4)
v_mfma_f32_16x16x32_bf16 v[100:103], v[156:159], v[36:39], v[100:103]
ds_read_b128 v[148:151], v248 offset:4096
v_mfma_f32_16x16x32_bf16 v[100:103], v[160:163], v[44:47], v[100:103]
v_mfma_f32_16x16x32_bf16 v[84:87], v[160:163], v[40:43], v[84:87]
ds_read_b128 v[152:155], v248 offset:12288
v_mfma_f32_16x16x32_bf16 v[84:87], v[156:159], v[32:35], v[84:87]
s_waitcnt lgkmcnt(4)
v_mfma_f32_16x16x32_bf16 v[88:91], v[164:167], v[32:35], v[88:91]
ds_read_b128 v[156:159], v248 offset:5120
v_mfma_f32_16x16x32_bf16 v[88:91], v[168:171], v[40:43], v[88:91]
v_mfma_f32_16x16x32_bf16 v[104:107], v[168:171], v[44:47], v[104:107]
ds_read_b128 v[160:163], v248 offset:13312
v_mfma_f32_16x16x32_bf16 v[104:107], v[164:167], v[36:39], v[104:107]
s_waitcnt lgkmcnt(4)
v_mfma_f32_16x16x32_bf16 v[108:111], v[172:175], v[36:39], v[108:111]
ds_read_b128 v[164:167], v248 offset:6144
v_mfma_f32_16x16x32_bf16 v[108:111], v[176:179], v[44:47], v[108:111]
v_mfma_f32_16x16x32_bf16 v[92:95], v[176:179], v[40:43], v[92:95]
ds_read_b128 v[168:171], v248 offset:14336
v_mfma_f32_16x16x32_bf16 v[92:95], v[172:175], v[32:35], v[92:95]
s_waitcnt lgkmcnt(4)
v_mfma_f32_16x16x32_bf16 v[80:83], v[148:151], a[192:195], v[80:83]
ds_read_b128 v[172:175], v248 offset:7168
v_mfma_f32_16x16x32_bf16 v[80:83], v[152:155], a[200:203], v[80:83]
v_mfma_f32_16x16x32_bf16 v[96:99], v[152:155], a[204:207], v[96:99]
ds_read_b128 v[176:179], v248 offset:15360
v_mfma_f32_16x16x32_bf16 v[96:99], v[148:151], a[196:199], v[96:99]
s_waitcnt lgkmcnt(4)
v_mfma_f32_16x16x32_bf16 v[100:103], v[156:159], a[196:199], v[100:103]
ds_read_b128 v[148:151], v248 offset:20480
v_mfma_f32_16x16x32_bf16 v[100:103], v[160:163], a[204:207], v[100:103]
v_mfma_f32_16x16x32_bf16 v[84:87], v[160:163], a[200:203], v[84:87]
ds_read_b128 v[152:155], v248 offset:28672
v_mfma_f32_16x16x32_bf16 v[84:87], v[156:159], a[192:195], v[84:87]
s_waitcnt lgkmcnt(4)
v_mfma_f32_16x16x32_bf16 v[88:91], v[164:167], a[192:195], v[88:91]
ds_read_b128 v[156:159], v248 offset:21504
v_mfma_f32_16x16x32_bf16 v[88:91], v[168:171], a[200:203], v[88:91]
v_mfma_f32_16x16x32_bf16 v[104:107], v[168:171], a[204:207], v[104:107]
ds_read_b128 v[160:163], v248 offset:29696
v_mfma_f32_16x16x32_bf16 v[104:107], v[164:167], a[196:199], v[104:107]
s_waitcnt lgkmcnt(4)
v_mfma_f32_16x16x32_bf16 v[108:111], v[172:175], a[196:199], v[108:111]
ds_read_b128 v[164:167], v248 offset:22528
v_mfma_f32_16x16x32_bf16 v[108:111], v[176:179], a[204:207], v[108:111]
v_mfma_f32_16x16x32_bf16 v[92:95], v[176:179], a[200:203], v[92:95]
ds_read_b128 v[168:171], v248 offset:30720
v_mfma_f32_16x16x32_bf16 v[92:95], v[172:175], a[192:195], v[92:95]
s_waitcnt lgkmcnt(4)
v_mfma_f32_16x16x32_bf16 v[80:83], v[148:151], a[208:211], v[80:83]
ds_read_b128 v[172:175], v248 offset:23552
v_mfma_f32_16x16x32_bf16 v[80:83], v[152:155], a[216:219], v[80:83]
v_mfma_f32_16x16x32_bf16 v[96:99], v[152:155], a[220:223], v[96:99]
ds_read_b128 v[176:179], v248 offset:31744
v_mfma_f32_16x16x32_bf16 v[96:99], v[148:151], a[212:215], v[96:99]
s_waitcnt vmcnt(0)
buffer_store_dword v14, off, s[32:35], s82 offset:64 sc0 sc1
s_waitcnt lgkmcnt(4)
v_mfma_f32_16x16x32_bf16 v[100:103], v[156:159], a[212:215], v[100:103]
ds_read_b128 v[148:151], v248 offset:36864
v_mfma_f32_16x16x32_bf16 v[100:103], v[160:163], a[220:223], v[100:103]
v_mfma_f32_16x16x32_bf16 v[84:87], v[160:163], a[216:219], v[84:87]
ds_read_b128 v[152:155], v248 offset:45056
v_mfma_f32_16x16x32_bf16 v[84:87], v[156:159], a[208:211], v[84:87]
s_waitcnt lgkmcnt(4)
v_mfma_f32_16x16x32_bf16 v[88:91], v[164:167], a[208:211], v[88:91]
ds_read_b128 v[156:159], v248 offset:37888
v_mfma_f32_16x16x32_bf16 v[88:91], v[168:171], a[216:219], v[88:91]
v_mfma_f32_16x16x32_bf16 v[104:107], v[168:171], a[220:223], v[104:107]
ds_read_b128 v[160:163], v248 offset:46080
v_mfma_f32_16x16x32_bf16 v[104:107], v[164:167], a[212:215], v[104:107]
s_waitcnt lgkmcnt(4)
v_mfma_f32_16x16x32_bf16 v[108:111], v[172:175], a[212:215], v[108:111]
ds_read_b128 v[164:167], v248 offset:38912
v_mfma_f32_16x16x32_bf16 v[108:111], v[176:179], a[220:223], v[108:111]
v_mfma_f32_16x16x32_bf16 v[92:95], v[176:179], a[216:219], v[92:95]
ds_read_b128 v[168:171], v248 offset:47104
v_mfma_f32_16x16x32_bf16 v[92:95], v[172:175], a[208:211], v[92:95]
s_waitcnt lgkmcnt(4)
v_mfma_f32_16x16x32_bf16 v[80:83], v[148:151], a[128:131], v[80:83]
ds_read_b128 v[172:175], v248 offset:39936
v_mfma_f32_16x16x32_bf16 v[80:83], v[152:155], a[136:139], v[80:83]
v_mfma_f32_16x16x32_bf16 v[96:99], v[152:155], a[140:143], v[96:99]
ds_read_b128 v[176:179], v248 offset:48128
v_mfma_f32_16x16x32_bf16 v[96:99], v[148:151], a[132:135], v[96:99]
s_waitcnt lgkmcnt(4)
v_mfma_f32_16x16x32_bf16 v[100:103], v[156:159], a[132:135], v[100:103]
v_mfma_f32_16x16x32_bf16 v[100:103], v[160:163], a[140:143], v[100:103]
v_mfma_f32_16x16x32_bf16 v[84:87], v[160:163], a[136:139], v[84:87]
v_mfma_f32_16x16x32_bf16 v[84:87], v[156:159], a[128:131], v[84:87]
s_waitcnt lgkmcnt(2)
v_mfma_f32_16x16x32_bf16 v[88:91], v[164:167], a[128:131], v[88:91]
v_mfma_f32_16x16x32_bf16 v[88:91], v[168:171], a[136:139], v[88:91]
v_mfma_f32_16x16x32_bf16 v[104:107], v[168:171], a[140:143], v[104:107]
v_mfma_f32_16x16x32_bf16 v[104:107], v[164:167], a[132:135], v[104:107]
s_waitcnt lgkmcnt(0)
v_mfma_f32_16x16x32_bf16 v[108:111], v[172:175], a[132:135], v[108:111]
v_mfma_f32_16x16x32_bf16 v[108:111], v[176:179], a[140:143], v[108:111]
v_mfma_f32_16x16x32_bf16 v[92:95], v[176:179], a[136:139], v[92:95]
v_mfma_f32_16x16x32_bf16 v[92:95], v[172:175], a[128:131], v[92:95]
s_branch L_main_kernel_tl
L_code_end:
.section .rodata,"a"
.p2align 6
.amdhsa_kernel main_kernel
  .amdhsa_next_free_vgpr 512
  .amdhsa_next_free_sgpr 102
  .amdhsa_accum_offset 256
  .amdhsa_group_segment_fixed_size 0
  .amdhsa_kernarg_size 96
  .amdhsa_user_sgpr_count 2
  .amdhsa_user_sgpr_kernarg_segment_ptr 1
  .amdhsa_system_sgpr_workgroup_id_x 1
.end_amdhsa_kernel
```
